```python
import torch

def _softmax(x, axis=-1):
    return torch.softmax(x, dim=axis)
def _gelu(x):
    return torch.nn.functional.gelu(x, approximate="tanh")
def _silu(x):
    return torch.nn.functional.silu(x)
def _sigmoid(x):
    return torch.sigmoid(x)
def _layernorm(x, axis=-1, eps=1e-5):
    m = x.mean(dim=axis, keepdim=True)
    v = x.var(dim=axis, keepdim=True, unbiased=False)
    return (x - m) / torch.sqrt(v + eps)
def _scatter_add(tgt, idx, src, axis=0):
    return tgt.clone().index_add_(axis, idx, src)
def _segment_sum(src, seg, n):
    out = torch.zeros((n,) + src.shape[1:], dtype=src.dtype)
    return out.index_add_(0, seg, src)
def _pad(x, pw):
    flat = tuple(v for pair in reversed(pw) for v in pair)
    return torch.nn.functional.pad(x, flat)

kernel_name = 'gated_mix__linear_kernel_hedgehog__mixer_s_mlp__prompt'

def setup_inputs():

    _w = (lambda a: (lambda t: t.to(torch.bfloat16) if t.is_floating_point() else t)(torch.as_tensor(a)))
    def _A_setup():
        B, S, D, H = 1, 2048, 640, 32
        Dh = D // H
        return {
            "x": _w((lambda *s: torch.randn(*s, dtype=torch.bfloat16) * 0.05)(B, S, D)),
            "wqkv": _w((lambda *s: torch.randn(*s, dtype=torch.bfloat16) * 3.2)(D, 3 * D)),
            "w_phi": _w((lambda *s: torch.randn(*s, dtype=torch.bfloat16) * 3.2)(H, Dh, Dh) * (Dh ** -0.5)),
            "wo": _w((lambda *s: torch.randn(*s, dtype=torch.bfloat16) * 1.6)(D, D)),
        }
    _A_in = _A_setup()

    def _B_setup():
        B, S, D, F = 1, 2048, 640, 1536
        return {
            "x":  _w((lambda *s: torch.randn(*s, dtype=torch.bfloat16) * 0.05)(B, S, D)),
            "w1": _w((lambda *s: torch.randn(*s, dtype=torch.bfloat16) * 3.2)(D, D) * (D ** -0.5)),
            "w2": _w((lambda *s: torch.randn(*s, dtype=torch.bfloat16) * 3.2)(D, D) * (D ** -0.5)),
            "w3": _w((lambda *s: torch.randn(*s, dtype=torch.bfloat16) * 3.2)(D, F) * (D ** -0.5)),
            "w4": _w((lambda *s: torch.randn(*s, dtype=torch.bfloat16) * 3.2)(F, D) * (F ** -0.5)),
        }
    _B_in = _B_setup()

    return {
        "A_x": _A_in["x"],
        "A_wqkv": _A_in["wqkv"],
        "A_w_phi": _A_in["w_phi"],
        "A_wo": _A_in["wo"],
        "B_x": _B_in["x"],
        "B_w1": _B_in["w1"],
        "B_w2": _B_in["w2"],
        "B_w3": _B_in["w3"],
        "B_w4": _B_in["w4"],
        "gate_w": _w((lambda *s: torch.randn(*s, dtype=torch.bfloat16) * 0.05)(640) * 16.0),
    }

def reference(A_x, A_wqkv, A_w_phi, A_wo, B_x, B_w1, B_w2, B_w3, B_w4, gate_w):
    def _A_ref(x, wqkv, w_phi, wo):
        B, S, D = x.shape
        H = 32; Dh = D // H
        qkv = (lambda x, *d: x.permute(*d))((x @ wqkv).reshape(B, S, 3, H, Dh), 2, 0, 3, 1, 4)
        q, k, v = qkv[0], qkv[1], qkv[2]
        pq = torch.einsum("bhsd,hdf->bhsf", q, w_phi)
        pk = torch.einsum("bhsd,hdf->bhsf", k, w_phi)
        phi_q = torch.concatenate([_softmax(pq, axis=-1), _softmax(-pq, axis=-1)], axis=-1)
        phi_k = torch.concatenate([_softmax(pk, axis=-1), _softmax(-pk, axis=-1)], axis=-1)
        kv = torch.einsum("bhsf,bhsd->bhfd", phi_k, v)
        z  = torch.einsum("bhsf->bhf", phi_k)
        num = torch.einsum("bhqf,bhfd->bhqd", phi_q, kv)
        den = torch.einsum("bhqf,bhf->bhq", phi_q, z)[..., None] + 1e-6
        o = num / den
        return (lambda x, *d: x.permute(*d))(o, 0, 2, 1, 3).reshape(B, S, D) @ wo

    def _B_ref(x, w1, w2, w3, w4):
        B, S, D = x.shape
        h = _gelu(_layernorm(x, axis=-1) @ w1)
        c = D // 4
        g0 = _pad(h[:, :, 0*c:1*c], ((0, 0), (1, 0), (0, 0)))[:, :S, :]
        g1 = _pad(h[:, :, 1*c:2*c], ((0, 0), (0, 1), (0, 0)))[:, 1:, :]
        g2 = _pad(h[:, :, 2*c:3*c], ((0, 0), (2, 0), (0, 0)))[:, :S, :]
        g3 = _pad(h[:, :, 3*c:   ], ((0, 0), (0, 2), (0, 0)))[:, 2:, :]
        hs = torch.concatenate([g0, g1, g2, g3], axis=-1) @ w2
        x1 = x + hs
        h2 = _gelu(_layernorm(x1, axis=-1) @ w3) @ w4
        return x1 + h2

    x = A_x
    g = _sigmoid((x * gate_w).sum(-1, keepdims=True))
    a = _A_ref(x, A_wqkv, A_w_phi, A_wo)
    b = _B_ref(x, B_w1, B_w2, B_w3, B_w4)
    return g * a + (1 - g) * b
```

```asm
; @launch grid=(256,1,1) block=(512,1,1) lds=163840
.amdgcn_target "amdgcn-amd-amdhsa--gfx950"
.text
text_begin:
.globl gated_mix__linear_kernel_hedgehog__mixer_s_mlp__prompt_kernel
.p2align 8
.type gated_mix__linear_kernel_hedgehog__mixer_s_mlp__prompt_kernel,@function
gated_mix__linear_kernel_hedgehog__mixer_s_mlp__prompt_kernel:
    s_cmp_ge_u32 s2, 256
    s_cbranch_scc1 gated_mix__linear_kernel_hedgehog__mixer_s_mlp__prompt_kernel_end
    s_load_dwordx16 s[16:31], s[0:1], 0
    s_load_dwordx8 s[32:39], s[0:1], 64
    s_load_dwordx2 s[40:41], s[0:1], 96
    v_lshrrev_b32 v120, 6, v0
    v_and_b32 v128, 63, v0
    v_readfirstlane_b32 s8, v120
    s_and_b32 s11, s2, 7
    s_lshr_b32 s10, s2, 3
    s_lshr_b32 s3, s11, 2
    s_lshr_b32 s4, s10, 2
    s_and_b32 s5, s11, 3
    s_lshl_b32 s5, s5, 2
    s_and_b32 s13, s10, 3
    s_add_u32 s5, s5, s13
    s_lshr_b32 s6, s4, 2
    s_xor_b32 s6, s6, 1
    s_lshl_b32 s7, s3, 2
    s_and_b32 s11, s4, 3
    s_add_u32 s7, s7, s11
    s_mov_b32 s79, 2146435072
    v_and_b32 v129, 15, v128
    v_lshrrev_b32 v130, 4, v128
    v_bfe_u32 v131, v128, 2, 2
    v_and_b32 v132, 3, v128
    v_lshlrev_b32 v143, 4, v128
    s_cmp_ge_u32 s8, 4
    s_cbranch_scc1 p_loader
    s_lshl_b32 s61, s8, 12
    s_mov_b32 s63, 0
    s_mov_b32 s64, 1069066811
    s_mov_b32 s65, 1069066811
    s_mov_b32 s66, 3216550459
    s_mov_b32 s67, 3216550459
    s_mov_b32 s68, 3184710632
    s_mov_b32 s69, 3184710632
    s_mov_b32 s70, 1.0
    s_mov_b32 s71, 1.0
    s_mov_b32 s72, 0xffff0000
    s_mov_b32 s73, 0x3f803f80
    v_lshl_add_u32 v121, v130, 2, v131
    v_mul_u32_u24 v137, 160, v121
    v_lshl_add_u32 v137, v132, 3, v137
    v_add_u32 v137, 73728, v137
    v_mul_u32_u24 v123, 320, v121
    v_lshl_add_u32 v123, v132, 3, v123
    v_and_b32 v124, 1, v130
    v_lshlrev_b32 v124, 5, v124
    v_lshrrev_b32 v122, 1, v129
    v_xor_b32 v122, v122, v130
    v_lshlrev_b32 v122, 4, v122
    v_lshl_add_u32 v125, v129, 7, v122
    s_waitcnt lgkmcnt(0)
    s_mov_b32 s52, s40
    s_mov_b32 s53, s41
    s_mov_b32 s54, 17498112
    s_mov_b32 s55, 0x20000
    s_mov_b32 s88, s38
    s_mov_b32 s89, s39
    s_mov_b32 s90, 256
    s_mov_b32 s91, 0x20000
    s_cmp_eq_u32 s6, 1
    s_cbranch_scc1 p_w1
    v_mov_b32 v0, 0
    v_mov_b32 v1, 0
    v_mov_b32 v2, 0
    v_mov_b32 v3, 0
    v_mov_b32 v4, 0
    v_mov_b32 v5, 0
    v_mov_b32 v6, 0
    v_mov_b32 v7, 0
    v_mov_b32 v8, 0
    v_mov_b32 v9, 0
    v_mov_b32 v10, 0
    v_mov_b32 v11, 0
    v_mov_b32 v12, 0
    v_mov_b32 v13, 0
    v_mov_b32 v14, 0
    v_mov_b32 v15, 0
    v_mov_b32 v16, 0
    v_mov_b32 v17, 0
    v_mov_b32 v18, 0
    v_mov_b32 v19, 0
    v_mov_b32 v20, 0
    v_mov_b32 v21, 0
    v_mov_b32 v22, 0
    v_mov_b32 v23, 0
    v_mov_b32 v24, 0
    v_mov_b32 v25, 0
    v_mov_b32 v26, 0
    v_mov_b32 v27, 0
    v_mov_b32 v28, 0
    v_mov_b32 v29, 0
    v_mov_b32 v30, 0
    v_mov_b32 v31, 0
    v_mov_b32 v32, 0
    v_mov_b32 v33, 0
    v_mov_b32 v34, 0
    v_mov_b32 v35, 0
    v_mov_b32 v36, 0
    v_mov_b32 v37, 0
    v_mov_b32 v38, 0
    v_mov_b32 v39, 0
    v_mov_b32 v40, 0
    v_mov_b32 v41, 0
    v_mov_b32 v42, 0
    v_mov_b32 v43, 0
    v_mov_b32 v44, 0
    v_mov_b32 v45, 0
    v_mov_b32 v46, 0
    v_mov_b32 v47, 0
    v_mov_b32 v48, 0
    v_mov_b32 v49, 0
    v_mov_b32 v50, 0
    v_mov_b32 v51, 0
    v_mov_b32 v52, 0
    v_mov_b32 v53, 0
    v_mov_b32 v54, 0
    v_mov_b32 v55, 0
    v_mov_b32 v56, 0
    v_mov_b32 v57, 0
    v_mov_b32 v58, 0
    v_mov_b32 v59, 0
    v_mov_b32 v60, 0
    v_mov_b32 v61, 0
    v_mov_b32 v62, 0
    v_mov_b32 v63, 0
    v_mov_b32 v64, 0
    v_mov_b32 v65, 0
    v_mov_b32 v66, 0
    v_mov_b32 v67, 0
    v_mov_b32 v68, 0
    v_mov_b32 v69, 0
    v_mov_b32 v70, 0
    v_mov_b32 v71, 0
    v_mov_b32 v72, 0
    v_mov_b32 v73, 0
    v_mov_b32 v74, 0
    v_mov_b32 v75, 0
    v_mov_b32 v76, 0
    v_mov_b32 v77, 0
    v_mov_b32 v78, 0
    v_mov_b32 v79, 0
    v_add_u32 v133, 16384, v123
    v_sub_u32 v134, v133, v124
    v_add_u32 v133, v133, v124
    v_add_u32 v135, s61, v125
    v_xor_b32 v136, 64, v135
    v_mov_b32 v138, v135
    s_cmp_lg_u32 s8, 0
    s_cbranch_scc1 p_nozero
    v_mov_b32 v121, 0
    s_cmp_lg_u32 s2, 128
    s_cbranch_scc1 p_notag
    buffer_load_dword v120, v121, s[52:55], 0 offen sc1
    s_waitcnt vmcnt(0)
    v_add_u32 v120, 1, v120
    v_max_u32 v120, 1, v120
    s_mov_b64 exec, 1
    buffer_store_dword v120, v121, s[52:55], 0 offen sc1
    buffer_store_dword v120, v121, s[88:91], 0 offen sc1
    s_mov_b64 exec, -1
p_notag:
    s_lshl_b32 s11, s7, 4
    s_add_u32 s11, s11, s5
    s_mul_i32 s11, s11, 896
    s_add_u32 s11, s11, 2756608
    v_mov_b32 v120, s79
    v_cmp_gt_u32 vcc, 56, v128
    s_nop 1
    v_cndmask_b32 v120, v120, v143, vcc
    buffer_store_dwordx4 v[0:3], v120, s[52:55], s11 offen sc1
    v_mov_b32 v120, 1
    v_mov_b32 v121, 64
    s_waitcnt vmcnt(0)
    s_mov_b64 exec, 1
    buffer_atomic_add v120, v121, s[88:91], 0 offen sc1
    s_mov_b64 exec, -1
p_nozero:
    s_barrier
    ds_read_b128 a[40:43], v135 offset:0
    ds_read_b128 a[44:47], v135 offset:2048
    ds_read_b64_tr_b16 a[0:1], v133 offset:0
    ds_read_b64_tr_b16 a[2:3], v133 offset:5120
    ds_read_b64_tr_b16 a[4:5], v134 offset:32
    ds_read_b64_tr_b16 a[6:7], v134 offset:5152
    ds_read_b64_tr_b16 a[8:9], v133 offset:64
    ds_read_b64_tr_b16 a[10:11], v133 offset:5184
    ds_read_b64_tr_b16 a[12:13], v134 offset:96
    ds_read_b64_tr_b16 a[14:15], v134 offset:5216
    ds_read_b64_tr_b16 a[16:17], v133 offset:128
    ds_read_b64_tr_b16 a[18:19], v133 offset:5248
    ds_read_b64_tr_b16 a[20:21], v134 offset:160
    ds_read_b64_tr_b16 a[22:23], v134 offset:5280
    ds_read_b64_tr_b16 a[24:25], v133 offset:192
    ds_read_b64_tr_b16 a[26:27], v133 offset:5312
    ds_read_b64_tr_b16 a[28:29], v134 offset:224
    ds_read_b64_tr_b16 a[30:31], v134 offset:5344
    ds_read_b64_tr_b16 a[32:33], v133 offset:256
    ds_read_b64_tr_b16 a[34:35], v133 offset:5376
    ds_read_b64_tr_b16 a[36:37], v134 offset:288
    ds_read_b64_tr_b16 a[38:39], v134 offset:5408
    s_mov_b32 s11, 0
    s_mov_b32 s12, 36864
    s_mov_b32 s15, 4294856704
.p2align 6
p_loop:
    s_waitcnt lgkmcnt(10)
    v_mfma_f32_16x16x32_bf16 v[0:3], a[0:3], a[40:43], v[0:3]
    ds_read_b128 a[88:91], v136 offset:0
    ds_read_b128 a[92:95], v136 offset:2048
    v_mfma_f32_16x16x32_bf16 v[40:43], a[0:3], a[44:47], v[40:43]
    ds_read_b64_tr_b16 a[48:49], v133 offset:10240
    ds_read_b64_tr_b16 a[50:51], v133 offset:15360
    v_mfma_f32_16x16x32_bf16 v[4:7], a[4:7], a[40:43], v[4:7]
    ds_read_b64_tr_b16 a[52:53], v134 offset:10272
    v_mfma_f32_16x16x32_bf16 v[44:47], a[4:7], a[44:47], v[44:47]
    ds_read_b64_tr_b16 a[54:55], v134 offset:15392
    v_mfma_f32_16x16x32_bf16 v[8:11], a[8:11], a[40:43], v[8:11]
    ds_read_b64_tr_b16 a[56:57], v133 offset:10304
    v_mfma_f32_16x16x32_bf16 v[48:51], a[8:11], a[44:47], v[48:51]
    ds_read_b64_tr_b16 a[58:59], v133 offset:15424
    v_mfma_f32_16x16x32_bf16 v[12:15], a[12:15], a[40:43], v[12:15]
    ds_read_b64_tr_b16 a[60:61], v134 offset:10336
    v_mfma_f32_16x16x32_bf16 v[52:55], a[12:15], a[44:47], v[52:55]
    ds_read_b64_tr_b16 a[62:63], v134 offset:15456
    v_mfma_f32_16x16x32_bf16 v[16:19], a[16:19], a[40:43], v[16:19]
    ds_read_b64_tr_b16 a[64:65], v133 offset:10368
    v_mfma_f32_16x16x32_bf16 v[56:59], a[16:19], a[44:47], v[56:59]
    ds_read_b64_tr_b16 a[66:67], v133 offset:15488
    s_waitcnt lgkmcnt(12)
    v_mfma_f32_16x16x32_bf16 v[20:23], a[20:23], a[40:43], v[20:23]
    ds_read_b64_tr_b16 a[68:69], v134 offset:10400
    v_mfma_f32_16x16x32_bf16 v[60:63], a[20:23], a[44:47], v[60:63]
    ds_read_b64_tr_b16 a[70:71], v134 offset:15520
    v_mfma_f32_16x16x32_bf16 v[24:27], a[24:27], a[40:43], v[24:27]
    ds_read_b64_tr_b16 a[72:73], v133 offset:10432
    v_mfma_f32_16x16x32_bf16 v[64:67], a[24:27], a[44:47], v[64:67]
    ds_read_b64_tr_b16 a[74:75], v133 offset:15552
    v_mfma_f32_16x16x32_bf16 v[28:31], a[28:31], a[40:43], v[28:31]
    ds_read_b64_tr_b16 a[76:77], v134 offset:10464
    s_add_u32 s63, s63, 1
    v_mfma_f32_16x16x32_bf16 v[68:71], a[28:31], a[44:47], v[68:71]
    ds_read_b64_tr_b16 a[78:79], v134 offset:15584
    s_and_b32 s63, s63, 3
    v_mfma_f32_16x16x32_bf16 v[32:35], a[32:35], a[40:43], v[32:35]
    ds_read_b64_tr_b16 a[80:81], v133 offset:10496
    s_cmp_eq_u32 s63, 0
    v_mfma_f32_16x16x32_bf16 v[72:75], a[32:35], a[44:47], v[72:75]
    ds_read_b64_tr_b16 a[82:83], v133 offset:15616
    s_cselect_b32 s14, s15, s12
    v_mfma_f32_16x16x32_bf16 v[36:39], a[36:39], a[40:43], v[36:39]
    ds_read_b64_tr_b16 a[84:85], v134 offset:10528
    v_mfma_f32_16x16x32_bf16 v[76:79], a[36:39], a[44:47], v[76:79]
    ds_read_b64_tr_b16 a[86:87], v134 offset:15648
    v_add_u32 v135, s14, v135
    v_add_u32 v136, s14, v136
    v_add_u32 v133, s14, v133
    v_add_u32 v134, s14, v134
    s_barrier
    s_waitcnt lgkmcnt(10)
    v_mfma_f32_16x16x32_bf16 v[0:3], a[48:51], a[88:91], v[0:3]
    ds_read_b128 a[40:43], v135 offset:0
    ds_read_b128 a[44:47], v135 offset:2048
    v_mfma_f32_16x16x32_bf16 v[40:43], a[48:51], a[92:95], v[40:43]
    ds_read_b64_tr_b16 a[0:1], v133 offset:0
    ds_read_b64_tr_b16 a[2:3], v133 offset:5120
    v_mfma_f32_16x16x32_bf16 v[4:7], a[52:55], a[88:91], v[4:7]
    ds_read_b64_tr_b16 a[4:5], v134 offset:32
    v_mfma_f32_16x16x32_bf16 v[44:47], a[52:55], a[92:95], v[44:47]
    ds_read_b64_tr_b16 a[6:7], v134 offset:5152
    v_mfma_f32_16x16x32_bf16 v[8:11], a[56:59], a[88:91], v[8:11]
    ds_read_b64_tr_b16 a[8:9], v133 offset:64
    v_mfma_f32_16x16x32_bf16 v[48:51], a[56:59], a[92:95], v[48:51]
    ds_read_b64_tr_b16 a[10:11], v133 offset:5184
    v_mfma_f32_16x16x32_bf16 v[12:15], a[60:63], a[88:91], v[12:15]
    ds_read_b64_tr_b16 a[12:13], v134 offset:96
    v_mfma_f32_16x16x32_bf16 v[52:55], a[60:63], a[92:95], v[52:55]
    ds_read_b64_tr_b16 a[14:15], v134 offset:5216
    v_mfma_f32_16x16x32_bf16 v[16:19], a[64:67], a[88:91], v[16:19]
    ds_read_b64_tr_b16 a[16:17], v133 offset:128
    v_mfma_f32_16x16x32_bf16 v[56:59], a[64:67], a[92:95], v[56:59]
    ds_read_b64_tr_b16 a[18:19], v133 offset:5248
    s_waitcnt lgkmcnt(12)
    v_mfma_f32_16x16x32_bf16 v[20:23], a[68:71], a[88:91], v[20:23]
    ds_read_b64_tr_b16 a[20:21], v134 offset:160
    v_mfma_f32_16x16x32_bf16 v[60:63], a[68:71], a[92:95], v[60:63]
    ds_read_b64_tr_b16 a[22:23], v134 offset:5280
    v_mfma_f32_16x16x32_bf16 v[24:27], a[72:75], a[88:91], v[24:27]
    ds_read_b64_tr_b16 a[24:25], v133 offset:192
    v_mfma_f32_16x16x32_bf16 v[64:67], a[72:75], a[92:95], v[64:67]
    ds_read_b64_tr_b16 a[26:27], v133 offset:5312
    v_mfma_f32_16x16x32_bf16 v[28:31], a[76:79], a[88:91], v[28:31]
    ds_read_b64_tr_b16 a[28:29], v134 offset:224
    v_mfma_f32_16x16x32_bf16 v[68:71], a[76:79], a[92:95], v[68:71]
    ds_read_b64_tr_b16 a[30:31], v134 offset:5344
    v_mfma_f32_16x16x32_bf16 v[32:35], a[80:83], a[88:91], v[32:35]
    ds_read_b64_tr_b16 a[32:33], v133 offset:256
    s_add_u32 s11, s11, 1
    v_mfma_f32_16x16x32_bf16 v[72:75], a[80:83], a[92:95], v[72:75]
    ds_read_b64_tr_b16 a[34:35], v133 offset:5376
    s_cmp_lt_u32 s11, 9
    v_mfma_f32_16x16x32_bf16 v[36:39], a[84:87], a[88:91], v[36:39]
    ds_read_b64_tr_b16 a[36:37], v134 offset:288
    v_mfma_f32_16x16x32_bf16 v[76:79], a[84:87], a[92:95], v[76:79]
    ds_read_b64_tr_b16 a[38:39], v134 offset:5408
    s_cbranch_scc1 p_loop
    s_waitcnt lgkmcnt(10)
    v_mfma_f32_16x16x32_bf16 v[0:3], a[0:3], a[40:43], v[0:3]
    ds_read_b128 a[88:91], v136 offset:0
    ds_read_b128 a[92:95], v136 offset:2048
    v_mfma_f32_16x16x32_bf16 v[40:43], a[0:3], a[44:47], v[40:43]
    ds_read_b64_tr_b16 a[48:49], v133 offset:10240
    ds_read_b64_tr_b16 a[50:51], v133 offset:15360
    v_mfma_f32_16x16x32_bf16 v[4:7], a[4:7], a[40:43], v[4:7]
    ds_read_b64_tr_b16 a[52:53], v134 offset:10272
    v_mfma_f32_16x16x32_bf16 v[44:47], a[4:7], a[44:47], v[44:47]
    ds_read_b64_tr_b16 a[54:55], v134 offset:15392
    v_mfma_f32_16x16x32_bf16 v[8:11], a[8:11], a[40:43], v[8:11]
    ds_read_b64_tr_b16 a[56:57], v133 offset:10304
    v_mfma_f32_16x16x32_bf16 v[48:51], a[8:11], a[44:47], v[48:51]
    ds_read_b64_tr_b16 a[58:59], v133 offset:15424
    v_mfma_f32_16x16x32_bf16 v[12:15], a[12:15], a[40:43], v[12:15]
    ds_read_b64_tr_b16 a[60:61], v134 offset:10336
    v_mfma_f32_16x16x32_bf16 v[52:55], a[12:15], a[44:47], v[52:55]
    ds_read_b64_tr_b16 a[62:63], v134 offset:15456
    v_mfma_f32_16x16x32_bf16 v[16:19], a[16:19], a[40:43], v[16:19]
    ds_read_b64_tr_b16 a[64:65], v133 offset:10368
    v_mfma_f32_16x16x32_bf16 v[56:59], a[16:19], a[44:47], v[56:59]
    ds_read_b64_tr_b16 a[66:67], v133 offset:15488
    s_waitcnt lgkmcnt(12)
    v_mfma_f32_16x16x32_bf16 v[20:23], a[20:23], a[40:43], v[20:23]
    ds_read_b64_tr_b16 a[68:69], v134 offset:10400
    v_mfma_f32_16x16x32_bf16 v[60:63], a[20:23], a[44:47], v[60:63]
    ds_read_b64_tr_b16 a[70:71], v134 offset:15520
    v_mfma_f32_16x16x32_bf16 v[24:27], a[24:27], a[40:43], v[24:27]
    ds_read_b64_tr_b16 a[72:73], v133 offset:10432
    v_mfma_f32_16x16x32_bf16 v[64:67], a[24:27], a[44:47], v[64:67]
    ds_read_b64_tr_b16 a[74:75], v133 offset:15552
    v_mfma_f32_16x16x32_bf16 v[28:31], a[28:31], a[40:43], v[28:31]
    ds_read_b64_tr_b16 a[76:77], v134 offset:10464
    v_mfma_f32_16x16x32_bf16 v[68:71], a[28:31], a[44:47], v[68:71]
    ds_read_b64_tr_b16 a[78:79], v134 offset:15584
    v_mfma_f32_16x16x32_bf16 v[32:35], a[32:35], a[40:43], v[32:35]
    ds_read_b64_tr_b16 a[80:81], v133 offset:10496
    v_mfma_f32_16x16x32_bf16 v[72:75], a[32:35], a[44:47], v[72:75]
    ds_read_b64_tr_b16 a[82:83], v133 offset:15616
    v_mfma_f32_16x16x32_bf16 v[36:39], a[36:39], a[40:43], v[36:39]
    ds_read_b64_tr_b16 a[84:85], v134 offset:10528
    v_mfma_f32_16x16x32_bf16 v[76:79], a[36:39], a[44:47], v[76:79]
    ds_read_b64_tr_b16 a[86:87], v134 offset:15648
    s_barrier
    s_waitcnt lgkmcnt(10)
    v_mfma_f32_16x16x32_bf16 v[0:3], a[48:51], a[88:91], v[0:3]
    ds_read_b64_tr_b16 a[0:1], v137 offset:0
    ds_read_b64_tr_b16 a[2:3], v137 offset:2560
    v_mfma_f32_16x16x32_bf16 v[40:43], a[48:51], a[92:95], v[40:43]
    ds_read_b64_tr_b16 a[4:5], v137 offset:5120
    ds_read_b64_tr_b16 a[6:7], v137 offset:7680
    v_mfma_f32_16x16x32_bf16 v[4:7], a[52:55], a[88:91], v[4:7]
    ds_read_b64_tr_b16 a[8:9], v137 offset:10240
    ds_read_b64_tr_b16 a[10:11], v137 offset:12800
    v_mfma_f32_16x16x32_bf16 v[44:47], a[52:55], a[92:95], v[44:47]
    ds_read_b64_tr_b16 a[12:13], v137 offset:32
    ds_read_b64_tr_b16 a[14:15], v137 offset:2592
    v_mfma_f32_16x16x32_bf16 v[8:11], a[56:59], a[88:91], v[8:11]
    ds_read_b64_tr_b16 a[16:17], v137 offset:5152
    ds_read_b64_tr_b16 a[18:19], v137 offset:7712
    v_mfma_f32_16x16x32_bf16 v[48:51], a[56:59], a[92:95], v[48:51]
    ds_read_b64_tr_b16 a[20:21], v137 offset:10272
    ds_read_b64_tr_b16 a[22:23], v137 offset:12832
    v_mfma_f32_16x16x32_bf16 v[12:15], a[60:63], a[88:91], v[12:15]
    ds_read_b64_tr_b16 a[24:25], v137 offset:64
    ds_read_b64_tr_b16 a[26:27], v137 offset:2624
    v_mfma_f32_16x16x32_bf16 v[52:55], a[60:63], a[92:95], v[52:55]
    ds_read_b64_tr_b16 a[28:29], v137 offset:5184
    ds_read_b64_tr_b16 a[30:31], v137 offset:7744
    v_mfma_f32_16x16x32_bf16 v[16:19], a[64:67], a[88:91], v[16:19]
    ds_read_b64_tr_b16 a[32:33], v137 offset:10304
    ds_read_b64_tr_b16 a[34:35], v137 offset:12864
    v_mfma_f32_16x16x32_bf16 v[56:59], a[64:67], a[92:95], v[56:59]
    ds_read_b64_tr_b16 a[36:37], v137 offset:96
    ds_read_b64_tr_b16 a[38:39], v137 offset:2656
    s_waitcnt lgkmcnt(15)
    v_mfma_f32_16x16x32_bf16 v[20:23], a[68:71], a[88:91], v[20:23]
    ds_read_b64_tr_b16 a[40:41], v137 offset:5216
    v_mfma_f32_16x16x32_bf16 v[60:63], a[68:71], a[92:95], v[60:63]
    ds_read_b64_tr_b16 a[42:43], v137 offset:7776
    v_mfma_f32_16x16x32_bf16 v[24:27], a[72:75], a[88:91], v[24:27]
    ds_read_b64_tr_b16 a[44:45], v137 offset:10336
    v_mfma_f32_16x16x32_bf16 v[64:67], a[72:75], a[92:95], v[64:67]
    ds_read_b64_tr_b16 a[46:47], v137 offset:12896
    v_mfma_f32_16x16x32_bf16 v[28:31], a[76:79], a[88:91], v[28:31]
    ds_read_b64_tr_b16 a[96:97], v137 offset:128
    v_mfma_f32_16x16x32_bf16 v[68:71], a[76:79], a[92:95], v[68:71]
    ds_read_b64_tr_b16 a[98:99], v137 offset:2688
    v_mfma_f32_16x16x32_bf16 v[32:35], a[80:83], a[88:91], v[32:35]
    ds_read_b64_tr_b16 a[100:101], v137 offset:5248
    v_mfma_f32_16x16x32_bf16 v[72:75], a[80:83], a[92:95], v[72:75]
    ds_read_b64_tr_b16 a[102:103], v137 offset:7808
    v_mfma_f32_16x16x32_bf16 v[36:39], a[84:87], a[88:91], v[36:39]
    ds_read_b64_tr_b16 a[104:105], v137 offset:10368
    v_mfma_f32_16x16x32_bf16 v[76:79], a[84:87], a[92:95], v[76:79]
    ds_read_b64_tr_b16 a[106:107], v137 offset:12928
    v_mov_b32 v141, 0
    buffer_load_dword v140, v141, s[88:91], 0 offen sc1
    v_cvt_pk_bf16_f32 v80, v0, v1
    v_cvt_pk_bf16_f32 v81, v2, v3
    v_cvt_pk_bf16_f32 v82, v4, v5
    v_cvt_pk_bf16_f32 v83, v6, v7
    v_cvt_pk_bf16_f32 v84, v8, v9
    v_cvt_pk_bf16_f32 v85, v10, v11
    v_cvt_pk_bf16_f32 v86, v12, v13
    v_cvt_pk_bf16_f32 v87, v14, v15
    v_cvt_pk_bf16_f32 v88, v16, v17
    v_cvt_pk_bf16_f32 v89, v18, v19
    v_mov_b32 v90, 0
    v_mov_b32 v91, 0
    v_cvt_pk_bf16_f32 v92, v40, v41
    v_cvt_pk_bf16_f32 v93, v42, v43
    v_cvt_pk_bf16_f32 v94, v44, v45
    v_cvt_pk_bf16_f32 v95, v46, v47
    v_cvt_pk_bf16_f32 v96, v48, v49
    v_cvt_pk_bf16_f32 v97, v50, v51
    v_cvt_pk_bf16_f32 v98, v52, v53
    v_cvt_pk_bf16_f32 v99, v54, v55
    v_cvt_pk_bf16_f32 v100, v56, v57
    v_cvt_pk_bf16_f32 v101, v58, v59
    v_mov_b32 v102, 0
    v_mov_b32 v103, 0
    v_cvt_pk_bf16_f32 v0, v20, v21
    v_cvt_pk_bf16_f32 v1, v22, v23
    v_cvt_pk_bf16_f32 v2, v24, v25
    v_cvt_pk_bf16_f32 v3, v26, v27
    v_cvt_pk_bf16_f32 v4, v28, v29
    v_cvt_pk_bf16_f32 v5, v30, v31
    v_cvt_pk_bf16_f32 v6, v32, v33
    v_cvt_pk_bf16_f32 v7, v34, v35
    v_cvt_pk_bf16_f32 v8, v36, v37
    v_cvt_pk_bf16_f32 v9, v38, v39
    v_cvt_pk_bf16_f32 v10, v60, v61
    v_cvt_pk_bf16_f32 v11, v62, v63
    v_cvt_pk_bf16_f32 v12, v64, v65
    v_cvt_pk_bf16_f32 v13, v66, v67
    v_cvt_pk_bf16_f32 v14, v68, v69
    v_cvt_pk_bf16_f32 v15, v70, v71
    v_cvt_pk_bf16_f32 v16, v72, v73
    v_cvt_pk_bf16_f32 v17, v74, v75
    v_cvt_pk_bf16_f32 v18, v76, v77
    v_cvt_pk_bf16_f32 v19, v78, v79
    s_waitcnt lgkmcnt(0)
    s_barrier
    v_mfma_f32_16x16x32_bf16 v[20:23], a[0:3], v[80:83], 0
    s_lshl_b32 s11, s8, 5
    v_add_u32 v104, s11, v129
    v_mfma_f32_16x16x32_bf16 v[24:27], a[12:15], v[80:83], 0
    v_lshrrev_b32 v105, 2, v129
    v_mul_u32_u24 v133, 416, v104
    v_mfma_f32_16x16x32_bf16 v[28:31], a[24:27], v[80:83], 0
    v_mul_u32_u24 v114, 96, v130
    v_add_u32 v133, v133, v114
    v_mfma_f32_16x16x32_bf16 v[32:35], a[36:39], v[80:83], 0
    v_add_u32 v133, 110592, v133
    v_and_b32 v114, 1, v105
    v_mfma_f32_16x16x32_bf16 v[36:39], a[96:99], v[80:83], 0
    v_lshlrev_b32 v114, 4, v114
    v_sub_u32 v134, v133, v114
    v_mfma_f32_16x16x32_bf16 v[20:23], a[4:7], v[84:87], v[20:23]
    v_add_u32 v133, v133, v114
    v_mul_u32_u24 v104, 288, v104
    v_mfma_f32_16x16x32_bf16 v[24:27], a[16:19], v[84:87], v[24:27]
    v_add_u32 v114, 0, v130
    v_mul_u32_u24 v115, 52, v114
    v_mfma_f32_16x16x32_bf16 v[28:31], a[28:31], v[84:87], v[28:31]
    v_lshrrev_b32 v115, 8, v115
    v_mad_u32_u24 v114, v115, 3, v114
    v_mfma_f32_16x16x32_bf16 v[32:35], a[40:43], v[84:87], v[32:35]
    v_xor_b32 v114, v114, v105
    v_lshl_add_u32 v106, v114, 3, v104
    v_mfma_f32_16x16x32_bf16 v[36:39], a[100:103], v[84:87], v[36:39]
    v_add_u32 v114, 4, v130
    v_mul_u32_u24 v115, 52, v114
    v_mfma_f32_16x16x32_bf16 v[20:23], a[8:11], v[88:91], v[20:23]
    v_lshrrev_b32 v115, 8, v115
    v_mad_u32_u24 v114, v115, 3, v114
    v_mfma_f32_16x16x32_bf16 v[24:27], a[20:23], v[88:91], v[24:27]
    v_xor_b32 v114, v114, v105
    v_lshl_add_u32 v107, v114, 3, v104
    v_mfma_f32_16x16x32_bf16 v[28:31], a[32:35], v[88:91], v[28:31]
    v_add_u32 v114, 8, v130
    v_mul_u32_u24 v115, 52, v114
    v_mfma_f32_16x16x32_bf16 v[32:35], a[44:47], v[88:91], v[32:35]
    v_lshrrev_b32 v115, 8, v115
    v_mad_u32_u24 v114, v115, 3, v114
    v_mfma_f32_16x16x32_bf16 v[36:39], a[104:107], v[88:91], v[36:39]
    v_xor_b32 v114, v114, v105
    v_lshl_add_u32 v108, v114, 3, v104
    v_mfma_f32_16x16x32_bf16 v[40:43], a[0:3], v[92:95], 0
    v_add_u32 v114, 12, v130
    v_mul_u32_u24 v115, 52, v114
    v_mfma_f32_16x16x32_bf16 v[44:47], a[12:15], v[92:95], 0
    v_lshrrev_b32 v115, 8, v115
    v_mad_u32_u24 v114, v115, 3, v114
    v_mfma_f32_16x16x32_bf16 v[48:51], a[24:27], v[92:95], 0
    v_xor_b32 v114, v114, v105
    v_lshl_add_u32 v109, v114, 3, v104
    v_mfma_f32_16x16x32_bf16 v[52:55], a[36:39], v[92:95], 0
    v_add_u32 v114, 16, v130
    v_mul_u32_u24 v115, 52, v114
    v_mfma_f32_16x16x32_bf16 v[56:59], a[96:99], v[92:95], 0
    v_lshrrev_b32 v115, 8, v115
    v_mad_u32_u24 v114, v115, 3, v114
    v_mfma_f32_16x16x32_bf16 v[40:43], a[4:7], v[96:99], v[40:43]
    v_xor_b32 v114, v114, v105
    v_lshl_add_u32 v110, v114, 3, v104
    v_mfma_f32_16x16x32_bf16 v[44:47], a[16:19], v[96:99], v[44:47]
    v_lshl_add_u32 v114, v130, 3, 5
    v_xor_b32 v114, v114, v105
    v_mfma_f32_16x16x32_bf16 v[48:51], a[28:31], v[96:99], v[48:51]
    v_lshl_add_u32 v111, v114, 3, v104
    v_mov_b32 v112, 0x3f80
    v_mfma_f32_16x16x32_bf16 v[52:55], a[40:43], v[96:99], v[52:55]
    v_mov_b32 v113, 0
    v_mfma_f32_16x16x32_bf16 v[56:59], a[100:103], v[96:99], v[56:59]
    v_mfma_f32_16x16x32_bf16 v[40:43], a[8:11], v[100:103], v[40:43]
    v_mfma_f32_16x16x32_bf16 v[44:47], a[20:23], v[100:103], v[44:47]
    v_mfma_f32_16x16x32_bf16 v[48:51], a[32:35], v[100:103], v[48:51]
    v_mfma_f32_16x16x32_bf16 v[52:55], a[44:47], v[100:103], v[52:55]
    v_mfma_f32_16x16x32_bf16 v[56:59], a[104:107], v[100:103], v[56:59]
    v_max3_f32 v120, v20, v21, v22
    ds_write_b64 v106, v[0:1] offset:0
    v_min3_f32 v122, v20, v21, v22
    v_max3_f32 v121, v23, v24, v25
    v_min3_f32 v123, v23, v24, v25
    v_max3_f32 v120, v120, v26, v27
    v_min3_f32 v122, v122, v26, v27
    v_max3_f32 v121, v121, v28, v29
    v_min3_f32 v123, v123, v28, v29
    ds_write_b64 v107, v[2:3] offset:0
    v_max3_f32 v120, v120, v30, v31
    v_min3_f32 v122, v122, v30, v31
    v_max3_f32 v121, v121, v32, v33
    v_min3_f32 v123, v123, v32, v33
    v_max3_f32 v120, v120, v34, v35
    v_min3_f32 v122, v122, v34, v35
    v_max3_f32 v121, v121, v36, v37
    ds_write_b64 v108, v[4:5] offset:0
    v_min3_f32 v123, v123, v36, v37
    v_max3_f32 v120, v120, v38, v39
    v_min3_f32 v122, v122, v38, v39
    v_max_f32 v120, v120, v121
    v_min_f32 v122, v122, v123
    v_mul_f32 v120, s66, v120
    v_mul_f32 v122, s64, v122
    ds_write_b64 v109, v[6:7] offset:0
    v_pk_fma_f32 v[60:61], v[20:21], s[64:65], v[120:121] op_sel_hi:[1,1,0]
    v_pk_fma_f32 v[80:81], v[20:21], s[66:67], v[122:123] op_sel_hi:[1,1,0]
    v_pk_fma_f32 v[62:63], v[22:23], s[64:65], v[120:121] op_sel_hi:[1,1,0]
    v_pk_fma_f32 v[82:83], v[22:23], s[66:67], v[122:123] op_sel_hi:[1,1,0]
    v_pk_fma_f32 v[64:65], v[24:25], s[64:65], v[120:121] op_sel_hi:[1,1,0]
    v_pk_fma_f32 v[84:85], v[24:25], s[66:67], v[122:123] op_sel_hi:[1,1,0]
    v_pk_fma_f32 v[66:67], v[26:27], s[64:65], v[120:121] op_sel_hi:[1,1,0]
    ds_write_b64 v110, v[8:9] offset:0
    v_pk_fma_f32 v[86:87], v[26:27], s[66:67], v[122:123] op_sel_hi:[1,1,0]
    v_pk_fma_f32 v[68:69], v[28:29], s[64:65], v[120:121] op_sel_hi:[1,1,0]
    v_pk_fma_f32 v[88:89], v[28:29], s[66:67], v[122:123] op_sel_hi:[1,1,0]
    v_pk_fma_f32 v[70:71], v[30:31], s[64:65], v[120:121] op_sel_hi:[1,1,0]
    v_pk_fma_f32 v[90:91], v[30:31], s[66:67], v[122:123] op_sel_hi:[1,1,0]
    v_pk_fma_f32 v[72:73], v[32:33], s[64:65], v[120:121] op_sel_hi:[1,1,0]
    v_pk_fma_f32 v[92:93], v[32:33], s[66:67], v[122:123] op_sel_hi:[1,1,0]
    ds_write_b64 v111, v[112:113] offset:0
    v_pk_fma_f32 v[74:75], v[34:35], s[64:65], v[120:121] op_sel_hi:[1,1,0]
    v_pk_fma_f32 v[94:95], v[34:35], s[66:67], v[122:123] op_sel_hi:[1,1,0]
    v_pk_fma_f32 v[76:77], v[36:37], s[64:65], v[120:121] op_sel_hi:[1,1,0]
    v_pk_fma_f32 v[96:97], v[36:37], s[66:67], v[122:123] op_sel_hi:[1,1,0]
    v_pk_fma_f32 v[78:79], v[38:39], s[64:65], v[120:121] op_sel_hi:[1,1,0]
    v_pk_fma_f32 v[98:99], v[38:39], s[66:67], v[122:123] op_sel_hi:[1,1,0]
    v_exp_f32 v60, v60
    ds_write_b64 v106, v[10:11] offset:4608
    v_exp_f32 v61, v61
    v_exp_f32 v62, v62
    v_exp_f32 v63, v63
    v_exp_f32 v64, v64
    v_exp_f32 v65, v65
    v_exp_f32 v66, v66
    v_exp_f32 v67, v67
    ds_write_b64 v107, v[12:13] offset:4608
    v_exp_f32 v68, v68
    v_exp_f32 v69, v69
    v_exp_f32 v70, v70
    v_exp_f32 v71, v71
    v_exp_f32 v72, v72
    v_exp_f32 v73, v73
    v_exp_f32 v74, v74
    ds_write_b64 v108, v[14:15] offset:4608
    v_exp_f32 v75, v75
    v_exp_f32 v76, v76
    v_exp_f32 v77, v77
    v_exp_f32 v78, v78
    v_exp_f32 v79, v79
    v_exp_f32 v80, v80
    v_exp_f32 v81, v81
    ds_write_b64 v109, v[16:17] offset:4608
    v_exp_f32 v82, v82
    v_exp_f32 v83, v83
    v_exp_f32 v84, v84
    v_exp_f32 v85, v85
    v_exp_f32 v86, v86
    v_exp_f32 v87, v87
    v_exp_f32 v88, v88
    ds_write_b64 v110, v[18:19] offset:4608
    v_exp_f32 v89, v89
    v_exp_f32 v90, v90
    v_exp_f32 v91, v91
    v_exp_f32 v92, v92
    v_exp_f32 v93, v93
    v_exp_f32 v94, v94
    v_exp_f32 v95, v95
    ds_write_b64 v111, v[112:113] offset:4608
    v_exp_f32 v96, v96
    v_exp_f32 v97, v97
    v_exp_f32 v98, v98
    v_exp_f32 v99, v99
    v_pk_add_f32 v[124:125], v[60:61], v[62:63]
    v_pk_add_f32 v[126:127], v[80:81], v[82:83]
    v_pk_add_f32 v[120:121], v[64:65], v[66:67]
    v_pk_add_f32 v[122:123], v[84:85], v[86:87]
    v_pk_add_f32 v[124:125], v[124:125], v[68:69]
    v_pk_add_f32 v[126:127], v[126:127], v[88:89]
    v_pk_add_f32 v[120:121], v[120:121], v[70:71]
    v_pk_add_f32 v[122:123], v[122:123], v[90:91]
    v_pk_add_f32 v[124:125], v[124:125], v[72:73]
    v_pk_add_f32 v[126:127], v[126:127], v[92:93]
    v_pk_add_f32 v[120:121], v[120:121], v[74:75]
    v_pk_add_f32 v[122:123], v[122:123], v[94:95]
    v_pk_add_f32 v[124:125], v[124:125], v[76:77]
    v_pk_add_f32 v[126:127], v[126:127], v[96:97]
    v_pk_add_f32 v[120:121], v[120:121], v[78:79]
    v_pk_add_f32 v[122:123], v[122:123], v[98:99]
    v_pk_add_f32 v[124:125], v[124:125], v[120:121]
    v_pk_add_f32 v[126:127], v[126:127], v[122:123]
    v_add_f32 v124, v124, v125
    v_add_f32 v126, v126, v127
    v_rcp_f32 v124, v124
    v_rcp_f32 v126, v126
    v_pk_mul_f32 v[60:61], v[60:61], v[124:125] op_sel_hi:[1,0]
    v_pk_mul_f32 v[80:81], v[80:81], v[126:127] op_sel_hi:[1,0]
    v_pk_mul_f32 v[62:63], v[62:63], v[124:125] op_sel_hi:[1,0]
    v_pk_mul_f32 v[82:83], v[82:83], v[126:127] op_sel_hi:[1,0]
    v_pk_mul_f32 v[64:65], v[64:65], v[124:125] op_sel_hi:[1,0]
    v_pk_mul_f32 v[84:85], v[84:85], v[126:127] op_sel_hi:[1,0]
    v_pk_mul_f32 v[66:67], v[66:67], v[124:125] op_sel_hi:[1,0]
    v_pk_mul_f32 v[86:87], v[86:87], v[126:127] op_sel_hi:[1,0]
    v_pk_mul_f32 v[68:69], v[68:69], v[124:125] op_sel_hi:[1,0]
    v_pk_mul_f32 v[88:89], v[88:89], v[126:127] op_sel_hi:[1,0]
    v_pk_mul_f32 v[70:71], v[70:71], v[124:125] op_sel_hi:[1,0]
    v_pk_mul_f32 v[90:91], v[90:91], v[126:127] op_sel_hi:[1,0]
    v_pk_mul_f32 v[72:73], v[72:73], v[124:125] op_sel_hi:[1,0]
    v_pk_mul_f32 v[92:93], v[92:93], v[126:127] op_sel_hi:[1,0]
    v_pk_mul_f32 v[74:75], v[74:75], v[124:125] op_sel_hi:[1,0]
    v_pk_mul_f32 v[94:95], v[94:95], v[126:127] op_sel_hi:[1,0]
    v_pk_mul_f32 v[76:77], v[76:77], v[124:125] op_sel_hi:[1,0]
    v_pk_mul_f32 v[96:97], v[96:97], v[126:127] op_sel_hi:[1,0]
    v_pk_mul_f32 v[78:79], v[78:79], v[124:125] op_sel_hi:[1,0]
    v_pk_mul_f32 v[98:99], v[98:99], v[126:127] op_sel_hi:[1,0]
    v_cvt_pk_bf16_f32 v100, v60, v61
    v_cvt_pk_bf16_f32 v101, v62, v63
    v_cvt_pk_bf16_f32 v102, v64, v65
    v_cvt_pk_bf16_f32 v103, v66, v67
    v_cvt_pk_bf16_f32 v104, v68, v69
    v_cvt_pk_bf16_f32 v105, v70, v71
    v_cvt_pk_bf16_f32 v106, v72, v73
    v_cvt_pk_bf16_f32 v107, v74, v75
    v_cvt_pk_bf16_f32 v108, v76, v77
    v_cvt_pk_bf16_f32 v109, v78, v79
    v_cvt_pk_bf16_f32 v110, v80, v81
    v_cvt_pk_bf16_f32 v111, v82, v83
    v_cvt_pk_bf16_f32 v112, v84, v85
    v_cvt_pk_bf16_f32 v113, v86, v87
    v_cvt_pk_bf16_f32 v114, v88, v89
    v_cvt_pk_bf16_f32 v115, v90, v91
    v_cvt_pk_bf16_f32 v116, v92, v93
    v_cvt_pk_bf16_f32 v117, v94, v95
    v_cvt_pk_bf16_f32 v118, v96, v97
    v_cvt_pk_bf16_f32 v119, v98, v99
    v_max3_f32 v120, v40, v41, v42
    ds_write_b128 v133, v[100:103] offset:0
    v_min3_f32 v122, v40, v41, v42
    v_max3_f32 v121, v43, v44, v45
    v_min3_f32 v123, v43, v44, v45
    v_max3_f32 v120, v120, v46, v47
    v_min3_f32 v122, v122, v46, v47
    v_max3_f32 v121, v121, v48, v49
    v_min3_f32 v123, v123, v48, v49
    v_max3_f32 v120, v120, v50, v51
    v_min3_f32 v122, v122, v50, v51
    v_max3_f32 v121, v121, v52, v53
    v_min3_f32 v123, v123, v52, v53
    v_max3_f32 v120, v120, v54, v55
    v_min3_f32 v122, v122, v54, v55
    v_max3_f32 v121, v121, v56, v57
    v_min3_f32 v123, v123, v56, v57
    v_max3_f32 v120, v120, v58, v59
    ds_write_b128 v134, v[104:107] offset:16
    v_min3_f32 v122, v122, v58, v59
    v_max_f32 v120, v120, v121
    v_min_f32 v122, v122, v123
    v_mul_f32 v120, s66, v120
    v_mul_f32 v122, s64, v122
    v_pk_fma_f32 v[60:61], v[40:41], s[64:65], v[120:121] op_sel_hi:[1,1,0]
    v_pk_fma_f32 v[80:81], v[40:41], s[66:67], v[122:123] op_sel_hi:[1,1,0]
    v_pk_fma_f32 v[62:63], v[42:43], s[64:65], v[120:121] op_sel_hi:[1,1,0]
    v_pk_fma_f32 v[82:83], v[42:43], s[66:67], v[122:123] op_sel_hi:[1,1,0]
    v_pk_fma_f32 v[64:65], v[44:45], s[64:65], v[120:121] op_sel_hi:[1,1,0]
    v_pk_fma_f32 v[84:85], v[44:45], s[66:67], v[122:123] op_sel_hi:[1,1,0]
    v_pk_fma_f32 v[66:67], v[46:47], s[64:65], v[120:121] op_sel_hi:[1,1,0]
    v_pk_fma_f32 v[86:87], v[46:47], s[66:67], v[122:123] op_sel_hi:[1,1,0]
    v_pk_fma_f32 v[68:69], v[48:49], s[64:65], v[120:121] op_sel_hi:[1,1,0]
    v_pk_fma_f32 v[88:89], v[48:49], s[66:67], v[122:123] op_sel_hi:[1,1,0]
    v_pk_fma_f32 v[70:71], v[50:51], s[64:65], v[120:121] op_sel_hi:[1,1,0]
    ds_write_b128 v133, v[108:111] offset:32
    v_pk_fma_f32 v[90:91], v[50:51], s[66:67], v[122:123] op_sel_hi:[1,1,0]
    v_pk_fma_f32 v[72:73], v[52:53], s[64:65], v[120:121] op_sel_hi:[1,1,0]
    v_pk_fma_f32 v[92:93], v[52:53], s[66:67], v[122:123] op_sel_hi:[1,1,0]
    v_pk_fma_f32 v[74:75], v[54:55], s[64:65], v[120:121] op_sel_hi:[1,1,0]
    v_pk_fma_f32 v[94:95], v[54:55], s[66:67], v[122:123] op_sel_hi:[1,1,0]
    v_pk_fma_f32 v[76:77], v[56:57], s[64:65], v[120:121] op_sel_hi:[1,1,0]
    v_pk_fma_f32 v[96:97], v[56:57], s[66:67], v[122:123] op_sel_hi:[1,1,0]
    v_pk_fma_f32 v[78:79], v[58:59], s[64:65], v[120:121] op_sel_hi:[1,1,0]
    v_pk_fma_f32 v[98:99], v[58:59], s[66:67], v[122:123] op_sel_hi:[1,1,0]
    v_exp_f32 v60, v60
    v_exp_f32 v61, v61
    v_exp_f32 v62, v62
    v_exp_f32 v63, v63
    v_exp_f32 v64, v64
    v_exp_f32 v65, v65
    v_exp_f32 v66, v66
    ds_write_b128 v134, v[112:115] offset:48
    v_exp_f32 v67, v67
    v_exp_f32 v68, v68
    v_exp_f32 v69, v69
    v_exp_f32 v70, v70
    v_exp_f32 v71, v71
    v_exp_f32 v72, v72
    v_exp_f32 v73, v73
    v_exp_f32 v74, v74
    v_exp_f32 v75, v75
    v_exp_f32 v76, v76
    v_exp_f32 v77, v77
    v_exp_f32 v78, v78
    v_exp_f32 v79, v79
    v_exp_f32 v80, v80
    v_exp_f32 v81, v81
    v_exp_f32 v82, v82
    ds_write_b128 v133, v[116:119] offset:64
    v_exp_f32 v83, v83
    v_exp_f32 v84, v84
    v_exp_f32 v85, v85
    v_exp_f32 v86, v86
    v_exp_f32 v87, v87
    v_exp_f32 v88, v88
    v_exp_f32 v89, v89
    v_exp_f32 v90, v90
    v_exp_f32 v91, v91
    v_exp_f32 v92, v92
    v_exp_f32 v93, v93
    v_exp_f32 v94, v94
    v_exp_f32 v95, v95
    v_exp_f32 v96, v96
    v_exp_f32 v97, v97
    v_exp_f32 v98, v98
    v_exp_f32 v99, v99
    v_pk_add_f32 v[124:125], v[60:61], v[62:63]
    v_pk_add_f32 v[126:127], v[80:81], v[82:83]
    v_pk_add_f32 v[120:121], v[64:65], v[66:67]
    v_pk_add_f32 v[122:123], v[84:85], v[86:87]
    v_pk_add_f32 v[124:125], v[124:125], v[68:69]
    v_pk_add_f32 v[126:127], v[126:127], v[88:89]
    v_pk_add_f32 v[120:121], v[120:121], v[70:71]
    v_pk_add_f32 v[122:123], v[122:123], v[90:91]
    v_pk_add_f32 v[124:125], v[124:125], v[72:73]
    v_pk_add_f32 v[126:127], v[126:127], v[92:93]
    v_pk_add_f32 v[120:121], v[120:121], v[74:75]
    v_pk_add_f32 v[122:123], v[122:123], v[94:95]
    v_pk_add_f32 v[124:125], v[124:125], v[76:77]
    v_pk_add_f32 v[126:127], v[126:127], v[96:97]
    v_pk_add_f32 v[120:121], v[120:121], v[78:79]
    v_pk_add_f32 v[122:123], v[122:123], v[98:99]
    v_pk_add_f32 v[124:125], v[124:125], v[120:121]
    v_pk_add_f32 v[126:127], v[126:127], v[122:123]
    v_add_f32 v124, v124, v125
    v_add_f32 v126, v126, v127
    v_rcp_f32 v124, v124
    v_rcp_f32 v126, v126
    v_pk_mul_f32 v[60:61], v[60:61], v[124:125] op_sel_hi:[1,0]
    v_pk_mul_f32 v[80:81], v[80:81], v[126:127] op_sel_hi:[1,0]
    v_pk_mul_f32 v[62:63], v[62:63], v[124:125] op_sel_hi:[1,0]
    v_pk_mul_f32 v[82:83], v[82:83], v[126:127] op_sel_hi:[1,0]
    v_pk_mul_f32 v[64:65], v[64:65], v[124:125] op_sel_hi:[1,0]
    v_pk_mul_f32 v[84:85], v[84:85], v[126:127] op_sel_hi:[1,0]
    v_pk_mul_f32 v[66:67], v[66:67], v[124:125] op_sel_hi:[1,0]
    v_pk_mul_f32 v[86:87], v[86:87], v[126:127] op_sel_hi:[1,0]
    v_pk_mul_f32 v[68:69], v[68:69], v[124:125] op_sel_hi:[1,0]
    v_pk_mul_f32 v[88:89], v[88:89], v[126:127] op_sel_hi:[1,0]
    v_pk_mul_f32 v[70:71], v[70:71], v[124:125] op_sel_hi:[1,0]
    v_pk_mul_f32 v[90:91], v[90:91], v[126:127] op_sel_hi:[1,0]
    v_pk_mul_f32 v[72:73], v[72:73], v[124:125] op_sel_hi:[1,0]
    v_pk_mul_f32 v[92:93], v[92:93], v[126:127] op_sel_hi:[1,0]
    v_pk_mul_f32 v[74:75], v[74:75], v[124:125] op_sel_hi:[1,0]
    v_pk_mul_f32 v[94:95], v[94:95], v[126:127] op_sel_hi:[1,0]
    v_pk_mul_f32 v[76:77], v[76:77], v[124:125] op_sel_hi:[1,0]
    v_pk_mul_f32 v[96:97], v[96:97], v[126:127] op_sel_hi:[1,0]
    v_pk_mul_f32 v[78:79], v[78:79], v[124:125] op_sel_hi:[1,0]
    v_pk_mul_f32 v[98:99], v[98:99], v[126:127] op_sel_hi:[1,0]
    v_cvt_pk_bf16_f32 v20, v60, v61
    v_cvt_pk_bf16_f32 v21, v62, v63
    v_cvt_pk_bf16_f32 v22, v64, v65
    v_cvt_pk_bf16_f32 v23, v66, v67
    v_cvt_pk_bf16_f32 v24, v68, v69
    v_cvt_pk_bf16_f32 v25, v70, v71
    v_cvt_pk_bf16_f32 v26, v72, v73
    v_cvt_pk_bf16_f32 v27, v74, v75
    v_cvt_pk_bf16_f32 v28, v76, v77
    v_cvt_pk_bf16_f32 v29, v78, v79
    v_cvt_pk_bf16_f32 v30, v80, v81
    v_cvt_pk_bf16_f32 v31, v82, v83
    v_cvt_pk_bf16_f32 v32, v84, v85
    v_cvt_pk_bf16_f32 v33, v86, v87
    v_cvt_pk_bf16_f32 v34, v88, v89
    v_cvt_pk_bf16_f32 v35, v90, v91
    v_cvt_pk_bf16_f32 v36, v92, v93
    v_cvt_pk_bf16_f32 v37, v94, v95
    v_cvt_pk_bf16_f32 v38, v96, v97
    v_cvt_pk_bf16_f32 v39, v98, v99
    ds_write_b128 v133, v[20:23] offset:6656
    ds_write_b128 v134, v[24:27] offset:6672
    ds_write_b128 v133, v[28:31] offset:6688
    ds_write_b128 v134, v[32:35] offset:6704
    ds_write_b128 v133, v[36:39] offset:6720
    v_lshl_add_u32 v66, v130, 2, v131
    v_and_b32 v69, 1, v130
    v_lshlrev_b32 v69, 1, v69
    v_xor_b32 v69, v69, v132
    v_xor_b32 v70, v130, v132
    s_mul_i32 s11, s8, 96
    s_add_u32 s11, s11, 110592
    v_mul_u32_u24 v60, 416, v66
    v_lshl_add_u32 v60, v69, 3, v60
    v_add_u32 v60, s11, v60
    s_lshl_b32 s11, s8, 6
    v_mul_u32_u24 v61, 288, v66
    v_lshl_add_u32 v61, v70, 3, v61
    v_add_u32 v61, s11, v61
    v_mov_b32 v67, 163824
    v_mov_b32 v68, 1
    s_waitcnt lgkmcnt(0)
    s_mov_b64 exec, 1
    ds_add_u32 v67, v68
    s_mov_b64 exec, -1
p_spin:
    ds_read_b32 v68, v67
    s_waitcnt lgkmcnt(0)
    v_readfirstlane_b32 s14, v68
    s_nop 0
    s_cmp_lt_u32 s14, 4
    s_cbranch_scc1 p_spin
    ds_read_b64_tr_b16 a[0:1], v60 offset:0
    ds_read_b64_tr_b16 a[2:3], v60 offset:6656
    ds_read_b64_tr_b16 a[4:5], v60 offset:32
    ds_read_b64_tr_b16 a[6:7], v60 offset:6688
    ds_read_b64_tr_b16 a[8:9], v60 offset:64
    ds_read_b64_tr_b16 a[10:11], v60 offset:6720
    ds_read_b64_tr_b16 a[12:13], v61 offset:0
    ds_read_b64_tr_b16 a[14:15], v61 offset:4608
    ds_read_b64_tr_b16 a[16:17], v61 offset:32
    ds_read_b64_tr_b16 a[18:19], v61 offset:4640
    ds_read_b64_tr_b16 a[20:21], v60 offset:13312
    ds_read_b64_tr_b16 a[22:23], v60 offset:19968
    ds_read_b64_tr_b16 a[24:25], v60 offset:13344
    ds_read_b64_tr_b16 a[26:27], v60 offset:20000
    ds_read_b64_tr_b16 a[28:29], v60 offset:13376
    ds_read_b64_tr_b16 a[30:31], v60 offset:20032
    ds_read_b64_tr_b16 a[32:33], v61 offset:9216
    ds_read_b64_tr_b16 a[34:35], v61 offset:13824
    ds_read_b64_tr_b16 a[36:37], v61 offset:9248
    ds_read_b64_tr_b16 a[38:39], v61 offset:13856
    ds_read_b64_tr_b16 a[40:41], v60 offset:26624
    ds_read_b64_tr_b16 a[42:43], v60 offset:33280
    ds_read_b64_tr_b16 a[44:45], v60 offset:26656
    ds_read_b64_tr_b16 a[46:47], v60 offset:33312
    ds_read_b64_tr_b16 a[48:49], v60 offset:26688
    ds_read_b64_tr_b16 a[50:51], v60 offset:33344
    ds_read_b64_tr_b16 a[52:53], v61 offset:18432
    ds_read_b64_tr_b16 a[54:55], v61 offset:23040
    ds_read_b64_tr_b16 a[56:57], v61 offset:18464
    ds_read_b64_tr_b16 a[58:59], v61 offset:23072
    ds_read_b64_tr_b16 a[60:61], v60 offset:39936
    ds_read_b64_tr_b16 a[62:63], v60 offset:46592
    ds_read_b64_tr_b16 a[64:65], v60 offset:39968
    ds_read_b64_tr_b16 a[66:67], v60 offset:46624
    ds_read_b64_tr_b16 a[68:69], v60 offset:40000
    ds_read_b64_tr_b16 a[70:71], v60 offset:46656
    ds_read_b64_tr_b16 a[72:73], v61 offset:27648
    ds_read_b64_tr_b16 a[74:75], v61 offset:32256
    ds_read_b64_tr_b16 a[76:77], v61 offset:27680
    ds_read_b64_tr_b16 a[78:79], v61 offset:32288
    s_lshl_b32 s12, s8, 12
    s_add_u32 s12, s12, 36864
    v_mul_u32_u24 v62, 160, v129
    v_lshl_add_u32 v62, v130, 4, v62
    v_add_u32 v62, s12, v62
    v_lshlrev_b32 v73, 2, v128
    v_add_u32 v71, s12, v73
    s_add_u32 s12, s12, 3584
    v_mov_b32 v66, s12
    v_add_u32 v63, 2560, v62
    v_cmp_gt_u32 vcc, 5, v129
    s_nop 1
    v_cndmask_b32 v63, v66, v63, vcc
    v_cmp_gt_u32 vcc, 2, v130
    s_nop 1
    v_cndmask_b32 v64, v66, v62, vcc
    v_cndmask_b32 v65, v66, v63, vcc
    v_mov_b32 v66, s79
    v_cmp_gt_u32 vcc, 8, v128
    s_nop 1
    v_cndmask_b32 v72, v66, v73, vcc
    s_mul_i32 s11, s7, 14336
    s_mul_i32 s12, s8, 3456
    s_add_u32 s11, s11, s12
    s_add_u32 s11, s11, 2756608
    s_waitcnt lgkmcnt(15)
    v_mfma_f32_16x16x32_bf16 v[80:83], a[0:3], a[12:15], 0
    v_mfma_f32_16x16x32_bf16 v[84:87], a[0:3], a[16:19], 0
    v_mfma_f32_16x16x32_bf16 v[88:91], a[4:7], a[12:15], 0
    v_mfma_f32_16x16x32_bf16 v[92:95], a[4:7], a[16:19], 0
    v_mfma_f32_16x16x32_bf16 v[96:99], a[8:11], a[12:15], 0
    v_mfma_f32_16x16x32_bf16 v[100:103], a[8:11], a[16:19], 0
    s_waitcnt lgkmcnt(15)
    v_mfma_f32_16x16x32_bf16 v[80:83], a[20:23], a[32:35], v[80:83]
    v_mfma_f32_16x16x32_bf16 v[84:87], a[20:23], a[36:39], v[84:87]
    v_mfma_f32_16x16x32_bf16 v[88:91], a[24:27], a[32:35], v[88:91]
    v_mfma_f32_16x16x32_bf16 v[92:95], a[24:27], a[36:39], v[92:95]
    v_mfma_f32_16x16x32_bf16 v[96:99], a[28:31], a[32:35], v[96:99]
    v_mfma_f32_16x16x32_bf16 v[100:103], a[28:31], a[36:39], v[100:103]
    s_waitcnt lgkmcnt(10)
    v_mfma_f32_16x16x32_bf16 v[80:83], a[40:43], a[52:55], v[80:83]
    v_mfma_f32_16x16x32_bf16 v[84:87], a[40:43], a[56:59], v[84:87]
    v_mfma_f32_16x16x32_bf16 v[88:91], a[44:47], a[52:55], v[88:91]
    v_mfma_f32_16x16x32_bf16 v[92:95], a[44:47], a[56:59], v[92:95]
    v_mfma_f32_16x16x32_bf16 v[96:99], a[48:51], a[52:55], v[96:99]
    v_mfma_f32_16x16x32_bf16 v[100:103], a[48:51], a[56:59], v[100:103]
    s_waitcnt lgkmcnt(0)
    s_barrier
    v_mfma_f32_16x16x32_bf16 v[80:83], a[60:63], a[72:75], v[80:83]
    v_mfma_f32_16x16x32_bf16 v[84:87], a[60:63], a[76:79], v[84:87]
    v_mfma_f32_16x16x32_bf16 v[88:91], a[64:67], a[72:75], v[88:91]
    v_mfma_f32_16x16x32_bf16 v[92:95], a[64:67], a[76:79], v[92:95]
    v_mfma_f32_16x16x32_bf16 v[96:99], a[68:71], a[72:75], v[96:99]
    v_mfma_f32_16x16x32_bf16 v[100:103], a[68:71], a[76:79], v[100:103]
    s_nop 2
    ds_write_b128 v62, v[80:83] offset:0
    ds_write_b128 v63, v[84:87] offset:0
    ds_write_b128 v62, v[88:91] offset:64
    ds_write_b128 v63, v[92:95] offset:64
    ds_write_b128 v64, v[96:99] offset:128
    ds_write_b128 v65, v[100:103] offset:128
    s_waitcnt lgkmcnt(0)
    ds_read_b32 v104, v71 offset:0
    ds_read_b32 v105, v71 offset:256
    ds_read_b32 v106, v71 offset:512
    ds_read_b32 v107, v71 offset:768
    ds_read_b32 v108, v71 offset:1024
    ds_read_b32 v109, v71 offset:1280
    ds_read_b32 v110, v71 offset:1536
    ds_read_b32 v111, v71 offset:1792
    ds_read_b32 v112, v71 offset:2048
    ds_read_b32 v113, v71 offset:2304
    ds_read_b32 v114, v71 offset:2560
    ds_read_b32 v115, v71 offset:2816
    ds_read_b32 v116, v71 offset:3072
    ds_read_b32 v117, v71 offset:3328
    s_mov_b32 s84, s11
    s_waitcnt lgkmcnt(0)
    v_lshl_add_u32 v120, v130, 2, v131
    v_mul_u32_u24 v120, 160, v120
    v_lshl_add_u32 v120, v132, 3, v120
    v_add_u32 v133, 90112, v120
    v_mov_b32 v134, v138
    v_xor_b32 v135, 64, v138
    s_barrier
    ds_read_b128 a[0:3], v134 offset:53248
    ds_read_b128 a[4:7], v134 offset:55296
    ds_read_b64_tr_b16 a[16:17], v133 offset:0
    ds_read_b64_tr_b16 a[18:19], v133 offset:2560
    ds_read_b64_tr_b16 a[20:21], v133 offset:32
    ds_read_b64_tr_b16 a[22:23], v133 offset:2592
    ds_read_b64_tr_b16 a[24:25], v133 offset:64
    ds_read_b64_tr_b16 a[26:27], v133 offset:2624
    ds_read_b64_tr_b16 a[28:29], v133 offset:96
    ds_read_b64_tr_b16 a[30:31], v133 offset:2656
    ds_read_b64_tr_b16 a[32:33], v133 offset:128
    ds_read_b64_tr_b16 a[34:35], v133 offset:2688
    s_waitcnt lgkmcnt(0)
    v_mfma_f32_16x16x32_bf16 v[0:3], a[16:19], a[0:3], 0
    ds_read_b128 a[8:11], v135 offset:53248
    ds_read_b128 a[12:15], v135 offset:55296
    buffer_atomic_add_f32 v104, v73, s[52:55], s84 offen offset:0 sc1
    v_mfma_f32_16x16x32_bf16 v[20:23], a[16:19], a[4:7], 0
    ds_read_b64_tr_b16 a[36:37], v133 offset:5120
    buffer_atomic_add_f32 v105, v73, s[52:55], s84 offen offset:256 sc1
    v_mfma_f32_16x16x32_bf16 v[4:7], a[20:23], a[0:3], 0
    ds_read_b64_tr_b16 a[38:39], v133 offset:7680
    buffer_atomic_add_f32 v106, v73, s[52:55], s84 offen offset:512 sc1
    v_mfma_f32_16x16x32_bf16 v[24:27], a[20:23], a[4:7], 0
    ds_read_b64_tr_b16 a[40:41], v133 offset:5152
    buffer_atomic_add_f32 v107, v73, s[52:55], s84 offen offset:768 sc1
    v_mfma_f32_16x16x32_bf16 v[8:11], a[24:27], a[0:3], 0
    ds_read_b64_tr_b16 a[42:43], v133 offset:7712
    v_mfma_f32_16x16x32_bf16 v[28:31], a[24:27], a[4:7], 0
    ds_read_b64_tr_b16 a[44:45], v133 offset:5184
    ds_read_b64_tr_b16 a[46:47], v133 offset:7744
    v_mfma_f32_16x16x32_bf16 v[12:15], a[28:31], a[0:3], 0
    ds_read_b64_tr_b16 a[48:49], v133 offset:5216
    v_mfma_f32_16x16x32_bf16 v[32:35], a[28:31], a[4:7], 0
    ds_read_b64_tr_b16 a[50:51], v133 offset:7776
    v_mfma_f32_16x16x32_bf16 v[16:19], a[32:35], a[0:3], 0
    ds_read_b64_tr_b16 a[52:53], v133 offset:5248
    v_mfma_f32_16x16x32_bf16 v[36:39], a[32:35], a[4:7], 0
    ds_read_b64_tr_b16 a[54:55], v133 offset:7808
    s_barrier
    s_waitcnt lgkmcnt(0)
    v_mfma_f32_16x16x32_bf16 v[0:3], a[36:39], a[8:11], v[0:3]
    ds_read_b128 a[0:3], v134 offset:0
    ds_read_b128 a[4:7], v134 offset:2048
    buffer_atomic_add_f32 v108, v73, s[52:55], s84 offen offset:1024 sc1
    v_mfma_f32_16x16x32_bf16 v[20:23], a[36:39], a[12:15], v[20:23]
    ds_read_b64_tr_b16 a[16:17], v133 offset:10240
    buffer_atomic_add_f32 v109, v73, s[52:55], s84 offen offset:1280 sc1
    v_mfma_f32_16x16x32_bf16 v[4:7], a[40:43], a[8:11], v[4:7]
    ds_read_b64_tr_b16 a[18:19], v133 offset:12800
    buffer_atomic_add_f32 v110, v73, s[52:55], s84 offen offset:1536 sc1
    v_mfma_f32_16x16x32_bf16 v[24:27], a[40:43], a[12:15], v[24:27]
    ds_read_b64_tr_b16 a[20:21], v133 offset:10272
    buffer_atomic_add_f32 v111, v73, s[52:55], s84 offen offset:1792 sc1
    v_mfma_f32_16x16x32_bf16 v[8:11], a[44:47], a[8:11], v[8:11]
    ds_read_b64_tr_b16 a[22:23], v133 offset:12832
    v_mfma_f32_16x16x32_bf16 v[28:31], a[44:47], a[12:15], v[28:31]
    ds_read_b64_tr_b16 a[24:25], v133 offset:10304
    ds_read_b64_tr_b16 a[26:27], v133 offset:12864
    v_mfma_f32_16x16x32_bf16 v[12:15], a[48:51], a[8:11], v[12:15]
    ds_read_b64_tr_b16 a[28:29], v133 offset:10336
    v_mfma_f32_16x16x32_bf16 v[32:35], a[48:51], a[12:15], v[32:35]
    ds_read_b64_tr_b16 a[30:31], v133 offset:12896
    v_mfma_f32_16x16x32_bf16 v[16:19], a[52:55], a[8:11], v[16:19]
    ds_read_b64_tr_b16 a[32:33], v133 offset:10368
    v_mfma_f32_16x16x32_bf16 v[36:39], a[52:55], a[12:15], v[36:39]
    ds_read_b64_tr_b16 a[34:35], v133 offset:12928
    s_waitcnt lgkmcnt(0)
    v_mfma_f32_16x16x32_bf16 v[0:3], a[16:19], a[0:3], v[0:3]
    ds_read_b128 a[8:11], v135 offset:0
    ds_read_b128 a[12:15], v135 offset:2048
    buffer_atomic_add_f32 v112, v73, s[52:55], s84 offen offset:2048 sc1
    v_mfma_f32_16x16x32_bf16 v[20:23], a[16:19], a[4:7], v[20:23]
    ds_read_b64_tr_b16 a[36:37], v133 offset:15360
    buffer_atomic_add_f32 v113, v73, s[52:55], s84 offen offset:2304 sc1
    v_mfma_f32_16x16x32_bf16 v[4:7], a[20:23], a[0:3], v[4:7]
    ds_read_b64_tr_b16 a[38:39], v133 offset:17920
    buffer_atomic_add_f32 v114, v73, s[52:55], s84 offen offset:2560 sc1
    v_mfma_f32_16x16x32_bf16 v[24:27], a[20:23], a[4:7], v[24:27]
    ds_read_b64_tr_b16 a[40:41], v133 offset:15392
    buffer_atomic_add_f32 v115, v73, s[52:55], s84 offen offset:2816 sc1
    v_mfma_f32_16x16x32_bf16 v[8:11], a[24:27], a[0:3], v[8:11]
    ds_read_b64_tr_b16 a[42:43], v133 offset:17952
    v_mfma_f32_16x16x32_bf16 v[28:31], a[24:27], a[4:7], v[28:31]
    ds_read_b64_tr_b16 a[44:45], v133 offset:15424
    ds_read_b64_tr_b16 a[46:47], v133 offset:17984
    v_mfma_f32_16x16x32_bf16 v[12:15], a[28:31], a[0:3], v[12:15]
    ds_read_b64_tr_b16 a[48:49], v133 offset:15456
    v_mfma_f32_16x16x32_bf16 v[32:35], a[28:31], a[4:7], v[32:35]
    ds_read_b64_tr_b16 a[50:51], v133 offset:18016
    v_mfma_f32_16x16x32_bf16 v[16:19], a[32:35], a[0:3], v[16:19]
    ds_read_b64_tr_b16 a[52:53], v133 offset:15488
    v_mfma_f32_16x16x32_bf16 v[36:39], a[32:35], a[4:7], v[36:39]
    ds_read_b64_tr_b16 a[54:55], v133 offset:18048
    s_barrier
    s_waitcnt lgkmcnt(0)
    v_mfma_f32_16x16x32_bf16 v[0:3], a[36:39], a[8:11], v[0:3]
    ds_read_b128 a[0:3], v134 offset:16384
    ds_read_b128 a[4:7], v134 offset:18432
    buffer_atomic_add_f32 v116, v73, s[52:55], s84 offen offset:3072 sc1
    v_mfma_f32_16x16x32_bf16 v[20:23], a[36:39], a[12:15], v[20:23]
    ds_read_b64_tr_b16 a[16:17], v133 offset:20480
    buffer_atomic_add_f32 v117, v72, s[52:55], s84 offen offset:3328 sc1
    v_mfma_f32_16x16x32_bf16 v[4:7], a[40:43], a[8:11], v[4:7]
    ds_read_b64_tr_b16 a[18:19], v133 offset:23040
    v_mfma_f32_16x16x32_bf16 v[24:27], a[40:43], a[12:15], v[24:27]
    ds_read_b64_tr_b16 a[20:21], v133 offset:20512
    v_mfma_f32_16x16x32_bf16 v[8:11], a[44:47], a[8:11], v[8:11]
    ds_read_b64_tr_b16 a[22:23], v133 offset:23072
    v_mfma_f32_16x16x32_bf16 v[28:31], a[44:47], a[12:15], v[28:31]
    ds_read_b64_tr_b16 a[24:25], v133 offset:20544
    ds_read_b64_tr_b16 a[26:27], v133 offset:23104
    v_mfma_f32_16x16x32_bf16 v[12:15], a[48:51], a[8:11], v[12:15]
    ds_read_b64_tr_b16 a[28:29], v133 offset:20576
    v_mfma_f32_16x16x32_bf16 v[32:35], a[48:51], a[12:15], v[32:35]
    ds_read_b64_tr_b16 a[30:31], v133 offset:23136
    v_mfma_f32_16x16x32_bf16 v[16:19], a[52:55], a[8:11], v[16:19]
    ds_read_b64_tr_b16 a[32:33], v133 offset:20608
    v_mfma_f32_16x16x32_bf16 v[36:39], a[52:55], a[12:15], v[36:39]
    ds_read_b64_tr_b16 a[34:35], v133 offset:23168
    s_waitcnt lgkmcnt(0)
    v_mfma_f32_16x16x32_bf16 v[0:3], a[16:19], a[0:3], v[0:3]
    ds_read_b128 a[8:11], v135 offset:16384
    ds_read_b128 a[12:15], v135 offset:18432
    v_mfma_f32_16x16x32_bf16 v[20:23], a[16:19], a[4:7], v[20:23]
    ds_read_b64_tr_b16 a[36:37], v133 offset:25600
    v_mfma_f32_16x16x32_bf16 v[4:7], a[20:23], a[0:3], v[4:7]
    ds_read_b64_tr_b16 a[38:39], v133 offset:28160
    v_mfma_f32_16x16x32_bf16 v[24:27], a[20:23], a[4:7], v[24:27]
    ds_read_b64_tr_b16 a[40:41], v133 offset:25632
    v_mfma_f32_16x16x32_bf16 v[8:11], a[24:27], a[0:3], v[8:11]
    ds_read_b64_tr_b16 a[42:43], v133 offset:28192
    v_mfma_f32_16x16x32_bf16 v[28:31], a[24:27], a[4:7], v[28:31]
    ds_read_b64_tr_b16 a[44:45], v133 offset:25664
    ds_read_b64_tr_b16 a[46:47], v133 offset:28224
    v_mfma_f32_16x16x32_bf16 v[12:15], a[28:31], a[0:3], v[12:15]
    ds_read_b64_tr_b16 a[48:49], v133 offset:25696
    v_mfma_f32_16x16x32_bf16 v[32:35], a[28:31], a[4:7], v[32:35]
    ds_read_b64_tr_b16 a[50:51], v133 offset:28256
    v_mfma_f32_16x16x32_bf16 v[16:19], a[32:35], a[0:3], v[16:19]
    ds_read_b64_tr_b16 a[52:53], v133 offset:25728
    v_mfma_f32_16x16x32_bf16 v[36:39], a[32:35], a[4:7], v[36:39]
    ds_read_b64_tr_b16 a[54:55], v133 offset:28288
    s_barrier
    s_waitcnt lgkmcnt(0)
    v_mfma_f32_16x16x32_bf16 v[0:3], a[36:39], a[8:11], v[0:3]
    ds_read_b128 a[0:3], v134 offset:32768
    ds_read_b128 a[4:7], v134 offset:34816
    v_mfma_f32_16x16x32_bf16 v[20:23], a[36:39], a[12:15], v[20:23]
    ds_read_b64_tr_b16 a[16:17], v133 offset:30720
    v_mfma_f32_16x16x32_bf16 v[4:7], a[40:43], a[8:11], v[4:7]
    ds_read_b64_tr_b16 a[18:19], v133 offset:33280
    v_mfma_f32_16x16x32_bf16 v[24:27], a[40:43], a[12:15], v[24:27]
    ds_read_b64_tr_b16 a[20:21], v133 offset:30752
    v_mfma_f32_16x16x32_bf16 v[8:11], a[44:47], a[8:11], v[8:11]
    ds_read_b64_tr_b16 a[22:23], v133 offset:33312
    v_mfma_f32_16x16x32_bf16 v[28:31], a[44:47], a[12:15], v[28:31]
    ds_read_b64_tr_b16 a[24:25], v133 offset:30784
    ds_read_b64_tr_b16 a[26:27], v133 offset:33344
    v_mfma_f32_16x16x32_bf16 v[12:15], a[48:51], a[8:11], v[12:15]
    ds_read_b64_tr_b16 a[28:29], v133 offset:30816
    v_mfma_f32_16x16x32_bf16 v[32:35], a[48:51], a[12:15], v[32:35]
    ds_read_b64_tr_b16 a[30:31], v133 offset:33376
    v_mfma_f32_16x16x32_bf16 v[16:19], a[52:55], a[8:11], v[16:19]
    ds_read_b64_tr_b16 a[32:33], v133 offset:30848
    v_mfma_f32_16x16x32_bf16 v[36:39], a[52:55], a[12:15], v[36:39]
    ds_read_b64_tr_b16 a[34:35], v133 offset:33408
    s_waitcnt lgkmcnt(0)
    v_mfma_f32_16x16x32_bf16 v[0:3], a[16:19], a[0:3], v[0:3]
    ds_read_b128 a[8:11], v135 offset:32768
    ds_read_b128 a[12:15], v135 offset:34816
    v_mfma_f32_16x16x32_bf16 v[20:23], a[16:19], a[4:7], v[20:23]
    ds_read_b64_tr_b16 a[36:37], v133 offset:35840
    v_mfma_f32_16x16x32_bf16 v[4:7], a[20:23], a[0:3], v[4:7]
    ds_read_b64_tr_b16 a[38:39], v133 offset:38400
    v_mfma_f32_16x16x32_bf16 v[24:27], a[20:23], a[4:7], v[24:27]
    ds_read_b64_tr_b16 a[40:41], v133 offset:35872
    v_mfma_f32_16x16x32_bf16 v[8:11], a[24:27], a[0:3], v[8:11]
    ds_read_b64_tr_b16 a[42:43], v133 offset:38432
    v_mfma_f32_16x16x32_bf16 v[28:31], a[24:27], a[4:7], v[28:31]
    ds_read_b64_tr_b16 a[44:45], v133 offset:35904
    ds_read_b64_tr_b16 a[46:47], v133 offset:38464
    v_mfma_f32_16x16x32_bf16 v[12:15], a[28:31], a[0:3], v[12:15]
    ds_read_b64_tr_b16 a[48:49], v133 offset:35936
    v_mfma_f32_16x16x32_bf16 v[32:35], a[28:31], a[4:7], v[32:35]
    ds_read_b64_tr_b16 a[50:51], v133 offset:38496
    v_mfma_f32_16x16x32_bf16 v[16:19], a[32:35], a[0:3], v[16:19]
    ds_read_b64_tr_b16 a[52:53], v133 offset:35968
    v_mfma_f32_16x16x32_bf16 v[36:39], a[32:35], a[4:7], v[36:39]
    ds_read_b64_tr_b16 a[54:55], v133 offset:38528
    s_barrier
    s_waitcnt lgkmcnt(0)
    v_mfma_f32_16x16x32_bf16 v[0:3], a[36:39], a[8:11], v[0:3]
    ds_read_b128 a[0:3], v134 offset:53248
    ds_read_b128 a[4:7], v134 offset:55296
    v_mfma_f32_16x16x32_bf16 v[20:23], a[36:39], a[12:15], v[20:23]
    ds_read_b64_tr_b16 a[16:17], v133 offset:0
    v_mfma_f32_16x16x32_bf16 v[4:7], a[40:43], a[8:11], v[4:7]
    ds_read_b64_tr_b16 a[18:19], v133 offset:2560
    v_mfma_f32_16x16x32_bf16 v[24:27], a[40:43], a[12:15], v[24:27]
    ds_read_b64_tr_b16 a[20:21], v133 offset:32
    v_mfma_f32_16x16x32_bf16 v[8:11], a[44:47], a[8:11], v[8:11]
    ds_read_b64_tr_b16 a[22:23], v133 offset:2592
    v_mfma_f32_16x16x32_bf16 v[28:31], a[44:47], a[12:15], v[28:31]
    ds_read_b64_tr_b16 a[24:25], v133 offset:64
    ds_read_b64_tr_b16 a[26:27], v133 offset:2624
    v_mfma_f32_16x16x32_bf16 v[12:15], a[48:51], a[8:11], v[12:15]
    ds_read_b64_tr_b16 a[28:29], v133 offset:96
    v_mfma_f32_16x16x32_bf16 v[32:35], a[48:51], a[12:15], v[32:35]
    ds_read_b64_tr_b16 a[30:31], v133 offset:2656
    v_mfma_f32_16x16x32_bf16 v[16:19], a[52:55], a[8:11], v[16:19]
    ds_read_b64_tr_b16 a[32:33], v133 offset:128
    v_mfma_f32_16x16x32_bf16 v[36:39], a[52:55], a[12:15], v[36:39]
    ds_read_b64_tr_b16 a[34:35], v133 offset:2688
    s_waitcnt lgkmcnt(0)
    v_mfma_f32_16x16x32_bf16 v[0:3], a[16:19], a[0:3], v[0:3]
    ds_read_b128 a[8:11], v135 offset:53248
    ds_read_b128 a[12:15], v135 offset:55296
    v_mfma_f32_16x16x32_bf16 v[20:23], a[16:19], a[4:7], v[20:23]
    ds_read_b64_tr_b16 a[36:37], v133 offset:5120
    v_mfma_f32_16x16x32_bf16 v[4:7], a[20:23], a[0:3], v[4:7]
    ds_read_b64_tr_b16 a[38:39], v133 offset:7680
    v_mfma_f32_16x16x32_bf16 v[24:27], a[20:23], a[4:7], v[24:27]
    ds_read_b64_tr_b16 a[40:41], v133 offset:5152
    v_mfma_f32_16x16x32_bf16 v[8:11], a[24:27], a[0:3], v[8:11]
    ds_read_b64_tr_b16 a[42:43], v133 offset:7712
    v_mfma_f32_16x16x32_bf16 v[28:31], a[24:27], a[4:7], v[28:31]
    ds_read_b64_tr_b16 a[44:45], v133 offset:5184
    ds_read_b64_tr_b16 a[46:47], v133 offset:7744
    v_mfma_f32_16x16x32_bf16 v[12:15], a[28:31], a[0:3], v[12:15]
    ds_read_b64_tr_b16 a[48:49], v133 offset:5216
    v_mfma_f32_16x16x32_bf16 v[32:35], a[28:31], a[4:7], v[32:35]
    ds_read_b64_tr_b16 a[50:51], v133 offset:7776
    v_mfma_f32_16x16x32_bf16 v[16:19], a[32:35], a[0:3], v[16:19]
    ds_read_b64_tr_b16 a[52:53], v133 offset:5248
    v_mfma_f32_16x16x32_bf16 v[36:39], a[32:35], a[4:7], v[36:39]
    ds_read_b64_tr_b16 a[54:55], v133 offset:7808
    s_barrier
    s_waitcnt lgkmcnt(0)
    v_mfma_f32_16x16x32_bf16 v[0:3], a[36:39], a[8:11], v[0:3]
    ds_read_b128 a[0:3], v134 offset:0
    ds_read_b128 a[4:7], v134 offset:2048
    v_mfma_f32_16x16x32_bf16 v[20:23], a[36:39], a[12:15], v[20:23]
    ds_read_b64_tr_b16 a[16:17], v133 offset:10240
    v_mfma_f32_16x16x32_bf16 v[4:7], a[40:43], a[8:11], v[4:7]
    ds_read_b64_tr_b16 a[18:19], v133 offset:12800
    v_mfma_f32_16x16x32_bf16 v[24:27], a[40:43], a[12:15], v[24:27]
    ds_read_b64_tr_b16 a[20:21], v133 offset:10272
    v_mfma_f32_16x16x32_bf16 v[8:11], a[44:47], a[8:11], v[8:11]
    ds_read_b64_tr_b16 a[22:23], v133 offset:12832
    v_mfma_f32_16x16x32_bf16 v[28:31], a[44:47], a[12:15], v[28:31]
    ds_read_b64_tr_b16 a[24:25], v133 offset:10304
    ds_read_b64_tr_b16 a[26:27], v133 offset:12864
    v_mfma_f32_16x16x32_bf16 v[12:15], a[48:51], a[8:11], v[12:15]
    ds_read_b64_tr_b16 a[28:29], v133 offset:10336
    v_mfma_f32_16x16x32_bf16 v[32:35], a[48:51], a[12:15], v[32:35]
    ds_read_b64_tr_b16 a[30:31], v133 offset:12896
    v_mfma_f32_16x16x32_bf16 v[16:19], a[52:55], a[8:11], v[16:19]
    ds_read_b64_tr_b16 a[32:33], v133 offset:10368
    v_mfma_f32_16x16x32_bf16 v[36:39], a[52:55], a[12:15], v[36:39]
    ds_read_b64_tr_b16 a[34:35], v133 offset:12928
    s_waitcnt lgkmcnt(0)
    v_mfma_f32_16x16x32_bf16 v[0:3], a[16:19], a[0:3], v[0:3]
    ds_read_b128 a[8:11], v135 offset:0
    ds_read_b128 a[12:15], v135 offset:2048
    v_mfma_f32_16x16x32_bf16 v[20:23], a[16:19], a[4:7], v[20:23]
    ds_read_b64_tr_b16 a[36:37], v133 offset:15360
    v_mfma_f32_16x16x32_bf16 v[4:7], a[20:23], a[0:3], v[4:7]
    ds_read_b64_tr_b16 a[38:39], v133 offset:17920
    v_mfma_f32_16x16x32_bf16 v[24:27], a[20:23], a[4:7], v[24:27]
    ds_read_b64_tr_b16 a[40:41], v133 offset:15392
    v_mfma_f32_16x16x32_bf16 v[8:11], a[24:27], a[0:3], v[8:11]
    ds_read_b64_tr_b16 a[42:43], v133 offset:17952
    v_mfma_f32_16x16x32_bf16 v[28:31], a[24:27], a[4:7], v[28:31]
    ds_read_b64_tr_b16 a[44:45], v133 offset:15424
    ds_read_b64_tr_b16 a[46:47], v133 offset:17984
    v_mfma_f32_16x16x32_bf16 v[12:15], a[28:31], a[0:3], v[12:15]
    ds_read_b64_tr_b16 a[48:49], v133 offset:15456
    v_mfma_f32_16x16x32_bf16 v[32:35], a[28:31], a[4:7], v[32:35]
    ds_read_b64_tr_b16 a[50:51], v133 offset:18016
    v_mfma_f32_16x16x32_bf16 v[16:19], a[32:35], a[0:3], v[16:19]
    ds_read_b64_tr_b16 a[52:53], v133 offset:15488
    v_mfma_f32_16x16x32_bf16 v[36:39], a[32:35], a[4:7], v[36:39]
    ds_read_b64_tr_b16 a[54:55], v133 offset:18048
    s_barrier
    s_waitcnt vmcnt(0)
    s_mov_b32 s13, 0
nz_1:
    v_readfirstlane_b32 s9, v140
    s_add_u32 s13, s13, 1
    s_cmp_lg_u32 s9, 0
    s_cbranch_scc1 nd_2
    s_cmp_gt_u32 s13, 131072
    s_cbranch_scc1 nd_2
    s_sleep 4
    buffer_load_dword v140, v141, s[88:91], 0 offen sc1
    s_waitcnt vmcnt(0)
    s_branch nz_1
nd_2:
    v_mov_b32 v120, 163808
    v_mov_b32 v121, 1
    s_mov_b64 exec, 1
    ds_add_rtn_u32 v121, v120, v121
    s_waitcnt lgkmcnt(0)
    v_readfirstlane_b32 s13, v121
    s_nop 0
    s_cmp_lg_u32 s13, 3
    s_cbranch_scc1 arr_3
    s_lshl_b32 s11, s5, 4
    s_lshl_b32 s12, s6, 3
    s_add_u32 s11, s11, s12
    s_add_u32 s11, s11, s7
    s_lshl_b32 s11, s11, 7
    s_add_u32 s11, s11, 4096
    v_mov_b32 v120, s9
    v_mov_b32 v121, 0
    buffer_store_dword v120, v121, s[52:55], s11 offen sc1
arr_3:
    s_mov_b64 exec, -1
    v_mfma_f32_16x16x32_bf16 v[0:3], a[36:39], a[8:11], v[0:3]
    ds_read_b128 a[0:3], v134 offset:16384
    ds_read_b128 a[4:7], v134 offset:18432
    v_mfma_f32_16x16x32_bf16 v[20:23], a[36:39], a[12:15], v[20:23]
    ds_read_b64_tr_b16 a[16:17], v133 offset:20480
    v_mfma_f32_16x16x32_bf16 v[4:7], a[40:43], a[8:11], v[4:7]
    ds_read_b64_tr_b16 a[18:19], v133 offset:23040
    v_mfma_f32_16x16x32_bf16 v[24:27], a[40:43], a[12:15], v[24:27]
    ds_read_b64_tr_b16 a[20:21], v133 offset:20512
    v_mfma_f32_16x16x32_bf16 v[8:11], a[44:47], a[8:11], v[8:11]
    ds_read_b64_tr_b16 a[22:23], v133 offset:23072
    v_mfma_f32_16x16x32_bf16 v[28:31], a[44:47], a[12:15], v[28:31]
    ds_read_b64_tr_b16 a[24:25], v133 offset:20544
    ds_read_b64_tr_b16 a[26:27], v133 offset:23104
    v_mfma_f32_16x16x32_bf16 v[12:15], a[48:51], a[8:11], v[12:15]
    ds_read_b64_tr_b16 a[28:29], v133 offset:20576
    v_mfma_f32_16x16x32_bf16 v[32:35], a[48:51], a[12:15], v[32:35]
    ds_read_b64_tr_b16 a[30:31], v133 offset:23136
    v_mfma_f32_16x16x32_bf16 v[16:19], a[52:55], a[8:11], v[16:19]
    ds_read_b64_tr_b16 a[32:33], v133 offset:20608
    v_mfma_f32_16x16x32_bf16 v[36:39], a[52:55], a[12:15], v[36:39]
    ds_read_b64_tr_b16 a[34:35], v133 offset:23168
    s_waitcnt lgkmcnt(0)
    v_mfma_f32_16x16x32_bf16 v[0:3], a[16:19], a[0:3], v[0:3]
    ds_read_b128 a[8:11], v135 offset:16384
    ds_read_b128 a[12:15], v135 offset:18432
    v_mfma_f32_16x16x32_bf16 v[20:23], a[16:19], a[4:7], v[20:23]
    ds_read_b64_tr_b16 a[36:37], v133 offset:25600
    v_mfma_f32_16x16x32_bf16 v[4:7], a[20:23], a[0:3], v[4:7]
    ds_read_b64_tr_b16 a[38:39], v133 offset:28160
    v_mfma_f32_16x16x32_bf16 v[24:27], a[20:23], a[4:7], v[24:27]
    ds_read_b64_tr_b16 a[40:41], v133 offset:25632
    v_mfma_f32_16x16x32_bf16 v[8:11], a[24:27], a[0:3], v[8:11]
    ds_read_b64_tr_b16 a[42:43], v133 offset:28192
    v_mfma_f32_16x16x32_bf16 v[28:31], a[24:27], a[4:7], v[28:31]
    ds_read_b64_tr_b16 a[44:45], v133 offset:25664
    ds_read_b64_tr_b16 a[46:47], v133 offset:28224
    v_mfma_f32_16x16x32_bf16 v[12:15], a[28:31], a[0:3], v[12:15]
    ds_read_b64_tr_b16 a[48:49], v133 offset:25696
    v_mfma_f32_16x16x32_bf16 v[32:35], a[28:31], a[4:7], v[32:35]
    ds_read_b64_tr_b16 a[50:51], v133 offset:28256
    v_mfma_f32_16x16x32_bf16 v[16:19], a[32:35], a[0:3], v[16:19]
    ds_read_b64_tr_b16 a[52:53], v133 offset:25728
    v_mfma_f32_16x16x32_bf16 v[36:39], a[32:35], a[4:7], v[36:39]
    ds_read_b64_tr_b16 a[54:55], v133 offset:28288
    s_barrier
    s_waitcnt lgkmcnt(0)
    v_mfma_f32_16x16x32_bf16 v[0:3], a[36:39], a[8:11], v[0:3]
    ds_read_b128 a[0:3], v134 offset:32768
    ds_read_b128 a[4:7], v134 offset:34816
    v_mfma_f32_16x16x32_bf16 v[20:23], a[36:39], a[12:15], v[20:23]
    ds_read_b64_tr_b16 a[16:17], v133 offset:30720
    v_mfma_f32_16x16x32_bf16 v[4:7], a[40:43], a[8:11], v[4:7]
    ds_read_b64_tr_b16 a[18:19], v133 offset:33280
    v_mfma_f32_16x16x32_bf16 v[24:27], a[40:43], a[12:15], v[24:27]
    ds_read_b64_tr_b16 a[20:21], v133 offset:30752
    v_mfma_f32_16x16x32_bf16 v[8:11], a[44:47], a[8:11], v[8:11]
    ds_read_b64_tr_b16 a[22:23], v133 offset:33312
    v_mfma_f32_16x16x32_bf16 v[28:31], a[44:47], a[12:15], v[28:31]
    ds_read_b64_tr_b16 a[24:25], v133 offset:30784
    ds_read_b64_tr_b16 a[26:27], v133 offset:33344
    v_mfma_f32_16x16x32_bf16 v[12:15], a[48:51], a[8:11], v[12:15]
    ds_read_b64_tr_b16 a[28:29], v133 offset:30816
    v_mfma_f32_16x16x32_bf16 v[32:35], a[48:51], a[12:15], v[32:35]
    ds_read_b64_tr_b16 a[30:31], v133 offset:33376
    v_mfma_f32_16x16x32_bf16 v[16:19], a[52:55], a[8:11], v[16:19]
    ds_read_b64_tr_b16 a[32:33], v133 offset:30848
    v_mfma_f32_16x16x32_bf16 v[36:39], a[52:55], a[12:15], v[36:39]
    ds_read_b64_tr_b16 a[34:35], v133 offset:33408
    s_waitcnt lgkmcnt(0)
    v_mfma_f32_16x16x32_bf16 v[0:3], a[16:19], a[0:3], v[0:3]
    ds_read_b128 a[8:11], v135 offset:32768
    ds_read_b128 a[12:15], v135 offset:34816
    v_mfma_f32_16x16x32_bf16 v[20:23], a[16:19], a[4:7], v[20:23]
    ds_read_b64_tr_b16 a[36:37], v133 offset:35840
    v_mfma_f32_16x16x32_bf16 v[4:7], a[20:23], a[0:3], v[4:7]
    ds_read_b64_tr_b16 a[38:39], v133 offset:38400
    v_mfma_f32_16x16x32_bf16 v[24:27], a[20:23], a[4:7], v[24:27]
    ds_read_b64_tr_b16 a[40:41], v133 offset:35872
    v_mfma_f32_16x16x32_bf16 v[8:11], a[24:27], a[0:3], v[8:11]
    ds_read_b64_tr_b16 a[42:43], v133 offset:38432
    v_mfma_f32_16x16x32_bf16 v[28:31], a[24:27], a[4:7], v[28:31]
    ds_read_b64_tr_b16 a[44:45], v133 offset:35904
    ds_read_b64_tr_b16 a[46:47], v133 offset:38464
    v_mfma_f32_16x16x32_bf16 v[12:15], a[28:31], a[0:3], v[12:15]
    ds_read_b64_tr_b16 a[48:49], v133 offset:35936
    v_mfma_f32_16x16x32_bf16 v[32:35], a[28:31], a[4:7], v[32:35]
    ds_read_b64_tr_b16 a[50:51], v133 offset:38496
    v_mfma_f32_16x16x32_bf16 v[16:19], a[32:35], a[0:3], v[16:19]
    ds_read_b64_tr_b16 a[52:53], v133 offset:35968
    v_mfma_f32_16x16x32_bf16 v[36:39], a[32:35], a[4:7], v[36:39]
    ds_read_b64_tr_b16 a[54:55], v133 offset:38528
    s_barrier
    s_waitcnt lgkmcnt(0)
    v_mfma_f32_16x16x32_bf16 v[0:3], a[36:39], a[8:11], v[0:3]
    ds_read_b128 a[0:3], v134 offset:53248
    ds_read_b128 a[4:7], v134 offset:55296
    v_mfma_f32_16x16x32_bf16 v[20:23], a[36:39], a[12:15], v[20:23]
    ds_read_b64_tr_b16 a[16:17], v133 offset:0
    v_mfma_f32_16x16x32_bf16 v[4:7], a[40:43], a[8:11], v[4:7]
    ds_read_b64_tr_b16 a[18:19], v133 offset:2560
    v_mfma_f32_16x16x32_bf16 v[24:27], a[40:43], a[12:15], v[24:27]
    ds_read_b64_tr_b16 a[20:21], v133 offset:32
    v_mfma_f32_16x16x32_bf16 v[8:11], a[44:47], a[8:11], v[8:11]
    ds_read_b64_tr_b16 a[22:23], v133 offset:2592
    v_mfma_f32_16x16x32_bf16 v[28:31], a[44:47], a[12:15], v[28:31]
    ds_read_b64_tr_b16 a[24:25], v133 offset:64
    ds_read_b64_tr_b16 a[26:27], v133 offset:2624
    v_mfma_f32_16x16x32_bf16 v[12:15], a[48:51], a[8:11], v[12:15]
    ds_read_b64_tr_b16 a[28:29], v133 offset:96
    v_mfma_f32_16x16x32_bf16 v[32:35], a[48:51], a[12:15], v[32:35]
    ds_read_b64_tr_b16 a[30:31], v133 offset:2656
    v_mfma_f32_16x16x32_bf16 v[16:19], a[52:55], a[8:11], v[16:19]
    ds_read_b64_tr_b16 a[32:33], v133 offset:128
    v_mfma_f32_16x16x32_bf16 v[36:39], a[52:55], a[12:15], v[36:39]
    ds_read_b64_tr_b16 a[34:35], v133 offset:2688
    s_waitcnt lgkmcnt(0)
    v_mfma_f32_16x16x32_bf16 v[0:3], a[16:19], a[0:3], v[0:3]
    ds_read_b128 a[8:11], v135 offset:53248
    ds_read_b128 a[12:15], v135 offset:55296
    v_mfma_f32_16x16x32_bf16 v[20:23], a[16:19], a[4:7], v[20:23]
    ds_read_b64_tr_b16 a[36:37], v133 offset:5120
    v_mfma_f32_16x16x32_bf16 v[4:7], a[20:23], a[0:3], v[4:7]
    ds_read_b64_tr_b16 a[38:39], v133 offset:7680
    v_mfma_f32_16x16x32_bf16 v[24:27], a[20:23], a[4:7], v[24:27]
    ds_read_b64_tr_b16 a[40:41], v133 offset:5152
    v_mfma_f32_16x16x32_bf16 v[8:11], a[24:27], a[0:3], v[8:11]
    ds_read_b64_tr_b16 a[42:43], v133 offset:7712
    v_mfma_f32_16x16x32_bf16 v[28:31], a[24:27], a[4:7], v[28:31]
    ds_read_b64_tr_b16 a[44:45], v133 offset:5184
    ds_read_b64_tr_b16 a[46:47], v133 offset:7744
    v_mfma_f32_16x16x32_bf16 v[12:15], a[28:31], a[0:3], v[12:15]
    ds_read_b64_tr_b16 a[48:49], v133 offset:5216
    v_mfma_f32_16x16x32_bf16 v[32:35], a[28:31], a[4:7], v[32:35]
    ds_read_b64_tr_b16 a[50:51], v133 offset:7776
    v_mfma_f32_16x16x32_bf16 v[16:19], a[32:35], a[0:3], v[16:19]
    ds_read_b64_tr_b16 a[52:53], v133 offset:5248
    v_mfma_f32_16x16x32_bf16 v[36:39], a[32:35], a[4:7], v[36:39]
    ds_read_b64_tr_b16 a[54:55], v133 offset:7808
    s_barrier
    s_waitcnt lgkmcnt(0)
    v_mfma_f32_16x16x32_bf16 v[0:3], a[36:39], a[8:11], v[0:3]
    ds_read_b128 a[0:3], v134 offset:0
    ds_read_b128 a[4:7], v134 offset:2048
    v_mfma_f32_16x16x32_bf16 v[20:23], a[36:39], a[12:15], v[20:23]
    ds_read_b64_tr_b16 a[16:17], v133 offset:10240
    v_mfma_f32_16x16x32_bf16 v[4:7], a[40:43], a[8:11], v[4:7]
    ds_read_b64_tr_b16 a[18:19], v133 offset:12800
    v_mfma_f32_16x16x32_bf16 v[24:27], a[40:43], a[12:15], v[24:27]
    ds_read_b64_tr_b16 a[20:21], v133 offset:10272
    v_mfma_f32_16x16x32_bf16 v[8:11], a[44:47], a[8:11], v[8:11]
    ds_read_b64_tr_b16 a[22:23], v133 offset:12832
    v_mfma_f32_16x16x32_bf16 v[28:31], a[44:47], a[12:15], v[28:31]
    ds_read_b64_tr_b16 a[24:25], v133 offset:10304
    ds_read_b64_tr_b16 a[26:27], v133 offset:12864
    v_mfma_f32_16x16x32_bf16 v[12:15], a[48:51], a[8:11], v[12:15]
    ds_read_b64_tr_b16 a[28:29], v133 offset:10336
    v_mfma_f32_16x16x32_bf16 v[32:35], a[48:51], a[12:15], v[32:35]
    ds_read_b64_tr_b16 a[30:31], v133 offset:12896
    v_mfma_f32_16x16x32_bf16 v[16:19], a[52:55], a[8:11], v[16:19]
    ds_read_b64_tr_b16 a[32:33], v133 offset:10368
    v_mfma_f32_16x16x32_bf16 v[36:39], a[52:55], a[12:15], v[36:39]
    ds_read_b64_tr_b16 a[34:35], v133 offset:12928
    s_waitcnt lgkmcnt(0)
    v_mfma_f32_16x16x32_bf16 v[0:3], a[16:19], a[0:3], v[0:3]
    ds_read_b128 a[8:11], v135 offset:0
    ds_read_b128 a[12:15], v135 offset:2048
    v_mfma_f32_16x16x32_bf16 v[20:23], a[16:19], a[4:7], v[20:23]
    ds_read_b64_tr_b16 a[36:37], v133 offset:15360
    v_mfma_f32_16x16x32_bf16 v[4:7], a[20:23], a[0:3], v[4:7]
    ds_read_b64_tr_b16 a[38:39], v133 offset:17920
    v_mfma_f32_16x16x32_bf16 v[24:27], a[20:23], a[4:7], v[24:27]
    ds_read_b64_tr_b16 a[40:41], v133 offset:15392
    v_mfma_f32_16x16x32_bf16 v[8:11], a[24:27], a[0:3], v[8:11]
    ds_read_b64_tr_b16 a[42:43], v133 offset:17952
    v_mfma_f32_16x16x32_bf16 v[28:31], a[24:27], a[4:7], v[28:31]
    ds_read_b64_tr_b16 a[44:45], v133 offset:15424
    ds_read_b64_tr_b16 a[46:47], v133 offset:17984
    v_mfma_f32_16x16x32_bf16 v[12:15], a[28:31], a[0:3], v[12:15]
    ds_read_b64_tr_b16 a[48:49], v133 offset:15456
    v_mfma_f32_16x16x32_bf16 v[32:35], a[28:31], a[4:7], v[32:35]
    ds_read_b64_tr_b16 a[50:51], v133 offset:18016
    v_mfma_f32_16x16x32_bf16 v[16:19], a[32:35], a[0:3], v[16:19]
    ds_read_b64_tr_b16 a[52:53], v133 offset:15488
    v_mfma_f32_16x16x32_bf16 v[36:39], a[32:35], a[4:7], v[36:39]
    ds_read_b64_tr_b16 a[54:55], v133 offset:18048
    s_waitcnt lgkmcnt(0)
    v_mfma_f32_16x16x32_bf16 v[0:3], a[36:39], a[8:11], v[0:3]
    ds_read_b64_tr_b16 a[56:57], v137 offset:0
    ds_read_b64_tr_b16 a[58:59], v137 offset:2560
    ds_read_b64_tr_b16 a[60:61], v137 offset:5120
    v_mfma_f32_16x16x32_bf16 v[20:23], a[36:39], a[12:15], v[20:23]
    ds_read_b64_tr_b16 a[62:63], v137 offset:7680
    ds_read_b64_tr_b16 a[64:65], v137 offset:10240
    ds_read_b64_tr_b16 a[66:67], v137 offset:12800
    v_mfma_f32_16x16x32_bf16 v[4:7], a[40:43], a[8:11], v[4:7]
    ds_read_b64_tr_b16 a[68:69], v137 offset:32
    ds_read_b64_tr_b16 a[70:71], v137 offset:2592
    ds_read_b64_tr_b16 a[72:73], v137 offset:5152
    v_mfma_f32_16x16x32_bf16 v[24:27], a[40:43], a[12:15], v[24:27]
    ds_read_b64_tr_b16 a[74:75], v137 offset:7712
    ds_read_b64_tr_b16 a[76:77], v137 offset:10272
    ds_read_b64_tr_b16 a[78:79], v137 offset:12832
    v_mfma_f32_16x16x32_bf16 v[8:11], a[44:47], a[8:11], v[8:11]
    ds_read_b64_tr_b16 a[80:81], v137 offset:64
    ds_read_b64_tr_b16 a[82:83], v137 offset:2624
    ds_read_b64_tr_b16 a[84:85], v137 offset:5184
    v_mfma_f32_16x16x32_bf16 v[28:31], a[44:47], a[12:15], v[28:31]
    ds_read_b64_tr_b16 a[86:87], v137 offset:7744
    ds_read_b64_tr_b16 a[88:89], v137 offset:10304
    ds_read_b64_tr_b16 a[90:91], v137 offset:12864
    v_mfma_f32_16x16x32_bf16 v[12:15], a[48:51], a[8:11], v[12:15]
    ds_read_b64_tr_b16 a[92:93], v137 offset:96
    ds_read_b64_tr_b16 a[94:95], v137 offset:2656
    ds_read_b64_tr_b16 a[96:97], v137 offset:5216
    v_mfma_f32_16x16x32_bf16 v[32:35], a[48:51], a[12:15], v[32:35]
    ds_read_b64_tr_b16 a[98:99], v137 offset:7776
    ds_read_b64_tr_b16 a[100:101], v137 offset:10336
    ds_read_b64_tr_b16 a[102:103], v137 offset:12896
    v_mfma_f32_16x16x32_bf16 v[16:19], a[52:55], a[8:11], v[16:19]
    ds_read_b64_tr_b16 a[104:105], v137 offset:128
    ds_read_b64_tr_b16 a[106:107], v137 offset:2688
    ds_read_b64_tr_b16 a[108:109], v137 offset:5248
    v_mfma_f32_16x16x32_bf16 v[36:39], a[52:55], a[12:15], v[36:39]
    ds_read_b64_tr_b16 a[110:111], v137 offset:7808
    ds_read_b64_tr_b16 a[16:17], v137 offset:10368
    ds_read_b64_tr_b16 a[18:19], v137 offset:12928
    v_cvt_pk_bf16_f32 v40, v0, v1
    v_cvt_pk_bf16_f32 v41, v2, v3
    v_cvt_pk_bf16_f32 v42, v4, v5
    v_cvt_pk_bf16_f32 v43, v6, v7
    v_cvt_pk_bf16_f32 v44, v8, v9
    v_cvt_pk_bf16_f32 v45, v10, v11
    v_cvt_pk_bf16_f32 v46, v12, v13
    v_cvt_pk_bf16_f32 v47, v14, v15
    v_cvt_pk_bf16_f32 v48, v16, v17
    v_cvt_pk_bf16_f32 v49, v18, v19
    v_mov_b32 v50, 0
    v_mov_b32 v51, 0
    v_cvt_pk_bf16_f32 v52, v20, v21
    v_cvt_pk_bf16_f32 v53, v22, v23
    v_cvt_pk_bf16_f32 v54, v24, v25
    v_cvt_pk_bf16_f32 v55, v26, v27
    v_cvt_pk_bf16_f32 v56, v28, v29
    v_cvt_pk_bf16_f32 v57, v30, v31
    v_cvt_pk_bf16_f32 v58, v32, v33
    v_cvt_pk_bf16_f32 v59, v34, v35
    v_cvt_pk_bf16_f32 v60, v36, v37
    v_cvt_pk_bf16_f32 v61, v38, v39
    v_mov_b32 v62, 0
    v_mov_b32 v63, 0
    s_waitcnt lgkmcnt(0)
    v_mfma_f32_16x16x32_bf16 v[64:67], a[56:59], v[40:43], 0
    v_mul_u32_u24 v133, 1728, v130
    v_mfma_f32_16x16x32_bf16 v[68:71], a[68:71], v[40:43], 0
    v_mul_u32_u24 v112, 80, v132
    v_mfma_f32_16x16x32_bf16 v[72:75], a[80:83], v[40:43], 0
    v_add_u32 v133, v133, v112
    v_mfma_f32_16x16x32_bf16 v[76:79], a[92:95], v[40:43], 0
    v_mov_b32 v112, 6912
    v_mfma_f32_16x16x32_bf16 v[80:83], a[104:107], v[40:43], 0
    v_cmp_eq_u32 vcc, v131, v130
    v_mfma_f32_16x16x32_bf16 v[64:67], a[60:63], v[44:47], v[64:67]
    s_nop 0
    v_cndmask_b32 v133, v112, v133, vcc
    v_mfma_f32_16x16x32_bf16 v[68:71], a[72:75], v[44:47], v[68:71]
    v_add_u32 v133, 151552, v133
    v_mfma_f32_16x16x32_bf16 v[72:75], a[84:87], v[44:47], v[72:75]
    v_lshrrev_b32 v112, 1, v130
    v_mfma_f32_16x16x32_bf16 v[76:79], a[96:99], v[44:47], v[76:79]
    v_and_b32 v113, 1, v130
    v_mfma_f32_16x16x32_bf16 v[80:83], a[108:111], v[44:47], v[80:83]
    v_lshlrev_b32 v134, 4, v129
    v_mfma_f32_16x16x32_bf16 v[64:67], a[64:67], v[48:51], v[64:67]
    v_lshl_add_u32 v135, v112, 8, v134
    v_mfma_f32_16x16x32_bf16 v[68:71], a[76:79], v[48:51], v[68:71]
    v_lshl_add_u32 v135, v113, 3, v135
    v_mfma_f32_16x16x32_bf16 v[72:75], a[88:91], v[48:51], v[72:75]
    v_lshl_add_u32 v134, v112, 10, v134
    v_mfma_f32_16x16x32_bf16 v[76:79], a[100:103], v[48:51], v[76:79]
    v_lshl_add_u32 v134, v113, 9, v134
    v_mfma_f32_16x16x32_bf16 v[80:83], a[16:19], v[48:51], v[80:83]
    v_mfma_f32_16x16x32_bf16 v[84:87], a[56:59], v[52:55], 0
    v_mfma_f32_16x16x32_bf16 v[88:91], a[68:71], v[52:55], 0
    v_mfma_f32_16x16x32_bf16 v[92:95], a[80:83], v[52:55], 0
    v_mfma_f32_16x16x32_bf16 v[96:99], a[92:95], v[52:55], 0
    v_mfma_f32_16x16x32_bf16 v[100:103], a[104:107], v[52:55], 0
    v_mfma_f32_16x16x32_bf16 v[84:87], a[60:63], v[56:59], v[84:87]
    v_mfma_f32_16x16x32_bf16 v[88:91], a[72:75], v[56:59], v[88:91]
    v_mfma_f32_16x16x32_bf16 v[92:95], a[84:87], v[56:59], v[92:95]
    v_mfma_f32_16x16x32_bf16 v[96:99], a[96:99], v[56:59], v[96:99]
    v_mfma_f32_16x16x32_bf16 v[100:103], a[108:111], v[56:59], v[100:103]
    v_mfma_f32_16x16x32_bf16 v[84:87], a[64:67], v[60:63], v[84:87]
    v_mfma_f32_16x16x32_bf16 v[88:91], a[76:79], v[60:63], v[88:91]
    v_mfma_f32_16x16x32_bf16 v[92:95], a[88:91], v[60:63], v[92:95]
    v_mfma_f32_16x16x32_bf16 v[96:99], a[100:103], v[60:63], v[96:99]
    v_mfma_f32_16x16x32_bf16 v[100:103], a[16:19], v[60:63], v[100:103]
    s_lshl_b32 s43, s5, 3
    s_lshl_b32 s11, s8, 1
    s_add_u32 s43, s43, s11
    s_mul_i32 s43, s43, 20480
    s_lshl_b32 s84, s7, 11
    s_add_u32 s84, s84, s43
    s_add_u32 s84, s84, 5754880
    s_lshr_b32 s85, s7, 1
    s_lshl_b32 s85, s85, 10
    s_and_b32 s11, s7, 1
    s_lshl_b32 s11, s11, 9
    s_add_u32 s85, s85, s11
    s_add_u32 s85, s85, s43
    s_add_u32 s85, s85, 5771264
    v_max3_f32 v104, v64, v65, v66
    v_min3_f32 v106, v64, v65, v66
    v_max3_f32 v105, v67, v68, v69
    v_min3_f32 v107, v67, v68, v69
    v_max3_f32 v104, v104, v70, v71
    v_min3_f32 v106, v106, v70, v71
    v_max3_f32 v105, v105, v72, v73
    v_min3_f32 v107, v107, v72, v73
    v_max3_f32 v104, v104, v74, v75
    v_min3_f32 v106, v106, v74, v75
    v_max3_f32 v105, v105, v76, v77
    v_min3_f32 v107, v107, v76, v77
    v_max3_f32 v104, v104, v78, v79
    v_min3_f32 v106, v106, v78, v79
    v_max3_f32 v105, v105, v80, v81
    v_min3_f32 v107, v107, v80, v81
    v_max3_f32 v104, v104, v82, v83
    v_min3_f32 v106, v106, v82, v83
    v_max_f32 v104, v104, v105
    v_min_f32 v106, v106, v107
    v_mul_f32 v104, s66, v104
    v_mul_f32 v106, s64, v106
    v_pk_fma_f32 v[0:1], v[64:65], s[64:65], v[104:105] op_sel_hi:[1,1,0]
    v_pk_fma_f32 v[20:21], v[64:65], s[66:67], v[106:107] op_sel_hi:[1,1,0]
    v_pk_fma_f32 v[2:3], v[66:67], s[64:65], v[104:105] op_sel_hi:[1,1,0]
    v_pk_fma_f32 v[22:23], v[66:67], s[66:67], v[106:107] op_sel_hi:[1,1,0]
    v_pk_fma_f32 v[4:5], v[68:69], s[64:65], v[104:105] op_sel_hi:[1,1,0]
    v_pk_fma_f32 v[24:25], v[68:69], s[66:67], v[106:107] op_sel_hi:[1,1,0]
    v_pk_fma_f32 v[6:7], v[70:71], s[64:65], v[104:105] op_sel_hi:[1,1,0]
    v_pk_fma_f32 v[26:27], v[70:71], s[66:67], v[106:107] op_sel_hi:[1,1,0]
    v_pk_fma_f32 v[8:9], v[72:73], s[64:65], v[104:105] op_sel_hi:[1,1,0]
    v_pk_fma_f32 v[28:29], v[72:73], s[66:67], v[106:107] op_sel_hi:[1,1,0]
    v_pk_fma_f32 v[10:11], v[74:75], s[64:65], v[104:105] op_sel_hi:[1,1,0]
    v_pk_fma_f32 v[30:31], v[74:75], s[66:67], v[106:107] op_sel_hi:[1,1,0]
    v_pk_fma_f32 v[12:13], v[76:77], s[64:65], v[104:105] op_sel_hi:[1,1,0]
    v_pk_fma_f32 v[32:33], v[76:77], s[66:67], v[106:107] op_sel_hi:[1,1,0]
    v_pk_fma_f32 v[14:15], v[78:79], s[64:65], v[104:105] op_sel_hi:[1,1,0]
    v_pk_fma_f32 v[34:35], v[78:79], s[66:67], v[106:107] op_sel_hi:[1,1,0]
    v_pk_fma_f32 v[16:17], v[80:81], s[64:65], v[104:105] op_sel_hi:[1,1,0]
    v_pk_fma_f32 v[36:37], v[80:81], s[66:67], v[106:107] op_sel_hi:[1,1,0]
    v_pk_fma_f32 v[18:19], v[82:83], s[64:65], v[104:105] op_sel_hi:[1,1,0]
    v_pk_fma_f32 v[38:39], v[82:83], s[66:67], v[106:107] op_sel_hi:[1,1,0]
    v_exp_f32 v0, v0
    v_exp_f32 v1, v1
    v_exp_f32 v2, v2
    v_exp_f32 v3, v3
    v_exp_f32 v4, v4
    v_exp_f32 v5, v5
    v_exp_f32 v6, v6
    v_exp_f32 v7, v7
    v_exp_f32 v8, v8
    v_exp_f32 v9, v9
    v_exp_f32 v10, v10
    v_exp_f32 v11, v11
    v_exp_f32 v12, v12
    v_exp_f32 v13, v13
    v_exp_f32 v14, v14
    v_exp_f32 v15, v15
    v_exp_f32 v16, v16
    v_exp_f32 v17, v17
    v_exp_f32 v18, v18
    v_exp_f32 v19, v19
    v_exp_f32 v20, v20
    v_exp_f32 v21, v21
    v_exp_f32 v22, v22
    v_exp_f32 v23, v23
    v_exp_f32 v24, v24
    v_exp_f32 v25, v25
    v_exp_f32 v26, v26
    v_exp_f32 v27, v27
    v_exp_f32 v28, v28
    v_exp_f32 v29, v29
    v_exp_f32 v30, v30
    v_exp_f32 v31, v31
    v_exp_f32 v32, v32
    v_exp_f32 v33, v33
    v_exp_f32 v34, v34
    v_exp_f32 v35, v35
    v_exp_f32 v36, v36
    v_exp_f32 v37, v37
    v_exp_f32 v38, v38
    v_exp_f32 v39, v39
    v_pk_add_f32 v[108:109], v[0:1], v[2:3]
    v_pk_add_f32 v[110:111], v[20:21], v[22:23]
    v_pk_add_f32 v[104:105], v[4:5], v[6:7]
    v_pk_add_f32 v[106:107], v[24:25], v[26:27]
    v_pk_add_f32 v[108:109], v[108:109], v[8:9]
    v_pk_add_f32 v[110:111], v[110:111], v[28:29]
    v_pk_add_f32 v[104:105], v[104:105], v[10:11]
    v_pk_add_f32 v[106:107], v[106:107], v[30:31]
    v_pk_add_f32 v[108:109], v[108:109], v[12:13]
    v_pk_add_f32 v[110:111], v[110:111], v[32:33]
    v_pk_add_f32 v[104:105], v[104:105], v[14:15]
    v_pk_add_f32 v[106:107], v[106:107], v[34:35]
    v_pk_add_f32 v[108:109], v[108:109], v[16:17]
    v_pk_add_f32 v[110:111], v[110:111], v[36:37]
    v_pk_add_f32 v[104:105], v[104:105], v[18:19]
    v_pk_add_f32 v[106:107], v[106:107], v[38:39]
    v_pk_add_f32 v[108:109], v[108:109], v[104:105]
    v_pk_add_f32 v[110:111], v[110:111], v[106:107]
    v_add_f32 v108, v108, v109
    v_add_f32 v110, v110, v111
    v_rcp_f32 v108, v108
    v_rcp_f32 v110, v110
    v_pk_mul_f32 v[0:1], v[0:1], v[108:109] op_sel_hi:[1,0]
    v_pk_mul_f32 v[20:21], v[20:21], v[110:111] op_sel_hi:[1,0]
    v_pk_mul_f32 v[2:3], v[2:3], v[108:109] op_sel_hi:[1,0]
    v_pk_mul_f32 v[22:23], v[22:23], v[110:111] op_sel_hi:[1,0]
    v_pk_mul_f32 v[4:5], v[4:5], v[108:109] op_sel_hi:[1,0]
    v_pk_mul_f32 v[24:25], v[24:25], v[110:111] op_sel_hi:[1,0]
    v_pk_mul_f32 v[6:7], v[6:7], v[108:109] op_sel_hi:[1,0]
    v_pk_mul_f32 v[26:27], v[26:27], v[110:111] op_sel_hi:[1,0]
    v_pk_mul_f32 v[8:9], v[8:9], v[108:109] op_sel_hi:[1,0]
    v_pk_mul_f32 v[28:29], v[28:29], v[110:111] op_sel_hi:[1,0]
    v_pk_mul_f32 v[10:11], v[10:11], v[108:109] op_sel_hi:[1,0]
    v_pk_mul_f32 v[30:31], v[30:31], v[110:111] op_sel_hi:[1,0]
    v_pk_mul_f32 v[12:13], v[12:13], v[108:109] op_sel_hi:[1,0]
    v_pk_mul_f32 v[32:33], v[32:33], v[110:111] op_sel_hi:[1,0]
    v_pk_mul_f32 v[14:15], v[14:15], v[108:109] op_sel_hi:[1,0]
    v_pk_mul_f32 v[34:35], v[34:35], v[110:111] op_sel_hi:[1,0]
    v_pk_mul_f32 v[16:17], v[16:17], v[108:109] op_sel_hi:[1,0]
    v_pk_mul_f32 v[36:37], v[36:37], v[110:111] op_sel_hi:[1,0]
    v_pk_mul_f32 v[18:19], v[18:19], v[108:109] op_sel_hi:[1,0]
    v_pk_mul_f32 v[38:39], v[38:39], v[110:111] op_sel_hi:[1,0]
    v_cvt_pk_bf16_f32 v64, v0, v1
    v_cvt_pk_bf16_f32 v65, v2, v3
    v_cvt_pk_bf16_f32 v66, v4, v5
    v_cvt_pk_bf16_f32 v67, v6, v7
    v_cvt_pk_bf16_f32 v68, v8, v9
    v_cvt_pk_bf16_f32 v69, v10, v11
    v_cvt_pk_bf16_f32 v70, v12, v13
    v_cvt_pk_bf16_f32 v71, v14, v15
    v_cvt_pk_bf16_f32 v72, v16, v17
    v_cvt_pk_bf16_f32 v73, v18, v19
    v_cvt_pk_bf16_f32 v74, v20, v21
    v_cvt_pk_bf16_f32 v75, v22, v23
    v_cvt_pk_bf16_f32 v76, v24, v25
    v_cvt_pk_bf16_f32 v77, v26, v27
    v_cvt_pk_bf16_f32 v78, v28, v29
    v_cvt_pk_bf16_f32 v79, v30, v31
    v_cvt_pk_bf16_f32 v80, v32, v33
    v_cvt_pk_bf16_f32 v81, v34, v35
    v_cvt_pk_bf16_f32 v82, v36, v37
    v_cvt_pk_bf16_f32 v83, v38, v39
    v_max3_f32 v104, v84, v85, v86
    v_min3_f32 v106, v84, v85, v86
    v_max3_f32 v105, v87, v88, v89
    v_min3_f32 v107, v87, v88, v89
    v_max3_f32 v104, v104, v90, v91
    v_min3_f32 v106, v106, v90, v91
    v_max3_f32 v105, v105, v92, v93
    v_min3_f32 v107, v107, v92, v93
    v_max3_f32 v104, v104, v94, v95
    v_min3_f32 v106, v106, v94, v95
    v_max3_f32 v105, v105, v96, v97
    v_min3_f32 v107, v107, v96, v97
    v_max3_f32 v104, v104, v98, v99
    v_min3_f32 v106, v106, v98, v99
    v_max3_f32 v105, v105, v100, v101
    v_min3_f32 v107, v107, v100, v101
    v_max3_f32 v104, v104, v102, v103
    v_min3_f32 v106, v106, v102, v103
    v_max_f32 v104, v104, v105
    v_min_f32 v106, v106, v107
    v_mul_f32 v104, s66, v104
    v_mul_f32 v106, s64, v106
    v_pk_fma_f32 v[0:1], v[84:85], s[64:65], v[104:105] op_sel_hi:[1,1,0]
    v_pk_fma_f32 v[20:21], v[84:85], s[66:67], v[106:107] op_sel_hi:[1,1,0]
    v_pk_fma_f32 v[2:3], v[86:87], s[64:65], v[104:105] op_sel_hi:[1,1,0]
    v_pk_fma_f32 v[22:23], v[86:87], s[66:67], v[106:107] op_sel_hi:[1,1,0]
    v_pk_fma_f32 v[4:5], v[88:89], s[64:65], v[104:105] op_sel_hi:[1,1,0]
    v_pk_fma_f32 v[24:25], v[88:89], s[66:67], v[106:107] op_sel_hi:[1,1,0]
    v_pk_fma_f32 v[6:7], v[90:91], s[64:65], v[104:105] op_sel_hi:[1,1,0]
    v_pk_fma_f32 v[26:27], v[90:91], s[66:67], v[106:107] op_sel_hi:[1,1,0]
    v_pk_fma_f32 v[8:9], v[92:93], s[64:65], v[104:105] op_sel_hi:[1,1,0]
    v_pk_fma_f32 v[28:29], v[92:93], s[66:67], v[106:107] op_sel_hi:[1,1,0]
    v_pk_fma_f32 v[10:11], v[94:95], s[64:65], v[104:105] op_sel_hi:[1,1,0]
    v_pk_fma_f32 v[30:31], v[94:95], s[66:67], v[106:107] op_sel_hi:[1,1,0]
    v_pk_fma_f32 v[12:13], v[96:97], s[64:65], v[104:105] op_sel_hi:[1,1,0]
    v_pk_fma_f32 v[32:33], v[96:97], s[66:67], v[106:107] op_sel_hi:[1,1,0]
    v_pk_fma_f32 v[14:15], v[98:99], s[64:65], v[104:105] op_sel_hi:[1,1,0]
    v_pk_fma_f32 v[34:35], v[98:99], s[66:67], v[106:107] op_sel_hi:[1,1,0]
    v_pk_fma_f32 v[16:17], v[100:101], s[64:65], v[104:105] op_sel_hi:[1,1,0]
    v_pk_fma_f32 v[36:37], v[100:101], s[66:67], v[106:107] op_sel_hi:[1,1,0]
    v_pk_fma_f32 v[18:19], v[102:103], s[64:65], v[104:105] op_sel_hi:[1,1,0]
    v_pk_fma_f32 v[38:39], v[102:103], s[66:67], v[106:107] op_sel_hi:[1,1,0]
    v_exp_f32 v0, v0
    v_exp_f32 v1, v1
    v_exp_f32 v2, v2
    v_exp_f32 v3, v3
    v_exp_f32 v4, v4
    v_exp_f32 v5, v5
    v_exp_f32 v6, v6
    v_exp_f32 v7, v7
    v_exp_f32 v8, v8
    v_exp_f32 v9, v9
    v_exp_f32 v10, v10
    v_exp_f32 v11, v11
    v_exp_f32 v12, v12
    v_exp_f32 v13, v13
    v_exp_f32 v14, v14
    v_exp_f32 v15, v15
    v_exp_f32 v16, v16
    v_exp_f32 v17, v17
    v_exp_f32 v18, v18
    v_exp_f32 v19, v19
    v_exp_f32 v20, v20
    v_exp_f32 v21, v21
    v_exp_f32 v22, v22
    v_exp_f32 v23, v23
    v_exp_f32 v24, v24
    v_exp_f32 v25, v25
    v_exp_f32 v26, v26
    v_exp_f32 v27, v27
    v_exp_f32 v28, v28
    v_exp_f32 v29, v29
    v_exp_f32 v30, v30
    v_exp_f32 v31, v31
    v_exp_f32 v32, v32
    v_exp_f32 v33, v33
    v_exp_f32 v34, v34
    v_exp_f32 v35, v35
    v_exp_f32 v36, v36
    v_exp_f32 v37, v37
    v_exp_f32 v38, v38
    v_exp_f32 v39, v39
    v_pk_add_f32 v[108:109], v[0:1], v[2:3]
    v_pk_add_f32 v[110:111], v[20:21], v[22:23]
    v_pk_add_f32 v[104:105], v[4:5], v[6:7]
    v_pk_add_f32 v[106:107], v[24:25], v[26:27]
    v_pk_add_f32 v[108:109], v[108:109], v[8:9]
    v_pk_add_f32 v[110:111], v[110:111], v[28:29]
    v_pk_add_f32 v[104:105], v[104:105], v[10:11]
    v_pk_add_f32 v[106:107], v[106:107], v[30:31]
    v_pk_add_f32 v[108:109], v[108:109], v[12:13]
    v_pk_add_f32 v[110:111], v[110:111], v[32:33]
    v_pk_add_f32 v[104:105], v[104:105], v[14:15]
    v_pk_add_f32 v[106:107], v[106:107], v[34:35]
    v_pk_add_f32 v[108:109], v[108:109], v[16:17]
    v_pk_add_f32 v[110:111], v[110:111], v[36:37]
    v_pk_add_f32 v[104:105], v[104:105], v[18:19]
    v_pk_add_f32 v[106:107], v[106:107], v[38:39]
    v_pk_add_f32 v[108:109], v[108:109], v[104:105]
    v_pk_add_f32 v[110:111], v[110:111], v[106:107]
    v_add_f32 v108, v108, v109
    v_add_f32 v110, v110, v111
    v_rcp_f32 v108, v108
    v_rcp_f32 v110, v110
    v_pk_mul_f32 v[0:1], v[0:1], v[108:109] op_sel_hi:[1,0]
    v_pk_mul_f32 v[20:21], v[20:21], v[110:111] op_sel_hi:[1,0]
    v_pk_mul_f32 v[2:3], v[2:3], v[108:109] op_sel_hi:[1,0]
    v_pk_mul_f32 v[22:23], v[22:23], v[110:111] op_sel_hi:[1,0]
    v_pk_mul_f32 v[4:5], v[4:5], v[108:109] op_sel_hi:[1,0]
    v_pk_mul_f32 v[24:25], v[24:25], v[110:111] op_sel_hi:[1,0]
    v_pk_mul_f32 v[6:7], v[6:7], v[108:109] op_sel_hi:[1,0]
    v_pk_mul_f32 v[26:27], v[26:27], v[110:111] op_sel_hi:[1,0]
    v_pk_mul_f32 v[8:9], v[8:9], v[108:109] op_sel_hi:[1,0]
    v_pk_mul_f32 v[28:29], v[28:29], v[110:111] op_sel_hi:[1,0]
    v_pk_mul_f32 v[10:11], v[10:11], v[108:109] op_sel_hi:[1,0]
    v_pk_mul_f32 v[30:31], v[30:31], v[110:111] op_sel_hi:[1,0]
    v_pk_mul_f32 v[12:13], v[12:13], v[108:109] op_sel_hi:[1,0]
    v_pk_mul_f32 v[32:33], v[32:33], v[110:111] op_sel_hi:[1,0]
    v_pk_mul_f32 v[14:15], v[14:15], v[108:109] op_sel_hi:[1,0]
    v_pk_mul_f32 v[34:35], v[34:35], v[110:111] op_sel_hi:[1,0]
    v_pk_mul_f32 v[16:17], v[16:17], v[108:109] op_sel_hi:[1,0]
    v_pk_mul_f32 v[36:37], v[36:37], v[110:111] op_sel_hi:[1,0]
    v_pk_mul_f32 v[18:19], v[18:19], v[108:109] op_sel_hi:[1,0]
    v_pk_mul_f32 v[38:39], v[38:39], v[110:111] op_sel_hi:[1,0]
    v_cvt_pk_bf16_f32 v84, v0, v1
    v_cvt_pk_bf16_f32 v85, v2, v3
    v_cvt_pk_bf16_f32 v86, v4, v5
    v_cvt_pk_bf16_f32 v87, v6, v7
    v_cvt_pk_bf16_f32 v88, v8, v9
    v_cvt_pk_bf16_f32 v89, v10, v11
    v_cvt_pk_bf16_f32 v90, v12, v13
    v_cvt_pk_bf16_f32 v91, v14, v15
    v_cvt_pk_bf16_f32 v92, v16, v17
    v_cvt_pk_bf16_f32 v93, v18, v19
    v_cvt_pk_bf16_f32 v94, v20, v21
    v_cvt_pk_bf16_f32 v95, v22, v23
    v_cvt_pk_bf16_f32 v96, v24, v25
    v_cvt_pk_bf16_f32 v97, v26, v27
    v_cvt_pk_bf16_f32 v98, v28, v29
    v_cvt_pk_bf16_f32 v99, v30, v31
    v_cvt_pk_bf16_f32 v100, v32, v33
    v_cvt_pk_bf16_f32 v101, v34, v35
    v_cvt_pk_bf16_f32 v102, v36, v37
    v_cvt_pk_bf16_f32 v103, v38, v39
    s_barrier
    ds_read_b128 a[0:3], v133 offset:0
    ds_read_b128 a[4:7], v133 offset:16
    ds_read_b128 a[8:11], v133 offset:32
    ds_read_b128 a[12:15], v133 offset:48
    ds_read_b128 a[16:19], v133 offset:64
    ds_read_b128 a[20:23], v133 offset:320
    ds_read_b128 a[24:27], v133 offset:336
    ds_read_b128 a[28:31], v133 offset:352
    ds_read_b128 a[32:35], v133 offset:368
    ds_read_b128 a[36:39], v133 offset:384
    ds_read_b128 a[40:43], v133 offset:640
    ds_read_b128 a[44:47], v133 offset:656
    ds_read_b128 a[48:51], v133 offset:672
    ds_read_b128 a[52:55], v133 offset:688
    ds_read_b128 a[56:59], v133 offset:704
    ds_read_b128 a[60:63], v133 offset:960
    ds_read_b128 a[64:67], v133 offset:976
    ds_read_b128 a[68:71], v133 offset:992
    ds_read_b128 a[72:75], v133 offset:1008
    ds_read_b128 a[76:79], v133 offset:1024
    s_waitcnt lgkmcnt(15)
    v_mfma_f32_16x16x32_bf16 v[0:3], a[0:3], v[64:67], 0
    v_mfma_f32_16x16x32_bf16 v[24:27], a[0:3], v[84:87], 0
    v_mfma_f32_16x16x32_bf16 v[0:3], a[4:7], v[68:71], v[0:3]
    v_mfma_f32_16x16x32_bf16 v[24:27], a[4:7], v[88:91], v[24:27]
    v_mfma_f32_16x16x32_bf16 v[0:3], a[8:11], v[72:75], v[0:3]
    v_mfma_f32_16x16x32_bf16 v[24:27], a[8:11], v[92:95], v[24:27]
    v_mfma_f32_16x16x32_bf16 v[0:3], a[12:15], v[76:79], v[0:3]
    v_mfma_f32_16x16x32_bf16 v[24:27], a[12:15], v[96:99], v[24:27]
    v_mfma_f32_16x16x32_bf16 v[0:3], a[16:19], v[80:83], v[0:3]
    v_mfma_f32_16x16x32_bf16 v[24:27], a[16:19], v[100:103], v[24:27]
    s_waitcnt lgkmcnt(10)
    v_mfma_f32_16x16x32_bf16 v[4:7], a[20:23], v[64:67], 0
    v_mfma_f32_16x16x32_bf16 v[28:31], a[20:23], v[84:87], 0
    v_mfma_f32_16x16x32_bf16 v[4:7], a[24:27], v[68:71], v[4:7]
    v_mfma_f32_16x16x32_bf16 v[28:31], a[24:27], v[88:91], v[28:31]
    v_mfma_f32_16x16x32_bf16 v[4:7], a[28:31], v[72:75], v[4:7]
    v_mfma_f32_16x16x32_bf16 v[28:31], a[28:31], v[92:95], v[28:31]
    v_mfma_f32_16x16x32_bf16 v[4:7], a[32:35], v[76:79], v[4:7]
    v_mfma_f32_16x16x32_bf16 v[28:31], a[32:35], v[96:99], v[28:31]
    v_mfma_f32_16x16x32_bf16 v[4:7], a[36:39], v[80:83], v[4:7]
    v_mfma_f32_16x16x32_bf16 v[28:31], a[36:39], v[100:103], v[28:31]
    ds_read_b128 a[0:3], v133 offset:1280
    ds_read_b128 a[4:7], v133 offset:1296
    ds_read_b128 a[8:11], v133 offset:1312
    ds_read_b128 a[12:15], v133 offset:1328
    ds_read_b128 a[16:19], v133 offset:1344
    ds_read_b128 a[20:23], v133 offset:1600
    ds_read_b128 a[24:27], v133 offset:1616
    ds_read_b128 a[28:31], v133 offset:1632
    ds_read_b128 a[32:35], v133 offset:1648
    ds_read_b128 a[36:39], v133 offset:1664
    s_waitcnt lgkmcnt(15)
    v_mfma_f32_16x16x32_bf16 v[8:11], a[40:43], v[64:67], 0
    v_mfma_f32_16x16x32_bf16 v[32:35], a[40:43], v[84:87], 0
    v_mfma_f32_16x16x32_bf16 v[8:11], a[44:47], v[68:71], v[8:11]
    v_mfma_f32_16x16x32_bf16 v[32:35], a[44:47], v[88:91], v[32:35]
    v_mfma_f32_16x16x32_bf16 v[8:11], a[48:51], v[72:75], v[8:11]
    v_mfma_f32_16x16x32_bf16 v[32:35], a[48:51], v[92:95], v[32:35]
    v_mfma_f32_16x16x32_bf16 v[8:11], a[52:55], v[76:79], v[8:11]
    v_mfma_f32_16x16x32_bf16 v[32:35], a[52:55], v[96:99], v[32:35]
    v_mfma_f32_16x16x32_bf16 v[8:11], a[56:59], v[80:83], v[8:11]
    v_mfma_f32_16x16x32_bf16 v[32:35], a[56:59], v[100:103], v[32:35]
    s_waitcnt lgkmcnt(10)
    v_mfma_f32_16x16x32_bf16 v[12:15], a[60:63], v[64:67], 0
    v_mfma_f32_16x16x32_bf16 v[36:39], a[60:63], v[84:87], 0
    v_mfma_f32_16x16x32_bf16 v[12:15], a[64:67], v[68:71], v[12:15]
    v_mfma_f32_16x16x32_bf16 v[36:39], a[64:67], v[88:91], v[36:39]
    v_mfma_f32_16x16x32_bf16 v[12:15], a[68:71], v[72:75], v[12:15]
    v_mfma_f32_16x16x32_bf16 v[36:39], a[68:71], v[92:95], v[36:39]
    v_mfma_f32_16x16x32_bf16 v[12:15], a[72:75], v[76:79], v[12:15]
    v_mfma_f32_16x16x32_bf16 v[36:39], a[72:75], v[96:99], v[36:39]
    v_mfma_f32_16x16x32_bf16 v[12:15], a[76:79], v[80:83], v[12:15]
    v_mfma_f32_16x16x32_bf16 v[36:39], a[76:79], v[100:103], v[36:39]
    s_waitcnt lgkmcnt(5)
    v_mfma_f32_16x16x32_bf16 v[16:19], a[0:3], v[64:67], 0
    v_mfma_f32_16x16x32_bf16 v[40:43], a[0:3], v[84:87], 0
    v_mfma_f32_16x16x32_bf16 v[16:19], a[4:7], v[68:71], v[16:19]
    v_mfma_f32_16x16x32_bf16 v[40:43], a[4:7], v[88:91], v[40:43]
    v_mfma_f32_16x16x32_bf16 v[16:19], a[8:11], v[72:75], v[16:19]
    v_mfma_f32_16x16x32_bf16 v[40:43], a[8:11], v[92:95], v[40:43]
    v_mfma_f32_16x16x32_bf16 v[16:19], a[12:15], v[76:79], v[16:19]
    v_mfma_f32_16x16x32_bf16 v[40:43], a[12:15], v[96:99], v[40:43]
    v_mfma_f32_16x16x32_bf16 v[16:19], a[16:19], v[80:83], v[16:19]
    v_mfma_f32_16x16x32_bf16 v[40:43], a[16:19], v[100:103], v[40:43]
    s_waitcnt lgkmcnt(0)
    v_mfma_f32_16x16x32_bf16 v[20:23], a[20:23], v[64:67], 0
    v_mfma_f32_16x16x32_bf16 v[44:47], a[20:23], v[84:87], 0
    v_mfma_f32_16x16x32_bf16 v[20:23], a[24:27], v[68:71], v[20:23]
    v_mfma_f32_16x16x32_bf16 v[44:47], a[24:27], v[88:91], v[44:47]
    v_mfma_f32_16x16x32_bf16 v[20:23], a[28:31], v[72:75], v[20:23]
    v_mfma_f32_16x16x32_bf16 v[44:47], a[28:31], v[92:95], v[44:47]
    v_mfma_f32_16x16x32_bf16 v[20:23], a[32:35], v[76:79], v[20:23]
    v_mfma_f32_16x16x32_bf16 v[44:47], a[32:35], v[96:99], v[44:47]
    v_mfma_f32_16x16x32_bf16 v[20:23], a[36:39], v[80:83], v[20:23]
    v_mfma_f32_16x16x32_bf16 v[44:47], a[36:39], v[100:103], v[44:47]
    s_nop 6
    v_add_f32 v104, 897988541, v20
    v_rcp_f32 v104, v104
    s_nop 0
    v_pk_mul_f32 v[0:1], v[0:1], v[104:105] op_sel_hi:[1,0]
    v_pk_mul_f32 v[2:3], v[2:3], v[104:105] op_sel_hi:[1,0]
    v_pk_mul_f32 v[4:5], v[4:5], v[104:105] op_sel_hi:[1,0]
    v_pk_mul_f32 v[6:7], v[6:7], v[104:105] op_sel_hi:[1,0]
    v_pk_mul_f32 v[8:9], v[8:9], v[104:105] op_sel_hi:[1,0]
    v_pk_mul_f32 v[10:11], v[10:11], v[104:105] op_sel_hi:[1,0]
    v_pk_mul_f32 v[12:13], v[12:13], v[104:105] op_sel_hi:[1,0]
    v_pk_mul_f32 v[14:15], v[14:15], v[104:105] op_sel_hi:[1,0]
    v_pk_mul_f32 v[16:17], v[16:17], v[104:105] op_sel_hi:[1,0]
    v_pk_mul_f32 v[18:19], v[18:19], v[104:105] op_sel_hi:[1,0]
    v_cvt_pk_bf16_f32 v48, v0, v1
    v_cvt_pk_bf16_f32 v49, v2, v3
    v_cvt_pk_bf16_f32 v50, v4, v5
    v_cvt_pk_bf16_f32 v51, v6, v7
    v_cvt_pk_bf16_f32 v52, v8, v9
    v_cvt_pk_bf16_f32 v53, v10, v11
    v_cvt_pk_bf16_f32 v54, v12, v13
    v_cvt_pk_bf16_f32 v55, v14, v15
    v_cvt_pk_bf16_f32 v56, v16, v17
    v_cvt_pk_bf16_f32 v57, v18, v19
    buffer_store_dwordx4 v[48:51], v134, s[52:55], s84 offen sc1
    buffer_store_dwordx4 v[52:55], v134, s[52:55], s84 offen offset:256 sc1
    buffer_store_dwordx2 v[56:57], v135, s[52:55], s85 offen sc1
    s_add_u32 s84, s84, 20480
    s_add_u32 s85, s85, 20480
    v_add_f32 v104, 897988541, v44
    v_rcp_f32 v104, v104
    s_nop 0
    v_pk_mul_f32 v[24:25], v[24:25], v[104:105] op_sel_hi:[1,0]
    v_pk_mul_f32 v[26:27], v[26:27], v[104:105] op_sel_hi:[1,0]
    v_pk_mul_f32 v[28:29], v[28:29], v[104:105] op_sel_hi:[1,0]
    v_pk_mul_f32 v[30:31], v[30:31], v[104:105] op_sel_hi:[1,0]
    v_pk_mul_f32 v[32:33], v[32:33], v[104:105] op_sel_hi:[1,0]
    v_pk_mul_f32 v[34:35], v[34:35], v[104:105] op_sel_hi:[1,0]
    v_pk_mul_f32 v[36:37], v[36:37], v[104:105] op_sel_hi:[1,0]
    v_pk_mul_f32 v[38:39], v[38:39], v[104:105] op_sel_hi:[1,0]
    v_pk_mul_f32 v[40:41], v[40:41], v[104:105] op_sel_hi:[1,0]
    v_pk_mul_f32 v[42:43], v[42:43], v[104:105] op_sel_hi:[1,0]
    v_cvt_pk_bf16_f32 v58, v24, v25
    v_cvt_pk_bf16_f32 v59, v26, v27
    v_cvt_pk_bf16_f32 v60, v28, v29
    v_cvt_pk_bf16_f32 v61, v30, v31
    v_cvt_pk_bf16_f32 v62, v32, v33
    v_cvt_pk_bf16_f32 v63, v34, v35
    v_cvt_pk_bf16_f32 v64, v36, v37
    v_cvt_pk_bf16_f32 v65, v38, v39
    v_cvt_pk_bf16_f32 v66, v40, v41
    v_cvt_pk_bf16_f32 v67, v42, v43
    buffer_store_dwordx4 v[58:61], v134, s[52:55], s84 offen sc1
    buffer_store_dwordx4 v[62:65], v134, s[52:55], s84 offen offset:256 sc1
    buffer_store_dwordx2 v[66:67], v135, s[52:55], s85 offen sc1
    s_waitcnt vmcnt(0)
    v_mov_b32 v0, 163812
    v_mov_b32 v1, 1
    s_mov_b64 exec, 1
    ds_add_rtn_u32 v1, v0, v1
    s_waitcnt lgkmcnt(0)
    v_readfirstlane_b32 s13, v1
    s_nop 0
    s_cmp_lg_u32 s13, 3
    s_cbranch_scc1 arr_4
    s_lshl_b32 s11, s5, 4
    s_lshl_b32 s12, s6, 3
    s_add_u32 s11, s11, s12
    s_add_u32 s11, s11, s7
    s_lshl_b32 s11, s11, 7
    s_add_u32 s11, s11, 36864
    v_mov_b32 v0, s9
    v_mov_b32 v1, 0
    buffer_store_dword v0, v1, s[52:55], s11 offen sc1
arr_4:
    s_mov_b64 exec, -1
    v_add_u32 v141, s61, v143
    v_lshlrev_b32 v96, 3, v128
    v_add_u32 v96, s61, v96
    v_lshl_add_u32 v120, v130, 2, v131
    v_bfe_u32 v121, v120, 1, 2
    v_lshlrev_b32 v120, 7, v120
    v_lshl_add_u32 v120, v132, 3, v120
    v_add_u32 v120, 65536, v120
    v_xor_b32 v122, 0, v121
    v_lshl_add_u32 v133, v122, 5, v120
    v_add_u32 v137, 49152, v133
    v_xor_b32 v122, 1, v121
    v_lshl_add_u32 v134, v122, 5, v120
    v_add_u32 v138, 49152, v134
    v_xor_b32 v122, 2, v121
    v_lshl_add_u32 v135, v122, 5, v120
    v_add_u32 v139, 49152, v135
    v_xor_b32 v122, 3, v121
    v_lshl_add_u32 v136, v122, 5, v120
    v_add_u32 v140, 49152, v136
    v_lshlrev_b32 v97, 4, v130
    v_add_u32 v97, 151552, v97
    s_lshl_b32 s84, s5, 3
    s_lshl_b32 s11, s8, 1
    s_add_u32 s84, s84, s11
    s_lshl_b32 s86, s84, 8
    s_add_u32 s86, s86, 5492736
    s_lshl_b32 s87, s84, 6
    s_add_u32 s87, s87, 17453056
    s_cmp_eq_u32 s7, 0
    s_cselect_b32 s87, s87, s79
    v_lshlrev_b32 v104, 4, v129
    v_lshl_add_u32 v104, v130, 15, v104
    v_add_u32 v105, 131072, v104
    v_mov_b32 v106, 163832
go3_5:
    ds_read_b32 v107, v106
    s_waitcnt lgkmcnt(0)
    v_readfirstlane_b32 s13, v107
    s_nop 0
    s_cmp_eq_u32 s13, 0
    s_cbranch_scc1 go3_5
    buffer_load_dwordx4 v[112:115], v104, s[52:55], s86 offen offset:0 sc1
    buffer_load_dwordx4 v[116:119], v105, s[52:55], s86 offen offset:0 sc1
    buffer_load_dwordx4 v[120:123], v104, s[52:55], s86 offen offset:256 sc1
    buffer_load_dwordx4 v[124:127], v105, s[52:55], s86 offen offset:256 sc1
    s_mul_i32 s84, s84, 49152
    s_mul_i32 s12, s7, 2048
    s_add_u32 s84, s84, s12
    s_add_u32 s84, s84, 8409088
    s_add_u32 s85, s84, 49152
    s_barrier
    ds_read_b128 a[0:3], v141 offset:0
    ds_read_b128 a[4:7], v141 offset:2048
    ds_read_b64_tr_b16 a[16:17], v137 offset:24576
    ds_read_b64_tr_b16 a[18:19], v137 offset:26624
    ds_read_b64_tr_b16 a[20:21], v138 offset:24576
    ds_read_b64_tr_b16 a[22:23], v138 offset:26624
    ds_read_b64_tr_b16 a[24:25], v139 offset:24576
    ds_read_b64_tr_b16 a[26:27], v139 offset:26624
    ds_read_b64_tr_b16 a[28:29], v140 offset:24576
    ds_read_b64_tr_b16 a[30:31], v140 offset:26624
    s_waitcnt lgkmcnt(0)
    v_mfma_f32_16x16x32_bf16 v[0:3], a[16:19], a[0:3], 0
    ds_read_b128 a[8:11], v141 offset:1024
    ds_read_b128 a[12:15], v141 offset:3072
    v_mfma_f32_16x16x32_bf16 v[16:19], a[16:19], a[4:7], 0
    ds_read_b64_tr_b16 a[32:33], v137 offset:28672
    v_mfma_f32_16x16x32_bf16 v[4:7], a[20:23], a[0:3], 0
    ds_read_b64_tr_b16 a[34:35], v137 offset:30720
    v_mfma_f32_16x16x32_bf16 v[20:23], a[20:23], a[4:7], 0
    ds_read_b64_tr_b16 a[36:37], v138 offset:28672
    v_mfma_f32_16x16x32_bf16 v[8:11], a[24:27], a[0:3], 0
    ds_read_b64_tr_b16 a[38:39], v138 offset:30720
    ds_read_b64_tr_b16 a[40:41], v139 offset:28672
    v_mfma_f32_16x16x32_bf16 v[24:27], a[24:27], a[4:7], 0
    ds_read_b64_tr_b16 a[42:43], v139 offset:30720
    v_mfma_f32_16x16x32_bf16 v[12:15], a[28:31], a[0:3], 0
    ds_read_b64_tr_b16 a[44:45], v140 offset:28672
    v_mfma_f32_16x16x32_bf16 v[28:31], a[28:31], a[4:7], 0
    ds_read_b64_tr_b16 a[46:47], v140 offset:30720
    s_barrier
    s_waitcnt lgkmcnt(0)
    v_mfma_f32_16x16x32_bf16 v[0:3], a[32:35], a[8:11], v[0:3]
    ds_read_b64 a[0:1], v96 offset:16384
    ds_read_b64 a[2:3], v96 offset:16896
    v_mfma_f32_16x16x32_bf16 v[16:19], a[32:35], a[12:15], v[16:19]
    ds_read_b64 a[4:5], v96 offset:18432
    v_mfma_f32_16x16x32_bf16 v[4:7], a[36:39], a[8:11], v[4:7]
    ds_read_b64 a[6:7], v96 offset:18944
    ds_read_b64_tr_b16 a[16:17], v137 offset:16384
    v_mfma_f32_16x16x32_bf16 v[20:23], a[36:39], a[12:15], v[20:23]
    ds_read_b64_tr_b16 a[18:19], v137 offset:18432
    v_mfma_f32_16x16x32_bf16 v[8:11], a[40:43], a[8:11], v[8:11]
    ds_read_b64_tr_b16 a[20:21], v138 offset:16384
    ds_read_b64_tr_b16 a[22:23], v138 offset:18432
    v_mfma_f32_16x16x32_bf16 v[24:27], a[40:43], a[12:15], v[24:27]
    ds_read_b64_tr_b16 a[24:25], v139 offset:16384
    v_mfma_f32_16x16x32_bf16 v[12:15], a[44:47], a[8:11], v[12:15]
    ds_read_b64_tr_b16 a[26:27], v139 offset:18432
    ds_read_b64_tr_b16 a[28:29], v140 offset:16384
    v_mfma_f32_16x16x32_bf16 v[28:31], a[44:47], a[12:15], v[28:31]
    ds_read_b64_tr_b16 a[30:31], v140 offset:18432
    s_waitcnt lgkmcnt(0)
    v_mfma_f32_16x16x32_bf16 v[0:3], a[16:19], a[0:3], v[0:3]
    ds_read_b128 a[8:11], v141 offset:17408
    ds_read_b128 a[12:15], v141 offset:19456
    v_mfma_f32_16x16x32_bf16 v[16:19], a[16:19], a[4:7], v[16:19]
    ds_read_b64_tr_b16 a[32:33], v137 offset:20480
    v_mfma_f32_16x16x32_bf16 v[4:7], a[20:23], a[0:3], v[4:7]
    ds_read_b64_tr_b16 a[34:35], v137 offset:22528
    v_mfma_f32_16x16x32_bf16 v[20:23], a[20:23], a[4:7], v[20:23]
    ds_read_b64_tr_b16 a[36:37], v138 offset:20480
    v_mfma_f32_16x16x32_bf16 v[8:11], a[24:27], a[0:3], v[8:11]
    ds_read_b64_tr_b16 a[38:39], v138 offset:22528
    ds_read_b64_tr_b16 a[40:41], v139 offset:20480
    v_mfma_f32_16x16x32_bf16 v[24:27], a[24:27], a[4:7], v[24:27]
    ds_read_b64_tr_b16 a[42:43], v139 offset:22528
    v_mfma_f32_16x16x32_bf16 v[12:15], a[28:31], a[0:3], v[12:15]
    ds_read_b64_tr_b16 a[44:45], v140 offset:20480
    v_mfma_f32_16x16x32_bf16 v[28:31], a[28:31], a[4:7], v[28:31]
    ds_read_b64_tr_b16 a[46:47], v140 offset:22528
    s_barrier
    s_waitcnt lgkmcnt(0)
    v_mfma_f32_16x16x32_bf16 v[0:3], a[32:35], a[8:11], v[0:3]
    ds_read_b128 a[0:3], v141 offset:32768
    ds_read_b128 a[4:7], v141 offset:34816
    v_mfma_f32_16x16x32_bf16 v[16:19], a[32:35], a[12:15], v[16:19]
    ds_read_b64_tr_b16 a[16:17], v137 offset:8192
    v_mfma_f32_16x16x32_bf16 v[4:7], a[36:39], a[8:11], v[4:7]
    ds_read_b64_tr_b16 a[18:19], v137 offset:10240
    v_mfma_f32_16x16x32_bf16 v[20:23], a[36:39], a[12:15], v[20:23]
    ds_read_b64_tr_b16 a[20:21], v138 offset:8192
    v_mfma_f32_16x16x32_bf16 v[8:11], a[40:43], a[8:11], v[8:11]
    ds_read_b64_tr_b16 a[22:23], v138 offset:10240
    ds_read_b64_tr_b16 a[24:25], v139 offset:8192
    v_mfma_f32_16x16x32_bf16 v[24:27], a[40:43], a[12:15], v[24:27]
    ds_read_b64_tr_b16 a[26:27], v139 offset:10240
    v_mfma_f32_16x16x32_bf16 v[12:15], a[44:47], a[8:11], v[12:15]
    ds_read_b64_tr_b16 a[28:29], v140 offset:8192
    v_mfma_f32_16x16x32_bf16 v[28:31], a[44:47], a[12:15], v[28:31]
    ds_read_b64_tr_b16 a[30:31], v140 offset:10240
    s_waitcnt lgkmcnt(0)
    v_mfma_f32_16x16x32_bf16 v[0:3], a[16:19], a[0:3], v[0:3]
    ds_read_b128 a[8:11], v141 offset:33792
    ds_read_b128 a[12:15], v141 offset:35840
    v_mfma_f32_16x16x32_bf16 v[16:19], a[16:19], a[4:7], v[16:19]
    ds_read_b64_tr_b16 a[32:33], v137 offset:12288
    v_mfma_f32_16x16x32_bf16 v[4:7], a[20:23], a[0:3], v[4:7]
    ds_read_b64_tr_b16 a[34:35], v137 offset:14336
    v_mfma_f32_16x16x32_bf16 v[20:23], a[20:23], a[4:7], v[20:23]
    ds_read_b64_tr_b16 a[36:37], v138 offset:12288
    v_mfma_f32_16x16x32_bf16 v[8:11], a[24:27], a[0:3], v[8:11]
    ds_read_b64_tr_b16 a[38:39], v138 offset:14336
    ds_read_b64_tr_b16 a[40:41], v139 offset:12288
    v_mfma_f32_16x16x32_bf16 v[24:27], a[24:27], a[4:7], v[24:27]
    ds_read_b64_tr_b16 a[42:43], v139 offset:14336
    v_mfma_f32_16x16x32_bf16 v[12:15], a[28:31], a[0:3], v[12:15]
    ds_read_b64_tr_b16 a[44:45], v140 offset:12288
    v_mfma_f32_16x16x32_bf16 v[28:31], a[28:31], a[4:7], v[28:31]
    ds_read_b64_tr_b16 a[46:47], v140 offset:14336
    s_barrier
    s_waitcnt lgkmcnt(0)
    v_mfma_f32_16x16x32_bf16 v[0:3], a[32:35], a[8:11], v[0:3]
    ds_read_b128 a[0:3], v141 offset:49152
    ds_read_b128 a[4:7], v141 offset:51200
    v_mfma_f32_16x16x32_bf16 v[16:19], a[32:35], a[12:15], v[16:19]
    ds_read_b64_tr_b16 a[16:17], v137 offset:0
    v_mfma_f32_16x16x32_bf16 v[4:7], a[36:39], a[8:11], v[4:7]
    ds_read_b64_tr_b16 a[18:19], v137 offset:2048
    v_mfma_f32_16x16x32_bf16 v[20:23], a[36:39], a[12:15], v[20:23]
    ds_read_b64_tr_b16 a[20:21], v138 offset:0
    v_mfma_f32_16x16x32_bf16 v[8:11], a[40:43], a[8:11], v[8:11]
    ds_read_b64_tr_b16 a[22:23], v138 offset:2048
    ds_read_b64_tr_b16 a[24:25], v139 offset:0
    v_mfma_f32_16x16x32_bf16 v[24:27], a[40:43], a[12:15], v[24:27]
    ds_read_b64_tr_b16 a[26:27], v139 offset:2048
    v_mfma_f32_16x16x32_bf16 v[12:15], a[44:47], a[8:11], v[12:15]
    ds_read_b64_tr_b16 a[28:29], v140 offset:0
    v_mfma_f32_16x16x32_bf16 v[28:31], a[44:47], a[12:15], v[28:31]
    ds_read_b64_tr_b16 a[30:31], v140 offset:2048
    s_waitcnt lgkmcnt(0)
    v_mfma_f32_16x16x32_bf16 v[0:3], a[16:19], a[0:3], v[0:3]
    ds_read_b64 a[8:9], v96 offset:50176
    ds_read_b64 a[10:11], v96 offset:50688
    v_mfma_f32_16x16x32_bf16 v[16:19], a[16:19], a[4:7], v[16:19]
    ds_read_b64 a[12:13], v96 offset:52224
    v_mfma_f32_16x16x32_bf16 v[4:7], a[20:23], a[0:3], v[4:7]
    ds_read_b64 a[14:15], v96 offset:52736
    ds_read_b64_tr_b16 a[32:33], v137 offset:4096
    v_mfma_f32_16x16x32_bf16 v[20:23], a[20:23], a[4:7], v[20:23]
    ds_read_b64_tr_b16 a[34:35], v137 offset:6144
    v_mfma_f32_16x16x32_bf16 v[8:11], a[24:27], a[0:3], v[8:11]
    ds_read_b64_tr_b16 a[36:37], v138 offset:4096
    ds_read_b64_tr_b16 a[38:39], v138 offset:6144
    v_mfma_f32_16x16x32_bf16 v[24:27], a[24:27], a[4:7], v[24:27]
    ds_read_b64_tr_b16 a[40:41], v139 offset:4096
    v_mfma_f32_16x16x32_bf16 v[12:15], a[28:31], a[0:3], v[12:15]
    ds_read_b64_tr_b16 a[42:43], v139 offset:6144
    ds_read_b64_tr_b16 a[44:45], v140 offset:4096
    v_mfma_f32_16x16x32_bf16 v[28:31], a[28:31], a[4:7], v[28:31]
    ds_read_b64_tr_b16 a[46:47], v140 offset:6144
    s_barrier
    s_waitcnt lgkmcnt(0)
    v_mfma_f32_16x16x32_bf16 v[0:3], a[32:35], a[8:11], v[0:3]
    ds_read_b128 a[0:3], v141 offset:0
    ds_read_b128 a[4:7], v141 offset:2048
    v_mfma_f32_16x16x32_bf16 v[16:19], a[32:35], a[12:15], v[16:19]
    ds_read_b64_tr_b16 a[16:17], v133 offset:40960
    v_mfma_f32_16x16x32_bf16 v[4:7], a[36:39], a[8:11], v[4:7]
    ds_read_b64_tr_b16 a[18:19], v133 offset:43008
    v_mfma_f32_16x16x32_bf16 v[20:23], a[36:39], a[12:15], v[20:23]
    ds_read_b64_tr_b16 a[20:21], v134 offset:40960
    v_mfma_f32_16x16x32_bf16 v[8:11], a[40:43], a[8:11], v[8:11]
    ds_read_b64_tr_b16 a[22:23], v134 offset:43008
    ds_read_b64_tr_b16 a[24:25], v135 offset:40960
    v_mfma_f32_16x16x32_bf16 v[24:27], a[40:43], a[12:15], v[24:27]
    ds_read_b64_tr_b16 a[26:27], v135 offset:43008
    v_mfma_f32_16x16x32_bf16 v[12:15], a[44:47], a[8:11], v[12:15]
    ds_read_b64_tr_b16 a[28:29], v136 offset:40960
    v_mfma_f32_16x16x32_bf16 v[28:31], a[44:47], a[12:15], v[28:31]
    ds_read_b64_tr_b16 a[30:31], v136 offset:43008
    s_waitcnt lgkmcnt(0)
    v_mfma_f32_16x16x32_bf16 v[0:3], a[16:19], a[0:3], v[0:3]
    ds_read_b128 a[8:11], v141 offset:1024
    ds_read_b128 a[12:15], v141 offset:3072
    v_mfma_f32_16x16x32_bf16 v[16:19], a[16:19], a[4:7], v[16:19]
    ds_read_b64_tr_b16 a[32:33], v133 offset:45056
    v_mfma_f32_16x16x32_bf16 v[4:7], a[20:23], a[0:3], v[4:7]
    ds_read_b64_tr_b16 a[34:35], v133 offset:47104
    v_mfma_f32_16x16x32_bf16 v[20:23], a[20:23], a[4:7], v[20:23]
    ds_read_b64_tr_b16 a[36:37], v134 offset:45056
    v_mfma_f32_16x16x32_bf16 v[8:11], a[24:27], a[0:3], v[8:11]
    ds_read_b64_tr_b16 a[38:39], v134 offset:47104
    ds_read_b64_tr_b16 a[40:41], v135 offset:45056
    v_mfma_f32_16x16x32_bf16 v[24:27], a[24:27], a[4:7], v[24:27]
    ds_read_b64_tr_b16 a[42:43], v135 offset:47104
    v_mfma_f32_16x16x32_bf16 v[12:15], a[28:31], a[0:3], v[12:15]
    ds_read_b64_tr_b16 a[44:45], v136 offset:45056
    v_mfma_f32_16x16x32_bf16 v[28:31], a[28:31], a[4:7], v[28:31]
    ds_read_b64_tr_b16 a[46:47], v136 offset:47104
    s_barrier
    s_waitcnt lgkmcnt(0)
    v_mfma_f32_16x16x32_bf16 v[0:3], a[32:35], a[8:11], v[0:3]
    ds_read_b128 a[0:3], v141 offset:16384
    ds_read_b128 a[4:7], v141 offset:18432
    v_mfma_f32_16x16x32_bf16 v[16:19], a[32:35], a[12:15], v[16:19]
    ds_read_b64_tr_b16 a[16:17], v133 offset:32768
    v_mfma_f32_16x16x32_bf16 v[4:7], a[36:39], a[8:11], v[4:7]
    ds_read_b64_tr_b16 a[18:19], v133 offset:34816
    v_mfma_f32_16x16x32_bf16 v[20:23], a[36:39], a[12:15], v[20:23]
    ds_read_b64_tr_b16 a[20:21], v134 offset:32768
    v_mfma_f32_16x16x32_bf16 v[8:11], a[40:43], a[8:11], v[8:11]
    ds_read_b64_tr_b16 a[22:23], v134 offset:34816
    ds_read_b64_tr_b16 a[24:25], v135 offset:32768
    v_mfma_f32_16x16x32_bf16 v[24:27], a[40:43], a[12:15], v[24:27]
    ds_read_b64_tr_b16 a[26:27], v135 offset:34816
    v_mfma_f32_16x16x32_bf16 v[12:15], a[44:47], a[8:11], v[12:15]
    ds_read_b64_tr_b16 a[28:29], v136 offset:32768
    v_mfma_f32_16x16x32_bf16 v[28:31], a[44:47], a[12:15], v[28:31]
    ds_read_b64_tr_b16 a[30:31], v136 offset:34816
    s_waitcnt lgkmcnt(0)
    v_mfma_f32_16x16x32_bf16 v[0:3], a[16:19], a[0:3], v[0:3]
    ds_read_b128 a[8:11], v141 offset:17408
    ds_read_b128 a[12:15], v141 offset:19456
    v_mfma_f32_16x16x32_bf16 v[16:19], a[16:19], a[4:7], v[16:19]
    ds_read_b64_tr_b16 a[32:33], v133 offset:36864
    v_mfma_f32_16x16x32_bf16 v[4:7], a[20:23], a[0:3], v[4:7]
    ds_read_b64_tr_b16 a[34:35], v133 offset:38912
    v_mfma_f32_16x16x32_bf16 v[20:23], a[20:23], a[4:7], v[20:23]
    ds_read_b64_tr_b16 a[36:37], v134 offset:36864
    v_mfma_f32_16x16x32_bf16 v[8:11], a[24:27], a[0:3], v[8:11]
    ds_read_b64_tr_b16 a[38:39], v134 offset:38912
    ds_read_b64_tr_b16 a[40:41], v135 offset:36864
    v_mfma_f32_16x16x32_bf16 v[24:27], a[24:27], a[4:7], v[24:27]
    ds_read_b64_tr_b16 a[42:43], v135 offset:38912
    v_mfma_f32_16x16x32_bf16 v[12:15], a[28:31], a[0:3], v[12:15]
    ds_read_b64_tr_b16 a[44:45], v136 offset:36864
    v_mfma_f32_16x16x32_bf16 v[28:31], a[28:31], a[4:7], v[28:31]
    ds_read_b64_tr_b16 a[46:47], v136 offset:38912
    s_barrier
    s_waitcnt lgkmcnt(0)
    v_mfma_f32_16x16x32_bf16 v[0:3], a[32:35], a[8:11], v[0:3]
    ds_read_b64 a[0:1], v96 offset:32768
    ds_read_b64 a[2:3], v96 offset:33280
    v_mfma_f32_16x16x32_bf16 v[16:19], a[32:35], a[12:15], v[16:19]
    ds_read_b64 a[4:5], v96 offset:34816
    v_mfma_f32_16x16x32_bf16 v[4:7], a[36:39], a[8:11], v[4:7]
    ds_read_b64 a[6:7], v96 offset:35328
    ds_read_b64_tr_b16 a[16:17], v133 offset:24576
    v_mfma_f32_16x16x32_bf16 v[20:23], a[36:39], a[12:15], v[20:23]
    ds_read_b64_tr_b16 a[18:19], v133 offset:26624
    v_mfma_f32_16x16x32_bf16 v[8:11], a[40:43], a[8:11], v[8:11]
    ds_read_b64_tr_b16 a[20:21], v134 offset:24576
    ds_read_b64_tr_b16 a[22:23], v134 offset:26624
    v_mfma_f32_16x16x32_bf16 v[24:27], a[40:43], a[12:15], v[24:27]
    ds_read_b64_tr_b16 a[24:25], v135 offset:24576
    v_mfma_f32_16x16x32_bf16 v[12:15], a[44:47], a[8:11], v[12:15]
    ds_read_b64_tr_b16 a[26:27], v135 offset:26624
    ds_read_b64_tr_b16 a[28:29], v136 offset:24576
    v_mfma_f32_16x16x32_bf16 v[28:31], a[44:47], a[12:15], v[28:31]
    ds_read_b64_tr_b16 a[30:31], v136 offset:26624
    s_waitcnt lgkmcnt(0)
    v_mfma_f32_16x16x32_bf16 v[0:3], a[16:19], a[0:3], v[0:3]
    ds_read_b128 a[8:11], v141 offset:33792
    ds_read_b128 a[12:15], v141 offset:35840
    v_mfma_f32_16x16x32_bf16 v[16:19], a[16:19], a[4:7], v[16:19]
    ds_read_b64_tr_b16 a[32:33], v133 offset:28672
    v_mfma_f32_16x16x32_bf16 v[4:7], a[20:23], a[0:3], v[4:7]
    ds_read_b64_tr_b16 a[34:35], v133 offset:30720
    v_mfma_f32_16x16x32_bf16 v[20:23], a[20:23], a[4:7], v[20:23]
    ds_read_b64_tr_b16 a[36:37], v134 offset:28672
    v_mfma_f32_16x16x32_bf16 v[8:11], a[24:27], a[0:3], v[8:11]
    ds_read_b64_tr_b16 a[38:39], v134 offset:30720
    ds_read_b64_tr_b16 a[40:41], v135 offset:28672
    v_mfma_f32_16x16x32_bf16 v[24:27], a[24:27], a[4:7], v[24:27]
    ds_read_b64_tr_b16 a[42:43], v135 offset:30720
    v_mfma_f32_16x16x32_bf16 v[12:15], a[28:31], a[0:3], v[12:15]
    ds_read_b64_tr_b16 a[44:45], v136 offset:28672
    v_mfma_f32_16x16x32_bf16 v[28:31], a[28:31], a[4:7], v[28:31]
    ds_read_b64_tr_b16 a[46:47], v136 offset:30720
    s_barrier
    s_waitcnt lgkmcnt(0)
    v_mfma_f32_16x16x32_bf16 v[0:3], a[32:35], a[8:11], v[0:3]
    ds_read_b128 a[0:3], v141 offset:49152
    ds_read_b128 a[4:7], v141 offset:51200
    v_mfma_f32_16x16x32_bf16 v[16:19], a[32:35], a[12:15], v[16:19]
    ds_read_b64_tr_b16 a[16:17], v133 offset:16384
    v_mfma_f32_16x16x32_bf16 v[4:7], a[36:39], a[8:11], v[4:7]
    ds_read_b64_tr_b16 a[18:19], v133 offset:18432
    v_mfma_f32_16x16x32_bf16 v[20:23], a[36:39], a[12:15], v[20:23]
    ds_read_b64_tr_b16 a[20:21], v134 offset:16384
    v_mfma_f32_16x16x32_bf16 v[8:11], a[40:43], a[8:11], v[8:11]
    ds_read_b64_tr_b16 a[22:23], v134 offset:18432
    ds_read_b64_tr_b16 a[24:25], v135 offset:16384
    v_mfma_f32_16x16x32_bf16 v[24:27], a[40:43], a[12:15], v[24:27]
    ds_read_b64_tr_b16 a[26:27], v135 offset:18432
    v_mfma_f32_16x16x32_bf16 v[12:15], a[44:47], a[8:11], v[12:15]
    ds_read_b64_tr_b16 a[28:29], v136 offset:16384
    v_mfma_f32_16x16x32_bf16 v[28:31], a[44:47], a[12:15], v[28:31]
    ds_read_b64_tr_b16 a[30:31], v136 offset:18432
    s_waitcnt lgkmcnt(0)
    v_mfma_f32_16x16x32_bf16 v[0:3], a[16:19], a[0:3], v[0:3]
    ds_read_b128 a[8:11], v141 offset:50176
    ds_read_b128 a[12:15], v141 offset:52224
    v_mfma_f32_16x16x32_bf16 v[16:19], a[16:19], a[4:7], v[16:19]
    ds_read_b64_tr_b16 a[32:33], v133 offset:20480
    v_mfma_f32_16x16x32_bf16 v[4:7], a[20:23], a[0:3], v[4:7]
    ds_read_b64_tr_b16 a[34:35], v133 offset:22528
    v_mfma_f32_16x16x32_bf16 v[20:23], a[20:23], a[4:7], v[20:23]
    ds_read_b64_tr_b16 a[36:37], v134 offset:20480
    v_mfma_f32_16x16x32_bf16 v[8:11], a[24:27], a[0:3], v[8:11]
    ds_read_b64_tr_b16 a[38:39], v134 offset:22528
    ds_read_b64_tr_b16 a[40:41], v135 offset:20480
    v_mfma_f32_16x16x32_bf16 v[24:27], a[24:27], a[4:7], v[24:27]
    ds_read_b64_tr_b16 a[42:43], v135 offset:22528
    v_mfma_f32_16x16x32_bf16 v[12:15], a[28:31], a[0:3], v[12:15]
    ds_read_b64_tr_b16 a[44:45], v136 offset:20480
    v_mfma_f32_16x16x32_bf16 v[28:31], a[28:31], a[4:7], v[28:31]
    ds_read_b64_tr_b16 a[46:47], v136 offset:22528
    s_barrier
    s_waitcnt lgkmcnt(0)
    v_mfma_f32_16x16x32_bf16 v[0:3], a[32:35], a[8:11], v[0:3]
    ds_read_b128 a[0:3], v141 offset:0
    ds_read_b128 a[4:7], v141 offset:2048
    v_mfma_f32_16x16x32_bf16 v[16:19], a[32:35], a[12:15], v[16:19]
    ds_read_b64_tr_b16 a[16:17], v133 offset:8192
    v_mfma_f32_16x16x32_bf16 v[4:7], a[36:39], a[8:11], v[4:7]
    ds_read_b64_tr_b16 a[18:19], v133 offset:10240
    v_mfma_f32_16x16x32_bf16 v[20:23], a[36:39], a[12:15], v[20:23]
    ds_read_b64_tr_b16 a[20:21], v134 offset:8192
    v_mfma_f32_16x16x32_bf16 v[8:11], a[40:43], a[8:11], v[8:11]
    ds_read_b64_tr_b16 a[22:23], v134 offset:10240
    ds_read_b64_tr_b16 a[24:25], v135 offset:8192
    v_mfma_f32_16x16x32_bf16 v[24:27], a[40:43], a[12:15], v[24:27]
    ds_read_b64_tr_b16 a[26:27], v135 offset:10240
    v_mfma_f32_16x16x32_bf16 v[12:15], a[44:47], a[8:11], v[12:15]
    ds_read_b64_tr_b16 a[28:29], v136 offset:8192
    v_mfma_f32_16x16x32_bf16 v[28:31], a[44:47], a[12:15], v[28:31]
    ds_read_b64_tr_b16 a[30:31], v136 offset:10240
    s_waitcnt lgkmcnt(0)
    v_mfma_f32_16x16x32_bf16 v[0:3], a[16:19], a[0:3], v[0:3]
    ds_read_b64 a[8:9], v96 offset:1024
    ds_read_b64 a[10:11], v96 offset:1536
    v_mfma_f32_16x16x32_bf16 v[16:19], a[16:19], a[4:7], v[16:19]
    ds_read_b64 a[12:13], v96 offset:3072
    v_mfma_f32_16x16x32_bf16 v[4:7], a[20:23], a[0:3], v[4:7]
    ds_read_b64 a[14:15], v96 offset:3584
    ds_read_b64_tr_b16 a[32:33], v133 offset:12288
    v_mfma_f32_16x16x32_bf16 v[20:23], a[20:23], a[4:7], v[20:23]
    ds_read_b64_tr_b16 a[34:35], v133 offset:14336
    v_mfma_f32_16x16x32_bf16 v[8:11], a[24:27], a[0:3], v[8:11]
    ds_read_b64_tr_b16 a[36:37], v134 offset:12288
    ds_read_b64_tr_b16 a[38:39], v134 offset:14336
    v_mfma_f32_16x16x32_bf16 v[24:27], a[24:27], a[4:7], v[24:27]
    ds_read_b64_tr_b16 a[40:41], v135 offset:12288
    v_mfma_f32_16x16x32_bf16 v[12:15], a[28:31], a[0:3], v[12:15]
    ds_read_b64_tr_b16 a[42:43], v135 offset:14336
    ds_read_b64_tr_b16 a[44:45], v136 offset:12288
    v_mfma_f32_16x16x32_bf16 v[28:31], a[28:31], a[4:7], v[28:31]
    ds_read_b64_tr_b16 a[46:47], v136 offset:14336
    s_barrier
    s_waitcnt lgkmcnt(0)
    v_mfma_f32_16x16x32_bf16 v[0:3], a[32:35], a[8:11], v[0:3]
    ds_read_b128 a[0:3], v141 offset:16384
    ds_read_b128 a[4:7], v141 offset:18432
    v_mfma_f32_16x16x32_bf16 v[16:19], a[32:35], a[12:15], v[16:19]
    ds_read_b64_tr_b16 a[16:17], v133 offset:0
    v_mfma_f32_16x16x32_bf16 v[4:7], a[36:39], a[8:11], v[4:7]
    ds_read_b64_tr_b16 a[18:19], v133 offset:2048
    v_mfma_f32_16x16x32_bf16 v[20:23], a[36:39], a[12:15], v[20:23]
    ds_read_b64_tr_b16 a[20:21], v134 offset:0
    v_mfma_f32_16x16x32_bf16 v[8:11], a[40:43], a[8:11], v[8:11]
    ds_read_b64_tr_b16 a[22:23], v134 offset:2048
    ds_read_b64_tr_b16 a[24:25], v135 offset:0
    v_mfma_f32_16x16x32_bf16 v[24:27], a[40:43], a[12:15], v[24:27]
    ds_read_b64_tr_b16 a[26:27], v135 offset:2048
    v_mfma_f32_16x16x32_bf16 v[12:15], a[44:47], a[8:11], v[12:15]
    ds_read_b64_tr_b16 a[28:29], v136 offset:0
    v_mfma_f32_16x16x32_bf16 v[28:31], a[44:47], a[12:15], v[28:31]
    ds_read_b64_tr_b16 a[30:31], v136 offset:2048
    s_waitcnt lgkmcnt(0)
    v_mfma_f32_16x16x32_bf16 v[0:3], a[16:19], a[0:3], v[0:3]
    ds_read_b128 a[8:11], v141 offset:17408
    ds_read_b128 a[12:15], v141 offset:19456
    v_mfma_f32_16x16x32_bf16 v[16:19], a[16:19], a[4:7], v[16:19]
    ds_read_b64_tr_b16 a[32:33], v133 offset:4096
    v_mfma_f32_16x16x32_bf16 v[4:7], a[20:23], a[0:3], v[4:7]
    ds_read_b64_tr_b16 a[34:35], v133 offset:6144
    v_mfma_f32_16x16x32_bf16 v[20:23], a[20:23], a[4:7], v[20:23]
    ds_read_b64_tr_b16 a[36:37], v134 offset:4096
    v_mfma_f32_16x16x32_bf16 v[8:11], a[24:27], a[0:3], v[8:11]
    ds_read_b64_tr_b16 a[38:39], v134 offset:6144
    ds_read_b64_tr_b16 a[40:41], v135 offset:4096
    v_mfma_f32_16x16x32_bf16 v[24:27], a[24:27], a[4:7], v[24:27]
    ds_read_b64_tr_b16 a[42:43], v135 offset:6144
    v_mfma_f32_16x16x32_bf16 v[12:15], a[28:31], a[0:3], v[12:15]
    ds_read_b64_tr_b16 a[44:45], v136 offset:4096
    v_mfma_f32_16x16x32_bf16 v[28:31], a[28:31], a[4:7], v[28:31]
    ds_read_b64_tr_b16 a[46:47], v136 offset:6144
    s_waitcnt lgkmcnt(0)
    v_mfma_f32_16x16x32_bf16 v[0:3], a[32:35], a[8:11], v[0:3]
    v_mfma_f32_16x16x32_bf16 v[16:19], a[32:35], a[12:15], v[16:19]
    v_mfma_f32_16x16x32_bf16 v[4:7], a[36:39], a[8:11], v[4:7]
    v_mfma_f32_16x16x32_bf16 v[20:23], a[36:39], a[12:15], v[20:23]
    v_mfma_f32_16x16x32_bf16 v[8:11], a[40:43], a[8:11], v[8:11]
    v_mfma_f32_16x16x32_bf16 v[24:27], a[40:43], a[12:15], v[24:27]
    v_mfma_f32_16x16x32_bf16 v[12:15], a[44:47], a[8:11], v[12:15]
    v_mfma_f32_16x16x32_bf16 v[28:31], a[44:47], a[12:15], v[28:31]
    s_waitcnt vmcnt(0)
    s_barrier
    ds_read_b128 v[64:67], v97 offset:0
    ds_read_b128 v[68:71], v97 offset:64
    ds_read_b128 v[72:75], v97 offset:128
    ds_read_b128 v[76:79], v97 offset:192
    v_add_f32 v112, v112, v116
    v_add_f32 v113, v113, v117
    v_add_f32 v120, v120, v124
    v_add_f32 v121, v121, v125
    v_mov_b32 v116, v112
    v_mov_b32 v117, v113
    v_mov_b32 v124, v120
    v_mov_b32 v125, v121
    v_permlane16_swap_b32 v112, v116
    v_permlane16_swap_b32 v113, v117
    v_permlane16_swap_b32 v120, v124
    v_permlane16_swap_b32 v121, v125
    v_add_f32 v112, v112, v116
    v_add_f32 v113, v113, v117
    v_add_f32 v120, v120, v124
    v_add_f32 v121, v121, v125
    v_mov_b32 v116, v112
    v_mov_b32 v117, v113
    v_mov_b32 v124, v120
    v_mov_b32 v125, v121
    v_permlane32_swap_b32 v112, v116
    v_permlane32_swap_b32 v113, v117
    v_permlane32_swap_b32 v120, v124
    v_permlane32_swap_b32 v121, v125
    v_add_f32 v112, v112, v116
    v_add_f32 v113, v113, v117
    v_add_f32 v120, v120, v124
    v_add_f32 v121, v121, v125
    v_mul_f32 v96, 986500301, v112
    v_mul_f32 v113, 986500301, v113
    v_fma_f32 v113, -v96, v96, v113
    v_max_f32 v113, 0, v113
    v_add_f32 v113, 925353388, v113
    v_rsq_f32 v98, v113
    s_nop 0
    v_mul_f32 v97, v113, v98
    v_mul_f32 v99, v98, v98
    v_mul_f32 v99, v99, v98
    v_mul_f32 v99, 3184710632, v99
    v_mul_f32 v98, 3222493025, v98
    v_mul_f32 v100, 986500301, v120
    v_mul_f32 v121, 986500301, v121
    v_fma_f32 v121, -v100, v100, v121
    v_max_f32 v121, 0, v121
    v_add_f32 v121, 925353388, v121
    v_rsq_f32 v102, v121
    s_nop 0
    v_mul_f32 v101, v121, v102
    v_mul_f32 v103, v102, v102
    v_mul_f32 v103, v103, v102
    v_mul_f32 v103, 3184710632, v103
    v_mul_f32 v102, 3222493025, v102
    s_waitcnt lgkmcnt(0)
    v_pk_fma_f32 v[0:1], v[64:65], v[96:97], v[0:1] op_sel:[0,0,0] op_sel_hi:[1,0,1] neg_lo:[1,0,0] neg_hi:[1,0,0]
    v_pk_fma_f32 v[2:3], v[66:67], v[96:97], v[2:3] op_sel:[0,0,0] op_sel_hi:[1,0,1] neg_lo:[1,0,0] neg_hi:[1,0,0]
    v_pk_fma_f32 v[4:5], v[68:69], v[96:97], v[4:5] op_sel:[0,0,0] op_sel_hi:[1,0,1] neg_lo:[1,0,0] neg_hi:[1,0,0]
    v_pk_fma_f32 v[6:7], v[70:71], v[96:97], v[6:7] op_sel:[0,0,0] op_sel_hi:[1,0,1] neg_lo:[1,0,0] neg_hi:[1,0,0]
    v_pk_mul_f32 v[104:105], v[0:1], v[0:1]
    v_pk_mul_f32 v[106:107], v[2:3], v[2:3]
    v_pk_mul_f32 v[108:109], v[4:5], v[4:5]
    v_pk_mul_f32 v[110:111], v[6:7], v[6:7]
    v_pk_fma_f32 v[104:105], v[104:105], v[98:99], v[98:99] op_sel:[0,1,0] op_sel_hi:[1,1,0]
    v_pk_fma_f32 v[106:107], v[106:107], v[98:99], v[98:99] op_sel:[0,1,0] op_sel_hi:[1,1,0]
    v_pk_fma_f32 v[108:109], v[108:109], v[98:99], v[98:99] op_sel:[0,1,0] op_sel_hi:[1,1,0]
    v_pk_fma_f32 v[110:111], v[110:111], v[98:99], v[98:99] op_sel:[0,1,0] op_sel_hi:[1,1,0]
    v_pk_mul_f32 v[104:105], v[104:105], v[0:1]
    v_pk_mul_f32 v[106:107], v[106:107], v[2:3]
    v_pk_mul_f32 v[108:109], v[108:109], v[4:5]
    v_pk_mul_f32 v[110:111], v[110:111], v[6:7]
    v_exp_f32 v104, v104
    v_exp_f32 v105, v105
    v_exp_f32 v106, v106
    v_exp_f32 v107, v107
    v_exp_f32 v108, v108
    v_exp_f32 v109, v109
    v_exp_f32 v110, v110
    v_exp_f32 v111, v111
    v_pk_fma_f32 v[104:105], v[104:105], v[96:97], v[96:97] op_sel:[0,1,1] op_sel_hi:[1,1,1]
    v_pk_fma_f32 v[106:107], v[106:107], v[96:97], v[96:97] op_sel:[0,1,1] op_sel_hi:[1,1,1]
    v_pk_fma_f32 v[108:109], v[108:109], v[96:97], v[96:97] op_sel:[0,1,1] op_sel_hi:[1,1,1]
    v_pk_fma_f32 v[110:111], v[110:111], v[96:97], v[96:97] op_sel:[0,1,1] op_sel_hi:[1,1,1]
    v_rcp_f32 v104, v104
    v_rcp_f32 v105, v105
    v_rcp_f32 v106, v106
    v_rcp_f32 v107, v107
    v_rcp_f32 v108, v108
    v_rcp_f32 v109, v109
    v_rcp_f32 v110, v110
    v_rcp_f32 v111, v111
    v_pk_mul_f32 v[104:105], v[104:105], v[0:1]
    v_pk_mul_f32 v[106:107], v[106:107], v[2:3]
    v_pk_mul_f32 v[108:109], v[108:109], v[4:5]
    v_pk_mul_f32 v[110:111], v[110:111], v[6:7]
    v_cvt_pk_bf16_f32 v0, v104, v105
    v_cvt_pk_bf16_f32 v1, v106, v107
    v_cvt_pk_bf16_f32 v2, v108, v109
    v_cvt_pk_bf16_f32 v3, v110, v111
    buffer_store_dwordx4 v[0:3], v143, s[52:55], s84 offen offset:0 sc1
    v_pk_fma_f32 v[8:9], v[72:73], v[96:97], v[8:9] op_sel:[0,0,0] op_sel_hi:[1,0,1] neg_lo:[1,0,0] neg_hi:[1,0,0]
    v_pk_fma_f32 v[10:11], v[74:75], v[96:97], v[10:11] op_sel:[0,0,0] op_sel_hi:[1,0,1] neg_lo:[1,0,0] neg_hi:[1,0,0]
    v_pk_fma_f32 v[12:13], v[76:77], v[96:97], v[12:13] op_sel:[0,0,0] op_sel_hi:[1,0,1] neg_lo:[1,0,0] neg_hi:[1,0,0]
    v_pk_fma_f32 v[14:15], v[78:79], v[96:97], v[14:15] op_sel:[0,0,0] op_sel_hi:[1,0,1] neg_lo:[1,0,0] neg_hi:[1,0,0]
    v_pk_mul_f32 v[104:105], v[8:9], v[8:9]
    v_pk_mul_f32 v[106:107], v[10:11], v[10:11]
    v_pk_mul_f32 v[108:109], v[12:13], v[12:13]
    v_pk_mul_f32 v[110:111], v[14:15], v[14:15]
    v_pk_fma_f32 v[104:105], v[104:105], v[98:99], v[98:99] op_sel:[0,1,0] op_sel_hi:[1,1,0]
    v_pk_fma_f32 v[106:107], v[106:107], v[98:99], v[98:99] op_sel:[0,1,0] op_sel_hi:[1,1,0]
    v_pk_fma_f32 v[108:109], v[108:109], v[98:99], v[98:99] op_sel:[0,1,0] op_sel_hi:[1,1,0]
    v_pk_fma_f32 v[110:111], v[110:111], v[98:99], v[98:99] op_sel:[0,1,0] op_sel_hi:[1,1,0]
    v_pk_mul_f32 v[104:105], v[104:105], v[8:9]
    v_pk_mul_f32 v[106:107], v[106:107], v[10:11]
    v_pk_mul_f32 v[108:109], v[108:109], v[12:13]
    v_pk_mul_f32 v[110:111], v[110:111], v[14:15]
    v_exp_f32 v104, v104
    v_exp_f32 v105, v105
    v_exp_f32 v106, v106
    v_exp_f32 v107, v107
    v_exp_f32 v108, v108
    v_exp_f32 v109, v109
    v_exp_f32 v110, v110
    v_exp_f32 v111, v111
    v_pk_fma_f32 v[104:105], v[104:105], v[96:97], v[96:97] op_sel:[0,1,1] op_sel_hi:[1,1,1]
    v_pk_fma_f32 v[106:107], v[106:107], v[96:97], v[96:97] op_sel:[0,1,1] op_sel_hi:[1,1,1]
    v_pk_fma_f32 v[108:109], v[108:109], v[96:97], v[96:97] op_sel:[0,1,1] op_sel_hi:[1,1,1]
    v_pk_fma_f32 v[110:111], v[110:111], v[96:97], v[96:97] op_sel:[0,1,1] op_sel_hi:[1,1,1]
    v_rcp_f32 v104, v104
    v_rcp_f32 v105, v105
    v_rcp_f32 v106, v106
    v_rcp_f32 v107, v107
    v_rcp_f32 v108, v108
    v_rcp_f32 v109, v109
    v_rcp_f32 v110, v110
    v_rcp_f32 v111, v111
    v_pk_mul_f32 v[104:105], v[104:105], v[8:9]
    v_pk_mul_f32 v[106:107], v[106:107], v[10:11]
    v_pk_mul_f32 v[108:109], v[108:109], v[12:13]
    v_pk_mul_f32 v[110:111], v[110:111], v[14:15]
    v_cvt_pk_bf16_f32 v8, v104, v105
    v_cvt_pk_bf16_f32 v9, v106, v107
    v_cvt_pk_bf16_f32 v10, v108, v109
    v_cvt_pk_bf16_f32 v11, v110, v111
    buffer_store_dwordx4 v[8:11], v143, s[52:55], s84 offen offset:1024 sc1
    v_pk_fma_f32 v[16:17], v[64:65], v[100:101], v[16:17] op_sel:[0,0,0] op_sel_hi:[1,0,1] neg_lo:[1,0,0] neg_hi:[1,0,0]
    v_pk_fma_f32 v[18:19], v[66:67], v[100:101], v[18:19] op_sel:[0,0,0] op_sel_hi:[1,0,1] neg_lo:[1,0,0] neg_hi:[1,0,0]
    v_pk_fma_f32 v[20:21], v[68:69], v[100:101], v[20:21] op_sel:[0,0,0] op_sel_hi:[1,0,1] neg_lo:[1,0,0] neg_hi:[1,0,0]
    v_pk_fma_f32 v[22:23], v[70:71], v[100:101], v[22:23] op_sel:[0,0,0] op_sel_hi:[1,0,1] neg_lo:[1,0,0] neg_hi:[1,0,0]
    v_pk_mul_f32 v[104:105], v[16:17], v[16:17]
    v_pk_mul_f32 v[106:107], v[18:19], v[18:19]
    v_pk_mul_f32 v[108:109], v[20:21], v[20:21]
    v_pk_mul_f32 v[110:111], v[22:23], v[22:23]
    v_pk_fma_f32 v[104:105], v[104:105], v[102:103], v[102:103] op_sel:[0,1,0] op_sel_hi:[1,1,0]
    v_pk_fma_f32 v[106:107], v[106:107], v[102:103], v[102:103] op_sel:[0,1,0] op_sel_hi:[1,1,0]
    v_pk_fma_f32 v[108:109], v[108:109], v[102:103], v[102:103] op_sel:[0,1,0] op_sel_hi:[1,1,0]
    v_pk_fma_f32 v[110:111], v[110:111], v[102:103], v[102:103] op_sel:[0,1,0] op_sel_hi:[1,1,0]
    v_pk_mul_f32 v[104:105], v[104:105], v[16:17]
    v_pk_mul_f32 v[106:107], v[106:107], v[18:19]
    v_pk_mul_f32 v[108:109], v[108:109], v[20:21]
    v_pk_mul_f32 v[110:111], v[110:111], v[22:23]
    v_exp_f32 v104, v104
    v_exp_f32 v105, v105
    v_exp_f32 v106, v106
    v_exp_f32 v107, v107
    v_exp_f32 v108, v108
    v_exp_f32 v109, v109
    v_exp_f32 v110, v110
    v_exp_f32 v111, v111
    v_pk_fma_f32 v[104:105], v[104:105], v[100:101], v[100:101] op_sel:[0,1,1] op_sel_hi:[1,1,1]
    v_pk_fma_f32 v[106:107], v[106:107], v[100:101], v[100:101] op_sel:[0,1,1] op_sel_hi:[1,1,1]
    v_pk_fma_f32 v[108:109], v[108:109], v[100:101], v[100:101] op_sel:[0,1,1] op_sel_hi:[1,1,1]
    v_pk_fma_f32 v[110:111], v[110:111], v[100:101], v[100:101] op_sel:[0,1,1] op_sel_hi:[1,1,1]
    v_rcp_f32 v104, v104
    v_rcp_f32 v105, v105
    v_rcp_f32 v106, v106
    v_rcp_f32 v107, v107
    v_rcp_f32 v108, v108
    v_rcp_f32 v109, v109
    v_rcp_f32 v110, v110
    v_rcp_f32 v111, v111
    v_pk_mul_f32 v[104:105], v[104:105], v[16:17]
    v_pk_mul_f32 v[106:107], v[106:107], v[18:19]
    v_pk_mul_f32 v[108:109], v[108:109], v[20:21]
    v_pk_mul_f32 v[110:111], v[110:111], v[22:23]
    v_cvt_pk_bf16_f32 v16, v104, v105
    v_cvt_pk_bf16_f32 v17, v106, v107
    v_cvt_pk_bf16_f32 v18, v108, v109
    v_cvt_pk_bf16_f32 v19, v110, v111
    buffer_store_dwordx4 v[16:19], v143, s[52:55], s85 offen offset:0 sc1
    v_pk_fma_f32 v[24:25], v[72:73], v[100:101], v[24:25] op_sel:[0,0,0] op_sel_hi:[1,0,1] neg_lo:[1,0,0] neg_hi:[1,0,0]
    v_pk_fma_f32 v[26:27], v[74:75], v[100:101], v[26:27] op_sel:[0,0,0] op_sel_hi:[1,0,1] neg_lo:[1,0,0] neg_hi:[1,0,0]
    v_pk_fma_f32 v[28:29], v[76:77], v[100:101], v[28:29] op_sel:[0,0,0] op_sel_hi:[1,0,1] neg_lo:[1,0,0] neg_hi:[1,0,0]
    v_pk_fma_f32 v[30:31], v[78:79], v[100:101], v[30:31] op_sel:[0,0,0] op_sel_hi:[1,0,1] neg_lo:[1,0,0] neg_hi:[1,0,0]
    v_pk_mul_f32 v[104:105], v[24:25], v[24:25]
    v_pk_mul_f32 v[106:107], v[26:27], v[26:27]
    v_pk_mul_f32 v[108:109], v[28:29], v[28:29]
    v_pk_mul_f32 v[110:111], v[30:31], v[30:31]
    v_pk_fma_f32 v[104:105], v[104:105], v[102:103], v[102:103] op_sel:[0,1,0] op_sel_hi:[1,1,0]
    v_pk_fma_f32 v[106:107], v[106:107], v[102:103], v[102:103] op_sel:[0,1,0] op_sel_hi:[1,1,0]
    v_pk_fma_f32 v[108:109], v[108:109], v[102:103], v[102:103] op_sel:[0,1,0] op_sel_hi:[1,1,0]
    v_pk_fma_f32 v[110:111], v[110:111], v[102:103], v[102:103] op_sel:[0,1,0] op_sel_hi:[1,1,0]
    v_pk_mul_f32 v[104:105], v[104:105], v[24:25]
    v_pk_mul_f32 v[106:107], v[106:107], v[26:27]
    v_pk_mul_f32 v[108:109], v[108:109], v[28:29]
    v_pk_mul_f32 v[110:111], v[110:111], v[30:31]
    v_exp_f32 v104, v104
    v_exp_f32 v105, v105
    v_exp_f32 v106, v106
    v_exp_f32 v107, v107
    v_exp_f32 v108, v108
    v_exp_f32 v109, v109
    v_exp_f32 v110, v110
    v_exp_f32 v111, v111
    v_pk_fma_f32 v[104:105], v[104:105], v[100:101], v[100:101] op_sel:[0,1,1] op_sel_hi:[1,1,1]
    v_pk_fma_f32 v[106:107], v[106:107], v[100:101], v[100:101] op_sel:[0,1,1] op_sel_hi:[1,1,1]
    v_pk_fma_f32 v[108:109], v[108:109], v[100:101], v[100:101] op_sel:[0,1,1] op_sel_hi:[1,1,1]
    v_pk_fma_f32 v[110:111], v[110:111], v[100:101], v[100:101] op_sel:[0,1,1] op_sel_hi:[1,1,1]
    v_rcp_f32 v104, v104
    v_rcp_f32 v105, v105
    v_rcp_f32 v106, v106
    v_rcp_f32 v107, v107
    v_rcp_f32 v108, v108
    v_rcp_f32 v109, v109
    v_rcp_f32 v110, v110
    v_rcp_f32 v111, v111
    v_pk_mul_f32 v[104:105], v[104:105], v[24:25]
    v_pk_mul_f32 v[106:107], v[106:107], v[26:27]
    v_pk_mul_f32 v[108:109], v[108:109], v[28:29]
    v_pk_mul_f32 v[110:111], v[110:111], v[30:31]
    v_cvt_pk_bf16_f32 v24, v104, v105
    v_cvt_pk_bf16_f32 v25, v106, v107
    v_cvt_pk_bf16_f32 v26, v108, v109
    v_cvt_pk_bf16_f32 v27, v110, v111
    buffer_store_dwordx4 v[24:27], v143, s[52:55], s85 offen offset:1024 sc1
    s_branch p_sig3
p_w1:
    v_mov_b32 v120, 0x3f803f80
    v_accvgpr_write_b32 a108, v120
    v_accvgpr_write_b32 a109, v120
    v_accvgpr_write_b32 a110, v120
    v_accvgpr_write_b32 a111, v120
    s_lshl_b32 s11, s8, 11
    v_add_u32 v64, s11, v125
    v_xor_b32 v65, 64, v64
    v_add_u32 v123, 8192, v123
    v_add_u32 v66, 57344, v64
    v_add_u32 v67, 57344, v65
    s_lshl_b32 s87, s8, 2
    s_add_u32 s11, s87, 0
    s_cmp_ge_u32 s11, 10
    s_cselect_b32 s13, 10, 0
    s_sub_u32 s11, s11, s13
    s_cmp_ge_u32 s11, 10
    s_cselect_b32 s13, 10, 0
    s_sub_u32 s11, s11, s13
    s_lshl_b32 s11, s11, 5
    v_xor_b32 v120, s11, v124
    v_add_u32 v80, v123, v120
    v_add_u32 v90, 57344, v80
    s_add_u32 s11, s87, 1
    s_cmp_ge_u32 s11, 10
    s_cselect_b32 s13, 10, 0
    s_sub_u32 s11, s11, s13
    s_cmp_ge_u32 s11, 10
    s_cselect_b32 s13, 10, 0
    s_sub_u32 s11, s11, s13
    s_lshl_b32 s11, s11, 5
    v_xor_b32 v120, s11, v124
    v_add_u32 v81, v123, v120
    v_add_u32 v91, 57344, v81
    s_add_u32 s11, s87, 2
    s_cmp_ge_u32 s11, 10
    s_cselect_b32 s13, 10, 0
    s_sub_u32 s11, s11, s13
    s_cmp_ge_u32 s11, 10
    s_cselect_b32 s13, 10, 0
    s_sub_u32 s11, s11, s13
    s_lshl_b32 s11, s11, 5
    v_xor_b32 v120, s11, v124
    v_add_u32 v82, v123, v120
    v_add_u32 v92, 57344, v82
    s_add_u32 s11, s87, 3
    s_cmp_ge_u32 s11, 10
    s_cselect_b32 s13, 10, 0
    s_sub_u32 s11, s11, s13
    s_cmp_ge_u32 s11, 10
    s_cselect_b32 s13, 10, 0
    s_sub_u32 s11, s11, s13
    s_lshl_b32 s11, s11, 5
    v_xor_b32 v120, s11, v124
    v_add_u32 v83, v123, v120
    v_add_u32 v93, 57344, v83
    s_add_u32 s11, s87, 4
    s_cmp_ge_u32 s11, 10
    s_cselect_b32 s13, 10, 0
    s_sub_u32 s11, s11, s13
    s_cmp_ge_u32 s11, 10
    s_cselect_b32 s13, 10, 0
    s_sub_u32 s11, s11, s13
    s_lshl_b32 s11, s11, 5
    v_xor_b32 v120, s11, v124
    v_add_u32 v84, v123, v120
    v_add_u32 v94, 57344, v84
    s_add_u32 s11, s87, 5
    s_cmp_ge_u32 s11, 10
    s_cselect_b32 s13, 10, 0
    s_sub_u32 s11, s11, s13
    s_cmp_ge_u32 s11, 10
    s_cselect_b32 s13, 10, 0
    s_sub_u32 s11, s11, s13
    s_lshl_b32 s11, s11, 5
    v_xor_b32 v120, s11, v124
    v_add_u32 v85, v123, v120
    v_add_u32 v95, 57344, v85
    s_add_u32 s11, s87, 6
    s_cmp_ge_u32 s11, 10
    s_cselect_b32 s13, 10, 0
    s_sub_u32 s11, s11, s13
    s_cmp_ge_u32 s11, 10
    s_cselect_b32 s13, 10, 0
    s_sub_u32 s11, s11, s13
    s_lshl_b32 s11, s11, 5
    v_xor_b32 v120, s11, v124
    v_add_u32 v86, v123, v120
    v_add_u32 v96, 57344, v86
    s_add_u32 s11, s87, 7
    s_cmp_ge_u32 s11, 10
    s_cselect_b32 s13, 10, 0
    s_sub_u32 s11, s11, s13
    s_cmp_ge_u32 s11, 10
    s_cselect_b32 s13, 10, 0
    s_sub_u32 s11, s11, s13
    s_lshl_b32 s11, s11, 5
    v_xor_b32 v120, s11, v124
    v_add_u32 v87, v123, v120
    v_add_u32 v97, 57344, v87
    s_add_u32 s11, s87, 8
    s_cmp_ge_u32 s11, 10
    s_cselect_b32 s13, 10, 0
    s_sub_u32 s11, s11, s13
    s_cmp_ge_u32 s11, 10
    s_cselect_b32 s13, 10, 0
    s_sub_u32 s11, s11, s13
    s_lshl_b32 s11, s11, 5
    v_xor_b32 v120, s11, v124
    v_add_u32 v88, v123, v120
    v_add_u32 v98, 57344, v88
    s_add_u32 s11, s87, 9
    s_cmp_ge_u32 s11, 10
    s_cselect_b32 s13, 10, 0
    s_sub_u32 s11, s11, s13
    s_cmp_ge_u32 s11, 10
    s_cselect_b32 s13, 10, 0
    s_sub_u32 s11, s11, s13
    s_lshl_b32 s11, s11, 5
    v_xor_b32 v120, s11, v124
    v_add_u32 v89, v123, v120
    v_add_u32 v99, 57344, v89
    s_barrier
    ds_read_b128 a[0:3], v64 offset:0
    ds_read_b64_tr_b16 a[8:9], v80 offset:0
    ds_read_b64_tr_b16 a[10:11], v80 offset:5120
    ds_read_b64_tr_b16 a[12:13], v81 offset:0
    ds_read_b64_tr_b16 a[14:15], v81 offset:5120
    ds_read_b64_tr_b16 a[16:17], v82 offset:0
    ds_read_b64_tr_b16 a[18:19], v82 offset:5120
    ds_read_b64_tr_b16 a[20:21], v83 offset:0
    ds_read_b64_tr_b16 a[22:23], v83 offset:5120
    ds_read_b64_tr_b16 a[24:25], v84 offset:0
    ds_read_b64_tr_b16 a[26:27], v84 offset:5120
    ds_read_b64_tr_b16 a[28:29], v85 offset:0
    ds_read_b64_tr_b16 a[30:31], v85 offset:5120
    ds_read_b64_tr_b16 a[32:33], v86 offset:0
    ds_read_b64_tr_b16 a[34:35], v86 offset:5120
    ds_read_b64_tr_b16 a[36:37], v87 offset:0
    ds_read_b64_tr_b16 a[38:39], v87 offset:5120
    ds_read_b64_tr_b16 a[40:41], v88 offset:0
    ds_read_b64_tr_b16 a[42:43], v88 offset:5120
    ds_read_b64_tr_b16 a[44:45], v89 offset:0
    ds_read_b64_tr_b16 a[46:47], v89 offset:5120
    s_waitcnt lgkmcnt(10)
    v_mfma_f32_16x16x32_bf16 v[0:3], a[8:11], a[0:3], 0
    ds_read_b128 a[4:7], v65 offset:0
    ds_read_b64_tr_b16 a[48:49], v80 offset:10240
    v_mfma_f32_16x16x32_bf16 v[4:7], a[12:15], a[0:3], 0
    ds_read_b64_tr_b16 a[50:51], v80 offset:15360
    v_mfma_f32_16x16x32_bf16 v[8:11], a[16:19], a[0:3], 0
    ds_read_b64_tr_b16 a[52:53], v81 offset:10240
    v_mfma_f32_16x16x32_bf16 v[12:15], a[20:23], a[0:3], 0
    ds_read_b64_tr_b16 a[54:55], v81 offset:15360
    ds_read_b64_tr_b16 a[56:57], v82 offset:10240
    v_mfma_f32_16x16x32_bf16 v[16:19], a[24:27], a[0:3], 0
    ds_read_b64_tr_b16 a[58:59], v82 offset:15360
    s_waitcnt lgkmcnt(7)
    v_mfma_f32_16x16x32_bf16 v[20:23], a[28:31], a[0:3], 0
    ds_read_b64_tr_b16 a[60:61], v83 offset:10240
    v_mfma_f32_16x16x32_bf16 v[24:27], a[32:35], a[0:3], 0
    ds_read_b64_tr_b16 a[62:63], v83 offset:15360
    ds_read_b64_tr_b16 a[64:65], v84 offset:10240
    v_mfma_f32_16x16x32_bf16 v[28:31], a[36:39], a[0:3], 0
    ds_read_b64_tr_b16 a[66:67], v84 offset:15360
    v_mfma_f32_16x16x32_bf16 v[32:35], a[40:43], a[0:3], 0
    ds_read_b64_tr_b16 a[68:69], v85 offset:10240
    v_mfma_f32_16x16x32_bf16 v[36:39], a[44:47], a[0:3], 0
    ds_read_b64_tr_b16 a[70:71], v85 offset:15360
    ds_read_b64_tr_b16 a[72:73], v86 offset:10240
    v_mfma_f32_16x16x32_bf16 v[40:43], a[108:111], a[0:3], 0
    ds_read_b64_tr_b16 a[74:75], v86 offset:15360
    v_mfma_f32_16x16x32_bf16 v[44:47], a[0:3], a[0:3], 0
    ds_read_b64_tr_b16 a[76:77], v87 offset:10240
    v_mfma_f32_16x16x32_bf16 v[48:51], a[8:11], a[108:111], 0
    ds_read_b64_tr_b16 a[78:79], v87 offset:15360
    ds_read_b64_tr_b16 a[80:81], v88 offset:10240
    v_mfma_f32_16x16x32_bf16 v[52:55], a[12:15], a[108:111], 0
    ds_read_b64_tr_b16 a[82:83], v88 offset:15360
    v_mfma_f32_16x16x32_bf16 v[56:59], a[16:19], a[108:111], 0
    ds_read_b64_tr_b16 a[84:85], v89 offset:10240
    v_mfma_f32_16x16x32_bf16 v[60:63], a[20:23], a[108:111], 0
    ds_read_b64_tr_b16 a[86:87], v89 offset:15360
    s_barrier
    s_waitcnt lgkmcnt(10)
    v_mfma_f32_16x16x32_bf16 v[0:3], a[48:51], a[4:7], v[0:3]
    ds_read_b128 a[0:3], v64 offset:28672
    ds_read_b64_tr_b16 a[8:9], v80 offset:28672
    v_mfma_f32_16x16x32_bf16 v[4:7], a[52:55], a[4:7], v[4:7]
    ds_read_b64_tr_b16 a[10:11], v80 offset:33792
    v_mfma_f32_16x16x32_bf16 v[8:11], a[56:59], a[4:7], v[8:11]
    ds_read_b64_tr_b16 a[12:13], v81 offset:28672
    v_mfma_f32_16x16x32_bf16 v[12:15], a[60:63], a[4:7], v[12:15]
    ds_read_b64_tr_b16 a[14:15], v81 offset:33792
    ds_read_b64_tr_b16 a[16:17], v82 offset:28672
    v_mfma_f32_16x16x32_bf16 v[16:19], a[64:67], a[4:7], v[16:19]
    ds_read_b64_tr_b16 a[18:19], v82 offset:33792
    s_waitcnt lgkmcnt(7)
    v_mfma_f32_16x16x32_bf16 v[20:23], a[68:71], a[4:7], v[20:23]
    ds_read_b64_tr_b16 a[20:21], v83 offset:28672
    v_mfma_f32_16x16x32_bf16 v[24:27], a[72:75], a[4:7], v[24:27]
    ds_read_b64_tr_b16 a[22:23], v83 offset:33792
    ds_read_b64_tr_b16 a[24:25], v84 offset:28672
    v_mfma_f32_16x16x32_bf16 v[28:31], a[76:79], a[4:7], v[28:31]
    ds_read_b64_tr_b16 a[26:27], v84 offset:33792
    v_mfma_f32_16x16x32_bf16 v[32:35], a[80:83], a[4:7], v[32:35]
    ds_read_b64_tr_b16 a[28:29], v85 offset:28672
    v_mfma_f32_16x16x32_bf16 v[36:39], a[84:87], a[4:7], v[36:39]
    ds_read_b64_tr_b16 a[30:31], v85 offset:33792
    ds_read_b64_tr_b16 a[32:33], v86 offset:28672
    v_mfma_f32_16x16x32_bf16 v[40:43], a[108:111], a[4:7], v[40:43]
    ds_read_b64_tr_b16 a[34:35], v86 offset:33792
    v_mfma_f32_16x16x32_bf16 v[44:47], a[4:7], a[4:7], v[44:47]
    ds_read_b64_tr_b16 a[36:37], v87 offset:28672
    v_mfma_f32_16x16x32_bf16 v[48:51], a[48:51], a[108:111], v[48:51]
    ds_read_b64_tr_b16 a[38:39], v87 offset:33792
    ds_read_b64_tr_b16 a[40:41], v88 offset:28672
    v_mfma_f32_16x16x32_bf16 v[52:55], a[52:55], a[108:111], v[52:55]
    ds_read_b64_tr_b16 a[42:43], v88 offset:33792
    v_mfma_f32_16x16x32_bf16 v[56:59], a[56:59], a[108:111], v[56:59]
    ds_read_b64_tr_b16 a[44:45], v89 offset:28672
    v_mfma_f32_16x16x32_bf16 v[60:63], a[60:63], a[108:111], v[60:63]
    ds_read_b64_tr_b16 a[46:47], v89 offset:33792
    s_waitcnt lgkmcnt(10)
    v_mfma_f32_16x16x32_bf16 v[0:3], a[8:11], a[0:3], v[0:3]
    ds_read_b128 a[4:7], v65 offset:28672
    ds_read_b64_tr_b16 a[48:49], v80 offset:38912
    v_mfma_f32_16x16x32_bf16 v[4:7], a[12:15], a[0:3], v[4:7]
    ds_read_b64_tr_b16 a[50:51], v80 offset:44032
    v_mfma_f32_16x16x32_bf16 v[8:11], a[16:19], a[0:3], v[8:11]
    ds_read_b64_tr_b16 a[52:53], v81 offset:38912
    v_mfma_f32_16x16x32_bf16 v[12:15], a[20:23], a[0:3], v[12:15]
    ds_read_b64_tr_b16 a[54:55], v81 offset:44032
    ds_read_b64_tr_b16 a[56:57], v82 offset:38912
    v_mfma_f32_16x16x32_bf16 v[16:19], a[24:27], a[0:3], v[16:19]
    ds_read_b64_tr_b16 a[58:59], v82 offset:44032
    s_waitcnt lgkmcnt(7)
    v_mfma_f32_16x16x32_bf16 v[20:23], a[28:31], a[0:3], v[20:23]
    ds_read_b64_tr_b16 a[60:61], v83 offset:38912
    v_mfma_f32_16x16x32_bf16 v[24:27], a[32:35], a[0:3], v[24:27]
    ds_read_b64_tr_b16 a[62:63], v83 offset:44032
    ds_read_b64_tr_b16 a[64:65], v84 offset:38912
    v_mfma_f32_16x16x32_bf16 v[28:31], a[36:39], a[0:3], v[28:31]
    ds_read_b64_tr_b16 a[66:67], v84 offset:44032
    v_mfma_f32_16x16x32_bf16 v[32:35], a[40:43], a[0:3], v[32:35]
    ds_read_b64_tr_b16 a[68:69], v85 offset:38912
    v_mfma_f32_16x16x32_bf16 v[36:39], a[44:47], a[0:3], v[36:39]
    ds_read_b64_tr_b16 a[70:71], v85 offset:44032
    ds_read_b64_tr_b16 a[72:73], v86 offset:38912
    v_mfma_f32_16x16x32_bf16 v[40:43], a[108:111], a[0:3], v[40:43]
    ds_read_b64_tr_b16 a[74:75], v86 offset:44032
    v_mfma_f32_16x16x32_bf16 v[44:47], a[0:3], a[0:3], v[44:47]
    ds_read_b64_tr_b16 a[76:77], v87 offset:38912
    v_mfma_f32_16x16x32_bf16 v[48:51], a[8:11], a[108:111], v[48:51]
    ds_read_b64_tr_b16 a[78:79], v87 offset:44032
    ds_read_b64_tr_b16 a[80:81], v88 offset:38912
    v_mfma_f32_16x16x32_bf16 v[52:55], a[12:15], a[108:111], v[52:55]
    ds_read_b64_tr_b16 a[82:83], v88 offset:44032
    v_mfma_f32_16x16x32_bf16 v[56:59], a[16:19], a[108:111], v[56:59]
    ds_read_b64_tr_b16 a[84:85], v89 offset:38912
    v_mfma_f32_16x16x32_bf16 v[60:63], a[20:23], a[108:111], v[60:63]
    ds_read_b64_tr_b16 a[86:87], v89 offset:44032
    s_barrier
    s_waitcnt lgkmcnt(10)
    v_mfma_f32_16x16x32_bf16 v[0:3], a[48:51], a[4:7], v[0:3]
    ds_read_b128 a[0:3], v66 offset:0
    ds_read_b64_tr_b16 a[8:9], v90 offset:0
    v_mfma_f32_16x16x32_bf16 v[4:7], a[52:55], a[4:7], v[4:7]
    ds_read_b64_tr_b16 a[10:11], v90 offset:5120
    v_mfma_f32_16x16x32_bf16 v[8:11], a[56:59], a[4:7], v[8:11]
    ds_read_b64_tr_b16 a[12:13], v91 offset:0
    v_mfma_f32_16x16x32_bf16 v[12:15], a[60:63], a[4:7], v[12:15]
    ds_read_b64_tr_b16 a[14:15], v91 offset:5120
    ds_read_b64_tr_b16 a[16:17], v92 offset:0
    v_mfma_f32_16x16x32_bf16 v[16:19], a[64:67], a[4:7], v[16:19]
    ds_read_b64_tr_b16 a[18:19], v92 offset:5120
    s_waitcnt lgkmcnt(7)
    v_mfma_f32_16x16x32_bf16 v[20:23], a[68:71], a[4:7], v[20:23]
    ds_read_b64_tr_b16 a[20:21], v93 offset:0
    v_mfma_f32_16x16x32_bf16 v[24:27], a[72:75], a[4:7], v[24:27]
    ds_read_b64_tr_b16 a[22:23], v93 offset:5120
    ds_read_b64_tr_b16 a[24:25], v94 offset:0
    v_mfma_f32_16x16x32_bf16 v[28:31], a[76:79], a[4:7], v[28:31]
    ds_read_b64_tr_b16 a[26:27], v94 offset:5120
    v_mfma_f32_16x16x32_bf16 v[32:35], a[80:83], a[4:7], v[32:35]
    ds_read_b64_tr_b16 a[28:29], v95 offset:0
    v_mfma_f32_16x16x32_bf16 v[36:39], a[84:87], a[4:7], v[36:39]
    ds_read_b64_tr_b16 a[30:31], v95 offset:5120
    ds_read_b64_tr_b16 a[32:33], v96 offset:0
    v_mfma_f32_16x16x32_bf16 v[40:43], a[108:111], a[4:7], v[40:43]
    ds_read_b64_tr_b16 a[34:35], v96 offset:5120
    v_mfma_f32_16x16x32_bf16 v[44:47], a[4:7], a[4:7], v[44:47]
    ds_read_b64_tr_b16 a[36:37], v97 offset:0
    v_mfma_f32_16x16x32_bf16 v[48:51], a[48:51], a[108:111], v[48:51]
    ds_read_b64_tr_b16 a[38:39], v97 offset:5120
    ds_read_b64_tr_b16 a[40:41], v98 offset:0
    v_mfma_f32_16x16x32_bf16 v[52:55], a[52:55], a[108:111], v[52:55]
    ds_read_b64_tr_b16 a[42:43], v98 offset:5120
    v_mfma_f32_16x16x32_bf16 v[56:59], a[56:59], a[108:111], v[56:59]
    ds_read_b64_tr_b16 a[44:45], v99 offset:0
    v_mfma_f32_16x16x32_bf16 v[60:63], a[60:63], a[108:111], v[60:63]
    ds_read_b64_tr_b16 a[46:47], v99 offset:5120
    s_waitcnt lgkmcnt(10)
    v_mfma_f32_16x16x32_bf16 v[0:3], a[8:11], a[0:3], v[0:3]
    ds_read_b128 a[4:7], v67 offset:0
    ds_read_b64_tr_b16 a[48:49], v90 offset:10240
    v_mfma_f32_16x16x32_bf16 v[4:7], a[12:15], a[0:3], v[4:7]
    ds_read_b64_tr_b16 a[50:51], v90 offset:15360
    v_mfma_f32_16x16x32_bf16 v[8:11], a[16:19], a[0:3], v[8:11]
    ds_read_b64_tr_b16 a[52:53], v91 offset:10240
    v_mfma_f32_16x16x32_bf16 v[12:15], a[20:23], a[0:3], v[12:15]
    ds_read_b64_tr_b16 a[54:55], v91 offset:15360
    ds_read_b64_tr_b16 a[56:57], v92 offset:10240
    v_mfma_f32_16x16x32_bf16 v[16:19], a[24:27], a[0:3], v[16:19]
    ds_read_b64_tr_b16 a[58:59], v92 offset:15360
    s_waitcnt lgkmcnt(7)
    v_mfma_f32_16x16x32_bf16 v[20:23], a[28:31], a[0:3], v[20:23]
    ds_read_b64_tr_b16 a[60:61], v93 offset:10240
    v_mfma_f32_16x16x32_bf16 v[24:27], a[32:35], a[0:3], v[24:27]
    ds_read_b64_tr_b16 a[62:63], v93 offset:15360
    ds_read_b64_tr_b16 a[64:65], v94 offset:10240
    v_mfma_f32_16x16x32_bf16 v[28:31], a[36:39], a[0:3], v[28:31]
    ds_read_b64_tr_b16 a[66:67], v94 offset:15360
    v_mfma_f32_16x16x32_bf16 v[32:35], a[40:43], a[0:3], v[32:35]
    ds_read_b64_tr_b16 a[68:69], v95 offset:10240
    v_mfma_f32_16x16x32_bf16 v[36:39], a[44:47], a[0:3], v[36:39]
    ds_read_b64_tr_b16 a[70:71], v95 offset:15360
    ds_read_b64_tr_b16 a[72:73], v96 offset:10240
    v_mfma_f32_16x16x32_bf16 v[40:43], a[108:111], a[0:3], v[40:43]
    ds_read_b64_tr_b16 a[74:75], v96 offset:15360
    v_mfma_f32_16x16x32_bf16 v[44:47], a[0:3], a[0:3], v[44:47]
    ds_read_b64_tr_b16 a[76:77], v97 offset:10240
    v_mfma_f32_16x16x32_bf16 v[48:51], a[8:11], a[108:111], v[48:51]
    ds_read_b64_tr_b16 a[78:79], v97 offset:15360
    ds_read_b64_tr_b16 a[80:81], v98 offset:10240
    v_mfma_f32_16x16x32_bf16 v[52:55], a[12:15], a[108:111], v[52:55]
    ds_read_b64_tr_b16 a[82:83], v98 offset:15360
    v_mfma_f32_16x16x32_bf16 v[56:59], a[16:19], a[108:111], v[56:59]
    ds_read_b64_tr_b16 a[84:85], v99 offset:10240
    v_mfma_f32_16x16x32_bf16 v[60:63], a[20:23], a[108:111], v[60:63]
    ds_read_b64_tr_b16 a[86:87], v99 offset:15360
    s_barrier
    s_waitcnt lgkmcnt(10)
    v_mfma_f32_16x16x32_bf16 v[0:3], a[48:51], a[4:7], v[0:3]
    ds_read_b128 a[0:3], v66 offset:28672
    ds_read_b64_tr_b16 a[8:9], v90 offset:28672
    v_mfma_f32_16x16x32_bf16 v[4:7], a[52:55], a[4:7], v[4:7]
    ds_read_b64_tr_b16 a[10:11], v90 offset:33792
    v_mfma_f32_16x16x32_bf16 v[8:11], a[56:59], a[4:7], v[8:11]
    ds_read_b64_tr_b16 a[12:13], v91 offset:28672
    v_mfma_f32_16x16x32_bf16 v[12:15], a[60:63], a[4:7], v[12:15]
    ds_read_b64_tr_b16 a[14:15], v91 offset:33792
    ds_read_b64_tr_b16 a[16:17], v92 offset:28672
    v_mfma_f32_16x16x32_bf16 v[16:19], a[64:67], a[4:7], v[16:19]
    ds_read_b64_tr_b16 a[18:19], v92 offset:33792
    s_waitcnt lgkmcnt(7)
    v_mfma_f32_16x16x32_bf16 v[20:23], a[68:71], a[4:7], v[20:23]
    ds_read_b64_tr_b16 a[20:21], v93 offset:28672
    v_mfma_f32_16x16x32_bf16 v[24:27], a[72:75], a[4:7], v[24:27]
    ds_read_b64_tr_b16 a[22:23], v93 offset:33792
    ds_read_b64_tr_b16 a[24:25], v94 offset:28672
    v_mfma_f32_16x16x32_bf16 v[28:31], a[76:79], a[4:7], v[28:31]
    ds_read_b64_tr_b16 a[26:27], v94 offset:33792
    v_mfma_f32_16x16x32_bf16 v[32:35], a[80:83], a[4:7], v[32:35]
    ds_read_b64_tr_b16 a[28:29], v95 offset:28672
    v_mfma_f32_16x16x32_bf16 v[36:39], a[84:87], a[4:7], v[36:39]
    ds_read_b64_tr_b16 a[30:31], v95 offset:33792
    ds_read_b64_tr_b16 a[32:33], v96 offset:28672
    v_mfma_f32_16x16x32_bf16 v[40:43], a[108:111], a[4:7], v[40:43]
    ds_read_b64_tr_b16 a[34:35], v96 offset:33792
    v_mfma_f32_16x16x32_bf16 v[44:47], a[4:7], a[4:7], v[44:47]
    ds_read_b64_tr_b16 a[36:37], v97 offset:28672
    v_mfma_f32_16x16x32_bf16 v[48:51], a[48:51], a[108:111], v[48:51]
    ds_read_b64_tr_b16 a[38:39], v97 offset:33792
    ds_read_b64_tr_b16 a[40:41], v98 offset:28672
    v_mfma_f32_16x16x32_bf16 v[52:55], a[52:55], a[108:111], v[52:55]
    ds_read_b64_tr_b16 a[42:43], v98 offset:33792
    v_mfma_f32_16x16x32_bf16 v[56:59], a[56:59], a[108:111], v[56:59]
    ds_read_b64_tr_b16 a[44:45], v99 offset:28672
    v_mfma_f32_16x16x32_bf16 v[60:63], a[60:63], a[108:111], v[60:63]
    ds_read_b64_tr_b16 a[46:47], v99 offset:33792
    s_waitcnt lgkmcnt(10)
    v_mfma_f32_16x16x32_bf16 v[0:3], a[8:11], a[0:3], v[0:3]
    ds_read_b128 a[4:7], v67 offset:28672
    ds_read_b64_tr_b16 a[48:49], v90 offset:38912
    v_mfma_f32_16x16x32_bf16 v[4:7], a[12:15], a[0:3], v[4:7]
    ds_read_b64_tr_b16 a[50:51], v90 offset:44032
    v_mfma_f32_16x16x32_bf16 v[8:11], a[16:19], a[0:3], v[8:11]
    ds_read_b64_tr_b16 a[52:53], v91 offset:38912
    v_mfma_f32_16x16x32_bf16 v[12:15], a[20:23], a[0:3], v[12:15]
    ds_read_b64_tr_b16 a[54:55], v91 offset:44032
    ds_read_b64_tr_b16 a[56:57], v92 offset:38912
    v_mfma_f32_16x16x32_bf16 v[16:19], a[24:27], a[0:3], v[16:19]
    ds_read_b64_tr_b16 a[58:59], v92 offset:44032
    s_waitcnt lgkmcnt(7)
    v_mfma_f32_16x16x32_bf16 v[20:23], a[28:31], a[0:3], v[20:23]
    ds_read_b64_tr_b16 a[60:61], v93 offset:38912
    v_mfma_f32_16x16x32_bf16 v[24:27], a[32:35], a[0:3], v[24:27]
    ds_read_b64_tr_b16 a[62:63], v93 offset:44032
    ds_read_b64_tr_b16 a[64:65], v94 offset:38912
    v_mfma_f32_16x16x32_bf16 v[28:31], a[36:39], a[0:3], v[28:31]
    ds_read_b64_tr_b16 a[66:67], v94 offset:44032
    v_mfma_f32_16x16x32_bf16 v[32:35], a[40:43], a[0:3], v[32:35]
    ds_read_b64_tr_b16 a[68:69], v95 offset:38912
    v_mfma_f32_16x16x32_bf16 v[36:39], a[44:47], a[0:3], v[36:39]
    ds_read_b64_tr_b16 a[70:71], v95 offset:44032
    ds_read_b64_tr_b16 a[72:73], v96 offset:38912
    v_mfma_f32_16x16x32_bf16 v[40:43], a[108:111], a[0:3], v[40:43]
    ds_read_b64_tr_b16 a[74:75], v96 offset:44032
    v_mfma_f32_16x16x32_bf16 v[44:47], a[0:3], a[0:3], v[44:47]
    ds_read_b64_tr_b16 a[76:77], v97 offset:38912
    v_mfma_f32_16x16x32_bf16 v[48:51], a[8:11], a[108:111], v[48:51]
    ds_read_b64_tr_b16 a[78:79], v97 offset:44032
    ds_read_b64_tr_b16 a[80:81], v98 offset:38912
    v_mfma_f32_16x16x32_bf16 v[52:55], a[12:15], a[108:111], v[52:55]
    ds_read_b64_tr_b16 a[82:83], v98 offset:44032
    v_mfma_f32_16x16x32_bf16 v[56:59], a[16:19], a[108:111], v[56:59]
    ds_read_b64_tr_b16 a[84:85], v99 offset:38912
    v_mfma_f32_16x16x32_bf16 v[60:63], a[20:23], a[108:111], v[60:63]
    ds_read_b64_tr_b16 a[86:87], v99 offset:44032
    s_barrier
    s_waitcnt lgkmcnt(10)
    v_mfma_f32_16x16x32_bf16 v[0:3], a[48:51], a[4:7], v[0:3]
    ds_read_b128 a[0:3], v64 offset:0
    ds_read_b64_tr_b16 a[8:9], v80 offset:0
    v_mfma_f32_16x16x32_bf16 v[4:7], a[52:55], a[4:7], v[4:7]
    ds_read_b64_tr_b16 a[10:11], v80 offset:5120
    v_mfma_f32_16x16x32_bf16 v[8:11], a[56:59], a[4:7], v[8:11]
    ds_read_b64_tr_b16 a[12:13], v81 offset:0
    v_mfma_f32_16x16x32_bf16 v[12:15], a[60:63], a[4:7], v[12:15]
    ds_read_b64_tr_b16 a[14:15], v81 offset:5120
    ds_read_b64_tr_b16 a[16:17], v82 offset:0
    v_mfma_f32_16x16x32_bf16 v[16:19], a[64:67], a[4:7], v[16:19]
    ds_read_b64_tr_b16 a[18:19], v82 offset:5120
    s_waitcnt lgkmcnt(7)
    v_mfma_f32_16x16x32_bf16 v[20:23], a[68:71], a[4:7], v[20:23]
    ds_read_b64_tr_b16 a[20:21], v83 offset:0
    v_mfma_f32_16x16x32_bf16 v[24:27], a[72:75], a[4:7], v[24:27]
    ds_read_b64_tr_b16 a[22:23], v83 offset:5120
    ds_read_b64_tr_b16 a[24:25], v84 offset:0
    v_mfma_f32_16x16x32_bf16 v[28:31], a[76:79], a[4:7], v[28:31]
    ds_read_b64_tr_b16 a[26:27], v84 offset:5120
    v_mfma_f32_16x16x32_bf16 v[32:35], a[80:83], a[4:7], v[32:35]
    ds_read_b64_tr_b16 a[28:29], v85 offset:0
    v_mfma_f32_16x16x32_bf16 v[36:39], a[84:87], a[4:7], v[36:39]
    ds_read_b64_tr_b16 a[30:31], v85 offset:5120
    ds_read_b64_tr_b16 a[32:33], v86 offset:0
    v_mfma_f32_16x16x32_bf16 v[40:43], a[108:111], a[4:7], v[40:43]
    ds_read_b64_tr_b16 a[34:35], v86 offset:5120
    v_mfma_f32_16x16x32_bf16 v[44:47], a[4:7], a[4:7], v[44:47]
    ds_read_b64_tr_b16 a[36:37], v87 offset:0
    v_mfma_f32_16x16x32_bf16 v[48:51], a[48:51], a[108:111], v[48:51]
    ds_read_b64_tr_b16 a[38:39], v87 offset:5120
    ds_read_b64_tr_b16 a[40:41], v88 offset:0
    v_mfma_f32_16x16x32_bf16 v[52:55], a[52:55], a[108:111], v[52:55]
    ds_read_b64_tr_b16 a[42:43], v88 offset:5120
    v_mfma_f32_16x16x32_bf16 v[56:59], a[56:59], a[108:111], v[56:59]
    ds_read_b64_tr_b16 a[44:45], v89 offset:0
    v_mfma_f32_16x16x32_bf16 v[60:63], a[60:63], a[108:111], v[60:63]
    ds_read_b64_tr_b16 a[46:47], v89 offset:5120
    s_waitcnt lgkmcnt(10)
    v_mfma_f32_16x16x32_bf16 v[0:3], a[8:11], a[0:3], v[0:3]
    ds_read_b128 a[4:7], v65 offset:0
    ds_read_b64_tr_b16 a[48:49], v80 offset:10240
    v_mfma_f32_16x16x32_bf16 v[4:7], a[12:15], a[0:3], v[4:7]
    ds_read_b64_tr_b16 a[50:51], v80 offset:15360
    v_mfma_f32_16x16x32_bf16 v[8:11], a[16:19], a[0:3], v[8:11]
    ds_read_b64_tr_b16 a[52:53], v81 offset:10240
    v_mfma_f32_16x16x32_bf16 v[12:15], a[20:23], a[0:3], v[12:15]
    ds_read_b64_tr_b16 a[54:55], v81 offset:15360
    ds_read_b64_tr_b16 a[56:57], v82 offset:10240
    v_mfma_f32_16x16x32_bf16 v[16:19], a[24:27], a[0:3], v[16:19]
    ds_read_b64_tr_b16 a[58:59], v82 offset:15360
    s_waitcnt lgkmcnt(7)
    v_mfma_f32_16x16x32_bf16 v[20:23], a[28:31], a[0:3], v[20:23]
    ds_read_b64_tr_b16 a[60:61], v83 offset:10240
    v_mfma_f32_16x16x32_bf16 v[24:27], a[32:35], a[0:3], v[24:27]
    ds_read_b64_tr_b16 a[62:63], v83 offset:15360
    ds_read_b64_tr_b16 a[64:65], v84 offset:10240
    v_mfma_f32_16x16x32_bf16 v[28:31], a[36:39], a[0:3], v[28:31]
    ds_read_b64_tr_b16 a[66:67], v84 offset:15360
    v_mfma_f32_16x16x32_bf16 v[32:35], a[40:43], a[0:3], v[32:35]
    ds_read_b64_tr_b16 a[68:69], v85 offset:10240
    v_mfma_f32_16x16x32_bf16 v[36:39], a[44:47], a[0:3], v[36:39]
    ds_read_b64_tr_b16 a[70:71], v85 offset:15360
    ds_read_b64_tr_b16 a[72:73], v86 offset:10240
    v_mfma_f32_16x16x32_bf16 v[40:43], a[108:111], a[0:3], v[40:43]
    ds_read_b64_tr_b16 a[74:75], v86 offset:15360
    v_mfma_f32_16x16x32_bf16 v[44:47], a[0:3], a[0:3], v[44:47]
    ds_read_b64_tr_b16 a[76:77], v87 offset:10240
    v_mfma_f32_16x16x32_bf16 v[48:51], a[8:11], a[108:111], v[48:51]
    ds_read_b64_tr_b16 a[78:79], v87 offset:15360
    ds_read_b64_tr_b16 a[80:81], v88 offset:10240
    v_mfma_f32_16x16x32_bf16 v[52:55], a[12:15], a[108:111], v[52:55]
    ds_read_b64_tr_b16 a[82:83], v88 offset:15360
    v_mfma_f32_16x16x32_bf16 v[56:59], a[16:19], a[108:111], v[56:59]
    ds_read_b64_tr_b16 a[84:85], v89 offset:10240
    v_mfma_f32_16x16x32_bf16 v[60:63], a[20:23], a[108:111], v[60:63]
    ds_read_b64_tr_b16 a[86:87], v89 offset:15360
    s_barrier
    s_waitcnt lgkmcnt(10)
    v_mfma_f32_16x16x32_bf16 v[0:3], a[48:51], a[4:7], v[0:3]
    ds_read_b128 a[0:3], v64 offset:28672
    ds_read_b64_tr_b16 a[8:9], v80 offset:28672
    v_mfma_f32_16x16x32_bf16 v[4:7], a[52:55], a[4:7], v[4:7]
    ds_read_b64_tr_b16 a[10:11], v80 offset:33792
    v_mfma_f32_16x16x32_bf16 v[8:11], a[56:59], a[4:7], v[8:11]
    ds_read_b64_tr_b16 a[12:13], v81 offset:28672
    v_mfma_f32_16x16x32_bf16 v[12:15], a[60:63], a[4:7], v[12:15]
    ds_read_b64_tr_b16 a[14:15], v81 offset:33792
    ds_read_b64_tr_b16 a[16:17], v82 offset:28672
    v_mfma_f32_16x16x32_bf16 v[16:19], a[64:67], a[4:7], v[16:19]
    ds_read_b64_tr_b16 a[18:19], v82 offset:33792
    s_waitcnt lgkmcnt(7)
    v_mfma_f32_16x16x32_bf16 v[20:23], a[68:71], a[4:7], v[20:23]
    ds_read_b64_tr_b16 a[20:21], v83 offset:28672
    v_mfma_f32_16x16x32_bf16 v[24:27], a[72:75], a[4:7], v[24:27]
    ds_read_b64_tr_b16 a[22:23], v83 offset:33792
    ds_read_b64_tr_b16 a[24:25], v84 offset:28672
    v_mfma_f32_16x16x32_bf16 v[28:31], a[76:79], a[4:7], v[28:31]
    ds_read_b64_tr_b16 a[26:27], v84 offset:33792
    v_mfma_f32_16x16x32_bf16 v[32:35], a[80:83], a[4:7], v[32:35]
    ds_read_b64_tr_b16 a[28:29], v85 offset:28672
    v_mfma_f32_16x16x32_bf16 v[36:39], a[84:87], a[4:7], v[36:39]
    ds_read_b64_tr_b16 a[30:31], v85 offset:33792
    ds_read_b64_tr_b16 a[32:33], v86 offset:28672
    v_mfma_f32_16x16x32_bf16 v[40:43], a[108:111], a[4:7], v[40:43]
    ds_read_b64_tr_b16 a[34:35], v86 offset:33792
    v_mfma_f32_16x16x32_bf16 v[44:47], a[4:7], a[4:7], v[44:47]
    ds_read_b64_tr_b16 a[36:37], v87 offset:28672
    v_mfma_f32_16x16x32_bf16 v[48:51], a[48:51], a[108:111], v[48:51]
    ds_read_b64_tr_b16 a[38:39], v87 offset:33792
    ds_read_b64_tr_b16 a[40:41], v88 offset:28672
    v_mfma_f32_16x16x32_bf16 v[52:55], a[52:55], a[108:111], v[52:55]
    ds_read_b64_tr_b16 a[42:43], v88 offset:33792
    v_mfma_f32_16x16x32_bf16 v[56:59], a[56:59], a[108:111], v[56:59]
    ds_read_b64_tr_b16 a[44:45], v89 offset:28672
    v_mfma_f32_16x16x32_bf16 v[60:63], a[60:63], a[108:111], v[60:63]
    ds_read_b64_tr_b16 a[46:47], v89 offset:33792
    s_waitcnt lgkmcnt(10)
    v_mfma_f32_16x16x32_bf16 v[0:3], a[8:11], a[0:3], v[0:3]
    ds_read_b128 a[4:7], v65 offset:28672
    ds_read_b64_tr_b16 a[48:49], v80 offset:38912
    v_mfma_f32_16x16x32_bf16 v[4:7], a[12:15], a[0:3], v[4:7]
    ds_read_b64_tr_b16 a[50:51], v80 offset:44032
    v_mfma_f32_16x16x32_bf16 v[8:11], a[16:19], a[0:3], v[8:11]
    ds_read_b64_tr_b16 a[52:53], v81 offset:38912
    v_mfma_f32_16x16x32_bf16 v[12:15], a[20:23], a[0:3], v[12:15]
    ds_read_b64_tr_b16 a[54:55], v81 offset:44032
    ds_read_b64_tr_b16 a[56:57], v82 offset:38912
    v_mfma_f32_16x16x32_bf16 v[16:19], a[24:27], a[0:3], v[16:19]
    ds_read_b64_tr_b16 a[58:59], v82 offset:44032
    s_waitcnt lgkmcnt(7)
    v_mfma_f32_16x16x32_bf16 v[20:23], a[28:31], a[0:3], v[20:23]
    ds_read_b64_tr_b16 a[60:61], v83 offset:38912
    v_mfma_f32_16x16x32_bf16 v[24:27], a[32:35], a[0:3], v[24:27]
    ds_read_b64_tr_b16 a[62:63], v83 offset:44032
    ds_read_b64_tr_b16 a[64:65], v84 offset:38912
    v_mfma_f32_16x16x32_bf16 v[28:31], a[36:39], a[0:3], v[28:31]
    ds_read_b64_tr_b16 a[66:67], v84 offset:44032
    v_mfma_f32_16x16x32_bf16 v[32:35], a[40:43], a[0:3], v[32:35]
    ds_read_b64_tr_b16 a[68:69], v85 offset:38912
    v_mfma_f32_16x16x32_bf16 v[36:39], a[44:47], a[0:3], v[36:39]
    ds_read_b64_tr_b16 a[70:71], v85 offset:44032
    ds_read_b64_tr_b16 a[72:73], v86 offset:38912
    v_mfma_f32_16x16x32_bf16 v[40:43], a[108:111], a[0:3], v[40:43]
    ds_read_b64_tr_b16 a[74:75], v86 offset:44032
    v_mfma_f32_16x16x32_bf16 v[44:47], a[0:3], a[0:3], v[44:47]
    ds_read_b64_tr_b16 a[76:77], v87 offset:38912
    v_mfma_f32_16x16x32_bf16 v[48:51], a[8:11], a[108:111], v[48:51]
    ds_read_b64_tr_b16 a[78:79], v87 offset:44032
    ds_read_b64_tr_b16 a[80:81], v88 offset:38912
    v_mfma_f32_16x16x32_bf16 v[52:55], a[12:15], a[108:111], v[52:55]
    ds_read_b64_tr_b16 a[82:83], v88 offset:44032
    v_mfma_f32_16x16x32_bf16 v[56:59], a[16:19], a[108:111], v[56:59]
    ds_read_b64_tr_b16 a[84:85], v89 offset:38912
    v_mfma_f32_16x16x32_bf16 v[60:63], a[20:23], a[108:111], v[60:63]
    ds_read_b64_tr_b16 a[86:87], v89 offset:44032
    s_barrier
    s_waitcnt lgkmcnt(10)
    v_mfma_f32_16x16x32_bf16 v[0:3], a[48:51], a[4:7], v[0:3]
    ds_read_b128 a[0:3], v66 offset:0
    ds_read_b64_tr_b16 a[8:9], v90 offset:0
    v_mfma_f32_16x16x32_bf16 v[4:7], a[52:55], a[4:7], v[4:7]
    ds_read_b64_tr_b16 a[10:11], v90 offset:5120
    v_mfma_f32_16x16x32_bf16 v[8:11], a[56:59], a[4:7], v[8:11]
    ds_read_b64_tr_b16 a[12:13], v91 offset:0
    v_mfma_f32_16x16x32_bf16 v[12:15], a[60:63], a[4:7], v[12:15]
    ds_read_b64_tr_b16 a[14:15], v91 offset:5120
    ds_read_b64_tr_b16 a[16:17], v92 offset:0
    v_mfma_f32_16x16x32_bf16 v[16:19], a[64:67], a[4:7], v[16:19]
    ds_read_b64_tr_b16 a[18:19], v92 offset:5120
    s_waitcnt lgkmcnt(7)
    v_mfma_f32_16x16x32_bf16 v[20:23], a[68:71], a[4:7], v[20:23]
    ds_read_b64_tr_b16 a[20:21], v93 offset:0
    v_mfma_f32_16x16x32_bf16 v[24:27], a[72:75], a[4:7], v[24:27]
    ds_read_b64_tr_b16 a[22:23], v93 offset:5120
    ds_read_b64_tr_b16 a[24:25], v94 offset:0
    v_mfma_f32_16x16x32_bf16 v[28:31], a[76:79], a[4:7], v[28:31]
    ds_read_b64_tr_b16 a[26:27], v94 offset:5120
    v_mfma_f32_16x16x32_bf16 v[32:35], a[80:83], a[4:7], v[32:35]
    ds_read_b64_tr_b16 a[28:29], v95 offset:0
    v_mfma_f32_16x16x32_bf16 v[36:39], a[84:87], a[4:7], v[36:39]
    ds_read_b64_tr_b16 a[30:31], v95 offset:5120
    ds_read_b64_tr_b16 a[32:33], v96 offset:0
    v_mfma_f32_16x16x32_bf16 v[40:43], a[108:111], a[4:7], v[40:43]
    ds_read_b64_tr_b16 a[34:35], v96 offset:5120
    v_mfma_f32_16x16x32_bf16 v[44:47], a[4:7], a[4:7], v[44:47]
    ds_read_b64_tr_b16 a[36:37], v97 offset:0
    v_mfma_f32_16x16x32_bf16 v[48:51], a[48:51], a[108:111], v[48:51]
    ds_read_b64_tr_b16 a[38:39], v97 offset:5120
    ds_read_b64_tr_b16 a[40:41], v98 offset:0
    v_mfma_f32_16x16x32_bf16 v[52:55], a[52:55], a[108:111], v[52:55]
    ds_read_b64_tr_b16 a[42:43], v98 offset:5120
    v_mfma_f32_16x16x32_bf16 v[56:59], a[56:59], a[108:111], v[56:59]
    ds_read_b64_tr_b16 a[44:45], v99 offset:0
    v_mfma_f32_16x16x32_bf16 v[60:63], a[60:63], a[108:111], v[60:63]
    ds_read_b64_tr_b16 a[46:47], v99 offset:5120
    s_waitcnt lgkmcnt(10)
    v_mfma_f32_16x16x32_bf16 v[0:3], a[8:11], a[0:3], v[0:3]
    ds_read_b128 a[4:7], v67 offset:0
    ds_read_b64_tr_b16 a[48:49], v90 offset:10240
    v_mfma_f32_16x16x32_bf16 v[4:7], a[12:15], a[0:3], v[4:7]
    ds_read_b64_tr_b16 a[50:51], v90 offset:15360
    v_mfma_f32_16x16x32_bf16 v[8:11], a[16:19], a[0:3], v[8:11]
    ds_read_b64_tr_b16 a[52:53], v91 offset:10240
    v_mfma_f32_16x16x32_bf16 v[12:15], a[20:23], a[0:3], v[12:15]
    ds_read_b64_tr_b16 a[54:55], v91 offset:15360
    ds_read_b64_tr_b16 a[56:57], v92 offset:10240
    v_mfma_f32_16x16x32_bf16 v[16:19], a[24:27], a[0:3], v[16:19]
    ds_read_b64_tr_b16 a[58:59], v92 offset:15360
    s_waitcnt lgkmcnt(7)
    v_mfma_f32_16x16x32_bf16 v[20:23], a[28:31], a[0:3], v[20:23]
    ds_read_b64_tr_b16 a[60:61], v93 offset:10240
    v_mfma_f32_16x16x32_bf16 v[24:27], a[32:35], a[0:3], v[24:27]
    ds_read_b64_tr_b16 a[62:63], v93 offset:15360
    ds_read_b64_tr_b16 a[64:65], v94 offset:10240
    v_mfma_f32_16x16x32_bf16 v[28:31], a[36:39], a[0:3], v[28:31]
    ds_read_b64_tr_b16 a[66:67], v94 offset:15360
    v_mfma_f32_16x16x32_bf16 v[32:35], a[40:43], a[0:3], v[32:35]
    ds_read_b64_tr_b16 a[68:69], v95 offset:10240
    v_mfma_f32_16x16x32_bf16 v[36:39], a[44:47], a[0:3], v[36:39]
    ds_read_b64_tr_b16 a[70:71], v95 offset:15360
    ds_read_b64_tr_b16 a[72:73], v96 offset:10240
    v_mfma_f32_16x16x32_bf16 v[40:43], a[108:111], a[0:3], v[40:43]
    ds_read_b64_tr_b16 a[74:75], v96 offset:15360
    v_mfma_f32_16x16x32_bf16 v[44:47], a[0:3], a[0:3], v[44:47]
    ds_read_b64_tr_b16 a[76:77], v97 offset:10240
    v_mfma_f32_16x16x32_bf16 v[48:51], a[8:11], a[108:111], v[48:51]
    ds_read_b64_tr_b16 a[78:79], v97 offset:15360
    ds_read_b64_tr_b16 a[80:81], v98 offset:10240
    v_mfma_f32_16x16x32_bf16 v[52:55], a[12:15], a[108:111], v[52:55]
    ds_read_b64_tr_b16 a[82:83], v98 offset:15360
    v_mfma_f32_16x16x32_bf16 v[56:59], a[16:19], a[108:111], v[56:59]
    ds_read_b64_tr_b16 a[84:85], v99 offset:10240
    v_mfma_f32_16x16x32_bf16 v[60:63], a[20:23], a[108:111], v[60:63]
    ds_read_b64_tr_b16 a[86:87], v99 offset:15360
    s_barrier
    s_waitcnt lgkmcnt(10)
    v_mfma_f32_16x16x32_bf16 v[0:3], a[48:51], a[4:7], v[0:3]
    ds_read_b128 a[0:3], v66 offset:28672
    ds_read_b64_tr_b16 a[8:9], v90 offset:28672
    v_mfma_f32_16x16x32_bf16 v[4:7], a[52:55], a[4:7], v[4:7]
    ds_read_b64_tr_b16 a[10:11], v90 offset:33792
    v_mfma_f32_16x16x32_bf16 v[8:11], a[56:59], a[4:7], v[8:11]
    ds_read_b64_tr_b16 a[12:13], v91 offset:28672
    v_mfma_f32_16x16x32_bf16 v[12:15], a[60:63], a[4:7], v[12:15]
    ds_read_b64_tr_b16 a[14:15], v91 offset:33792
    ds_read_b64_tr_b16 a[16:17], v92 offset:28672
    v_mfma_f32_16x16x32_bf16 v[16:19], a[64:67], a[4:7], v[16:19]
    ds_read_b64_tr_b16 a[18:19], v92 offset:33792
    s_waitcnt lgkmcnt(7)
    v_mfma_f32_16x16x32_bf16 v[20:23], a[68:71], a[4:7], v[20:23]
    ds_read_b64_tr_b16 a[20:21], v93 offset:28672
    v_mfma_f32_16x16x32_bf16 v[24:27], a[72:75], a[4:7], v[24:27]
    ds_read_b64_tr_b16 a[22:23], v93 offset:33792
    ds_read_b64_tr_b16 a[24:25], v94 offset:28672
    v_mfma_f32_16x16x32_bf16 v[28:31], a[76:79], a[4:7], v[28:31]
    ds_read_b64_tr_b16 a[26:27], v94 offset:33792
    v_mfma_f32_16x16x32_bf16 v[32:35], a[80:83], a[4:7], v[32:35]
    ds_read_b64_tr_b16 a[28:29], v95 offset:28672
    v_mfma_f32_16x16x32_bf16 v[36:39], a[84:87], a[4:7], v[36:39]
    ds_read_b64_tr_b16 a[30:31], v95 offset:33792
    ds_read_b64_tr_b16 a[32:33], v96 offset:28672
    v_mfma_f32_16x16x32_bf16 v[40:43], a[108:111], a[4:7], v[40:43]
    ds_read_b64_tr_b16 a[34:35], v96 offset:33792
    v_mfma_f32_16x16x32_bf16 v[44:47], a[4:7], a[4:7], v[44:47]
    ds_read_b64_tr_b16 a[36:37], v97 offset:28672
    v_mfma_f32_16x16x32_bf16 v[48:51], a[48:51], a[108:111], v[48:51]
    ds_read_b64_tr_b16 a[38:39], v97 offset:33792
    ds_read_b64_tr_b16 a[40:41], v98 offset:28672
    v_mfma_f32_16x16x32_bf16 v[52:55], a[52:55], a[108:111], v[52:55]
    ds_read_b64_tr_b16 a[42:43], v98 offset:33792
    v_mfma_f32_16x16x32_bf16 v[56:59], a[56:59], a[108:111], v[56:59]
    ds_read_b64_tr_b16 a[44:45], v99 offset:28672
    v_mfma_f32_16x16x32_bf16 v[60:63], a[60:63], a[108:111], v[60:63]
    ds_read_b64_tr_b16 a[46:47], v99 offset:33792
    s_waitcnt lgkmcnt(10)
    v_mfma_f32_16x16x32_bf16 v[0:3], a[8:11], a[0:3], v[0:3]
    ds_read_b128 a[4:7], v67 offset:28672
    ds_read_b64_tr_b16 a[48:49], v90 offset:38912
    v_mfma_f32_16x16x32_bf16 v[4:7], a[12:15], a[0:3], v[4:7]
    ds_read_b64_tr_b16 a[50:51], v90 offset:44032
    v_mfma_f32_16x16x32_bf16 v[8:11], a[16:19], a[0:3], v[8:11]
    ds_read_b64_tr_b16 a[52:53], v91 offset:38912
    v_mfma_f32_16x16x32_bf16 v[12:15], a[20:23], a[0:3], v[12:15]
    ds_read_b64_tr_b16 a[54:55], v91 offset:44032
    ds_read_b64_tr_b16 a[56:57], v92 offset:38912
    v_mfma_f32_16x16x32_bf16 v[16:19], a[24:27], a[0:3], v[16:19]
    ds_read_b64_tr_b16 a[58:59], v92 offset:44032
    s_waitcnt lgkmcnt(7)
    v_mfma_f32_16x16x32_bf16 v[20:23], a[28:31], a[0:3], v[20:23]
    ds_read_b64_tr_b16 a[60:61], v93 offset:38912
    v_mfma_f32_16x16x32_bf16 v[24:27], a[32:35], a[0:3], v[24:27]
    ds_read_b64_tr_b16 a[62:63], v93 offset:44032
    ds_read_b64_tr_b16 a[64:65], v94 offset:38912
    v_mfma_f32_16x16x32_bf16 v[28:31], a[36:39], a[0:3], v[28:31]
    ds_read_b64_tr_b16 a[66:67], v94 offset:44032
    v_mfma_f32_16x16x32_bf16 v[32:35], a[40:43], a[0:3], v[32:35]
    ds_read_b64_tr_b16 a[68:69], v95 offset:38912
    v_mfma_f32_16x16x32_bf16 v[36:39], a[44:47], a[0:3], v[36:39]
    ds_read_b64_tr_b16 a[70:71], v95 offset:44032
    ds_read_b64_tr_b16 a[72:73], v96 offset:38912
    v_mfma_f32_16x16x32_bf16 v[40:43], a[108:111], a[0:3], v[40:43]
    ds_read_b64_tr_b16 a[74:75], v96 offset:44032
    v_mfma_f32_16x16x32_bf16 v[44:47], a[0:3], a[0:3], v[44:47]
    ds_read_b64_tr_b16 a[76:77], v97 offset:38912
    v_mfma_f32_16x16x32_bf16 v[48:51], a[8:11], a[108:111], v[48:51]
    ds_read_b64_tr_b16 a[78:79], v97 offset:44032
    ds_read_b64_tr_b16 a[80:81], v98 offset:38912
    v_mfma_f32_16x16x32_bf16 v[52:55], a[12:15], a[108:111], v[52:55]
    ds_read_b64_tr_b16 a[82:83], v98 offset:44032
    v_mfma_f32_16x16x32_bf16 v[56:59], a[16:19], a[108:111], v[56:59]
    ds_read_b64_tr_b16 a[84:85], v99 offset:38912
    v_mfma_f32_16x16x32_bf16 v[60:63], a[20:23], a[108:111], v[60:63]
    ds_read_b64_tr_b16 a[86:87], v99 offset:44032
    s_barrier
    s_waitcnt lgkmcnt(10)
    v_mfma_f32_16x16x32_bf16 v[0:3], a[48:51], a[4:7], v[0:3]
    ds_read_b128 a[0:3], v64 offset:0
    ds_read_b64_tr_b16 a[8:9], v80 offset:0
    v_mfma_f32_16x16x32_bf16 v[4:7], a[52:55], a[4:7], v[4:7]
    ds_read_b64_tr_b16 a[10:11], v80 offset:5120
    v_mfma_f32_16x16x32_bf16 v[8:11], a[56:59], a[4:7], v[8:11]
    ds_read_b64_tr_b16 a[12:13], v81 offset:0
    v_mfma_f32_16x16x32_bf16 v[12:15], a[60:63], a[4:7], v[12:15]
    ds_read_b64_tr_b16 a[14:15], v81 offset:5120
    ds_read_b64_tr_b16 a[16:17], v82 offset:0
    v_mfma_f32_16x16x32_bf16 v[16:19], a[64:67], a[4:7], v[16:19]
    ds_read_b64_tr_b16 a[18:19], v82 offset:5120
    s_waitcnt lgkmcnt(7)
    v_mfma_f32_16x16x32_bf16 v[20:23], a[68:71], a[4:7], v[20:23]
    ds_read_b64_tr_b16 a[20:21], v83 offset:0
    v_mfma_f32_16x16x32_bf16 v[24:27], a[72:75], a[4:7], v[24:27]
    ds_read_b64_tr_b16 a[22:23], v83 offset:5120
    ds_read_b64_tr_b16 a[24:25], v84 offset:0
    v_mfma_f32_16x16x32_bf16 v[28:31], a[76:79], a[4:7], v[28:31]
    ds_read_b64_tr_b16 a[26:27], v84 offset:5120
    v_mfma_f32_16x16x32_bf16 v[32:35], a[80:83], a[4:7], v[32:35]
    ds_read_b64_tr_b16 a[28:29], v85 offset:0
    v_mfma_f32_16x16x32_bf16 v[36:39], a[84:87], a[4:7], v[36:39]
    ds_read_b64_tr_b16 a[30:31], v85 offset:5120
    ds_read_b64_tr_b16 a[32:33], v86 offset:0
    v_mfma_f32_16x16x32_bf16 v[40:43], a[108:111], a[4:7], v[40:43]
    ds_read_b64_tr_b16 a[34:35], v86 offset:5120
    v_mfma_f32_16x16x32_bf16 v[44:47], a[4:7], a[4:7], v[44:47]
    ds_read_b64_tr_b16 a[36:37], v87 offset:0
    v_mfma_f32_16x16x32_bf16 v[48:51], a[48:51], a[108:111], v[48:51]
    ds_read_b64_tr_b16 a[38:39], v87 offset:5120
    ds_read_b64_tr_b16 a[40:41], v88 offset:0
    v_mfma_f32_16x16x32_bf16 v[52:55], a[52:55], a[108:111], v[52:55]
    ds_read_b64_tr_b16 a[42:43], v88 offset:5120
    v_mfma_f32_16x16x32_bf16 v[56:59], a[56:59], a[108:111], v[56:59]
    ds_read_b64_tr_b16 a[44:45], v89 offset:0
    v_mfma_f32_16x16x32_bf16 v[60:63], a[60:63], a[108:111], v[60:63]
    ds_read_b64_tr_b16 a[46:47], v89 offset:5120
    s_waitcnt lgkmcnt(10)
    v_mfma_f32_16x16x32_bf16 v[0:3], a[8:11], a[0:3], v[0:3]
    ds_read_b128 a[4:7], v65 offset:0
    ds_read_b64_tr_b16 a[48:49], v80 offset:10240
    v_mfma_f32_16x16x32_bf16 v[4:7], a[12:15], a[0:3], v[4:7]
    ds_read_b64_tr_b16 a[50:51], v80 offset:15360
    v_mfma_f32_16x16x32_bf16 v[8:11], a[16:19], a[0:3], v[8:11]
    ds_read_b64_tr_b16 a[52:53], v81 offset:10240
    v_mfma_f32_16x16x32_bf16 v[12:15], a[20:23], a[0:3], v[12:15]
    ds_read_b64_tr_b16 a[54:55], v81 offset:15360
    ds_read_b64_tr_b16 a[56:57], v82 offset:10240
    v_mfma_f32_16x16x32_bf16 v[16:19], a[24:27], a[0:3], v[16:19]
    ds_read_b64_tr_b16 a[58:59], v82 offset:15360
    s_waitcnt lgkmcnt(7)
    v_mfma_f32_16x16x32_bf16 v[20:23], a[28:31], a[0:3], v[20:23]
    ds_read_b64_tr_b16 a[60:61], v83 offset:10240
    v_mfma_f32_16x16x32_bf16 v[24:27], a[32:35], a[0:3], v[24:27]
    ds_read_b64_tr_b16 a[62:63], v83 offset:15360
    ds_read_b64_tr_b16 a[64:65], v84 offset:10240
    v_mfma_f32_16x16x32_bf16 v[28:31], a[36:39], a[0:3], v[28:31]
    ds_read_b64_tr_b16 a[66:67], v84 offset:15360
    v_mfma_f32_16x16x32_bf16 v[32:35], a[40:43], a[0:3], v[32:35]
    ds_read_b64_tr_b16 a[68:69], v85 offset:10240
    v_mfma_f32_16x16x32_bf16 v[36:39], a[44:47], a[0:3], v[36:39]
    ds_read_b64_tr_b16 a[70:71], v85 offset:15360
    ds_read_b64_tr_b16 a[72:73], v86 offset:10240
    v_mfma_f32_16x16x32_bf16 v[40:43], a[108:111], a[0:3], v[40:43]
    ds_read_b64_tr_b16 a[74:75], v86 offset:15360
    v_mfma_f32_16x16x32_bf16 v[44:47], a[0:3], a[0:3], v[44:47]
    ds_read_b64_tr_b16 a[76:77], v87 offset:10240
    v_mfma_f32_16x16x32_bf16 v[48:51], a[8:11], a[108:111], v[48:51]
    ds_read_b64_tr_b16 a[78:79], v87 offset:15360
    ds_read_b64_tr_b16 a[80:81], v88 offset:10240
    v_mfma_f32_16x16x32_bf16 v[52:55], a[12:15], a[108:111], v[52:55]
    ds_read_b64_tr_b16 a[82:83], v88 offset:15360
    v_mfma_f32_16x16x32_bf16 v[56:59], a[16:19], a[108:111], v[56:59]
    ds_read_b64_tr_b16 a[84:85], v89 offset:10240
    v_mfma_f32_16x16x32_bf16 v[60:63], a[20:23], a[108:111], v[60:63]
    ds_read_b64_tr_b16 a[86:87], v89 offset:15360
    s_barrier
    s_waitcnt lgkmcnt(10)
    v_mfma_f32_16x16x32_bf16 v[0:3], a[48:51], a[4:7], v[0:3]
    ds_read_b128 a[0:3], v64 offset:28672
    ds_read_b64_tr_b16 a[8:9], v80 offset:28672
    v_mfma_f32_16x16x32_bf16 v[4:7], a[52:55], a[4:7], v[4:7]
    ds_read_b64_tr_b16 a[10:11], v80 offset:33792
    v_mfma_f32_16x16x32_bf16 v[8:11], a[56:59], a[4:7], v[8:11]
    ds_read_b64_tr_b16 a[12:13], v81 offset:28672
    v_mfma_f32_16x16x32_bf16 v[12:15], a[60:63], a[4:7], v[12:15]
    ds_read_b64_tr_b16 a[14:15], v81 offset:33792
    ds_read_b64_tr_b16 a[16:17], v82 offset:28672
    v_mfma_f32_16x16x32_bf16 v[16:19], a[64:67], a[4:7], v[16:19]
    ds_read_b64_tr_b16 a[18:19], v82 offset:33792
    s_waitcnt lgkmcnt(7)
    v_mfma_f32_16x16x32_bf16 v[20:23], a[68:71], a[4:7], v[20:23]
    ds_read_b64_tr_b16 a[20:21], v83 offset:28672
    v_mfma_f32_16x16x32_bf16 v[24:27], a[72:75], a[4:7], v[24:27]
    ds_read_b64_tr_b16 a[22:23], v83 offset:33792
    ds_read_b64_tr_b16 a[24:25], v84 offset:28672
    v_mfma_f32_16x16x32_bf16 v[28:31], a[76:79], a[4:7], v[28:31]
    ds_read_b64_tr_b16 a[26:27], v84 offset:33792
    v_mfma_f32_16x16x32_bf16 v[32:35], a[80:83], a[4:7], v[32:35]
    ds_read_b64_tr_b16 a[28:29], v85 offset:28672
    v_mfma_f32_16x16x32_bf16 v[36:39], a[84:87], a[4:7], v[36:39]
    ds_read_b64_tr_b16 a[30:31], v85 offset:33792
    ds_read_b64_tr_b16 a[32:33], v86 offset:28672
    v_mfma_f32_16x16x32_bf16 v[40:43], a[108:111], a[4:7], v[40:43]
    ds_read_b64_tr_b16 a[34:35], v86 offset:33792
    v_mfma_f32_16x16x32_bf16 v[44:47], a[4:7], a[4:7], v[44:47]
    ds_read_b64_tr_b16 a[36:37], v87 offset:28672
    v_mfma_f32_16x16x32_bf16 v[48:51], a[48:51], a[108:111], v[48:51]
    ds_read_b64_tr_b16 a[38:39], v87 offset:33792
    ds_read_b64_tr_b16 a[40:41], v88 offset:28672
    v_mfma_f32_16x16x32_bf16 v[52:55], a[52:55], a[108:111], v[52:55]
    ds_read_b64_tr_b16 a[42:43], v88 offset:33792
    v_mfma_f32_16x16x32_bf16 v[56:59], a[56:59], a[108:111], v[56:59]
    ds_read_b64_tr_b16 a[44:45], v89 offset:28672
    v_mfma_f32_16x16x32_bf16 v[60:63], a[60:63], a[108:111], v[60:63]
    ds_read_b64_tr_b16 a[46:47], v89 offset:33792
    s_waitcnt lgkmcnt(10)
    v_mfma_f32_16x16x32_bf16 v[0:3], a[8:11], a[0:3], v[0:3]
    ds_read_b128 a[4:7], v65 offset:28672
    ds_read_b64_tr_b16 a[48:49], v80 offset:38912
    v_mfma_f32_16x16x32_bf16 v[4:7], a[12:15], a[0:3], v[4:7]
    ds_read_b64_tr_b16 a[50:51], v80 offset:44032
    v_mfma_f32_16x16x32_bf16 v[8:11], a[16:19], a[0:3], v[8:11]
    ds_read_b64_tr_b16 a[52:53], v81 offset:38912
    v_mfma_f32_16x16x32_bf16 v[12:15], a[20:23], a[0:3], v[12:15]
    ds_read_b64_tr_b16 a[54:55], v81 offset:44032
    ds_read_b64_tr_b16 a[56:57], v82 offset:38912
    v_mfma_f32_16x16x32_bf16 v[16:19], a[24:27], a[0:3], v[16:19]
    ds_read_b64_tr_b16 a[58:59], v82 offset:44032
    s_waitcnt lgkmcnt(7)
    v_mfma_f32_16x16x32_bf16 v[20:23], a[28:31], a[0:3], v[20:23]
    ds_read_b64_tr_b16 a[60:61], v83 offset:38912
    v_mfma_f32_16x16x32_bf16 v[24:27], a[32:35], a[0:3], v[24:27]
    ds_read_b64_tr_b16 a[62:63], v83 offset:44032
    ds_read_b64_tr_b16 a[64:65], v84 offset:38912
    v_mfma_f32_16x16x32_bf16 v[28:31], a[36:39], a[0:3], v[28:31]
    ds_read_b64_tr_b16 a[66:67], v84 offset:44032
    v_mfma_f32_16x16x32_bf16 v[32:35], a[40:43], a[0:3], v[32:35]
    ds_read_b64_tr_b16 a[68:69], v85 offset:38912
    v_mfma_f32_16x16x32_bf16 v[36:39], a[44:47], a[0:3], v[36:39]
    ds_read_b64_tr_b16 a[70:71], v85 offset:44032
    ds_read_b64_tr_b16 a[72:73], v86 offset:38912
    v_mfma_f32_16x16x32_bf16 v[40:43], a[108:111], a[0:3], v[40:43]
    ds_read_b64_tr_b16 a[74:75], v86 offset:44032
    v_mfma_f32_16x16x32_bf16 v[44:47], a[0:3], a[0:3], v[44:47]
    ds_read_b64_tr_b16 a[76:77], v87 offset:38912
    v_mfma_f32_16x16x32_bf16 v[48:51], a[8:11], a[108:111], v[48:51]
    ds_read_b64_tr_b16 a[78:79], v87 offset:44032
    ds_read_b64_tr_b16 a[80:81], v88 offset:38912
    v_mfma_f32_16x16x32_bf16 v[52:55], a[12:15], a[108:111], v[52:55]
    ds_read_b64_tr_b16 a[82:83], v88 offset:44032
    v_mfma_f32_16x16x32_bf16 v[56:59], a[16:19], a[108:111], v[56:59]
    ds_read_b64_tr_b16 a[84:85], v89 offset:38912
    v_mfma_f32_16x16x32_bf16 v[60:63], a[20:23], a[108:111], v[60:63]
    ds_read_b64_tr_b16 a[86:87], v89 offset:44032
    s_waitcnt lgkmcnt(10)
    v_mfma_f32_16x16x32_bf16 v[0:3], a[48:51], a[4:7], v[0:3]
    v_mfma_f32_16x16x32_bf16 v[4:7], a[52:55], a[4:7], v[4:7]
    v_mfma_f32_16x16x32_bf16 v[8:11], a[56:59], a[4:7], v[8:11]
    v_mfma_f32_16x16x32_bf16 v[12:15], a[60:63], a[4:7], v[12:15]
    v_mfma_f32_16x16x32_bf16 v[16:19], a[64:67], a[4:7], v[16:19]
    s_waitcnt lgkmcnt(0)
    v_mfma_f32_16x16x32_bf16 v[20:23], a[68:71], a[4:7], v[20:23]
    v_mfma_f32_16x16x32_bf16 v[24:27], a[72:75], a[4:7], v[24:27]
    v_mfma_f32_16x16x32_bf16 v[28:31], a[76:79], a[4:7], v[28:31]
    v_mfma_f32_16x16x32_bf16 v[32:35], a[80:83], a[4:7], v[32:35]
    v_mfma_f32_16x16x32_bf16 v[36:39], a[84:87], a[4:7], v[36:39]
    v_mfma_f32_16x16x32_bf16 v[40:43], a[108:111], a[4:7], v[40:43]
    v_mfma_f32_16x16x32_bf16 v[44:47], a[4:7], a[4:7], v[44:47]
    v_mfma_f32_16x16x32_bf16 v[48:51], a[48:51], a[108:111], v[48:51]
    v_mfma_f32_16x16x32_bf16 v[52:55], a[52:55], a[108:111], v[52:55]
    v_mfma_f32_16x16x32_bf16 v[56:59], a[56:59], a[108:111], v[56:59]
    v_mfma_f32_16x16x32_bf16 v[60:63], a[60:63], a[108:111], v[60:63]
    v_mov_b32 v141, 0
    buffer_load_dword v140, v141, s[88:91], 0 offen sc1
    s_cmp_ge_u32 s87, 10
    s_cselect_b32 s13, 10, 0
    s_sub_u32 s87, s87, s13
    s_lshl_b32 s11, s87, 6
    s_add_u32 s11, s11, 160768
    v_lshlrev_b32 v133, 4, v130
    v_add_u32 v133, s11, v133
    v_and_b32 v75, 3, v129
    v_lshrrev_b32 v76, 2, v129
    ds_write_b128 v133, v[48:51] offset:0
    ds_write_b128 v133, v[48:51] offset:640
    ds_write_b128 v133, v[52:55] offset:64
    ds_write_b128 v133, v[52:55] offset:704
    ds_write_b128 v133, v[56:59] offset:128
    ds_write_b128 v133, v[56:59] offset:768
    ds_write_b128 v133, v[60:63] offset:192
    ds_write_b128 v133, v[60:63] offset:832
    v_cmp_eq_u32 vcc, 1, v75
    s_nop 1
    v_cndmask_b32 v44, v44, v45, vcc
    v_cmp_eq_u32 vcc, 2, v75
    s_nop 1
    v_cndmask_b32 v44, v44, v46, vcc
    v_cmp_eq_u32 vcc, 3, v75
    s_nop 1
    v_cndmask_b32 v44, v44, v47, vcc
    v_cmp_eq_u32 vcc, v76, v130
    s_nop 1
    v_cndmask_b32 v44, 0, v44, vcc
    s_waitcnt lgkmcnt(0)
    s_barrier
    ds_read_b128 v[80:83], v133 offset:0
    ds_read_b128 v[84:87], v133 offset:64
    ds_read_b128 v[88:91], v133 offset:128
    ds_read_b128 v[92:95], v133 offset:192
    ds_read_b128 v[96:99], v133 offset:256
    ds_read_b128 v[100:103], v133 offset:320
    ds_read_b128 v[104:107], v133 offset:384
    ds_read_b128 v[108:111], v133 offset:448
    ds_read_b128 v[112:115], v133 offset:512
    ds_read_b128 v[116:119], v133 offset:576
    v_mov_b32 v45, v44
    s_nop 1
    v_permlane16_swap_b32 v44, v45
    v_add_f32 v44, v44, v45
    v_mov_b32 v45, v44
    s_nop 1
    v_permlane32_swap_b32 v44, v45
    v_add_f32 v44, v44, v45
    v_mul_f32 v120, 986500301, v40
    v_mul_f32 v44, 986500301, v44
    v_fma_f32 v44, -v120, v120, v44
    v_max_f32 v44, 0, v44
    v_add_f32 v44, 925353388, v44
    v_rsq_f32 v122, v44
    s_nop 0
    v_mul_f32 v121, v44, v122
    v_mul_f32 v123, v122, v122
    v_mul_f32 v123, v123, v122
    v_mul_f32 v123, 3184710632, v123
    v_mul_f32 v122, 3222493025, v122
    s_lshl_b32 s11, s5, 1
    s_and_b32 s12, s4, 1
    s_add_u32 s11, s11, s12
    s_lshl_b32 s11, s11, 2
    s_add_u32 s11, s11, s8
    s_lshl_b32 s11, s11, 2
    s_lshr_b32 s12, s7, 1
    s_add_u32 s11, s11, s12
    s_mul_i32 s11, s11, 5120
    s_add_u32 s84, s11, 135168
    s_lshr_b32 s87, s87, 1
    s_waitcnt lgkmcnt(0)
    v_pk_fma_f32 v[0:1], v[80:81], v[120:121], v[0:1] op_sel:[0,0,0] op_sel_hi:[1,0,1] neg_lo:[1,0,0] neg_hi:[1,0,0]
    v_pk_fma_f32 v[2:3], v[82:83], v[120:121], v[2:3] op_sel:[0,0,0] op_sel_hi:[1,0,1] neg_lo:[1,0,0] neg_hi:[1,0,0]
    v_pk_fma_f32 v[4:5], v[84:85], v[120:121], v[4:5] op_sel:[0,0,0] op_sel_hi:[1,0,1] neg_lo:[1,0,0] neg_hi:[1,0,0]
    v_pk_fma_f32 v[6:7], v[86:87], v[120:121], v[6:7] op_sel:[0,0,0] op_sel_hi:[1,0,1] neg_lo:[1,0,0] neg_hi:[1,0,0]
    v_pk_mul_f32 v[64:65], v[0:1], v[0:1]
    v_pk_mul_f32 v[66:67], v[2:3], v[2:3]
    v_pk_mul_f32 v[68:69], v[4:5], v[4:5]
    v_pk_mul_f32 v[70:71], v[6:7], v[6:7]
    v_pk_fma_f32 v[64:65], v[64:65], v[122:123], v[122:123] op_sel:[0,1,0] op_sel_hi:[1,1,0]
    v_pk_fma_f32 v[66:67], v[66:67], v[122:123], v[122:123] op_sel:[0,1,0] op_sel_hi:[1,1,0]
    v_pk_fma_f32 v[68:69], v[68:69], v[122:123], v[122:123] op_sel:[0,1,0] op_sel_hi:[1,1,0]
    v_pk_fma_f32 v[70:71], v[70:71], v[122:123], v[122:123] op_sel:[0,1,0] op_sel_hi:[1,1,0]
    v_pk_mul_f32 v[64:65], v[64:65], v[0:1]
    v_pk_mul_f32 v[66:67], v[66:67], v[2:3]
    v_pk_mul_f32 v[68:69], v[68:69], v[4:5]
    v_pk_mul_f32 v[70:71], v[70:71], v[6:7]
    v_exp_f32 v64, v64
    v_exp_f32 v65, v65
    v_exp_f32 v66, v66
    v_exp_f32 v67, v67
    v_exp_f32 v68, v68
    v_exp_f32 v69, v69
    v_exp_f32 v70, v70
    v_exp_f32 v71, v71
    v_pk_fma_f32 v[64:65], v[64:65], v[120:121], v[120:121] op_sel:[0,1,1] op_sel_hi:[1,1,1]
    v_pk_fma_f32 v[66:67], v[66:67], v[120:121], v[120:121] op_sel:[0,1,1] op_sel_hi:[1,1,1]
    v_pk_fma_f32 v[68:69], v[68:69], v[120:121], v[120:121] op_sel:[0,1,1] op_sel_hi:[1,1,1]
    v_pk_fma_f32 v[70:71], v[70:71], v[120:121], v[120:121] op_sel:[0,1,1] op_sel_hi:[1,1,1]
    v_rcp_f32 v64, v64
    v_rcp_f32 v65, v65
    v_rcp_f32 v66, v66
    v_rcp_f32 v67, v67
    v_rcp_f32 v68, v68
    v_rcp_f32 v69, v69
    v_rcp_f32 v70, v70
    v_rcp_f32 v71, v71
    v_pk_mul_f32 v[64:65], v[64:65], v[0:1]
    v_pk_mul_f32 v[66:67], v[66:67], v[2:3]
    v_pk_mul_f32 v[68:69], v[68:69], v[4:5]
    v_pk_mul_f32 v[70:71], v[70:71], v[6:7]
    v_cvt_pk_bf16_f32 v0, v64, v65
    v_cvt_pk_bf16_f32 v1, v66, v67
    v_cvt_pk_bf16_f32 v2, v68, v69
    v_cvt_pk_bf16_f32 v3, v70, v71
    s_add_u32 s11, s87, 0
    s_cmp_ge_u32 s11, 5
    s_cselect_b32 s13, 5, 0
    s_sub_u32 s11, s11, s13
    s_lshl_b32 s11, s11, 10
    s_add_u32 s11, s11, s84
    buffer_store_dwordx4 v[0:3], v143, s[52:55], s11 offen sc1
    v_pk_fma_f32 v[8:9], v[88:89], v[120:121], v[8:9] op_sel:[0,0,0] op_sel_hi:[1,0,1] neg_lo:[1,0,0] neg_hi:[1,0,0]
    v_pk_fma_f32 v[10:11], v[90:91], v[120:121], v[10:11] op_sel:[0,0,0] op_sel_hi:[1,0,1] neg_lo:[1,0,0] neg_hi:[1,0,0]
    v_pk_fma_f32 v[12:13], v[92:93], v[120:121], v[12:13] op_sel:[0,0,0] op_sel_hi:[1,0,1] neg_lo:[1,0,0] neg_hi:[1,0,0]
    v_pk_fma_f32 v[14:15], v[94:95], v[120:121], v[14:15] op_sel:[0,0,0] op_sel_hi:[1,0,1] neg_lo:[1,0,0] neg_hi:[1,0,0]
    v_pk_mul_f32 v[64:65], v[8:9], v[8:9]
    v_pk_mul_f32 v[66:67], v[10:11], v[10:11]
    v_pk_mul_f32 v[68:69], v[12:13], v[12:13]
    v_pk_mul_f32 v[70:71], v[14:15], v[14:15]
    v_pk_fma_f32 v[64:65], v[64:65], v[122:123], v[122:123] op_sel:[0,1,0] op_sel_hi:[1,1,0]
    v_pk_fma_f32 v[66:67], v[66:67], v[122:123], v[122:123] op_sel:[0,1,0] op_sel_hi:[1,1,0]
    v_pk_fma_f32 v[68:69], v[68:69], v[122:123], v[122:123] op_sel:[0,1,0] op_sel_hi:[1,1,0]
    v_pk_fma_f32 v[70:71], v[70:71], v[122:123], v[122:123] op_sel:[0,1,0] op_sel_hi:[1,1,0]
    v_pk_mul_f32 v[64:65], v[64:65], v[8:9]
    v_pk_mul_f32 v[66:67], v[66:67], v[10:11]
    v_pk_mul_f32 v[68:69], v[68:69], v[12:13]
    v_pk_mul_f32 v[70:71], v[70:71], v[14:15]
    v_exp_f32 v64, v64
    v_exp_f32 v65, v65
    v_exp_f32 v66, v66
    v_exp_f32 v67, v67
    v_exp_f32 v68, v68
    v_exp_f32 v69, v69
    v_exp_f32 v70, v70
    v_exp_f32 v71, v71
    v_pk_fma_f32 v[64:65], v[64:65], v[120:121], v[120:121] op_sel:[0,1,1] op_sel_hi:[1,1,1]
    v_pk_fma_f32 v[66:67], v[66:67], v[120:121], v[120:121] op_sel:[0,1,1] op_sel_hi:[1,1,1]
    v_pk_fma_f32 v[68:69], v[68:69], v[120:121], v[120:121] op_sel:[0,1,1] op_sel_hi:[1,1,1]
    v_pk_fma_f32 v[70:71], v[70:71], v[120:121], v[120:121] op_sel:[0,1,1] op_sel_hi:[1,1,1]
    v_rcp_f32 v64, v64
    v_rcp_f32 v65, v65
    v_rcp_f32 v66, v66
    v_rcp_f32 v67, v67
    v_rcp_f32 v68, v68
    v_rcp_f32 v69, v69
    v_rcp_f32 v70, v70
    v_rcp_f32 v71, v71
    v_pk_mul_f32 v[64:65], v[64:65], v[8:9]
    v_pk_mul_f32 v[66:67], v[66:67], v[10:11]
    v_pk_mul_f32 v[68:69], v[68:69], v[12:13]
    v_pk_mul_f32 v[70:71], v[70:71], v[14:15]
    v_cvt_pk_bf16_f32 v8, v64, v65
    v_cvt_pk_bf16_f32 v9, v66, v67
    v_cvt_pk_bf16_f32 v10, v68, v69
    v_cvt_pk_bf16_f32 v11, v70, v71
    s_add_u32 s11, s87, 1
    s_cmp_ge_u32 s11, 5
    s_cselect_b32 s13, 5, 0
    s_sub_u32 s11, s11, s13
    s_lshl_b32 s11, s11, 10
    s_add_u32 s11, s11, s84
    buffer_store_dwordx4 v[8:11], v143, s[52:55], s11 offen sc1
    v_pk_fma_f32 v[16:17], v[96:97], v[120:121], v[16:17] op_sel:[0,0,0] op_sel_hi:[1,0,1] neg_lo:[1,0,0] neg_hi:[1,0,0]
    v_pk_fma_f32 v[18:19], v[98:99], v[120:121], v[18:19] op_sel:[0,0,0] op_sel_hi:[1,0,1] neg_lo:[1,0,0] neg_hi:[1,0,0]
    v_pk_fma_f32 v[20:21], v[100:101], v[120:121], v[20:21] op_sel:[0,0,0] op_sel_hi:[1,0,1] neg_lo:[1,0,0] neg_hi:[1,0,0]
    v_pk_fma_f32 v[22:23], v[102:103], v[120:121], v[22:23] op_sel:[0,0,0] op_sel_hi:[1,0,1] neg_lo:[1,0,0] neg_hi:[1,0,0]
    v_pk_mul_f32 v[64:65], v[16:17], v[16:17]
    v_pk_mul_f32 v[66:67], v[18:19], v[18:19]
    v_pk_mul_f32 v[68:69], v[20:21], v[20:21]
    v_pk_mul_f32 v[70:71], v[22:23], v[22:23]
    v_pk_fma_f32 v[64:65], v[64:65], v[122:123], v[122:123] op_sel:[0,1,0] op_sel_hi:[1,1,0]
    v_pk_fma_f32 v[66:67], v[66:67], v[122:123], v[122:123] op_sel:[0,1,0] op_sel_hi:[1,1,0]
    v_pk_fma_f32 v[68:69], v[68:69], v[122:123], v[122:123] op_sel:[0,1,0] op_sel_hi:[1,1,0]
    v_pk_fma_f32 v[70:71], v[70:71], v[122:123], v[122:123] op_sel:[0,1,0] op_sel_hi:[1,1,0]
    v_pk_mul_f32 v[64:65], v[64:65], v[16:17]
    v_pk_mul_f32 v[66:67], v[66:67], v[18:19]
    v_pk_mul_f32 v[68:69], v[68:69], v[20:21]
    v_pk_mul_f32 v[70:71], v[70:71], v[22:23]
    v_exp_f32 v64, v64
    v_exp_f32 v65, v65
    v_exp_f32 v66, v66
    v_exp_f32 v67, v67
    v_exp_f32 v68, v68
    v_exp_f32 v69, v69
    v_exp_f32 v70, v70
    v_exp_f32 v71, v71
    v_pk_fma_f32 v[64:65], v[64:65], v[120:121], v[120:121] op_sel:[0,1,1] op_sel_hi:[1,1,1]
    v_pk_fma_f32 v[66:67], v[66:67], v[120:121], v[120:121] op_sel:[0,1,1] op_sel_hi:[1,1,1]
    v_pk_fma_f32 v[68:69], v[68:69], v[120:121], v[120:121] op_sel:[0,1,1] op_sel_hi:[1,1,1]
    v_pk_fma_f32 v[70:71], v[70:71], v[120:121], v[120:121] op_sel:[0,1,1] op_sel_hi:[1,1,1]
    v_rcp_f32 v64, v64
    v_rcp_f32 v65, v65
    v_rcp_f32 v66, v66
    v_rcp_f32 v67, v67
    v_rcp_f32 v68, v68
    v_rcp_f32 v69, v69
    v_rcp_f32 v70, v70
    v_rcp_f32 v71, v71
    v_pk_mul_f32 v[64:65], v[64:65], v[16:17]
    v_pk_mul_f32 v[66:67], v[66:67], v[18:19]
    v_pk_mul_f32 v[68:69], v[68:69], v[20:21]
    v_pk_mul_f32 v[70:71], v[70:71], v[22:23]
    v_cvt_pk_bf16_f32 v16, v64, v65
    v_cvt_pk_bf16_f32 v17, v66, v67
    v_cvt_pk_bf16_f32 v18, v68, v69
    v_cvt_pk_bf16_f32 v19, v70, v71
    s_add_u32 s11, s87, 2
    s_cmp_ge_u32 s11, 5
    s_cselect_b32 s13, 5, 0
    s_sub_u32 s11, s11, s13
    s_lshl_b32 s11, s11, 10
    s_add_u32 s11, s11, s84
    buffer_store_dwordx4 v[16:19], v143, s[52:55], s11 offen sc1
    v_pk_fma_f32 v[24:25], v[104:105], v[120:121], v[24:25] op_sel:[0,0,0] op_sel_hi:[1,0,1] neg_lo:[1,0,0] neg_hi:[1,0,0]
    v_pk_fma_f32 v[26:27], v[106:107], v[120:121], v[26:27] op_sel:[0,0,0] op_sel_hi:[1,0,1] neg_lo:[1,0,0] neg_hi:[1,0,0]
    v_pk_fma_f32 v[28:29], v[108:109], v[120:121], v[28:29] op_sel:[0,0,0] op_sel_hi:[1,0,1] neg_lo:[1,0,0] neg_hi:[1,0,0]
    v_pk_fma_f32 v[30:31], v[110:111], v[120:121], v[30:31] op_sel:[0,0,0] op_sel_hi:[1,0,1] neg_lo:[1,0,0] neg_hi:[1,0,0]
    v_pk_mul_f32 v[64:65], v[24:25], v[24:25]
    v_pk_mul_f32 v[66:67], v[26:27], v[26:27]
    v_pk_mul_f32 v[68:69], v[28:29], v[28:29]
    v_pk_mul_f32 v[70:71], v[30:31], v[30:31]
    v_pk_fma_f32 v[64:65], v[64:65], v[122:123], v[122:123] op_sel:[0,1,0] op_sel_hi:[1,1,0]
    v_pk_fma_f32 v[66:67], v[66:67], v[122:123], v[122:123] op_sel:[0,1,0] op_sel_hi:[1,1,0]
    v_pk_fma_f32 v[68:69], v[68:69], v[122:123], v[122:123] op_sel:[0,1,0] op_sel_hi:[1,1,0]
    v_pk_fma_f32 v[70:71], v[70:71], v[122:123], v[122:123] op_sel:[0,1,0] op_sel_hi:[1,1,0]
    v_pk_mul_f32 v[64:65], v[64:65], v[24:25]
    v_pk_mul_f32 v[66:67], v[66:67], v[26:27]
    v_pk_mul_f32 v[68:69], v[68:69], v[28:29]
    v_pk_mul_f32 v[70:71], v[70:71], v[30:31]
    v_exp_f32 v64, v64
    v_exp_f32 v65, v65
    v_exp_f32 v66, v66
    v_exp_f32 v67, v67
    v_exp_f32 v68, v68
    v_exp_f32 v69, v69
    v_exp_f32 v70, v70
    v_exp_f32 v71, v71
    v_pk_fma_f32 v[64:65], v[64:65], v[120:121], v[120:121] op_sel:[0,1,1] op_sel_hi:[1,1,1]
    v_pk_fma_f32 v[66:67], v[66:67], v[120:121], v[120:121] op_sel:[0,1,1] op_sel_hi:[1,1,1]
    v_pk_fma_f32 v[68:69], v[68:69], v[120:121], v[120:121] op_sel:[0,1,1] op_sel_hi:[1,1,1]
    v_pk_fma_f32 v[70:71], v[70:71], v[120:121], v[120:121] op_sel:[0,1,1] op_sel_hi:[1,1,1]
    v_rcp_f32 v64, v64
    v_rcp_f32 v65, v65
    v_rcp_f32 v66, v66
    v_rcp_f32 v67, v67
    v_rcp_f32 v68, v68
    v_rcp_f32 v69, v69
    v_rcp_f32 v70, v70
    v_rcp_f32 v71, v71
    v_pk_mul_f32 v[64:65], v[64:65], v[24:25]
    v_pk_mul_f32 v[66:67], v[66:67], v[26:27]
    v_pk_mul_f32 v[68:69], v[68:69], v[28:29]
    v_pk_mul_f32 v[70:71], v[70:71], v[30:31]
    v_cvt_pk_bf16_f32 v24, v64, v65
    v_cvt_pk_bf16_f32 v25, v66, v67
    v_cvt_pk_bf16_f32 v26, v68, v69
    v_cvt_pk_bf16_f32 v27, v70, v71
    s_add_u32 s11, s87, 3
    s_cmp_ge_u32 s11, 5
    s_cselect_b32 s13, 5, 0
    s_sub_u32 s11, s11, s13
    s_lshl_b32 s11, s11, 10
    s_add_u32 s11, s11, s84
    buffer_store_dwordx4 v[24:27], v143, s[52:55], s11 offen sc1
    v_pk_fma_f32 v[32:33], v[112:113], v[120:121], v[32:33] op_sel:[0,0,0] op_sel_hi:[1,0,1] neg_lo:[1,0,0] neg_hi:[1,0,0]
    v_pk_fma_f32 v[34:35], v[114:115], v[120:121], v[34:35] op_sel:[0,0,0] op_sel_hi:[1,0,1] neg_lo:[1,0,0] neg_hi:[1,0,0]
    v_pk_fma_f32 v[36:37], v[116:117], v[120:121], v[36:37] op_sel:[0,0,0] op_sel_hi:[1,0,1] neg_lo:[1,0,0] neg_hi:[1,0,0]
    v_pk_fma_f32 v[38:39], v[118:119], v[120:121], v[38:39] op_sel:[0,0,0] op_sel_hi:[1,0,1] neg_lo:[1,0,0] neg_hi:[1,0,0]
    v_pk_mul_f32 v[64:65], v[32:33], v[32:33]
    v_pk_mul_f32 v[66:67], v[34:35], v[34:35]
    v_pk_mul_f32 v[68:69], v[36:37], v[36:37]
    v_pk_mul_f32 v[70:71], v[38:39], v[38:39]
    v_pk_fma_f32 v[64:65], v[64:65], v[122:123], v[122:123] op_sel:[0,1,0] op_sel_hi:[1,1,0]
    v_pk_fma_f32 v[66:67], v[66:67], v[122:123], v[122:123] op_sel:[0,1,0] op_sel_hi:[1,1,0]
    v_pk_fma_f32 v[68:69], v[68:69], v[122:123], v[122:123] op_sel:[0,1,0] op_sel_hi:[1,1,0]
    v_pk_fma_f32 v[70:71], v[70:71], v[122:123], v[122:123] op_sel:[0,1,0] op_sel_hi:[1,1,0]
    v_pk_mul_f32 v[64:65], v[64:65], v[32:33]
    v_pk_mul_f32 v[66:67], v[66:67], v[34:35]
    v_pk_mul_f32 v[68:69], v[68:69], v[36:37]
    v_pk_mul_f32 v[70:71], v[70:71], v[38:39]
    v_exp_f32 v64, v64
    v_exp_f32 v65, v65
    v_exp_f32 v66, v66
    v_exp_f32 v67, v67
    v_exp_f32 v68, v68
    v_exp_f32 v69, v69
    v_exp_f32 v70, v70
    v_exp_f32 v71, v71
    v_pk_fma_f32 v[64:65], v[64:65], v[120:121], v[120:121] op_sel:[0,1,1] op_sel_hi:[1,1,1]
    v_pk_fma_f32 v[66:67], v[66:67], v[120:121], v[120:121] op_sel:[0,1,1] op_sel_hi:[1,1,1]
    v_pk_fma_f32 v[68:69], v[68:69], v[120:121], v[120:121] op_sel:[0,1,1] op_sel_hi:[1,1,1]
    v_pk_fma_f32 v[70:71], v[70:71], v[120:121], v[120:121] op_sel:[0,1,1] op_sel_hi:[1,1,1]
    v_rcp_f32 v64, v64
    v_rcp_f32 v65, v65
    v_rcp_f32 v66, v66
    v_rcp_f32 v67, v67
    v_rcp_f32 v68, v68
    v_rcp_f32 v69, v69
    v_rcp_f32 v70, v70
    v_rcp_f32 v71, v71
    v_pk_mul_f32 v[64:65], v[64:65], v[32:33]
    v_pk_mul_f32 v[66:67], v[66:67], v[34:35]
    v_pk_mul_f32 v[68:69], v[68:69], v[36:37]
    v_pk_mul_f32 v[70:71], v[70:71], v[38:39]
    v_cvt_pk_bf16_f32 v32, v64, v65
    v_cvt_pk_bf16_f32 v33, v66, v67
    v_cvt_pk_bf16_f32 v34, v68, v69
    v_cvt_pk_bf16_f32 v35, v70, v71
    s_add_u32 s11, s87, 4
    s_cmp_ge_u32 s11, 5
    s_cselect_b32 s13, 5, 0
    s_sub_u32 s11, s11, s13
    s_lshl_b32 s11, s11, 10
    s_add_u32 s11, s11, s84
    buffer_store_dwordx4 v[32:35], v143, s[52:55], s11 offen sc1
    s_waitcnt vmcnt(0)
    s_mov_b32 s13, 0
nz_6:
    v_readfirstlane_b32 s9, v140
    s_add_u32 s13, s13, 1
    s_cmp_lg_u32 s9, 0
    s_cbranch_scc1 nd_7
    s_cmp_gt_u32 s13, 131072
    s_cbranch_scc1 nd_7
    s_sleep 4
    buffer_load_dword v140, v141, s[88:91], 0 offen sc1
    s_waitcnt vmcnt(0)
    s_branch nz_6
nd_7:
    v_mov_b32 v60, 163808
    v_mov_b32 v61, 1
    s_mov_b64 exec, 1
    ds_add_rtn_u32 v61, v60, v61
    s_waitcnt lgkmcnt(0)
    v_readfirstlane_b32 s13, v61
    s_nop 0
    s_cmp_lg_u32 s13, 3
    s_cbranch_scc1 arr_8
    s_lshl_b32 s11, s5, 4
    s_lshl_b32 s12, s6, 3
    s_add_u32 s11, s11, s12
    s_add_u32 s11, s11, s7
    s_lshl_b32 s11, s11, 7
    s_add_u32 s11, s11, 4096
    v_mov_b32 v60, s9
    v_mov_b32 v61, 0
    buffer_store_dword v60, v61, s[52:55], s11 offen sc1
arr_8:
    s_mov_b64 exec, -1
    s_lshl_b32 s43, s5, 3
    s_lshl_b32 s11, s8, 1
    s_add_u32 s43, s43, s11
    s_lshl_b32 s60, s43, 4
    s_mul_i32 s43, s43, 20480
    s_mov_b32 s56, s34
    s_mov_b32 s57, s35
    s_mov_b32 s58, 1280
    s_mov_b32 s59, 0x20000
    v_lshlrev_b32 v120, 3, v130
    s_mul_i32 s84, s7, 160
    buffer_load_dwordx2 v[60:61], v120, s[56:59], s84 offen offset:0
    buffer_load_dwordx2 v[62:63], v120, s[56:59], s84 offen offset:32
    buffer_load_dwordx2 v[64:65], v120, s[56:59], s84 offen offset:64
    buffer_load_dwordx2 v[66:67], v120, s[56:59], s84 offen offset:96
    buffer_load_dwordx2 v[68:69], v120, s[56:59], s84 offen offset:128
    v_lshl_add_u32 v121, v130, 2, v131
    v_mul_u32_u24 v121, 160, v121
    v_lshl_add_u32 v121, v132, 3, v121
    v_add_u32 v133, 57344, v121
    v_add_u32 v134, 114688, v121
    s_mul_i32 s11, s8, 5120
    s_add_u32 s11, s11, 57344
    v_mul_u32_u24 v139, 160, v129
    v_add3_u32 v139, v139, v120, s11
    s_lshl_b32 s11, s8, 11
    v_add_u32 v135, s11, v143
    v_add_u32 v136, 20480, v143
    v_lshlrev_b32 v137, 3, v128
    v_add_u32 v138, 20480, v137
    s_barrier
    ds_read_b128 a[0:3], v135 offset:0
    ds_read_b128 a[4:7], v135 offset:1024
    ds_read_b64_tr_b16 a[16:17], v134 offset:0
    ds_read_b64_tr_b16 a[18:19], v134 offset:2560
    ds_read_b64_tr_b16 a[20:21], v134 offset:32
    ds_read_b64_tr_b16 a[22:23], v134 offset:2592
    ds_read_b64_tr_b16 a[24:25], v134 offset:64
    ds_read_b64_tr_b16 a[26:27], v134 offset:2624
    ds_read_b64_tr_b16 a[28:29], v134 offset:96
    ds_read_b64_tr_b16 a[30:31], v134 offset:2656
    ds_read_b64_tr_b16 a[32:33], v134 offset:128
    ds_read_b64_tr_b16 a[34:35], v134 offset:2688
    s_waitcnt lgkmcnt(0)
    v_mfma_f32_16x16x32_bf16 v[0:3], a[16:19], a[0:3], 0
    ds_read_b128 a[8:11], v135 offset:8192
    ds_read_b128 a[12:15], v135 offset:9216
    v_mfma_f32_16x16x32_bf16 v[20:23], a[16:19], a[4:7], 0
    ds_read_b64_tr_b16 a[36:37], v134 offset:5120
    ds_read_b64_tr_b16 a[38:39], v134 offset:7680
    v_mfma_f32_16x16x32_bf16 v[4:7], a[20:23], a[0:3], 0
    ds_read_b64_tr_b16 a[40:41], v134 offset:5152
    ds_read_b64_tr_b16 a[42:43], v134 offset:7712
    v_mfma_f32_16x16x32_bf16 v[24:27], a[20:23], a[4:7], 0
    ds_read_b64_tr_b16 a[44:45], v134 offset:5184
    ds_read_b64_tr_b16 a[46:47], v134 offset:7744
    v_mfma_f32_16x16x32_bf16 v[8:11], a[24:27], a[0:3], 0
    ds_read_b64_tr_b16 a[48:49], v134 offset:5216
    ds_read_b64_tr_b16 a[50:51], v134 offset:7776
    v_mfma_f32_16x16x32_bf16 v[28:31], a[24:27], a[4:7], 0
    ds_read_b64_tr_b16 a[52:53], v134 offset:5248
    ds_read_b64_tr_b16 a[54:55], v134 offset:7808
    v_mfma_f32_16x16x32_bf16 v[12:15], a[28:31], a[0:3], 0
    v_mfma_f32_16x16x32_bf16 v[32:35], a[28:31], a[4:7], 0
    v_mfma_f32_16x16x32_bf16 v[16:19], a[32:35], a[0:3], 0
    v_mfma_f32_16x16x32_bf16 v[36:39], a[32:35], a[4:7], 0
    s_waitcnt lgkmcnt(0)
    s_barrier
    v_mfma_f32_16x16x32_bf16 v[0:3], a[36:39], a[8:11], v[0:3]
    ds_read_b128 a[0:3], v135 offset:16384
    ds_read_b128 a[4:7], v135 offset:17408
    v_mfma_f32_16x16x32_bf16 v[20:23], a[36:39], a[12:15], v[20:23]
    ds_read_b64_tr_b16 a[16:17], v134 offset:10240
    v_mfma_f32_16x16x32_bf16 v[4:7], a[40:43], a[8:11], v[4:7]
    ds_read_b64_tr_b16 a[18:19], v134 offset:12800
    v_mfma_f32_16x16x32_bf16 v[24:27], a[40:43], a[12:15], v[24:27]
    ds_read_b64_tr_b16 a[20:21], v134 offset:10272
    v_mfma_f32_16x16x32_bf16 v[8:11], a[44:47], a[8:11], v[8:11]
    ds_read_b64_tr_b16 a[22:23], v134 offset:12832
    v_mfma_f32_16x16x32_bf16 v[28:31], a[44:47], a[12:15], v[28:31]
    ds_read_b64_tr_b16 a[24:25], v134 offset:10304
    ds_read_b64_tr_b16 a[26:27], v134 offset:12864
    v_mfma_f32_16x16x32_bf16 v[12:15], a[48:51], a[8:11], v[12:15]
    ds_read_b64_tr_b16 a[28:29], v134 offset:10336
    v_mfma_f32_16x16x32_bf16 v[32:35], a[48:51], a[12:15], v[32:35]
    ds_read_b64_tr_b16 a[30:31], v134 offset:12896
    v_mfma_f32_16x16x32_bf16 v[16:19], a[52:55], a[8:11], v[16:19]
    ds_read_b64_tr_b16 a[32:33], v134 offset:10368
    v_mfma_f32_16x16x32_bf16 v[36:39], a[52:55], a[12:15], v[36:39]
    ds_read_b64_tr_b16 a[34:35], v134 offset:12928
    s_waitcnt lgkmcnt(0)
    v_mfma_f32_16x16x32_bf16 v[0:3], a[16:19], a[0:3], v[0:3]
    ds_read_b128 a[8:11], v135 offset:24576
    ds_read_b128 a[12:15], v135 offset:25600
    v_mfma_f32_16x16x32_bf16 v[20:23], a[16:19], a[4:7], v[20:23]
    ds_read_b64_tr_b16 a[36:37], v134 offset:15360
    ds_read_b64_tr_b16 a[38:39], v134 offset:17920
    v_mfma_f32_16x16x32_bf16 v[4:7], a[20:23], a[0:3], v[4:7]
    ds_read_b64_tr_b16 a[40:41], v134 offset:15392
    ds_read_b64_tr_b16 a[42:43], v134 offset:17952
    v_mfma_f32_16x16x32_bf16 v[24:27], a[20:23], a[4:7], v[24:27]
    ds_read_b64_tr_b16 a[44:45], v134 offset:15424
    ds_read_b64_tr_b16 a[46:47], v134 offset:17984
    v_mfma_f32_16x16x32_bf16 v[8:11], a[24:27], a[0:3], v[8:11]
    ds_read_b64_tr_b16 a[48:49], v134 offset:15456
    ds_read_b64_tr_b16 a[50:51], v134 offset:18016
    v_mfma_f32_16x16x32_bf16 v[28:31], a[24:27], a[4:7], v[28:31]
    ds_read_b64_tr_b16 a[52:53], v134 offset:15488
    ds_read_b64_tr_b16 a[54:55], v134 offset:18048
    v_mfma_f32_16x16x32_bf16 v[12:15], a[28:31], a[0:3], v[12:15]
    v_mfma_f32_16x16x32_bf16 v[32:35], a[28:31], a[4:7], v[32:35]
    v_mfma_f32_16x16x32_bf16 v[16:19], a[32:35], a[0:3], v[16:19]
    v_mfma_f32_16x16x32_bf16 v[36:39], a[32:35], a[4:7], v[36:39]
    s_waitcnt lgkmcnt(0)
    s_barrier
    v_mfma_f32_16x16x32_bf16 v[0:3], a[36:39], a[8:11], v[0:3]
    ds_read_b128 a[0:3], v135 offset:32768
    ds_read_b128 a[4:7], v135 offset:33792
    v_mfma_f32_16x16x32_bf16 v[20:23], a[36:39], a[12:15], v[20:23]
    ds_read_b64_tr_b16 a[16:17], v134 offset:20480
    v_mfma_f32_16x16x32_bf16 v[4:7], a[40:43], a[8:11], v[4:7]
    ds_read_b64_tr_b16 a[18:19], v134 offset:23040
    v_mfma_f32_16x16x32_bf16 v[24:27], a[40:43], a[12:15], v[24:27]
    ds_read_b64_tr_b16 a[20:21], v134 offset:20512
    v_mfma_f32_16x16x32_bf16 v[8:11], a[44:47], a[8:11], v[8:11]
    ds_read_b64_tr_b16 a[22:23], v134 offset:23072
    v_mfma_f32_16x16x32_bf16 v[28:31], a[44:47], a[12:15], v[28:31]
    ds_read_b64_tr_b16 a[24:25], v134 offset:20544
    ds_read_b64_tr_b16 a[26:27], v134 offset:23104
    v_mfma_f32_16x16x32_bf16 v[12:15], a[48:51], a[8:11], v[12:15]
    ds_read_b64_tr_b16 a[28:29], v134 offset:20576
    v_mfma_f32_16x16x32_bf16 v[32:35], a[48:51], a[12:15], v[32:35]
    ds_read_b64_tr_b16 a[30:31], v134 offset:23136
    v_mfma_f32_16x16x32_bf16 v[16:19], a[52:55], a[8:11], v[16:19]
    ds_read_b64_tr_b16 a[32:33], v134 offset:20608
    v_mfma_f32_16x16x32_bf16 v[36:39], a[52:55], a[12:15], v[36:39]
    ds_read_b64_tr_b16 a[34:35], v134 offset:23168
    s_waitcnt lgkmcnt(0)
    v_mfma_f32_16x16x32_bf16 v[0:3], a[16:19], a[0:3], v[0:3]
    ds_read_b128 a[8:11], v135 offset:40960
    ds_read_b128 a[12:15], v135 offset:41984
    v_mfma_f32_16x16x32_bf16 v[20:23], a[16:19], a[4:7], v[20:23]
    ds_read_b64_tr_b16 a[36:37], v133 offset:0
    ds_read_b64_tr_b16 a[38:39], v133 offset:2560
    v_mfma_f32_16x16x32_bf16 v[4:7], a[20:23], a[0:3], v[4:7]
    ds_read_b64_tr_b16 a[40:41], v133 offset:32
    ds_read_b64_tr_b16 a[42:43], v133 offset:2592
    v_mfma_f32_16x16x32_bf16 v[24:27], a[20:23], a[4:7], v[24:27]
    ds_read_b64_tr_b16 a[44:45], v133 offset:64
    ds_read_b64_tr_b16 a[46:47], v133 offset:2624
    v_mfma_f32_16x16x32_bf16 v[8:11], a[24:27], a[0:3], v[8:11]
    ds_read_b64_tr_b16 a[48:49], v133 offset:96
    ds_read_b64_tr_b16 a[50:51], v133 offset:2656
    v_mfma_f32_16x16x32_bf16 v[28:31], a[24:27], a[4:7], v[28:31]
    ds_read_b64_tr_b16 a[52:53], v133 offset:128
    ds_read_b64_tr_b16 a[54:55], v133 offset:2688
    v_mfma_f32_16x16x32_bf16 v[12:15], a[28:31], a[0:3], v[12:15]
    v_mfma_f32_16x16x32_bf16 v[32:35], a[28:31], a[4:7], v[32:35]
    v_mfma_f32_16x16x32_bf16 v[16:19], a[32:35], a[0:3], v[16:19]
    v_mfma_f32_16x16x32_bf16 v[36:39], a[32:35], a[4:7], v[36:39]
    s_waitcnt lgkmcnt(0)
    s_barrier
    v_mfma_f32_16x16x32_bf16 v[0:3], a[36:39], a[8:11], v[0:3]
    ds_read_b128 a[0:3], v135 offset:49152
    ds_read_b128 a[4:7], v135 offset:50176
    v_mfma_f32_16x16x32_bf16 v[20:23], a[36:39], a[12:15], v[20:23]
    ds_read_b64_tr_b16 a[16:17], v133 offset:5120
    v_mfma_f32_16x16x32_bf16 v[4:7], a[40:43], a[8:11], v[4:7]
    ds_read_b64_tr_b16 a[18:19], v133 offset:7680
    v_mfma_f32_16x16x32_bf16 v[24:27], a[40:43], a[12:15], v[24:27]
    ds_read_b64_tr_b16 a[20:21], v133 offset:5152
    v_mfma_f32_16x16x32_bf16 v[8:11], a[44:47], a[8:11], v[8:11]
    ds_read_b64_tr_b16 a[22:23], v133 offset:7712
    v_mfma_f32_16x16x32_bf16 v[28:31], a[44:47], a[12:15], v[28:31]
    ds_read_b64_tr_b16 a[24:25], v133 offset:5184
    ds_read_b64_tr_b16 a[26:27], v133 offset:7744
    v_mfma_f32_16x16x32_bf16 v[12:15], a[48:51], a[8:11], v[12:15]
    ds_read_b64_tr_b16 a[28:29], v133 offset:5216
    v_mfma_f32_16x16x32_bf16 v[32:35], a[48:51], a[12:15], v[32:35]
    ds_read_b64_tr_b16 a[30:31], v133 offset:7776
    v_mfma_f32_16x16x32_bf16 v[16:19], a[52:55], a[8:11], v[16:19]
    ds_read_b64_tr_b16 a[32:33], v133 offset:5248
    v_mfma_f32_16x16x32_bf16 v[36:39], a[52:55], a[12:15], v[36:39]
    ds_read_b64_tr_b16 a[34:35], v133 offset:7808
    s_waitcnt lgkmcnt(0)
    v_mfma_f32_16x16x32_bf16 v[0:3], a[16:19], a[0:3], v[0:3]
    ds_read_b128 a[8:11], v135 offset:0
    ds_read_b128 a[12:15], v135 offset:1024
    v_mfma_f32_16x16x32_bf16 v[20:23], a[16:19], a[4:7], v[20:23]
    ds_read_b64_tr_b16 a[36:37], v133 offset:10240
    ds_read_b64_tr_b16 a[38:39], v133 offset:12800
    v_mfma_f32_16x16x32_bf16 v[4:7], a[20:23], a[0:3], v[4:7]
    ds_read_b64_tr_b16 a[40:41], v133 offset:10272
    ds_read_b64_tr_b16 a[42:43], v133 offset:12832
    v_mfma_f32_16x16x32_bf16 v[24:27], a[20:23], a[4:7], v[24:27]
    ds_read_b64_tr_b16 a[44:45], v133 offset:10304
    ds_read_b64_tr_b16 a[46:47], v133 offset:12864
    v_mfma_f32_16x16x32_bf16 v[8:11], a[24:27], a[0:3], v[8:11]
    ds_read_b64_tr_b16 a[48:49], v133 offset:10336
    ds_read_b64_tr_b16 a[50:51], v133 offset:12896
    v_mfma_f32_16x16x32_bf16 v[28:31], a[24:27], a[4:7], v[28:31]
    ds_read_b64_tr_b16 a[52:53], v133 offset:10368
    ds_read_b64_tr_b16 a[54:55], v133 offset:12928
    v_mfma_f32_16x16x32_bf16 v[12:15], a[28:31], a[0:3], v[12:15]
    v_mfma_f32_16x16x32_bf16 v[32:35], a[28:31], a[4:7], v[32:35]
    v_mfma_f32_16x16x32_bf16 v[16:19], a[32:35], a[0:3], v[16:19]
    v_mfma_f32_16x16x32_bf16 v[36:39], a[32:35], a[4:7], v[36:39]
    s_waitcnt lgkmcnt(0)
    s_barrier
    v_mfma_f32_16x16x32_bf16 v[0:3], a[36:39], a[8:11], v[0:3]
    ds_read_b128 a[0:3], v135 offset:8192
    ds_read_b128 a[4:7], v135 offset:9216
    v_mfma_f32_16x16x32_bf16 v[20:23], a[36:39], a[12:15], v[20:23]
    ds_read_b64_tr_b16 a[16:17], v133 offset:15360
    v_mfma_f32_16x16x32_bf16 v[4:7], a[40:43], a[8:11], v[4:7]
    ds_read_b64_tr_b16 a[18:19], v133 offset:17920
    v_mfma_f32_16x16x32_bf16 v[24:27], a[40:43], a[12:15], v[24:27]
    ds_read_b64_tr_b16 a[20:21], v133 offset:15392
    v_mfma_f32_16x16x32_bf16 v[8:11], a[44:47], a[8:11], v[8:11]
    ds_read_b64_tr_b16 a[22:23], v133 offset:17952
    v_mfma_f32_16x16x32_bf16 v[28:31], a[44:47], a[12:15], v[28:31]
    ds_read_b64_tr_b16 a[24:25], v133 offset:15424
    ds_read_b64_tr_b16 a[26:27], v133 offset:17984
    v_mfma_f32_16x16x32_bf16 v[12:15], a[48:51], a[8:11], v[12:15]
    ds_read_b64_tr_b16 a[28:29], v133 offset:15456
    v_mfma_f32_16x16x32_bf16 v[32:35], a[48:51], a[12:15], v[32:35]
    ds_read_b64_tr_b16 a[30:31], v133 offset:18016
    v_mfma_f32_16x16x32_bf16 v[16:19], a[52:55], a[8:11], v[16:19]
    ds_read_b64_tr_b16 a[32:33], v133 offset:15488
    v_mfma_f32_16x16x32_bf16 v[36:39], a[52:55], a[12:15], v[36:39]
    ds_read_b64_tr_b16 a[34:35], v133 offset:18048
    s_waitcnt lgkmcnt(0)
    v_mfma_f32_16x16x32_bf16 v[0:3], a[16:19], a[0:3], v[0:3]
    ds_read_b128 a[8:11], v135 offset:16384
    ds_read_b128 a[12:15], v135 offset:17408
    v_mfma_f32_16x16x32_bf16 v[20:23], a[16:19], a[4:7], v[20:23]
    ds_read_b64_tr_b16 a[36:37], v133 offset:20480
    ds_read_b64_tr_b16 a[38:39], v133 offset:23040
    v_mfma_f32_16x16x32_bf16 v[4:7], a[20:23], a[0:3], v[4:7]
    ds_read_b64_tr_b16 a[40:41], v133 offset:20512
    ds_read_b64_tr_b16 a[42:43], v133 offset:23072
    v_mfma_f32_16x16x32_bf16 v[24:27], a[20:23], a[4:7], v[24:27]
    ds_read_b64_tr_b16 a[44:45], v133 offset:20544
    ds_read_b64_tr_b16 a[46:47], v133 offset:23104
    v_mfma_f32_16x16x32_bf16 v[8:11], a[24:27], a[0:3], v[8:11]
    ds_read_b64_tr_b16 a[48:49], v133 offset:20576
    ds_read_b64_tr_b16 a[50:51], v133 offset:23136
    v_mfma_f32_16x16x32_bf16 v[28:31], a[24:27], a[4:7], v[28:31]
    ds_read_b64_tr_b16 a[52:53], v133 offset:20608
    ds_read_b64_tr_b16 a[54:55], v133 offset:23168
    v_mfma_f32_16x16x32_bf16 v[12:15], a[28:31], a[0:3], v[12:15]
    v_mfma_f32_16x16x32_bf16 v[32:35], a[28:31], a[4:7], v[32:35]
    v_mfma_f32_16x16x32_bf16 v[16:19], a[32:35], a[0:3], v[16:19]
    v_mfma_f32_16x16x32_bf16 v[36:39], a[32:35], a[4:7], v[36:39]
    s_waitcnt lgkmcnt(0)
    s_barrier
    v_mfma_f32_16x16x32_bf16 v[0:3], a[36:39], a[8:11], v[0:3]
    ds_read_b128 a[0:3], v135 offset:24576
    ds_read_b128 a[4:7], v135 offset:25600
    v_mfma_f32_16x16x32_bf16 v[20:23], a[36:39], a[12:15], v[20:23]
    ds_read_b64_tr_b16 a[16:17], v133 offset:28672
    v_mfma_f32_16x16x32_bf16 v[4:7], a[40:43], a[8:11], v[4:7]
    ds_read_b64_tr_b16 a[18:19], v133 offset:31232
    v_mfma_f32_16x16x32_bf16 v[24:27], a[40:43], a[12:15], v[24:27]
    ds_read_b64_tr_b16 a[20:21], v133 offset:28704
    v_mfma_f32_16x16x32_bf16 v[8:11], a[44:47], a[8:11], v[8:11]
    ds_read_b64_tr_b16 a[22:23], v133 offset:31264
    v_mfma_f32_16x16x32_bf16 v[28:31], a[44:47], a[12:15], v[28:31]
    ds_read_b64_tr_b16 a[24:25], v133 offset:28736
    ds_read_b64_tr_b16 a[26:27], v133 offset:31296
    v_mfma_f32_16x16x32_bf16 v[12:15], a[48:51], a[8:11], v[12:15]
    ds_read_b64_tr_b16 a[28:29], v133 offset:28768
    v_mfma_f32_16x16x32_bf16 v[32:35], a[48:51], a[12:15], v[32:35]
    ds_read_b64_tr_b16 a[30:31], v133 offset:31328
    v_mfma_f32_16x16x32_bf16 v[16:19], a[52:55], a[8:11], v[16:19]
    ds_read_b64_tr_b16 a[32:33], v133 offset:28800
    v_mfma_f32_16x16x32_bf16 v[36:39], a[52:55], a[12:15], v[36:39]
    ds_read_b64_tr_b16 a[34:35], v133 offset:31360
    s_waitcnt lgkmcnt(0)
    v_mfma_f32_16x16x32_bf16 v[0:3], a[16:19], a[0:3], v[0:3]
    ds_read_b128 a[8:11], v135 offset:32768
    ds_read_b128 a[12:15], v135 offset:33792
    v_mfma_f32_16x16x32_bf16 v[20:23], a[16:19], a[4:7], v[20:23]
    ds_read_b64_tr_b16 a[36:37], v133 offset:33792
    ds_read_b64_tr_b16 a[38:39], v133 offset:36352
    v_mfma_f32_16x16x32_bf16 v[4:7], a[20:23], a[0:3], v[4:7]
    ds_read_b64_tr_b16 a[40:41], v133 offset:33824
    ds_read_b64_tr_b16 a[42:43], v133 offset:36384
    v_mfma_f32_16x16x32_bf16 v[24:27], a[20:23], a[4:7], v[24:27]
    ds_read_b64_tr_b16 a[44:45], v133 offset:33856
    ds_read_b64_tr_b16 a[46:47], v133 offset:36416
    v_mfma_f32_16x16x32_bf16 v[8:11], a[24:27], a[0:3], v[8:11]
    ds_read_b64_tr_b16 a[48:49], v133 offset:33888
    ds_read_b64_tr_b16 a[50:51], v133 offset:36448
    v_mfma_f32_16x16x32_bf16 v[28:31], a[24:27], a[4:7], v[28:31]
    ds_read_b64_tr_b16 a[52:53], v133 offset:33920
    ds_read_b64_tr_b16 a[54:55], v133 offset:36480
    v_mfma_f32_16x16x32_bf16 v[12:15], a[28:31], a[0:3], v[12:15]
    v_mfma_f32_16x16x32_bf16 v[32:35], a[28:31], a[4:7], v[32:35]
    v_mfma_f32_16x16x32_bf16 v[16:19], a[32:35], a[0:3], v[16:19]
    v_mfma_f32_16x16x32_bf16 v[36:39], a[32:35], a[4:7], v[36:39]
    s_waitcnt lgkmcnt(0)
    s_barrier
    v_mfma_f32_16x16x32_bf16 v[0:3], a[36:39], a[8:11], v[0:3]
    ds_read_b128 a[0:3], v135 offset:40960
    ds_read_b128 a[4:7], v135 offset:41984
    v_mfma_f32_16x16x32_bf16 v[20:23], a[36:39], a[12:15], v[20:23]
    ds_read_b64_tr_b16 a[16:17], v133 offset:38912
    v_mfma_f32_16x16x32_bf16 v[4:7], a[40:43], a[8:11], v[4:7]
    ds_read_b64_tr_b16 a[18:19], v133 offset:41472
    v_mfma_f32_16x16x32_bf16 v[24:27], a[40:43], a[12:15], v[24:27]
    ds_read_b64_tr_b16 a[20:21], v133 offset:38944
    v_mfma_f32_16x16x32_bf16 v[8:11], a[44:47], a[8:11], v[8:11]
    ds_read_b64_tr_b16 a[22:23], v133 offset:41504
    v_mfma_f32_16x16x32_bf16 v[28:31], a[44:47], a[12:15], v[28:31]
    ds_read_b64_tr_b16 a[24:25], v133 offset:38976
    ds_read_b64_tr_b16 a[26:27], v133 offset:41536
    v_mfma_f32_16x16x32_bf16 v[12:15], a[48:51], a[8:11], v[12:15]
    ds_read_b64_tr_b16 a[28:29], v133 offset:39008
    v_mfma_f32_16x16x32_bf16 v[32:35], a[48:51], a[12:15], v[32:35]
    ds_read_b64_tr_b16 a[30:31], v133 offset:41568
    v_mfma_f32_16x16x32_bf16 v[16:19], a[52:55], a[8:11], v[16:19]
    ds_read_b64_tr_b16 a[32:33], v133 offset:39040
    v_mfma_f32_16x16x32_bf16 v[36:39], a[52:55], a[12:15], v[36:39]
    ds_read_b64_tr_b16 a[34:35], v133 offset:41600
    s_waitcnt lgkmcnt(0)
    v_mfma_f32_16x16x32_bf16 v[0:3], a[16:19], a[0:3], v[0:3]
    ds_read_b128 a[8:11], v135 offset:49152
    ds_read_b128 a[12:15], v135 offset:50176
    v_mfma_f32_16x16x32_bf16 v[20:23], a[16:19], a[4:7], v[20:23]
    ds_read_b64_tr_b16 a[36:37], v133 offset:44032
    ds_read_b64_tr_b16 a[38:39], v133 offset:46592
    v_mfma_f32_16x16x32_bf16 v[4:7], a[20:23], a[0:3], v[4:7]
    ds_read_b64_tr_b16 a[40:41], v133 offset:44064
    ds_read_b64_tr_b16 a[42:43], v133 offset:46624
    v_mfma_f32_16x16x32_bf16 v[24:27], a[20:23], a[4:7], v[24:27]
    ds_read_b64_tr_b16 a[44:45], v133 offset:44096
    ds_read_b64_tr_b16 a[46:47], v133 offset:46656
    v_mfma_f32_16x16x32_bf16 v[8:11], a[24:27], a[0:3], v[8:11]
    ds_read_b64_tr_b16 a[48:49], v133 offset:44128
    ds_read_b64_tr_b16 a[50:51], v133 offset:46688
    v_mfma_f32_16x16x32_bf16 v[28:31], a[24:27], a[4:7], v[28:31]
    ds_read_b64_tr_b16 a[52:53], v133 offset:44160
    ds_read_b64_tr_b16 a[54:55], v133 offset:46720
    v_mfma_f32_16x16x32_bf16 v[12:15], a[28:31], a[0:3], v[12:15]
    v_mfma_f32_16x16x32_bf16 v[32:35], a[28:31], a[4:7], v[32:35]
    v_mfma_f32_16x16x32_bf16 v[16:19], a[32:35], a[0:3], v[16:19]
    v_mfma_f32_16x16x32_bf16 v[36:39], a[32:35], a[4:7], v[36:39]
    s_waitcnt lgkmcnt(0)
    s_barrier
    v_mfma_f32_16x16x32_bf16 v[0:3], a[36:39], a[8:11], v[0:3]
    ds_read_b128 a[0:3], v135 offset:0
    ds_read_b128 a[4:7], v135 offset:1024
    v_mfma_f32_16x16x32_bf16 v[20:23], a[36:39], a[12:15], v[20:23]
    ds_read_b64_tr_b16 a[16:17], v133 offset:49152
    v_mfma_f32_16x16x32_bf16 v[4:7], a[40:43], a[8:11], v[4:7]
    ds_read_b64_tr_b16 a[18:19], v133 offset:51712
    v_mfma_f32_16x16x32_bf16 v[24:27], a[40:43], a[12:15], v[24:27]
    ds_read_b64_tr_b16 a[20:21], v133 offset:49184
    v_mfma_f32_16x16x32_bf16 v[8:11], a[44:47], a[8:11], v[8:11]
    ds_read_b64_tr_b16 a[22:23], v133 offset:51744
    v_mfma_f32_16x16x32_bf16 v[28:31], a[44:47], a[12:15], v[28:31]
    ds_read_b64_tr_b16 a[24:25], v133 offset:49216
    ds_read_b64_tr_b16 a[26:27], v133 offset:51776
    v_mfma_f32_16x16x32_bf16 v[12:15], a[48:51], a[8:11], v[12:15]
    ds_read_b64_tr_b16 a[28:29], v133 offset:49248
    v_mfma_f32_16x16x32_bf16 v[32:35], a[48:51], a[12:15], v[32:35]
    ds_read_b64_tr_b16 a[30:31], v133 offset:51808
    v_mfma_f32_16x16x32_bf16 v[16:19], a[52:55], a[8:11], v[16:19]
    ds_read_b64_tr_b16 a[32:33], v133 offset:49280
    v_mfma_f32_16x16x32_bf16 v[36:39], a[52:55], a[12:15], v[36:39]
    ds_read_b64_tr_b16 a[34:35], v133 offset:51840
    s_waitcnt lgkmcnt(0)
    v_mfma_f32_16x16x32_bf16 v[0:3], a[16:19], a[0:3], v[0:3]
    ds_read_b128 a[8:11], v135 offset:8192
    ds_read_b128 a[12:15], v135 offset:9216
    v_mfma_f32_16x16x32_bf16 v[20:23], a[16:19], a[4:7], v[20:23]
    ds_read_b64_tr_b16 a[36:37], v134 offset:0
    ds_read_b64_tr_b16 a[38:39], v134 offset:2560
    v_mfma_f32_16x16x32_bf16 v[4:7], a[20:23], a[0:3], v[4:7]
    ds_read_b64_tr_b16 a[40:41], v134 offset:32
    ds_read_b64_tr_b16 a[42:43], v134 offset:2592
    v_mfma_f32_16x16x32_bf16 v[24:27], a[20:23], a[4:7], v[24:27]
    ds_read_b64_tr_b16 a[44:45], v134 offset:64
    ds_read_b64_tr_b16 a[46:47], v134 offset:2624
    v_mfma_f32_16x16x32_bf16 v[8:11], a[24:27], a[0:3], v[8:11]
    ds_read_b64_tr_b16 a[48:49], v134 offset:96
    ds_read_b64_tr_b16 a[50:51], v134 offset:2656
    v_mfma_f32_16x16x32_bf16 v[28:31], a[24:27], a[4:7], v[28:31]
    ds_read_b64_tr_b16 a[52:53], v134 offset:128
    ds_read_b64_tr_b16 a[54:55], v134 offset:2688
    v_mfma_f32_16x16x32_bf16 v[12:15], a[28:31], a[0:3], v[12:15]
    v_mfma_f32_16x16x32_bf16 v[32:35], a[28:31], a[4:7], v[32:35]
    v_mfma_f32_16x16x32_bf16 v[16:19], a[32:35], a[0:3], v[16:19]
    v_mfma_f32_16x16x32_bf16 v[36:39], a[32:35], a[4:7], v[36:39]
    s_waitcnt lgkmcnt(0)
    s_barrier
    v_mfma_f32_16x16x32_bf16 v[0:3], a[36:39], a[8:11], v[0:3]
    ds_read_b128 a[0:3], v135 offset:16384
    ds_read_b128 a[4:7], v135 offset:17408
    v_mfma_f32_16x16x32_bf16 v[20:23], a[36:39], a[12:15], v[20:23]
    ds_read_b64_tr_b16 a[16:17], v134 offset:5120
    v_mfma_f32_16x16x32_bf16 v[4:7], a[40:43], a[8:11], v[4:7]
    ds_read_b64_tr_b16 a[18:19], v134 offset:7680
    v_mfma_f32_16x16x32_bf16 v[24:27], a[40:43], a[12:15], v[24:27]
    ds_read_b64_tr_b16 a[20:21], v134 offset:5152
    v_mfma_f32_16x16x32_bf16 v[8:11], a[44:47], a[8:11], v[8:11]
    ds_read_b64_tr_b16 a[22:23], v134 offset:7712
    v_mfma_f32_16x16x32_bf16 v[28:31], a[44:47], a[12:15], v[28:31]
    ds_read_b64_tr_b16 a[24:25], v134 offset:5184
    ds_read_b64_tr_b16 a[26:27], v134 offset:7744
    v_mfma_f32_16x16x32_bf16 v[12:15], a[48:51], a[8:11], v[12:15]
    ds_read_b64_tr_b16 a[28:29], v134 offset:5216
    v_mfma_f32_16x16x32_bf16 v[32:35], a[48:51], a[12:15], v[32:35]
    ds_read_b64_tr_b16 a[30:31], v134 offset:7776
    v_mfma_f32_16x16x32_bf16 v[16:19], a[52:55], a[8:11], v[16:19]
    ds_read_b64_tr_b16 a[32:33], v134 offset:5248
    v_mfma_f32_16x16x32_bf16 v[36:39], a[52:55], a[12:15], v[36:39]
    ds_read_b64_tr_b16 a[34:35], v134 offset:7808
    s_waitcnt lgkmcnt(0)
    v_mfma_f32_16x16x32_bf16 v[0:3], a[16:19], a[0:3], v[0:3]
    ds_read_b128 a[8:11], v135 offset:24576
    ds_read_b128 a[12:15], v135 offset:25600
    v_mfma_f32_16x16x32_bf16 v[20:23], a[16:19], a[4:7], v[20:23]
    ds_read_b64_tr_b16 a[36:37], v134 offset:10240
    ds_read_b64_tr_b16 a[38:39], v134 offset:12800
    v_mfma_f32_16x16x32_bf16 v[4:7], a[20:23], a[0:3], v[4:7]
    ds_read_b64_tr_b16 a[40:41], v134 offset:10272
    ds_read_b64_tr_b16 a[42:43], v134 offset:12832
    v_mfma_f32_16x16x32_bf16 v[24:27], a[20:23], a[4:7], v[24:27]
    ds_read_b64_tr_b16 a[44:45], v134 offset:10304
    ds_read_b64_tr_b16 a[46:47], v134 offset:12864
    v_mfma_f32_16x16x32_bf16 v[8:11], a[24:27], a[0:3], v[8:11]
    ds_read_b64_tr_b16 a[48:49], v134 offset:10336
    ds_read_b64_tr_b16 a[50:51], v134 offset:12896
    v_mfma_f32_16x16x32_bf16 v[28:31], a[24:27], a[4:7], v[28:31]
    ds_read_b64_tr_b16 a[52:53], v134 offset:10368
    ds_read_b64_tr_b16 a[54:55], v134 offset:12928
    v_mfma_f32_16x16x32_bf16 v[12:15], a[28:31], a[0:3], v[12:15]
    v_mfma_f32_16x16x32_bf16 v[32:35], a[28:31], a[4:7], v[32:35]
    v_mfma_f32_16x16x32_bf16 v[16:19], a[32:35], a[0:3], v[16:19]
    v_mfma_f32_16x16x32_bf16 v[36:39], a[32:35], a[4:7], v[36:39]
    s_waitcnt lgkmcnt(0)
    s_barrier
    v_mfma_f32_16x16x32_bf16 v[0:3], a[36:39], a[8:11], v[0:3]
    ds_read_b128 a[0:3], v135 offset:32768
    ds_read_b128 a[4:7], v135 offset:33792
    v_mfma_f32_16x16x32_bf16 v[20:23], a[36:39], a[12:15], v[20:23]
    ds_read_b64_tr_b16 a[16:17], v134 offset:15360
    v_mfma_f32_16x16x32_bf16 v[4:7], a[40:43], a[8:11], v[4:7]
    ds_read_b64_tr_b16 a[18:19], v134 offset:17920
    v_mfma_f32_16x16x32_bf16 v[24:27], a[40:43], a[12:15], v[24:27]
    ds_read_b64_tr_b16 a[20:21], v134 offset:15392
    v_mfma_f32_16x16x32_bf16 v[8:11], a[44:47], a[8:11], v[8:11]
    ds_read_b64_tr_b16 a[22:23], v134 offset:17952
    v_mfma_f32_16x16x32_bf16 v[28:31], a[44:47], a[12:15], v[28:31]
    ds_read_b64_tr_b16 a[24:25], v134 offset:15424
    ds_read_b64_tr_b16 a[26:27], v134 offset:17984
    v_mfma_f32_16x16x32_bf16 v[12:15], a[48:51], a[8:11], v[12:15]
    ds_read_b64_tr_b16 a[28:29], v134 offset:15456
    v_mfma_f32_16x16x32_bf16 v[32:35], a[48:51], a[12:15], v[32:35]
    ds_read_b64_tr_b16 a[30:31], v134 offset:18016
    v_mfma_f32_16x16x32_bf16 v[16:19], a[52:55], a[8:11], v[16:19]
    ds_read_b64_tr_b16 a[32:33], v134 offset:15488
    v_mfma_f32_16x16x32_bf16 v[36:39], a[52:55], a[12:15], v[36:39]
    ds_read_b64_tr_b16 a[34:35], v134 offset:18048
    s_waitcnt lgkmcnt(0)
    v_mfma_f32_16x16x32_bf16 v[0:3], a[16:19], a[0:3], v[0:3]
    ds_read_b128 a[8:11], v135 offset:40960
    ds_read_b128 a[12:15], v135 offset:41984
    v_mfma_f32_16x16x32_bf16 v[20:23], a[16:19], a[4:7], v[20:23]
    ds_read_b64_tr_b16 a[36:37], v134 offset:20480
    ds_read_b64_tr_b16 a[38:39], v134 offset:23040
    v_mfma_f32_16x16x32_bf16 v[4:7], a[20:23], a[0:3], v[4:7]
    ds_read_b64_tr_b16 a[40:41], v134 offset:20512
    ds_read_b64_tr_b16 a[42:43], v134 offset:23072
    v_mfma_f32_16x16x32_bf16 v[24:27], a[20:23], a[4:7], v[24:27]
    ds_read_b64_tr_b16 a[44:45], v134 offset:20544
    ds_read_b64_tr_b16 a[46:47], v134 offset:23104
    v_mfma_f32_16x16x32_bf16 v[8:11], a[24:27], a[0:3], v[8:11]
    ds_read_b64_tr_b16 a[48:49], v134 offset:20576
    ds_read_b64_tr_b16 a[50:51], v134 offset:23136
    v_mfma_f32_16x16x32_bf16 v[28:31], a[24:27], a[4:7], v[28:31]
    ds_read_b64_tr_b16 a[52:53], v134 offset:20608
    ds_read_b64_tr_b16 a[54:55], v134 offset:23168
    v_mfma_f32_16x16x32_bf16 v[12:15], a[28:31], a[0:3], v[12:15]
    v_mfma_f32_16x16x32_bf16 v[32:35], a[28:31], a[4:7], v[32:35]
    v_mfma_f32_16x16x32_bf16 v[16:19], a[32:35], a[0:3], v[16:19]
    v_mfma_f32_16x16x32_bf16 v[36:39], a[32:35], a[4:7], v[36:39]
    s_waitcnt lgkmcnt(0)
    v_mfma_f32_16x16x32_bf16 v[0:3], a[36:39], a[8:11], v[0:3]
    ds_read_b64 v[40:41], v139 offset:0
    v_mfma_f32_16x16x32_bf16 v[20:23], a[36:39], a[12:15], v[20:23]
    ds_read_b64 v[42:43], v139 offset:32
    v_mfma_f32_16x16x32_bf16 v[4:7], a[40:43], a[8:11], v[4:7]
    ds_read_b64 v[44:45], v139 offset:64
    v_mfma_f32_16x16x32_bf16 v[24:27], a[40:43], a[12:15], v[24:27]
    ds_read_b64 v[46:47], v139 offset:96
    v_mfma_f32_16x16x32_bf16 v[8:11], a[44:47], a[8:11], v[8:11]
    ds_read_b64 v[48:49], v139 offset:128
    v_mfma_f32_16x16x32_bf16 v[28:31], a[44:47], a[12:15], v[28:31]
    ds_read_b64 v[50:51], v139 offset:2560
    v_mfma_f32_16x16x32_bf16 v[12:15], a[48:51], a[8:11], v[12:15]
    ds_read_b64 v[52:53], v139 offset:2592
    v_mfma_f32_16x16x32_bf16 v[32:35], a[48:51], a[12:15], v[32:35]
    ds_read_b64 v[54:55], v139 offset:2624
    v_mfma_f32_16x16x32_bf16 v[16:19], a[52:55], a[8:11], v[16:19]
    ds_read_b64 v[56:57], v139 offset:2656
    v_mfma_f32_16x16x32_bf16 v[36:39], a[52:55], a[12:15], v[36:39]
    ds_read_b64 v[58:59], v139 offset:2688
    s_waitcnt vmcnt(0) lgkmcnt(0)
    s_barrier
    v_lshlrev_b32 v70, 16, v40
    v_and_b32 v71, s72, v40
    v_lshlrev_b32 v72, 16, v41
    v_and_b32 v73, s72, v41
    v_lshlrev_b32 v74, 16, v42
    v_and_b32 v75, s72, v42
    v_lshlrev_b32 v76, 16, v43
    v_and_b32 v77, s72, v43
    v_lshlrev_b32 v78, 16, v44
    v_and_b32 v79, s72, v44
    v_lshlrev_b32 v80, 16, v45
    v_and_b32 v81, s72, v45
    v_lshlrev_b32 v82, 16, v46
    v_and_b32 v83, s72, v46
    v_lshlrev_b32 v84, 16, v47
    v_and_b32 v85, s72, v47
    v_lshlrev_b32 v86, 16, v48
    v_and_b32 v87, s72, v48
    v_lshlrev_b32 v88, 16, v49
    v_and_b32 v89, s72, v49
    v_lshlrev_b32 v90, 16, v50
    v_and_b32 v91, s72, v50
    v_lshlrev_b32 v92, 16, v51
    v_and_b32 v93, s72, v51
    v_lshlrev_b32 v94, 16, v52
    v_and_b32 v95, s72, v52
    v_lshlrev_b32 v96, 16, v53
    v_and_b32 v97, s72, v53
    v_lshlrev_b32 v98, 16, v54
    v_and_b32 v99, s72, v54
    v_lshlrev_b32 v100, 16, v55
    v_and_b32 v101, s72, v55
    v_lshlrev_b32 v102, 16, v56
    v_and_b32 v103, s72, v56
    v_lshlrev_b32 v104, 16, v57
    v_and_b32 v105, s72, v57
    v_lshlrev_b32 v106, 16, v58
    v_and_b32 v107, s72, v58
    v_lshlrev_b32 v108, 16, v59
    v_and_b32 v109, s72, v59
    v_pk_add_f32 v[0:1], v[0:1], v[70:71]
    v_pk_add_f32 v[2:3], v[2:3], v[72:73]
    v_pk_add_f32 v[4:5], v[4:5], v[74:75]
    v_pk_add_f32 v[6:7], v[6:7], v[76:77]
    v_pk_add_f32 v[8:9], v[8:9], v[78:79]
    v_pk_add_f32 v[10:11], v[10:11], v[80:81]
    v_pk_add_f32 v[12:13], v[12:13], v[82:83]
    v_pk_add_f32 v[14:15], v[14:15], v[84:85]
    v_pk_add_f32 v[16:17], v[16:17], v[86:87]
    v_pk_add_f32 v[18:19], v[18:19], v[88:89]
    v_pk_add_f32 v[20:21], v[20:21], v[90:91]
    v_pk_add_f32 v[22:23], v[22:23], v[92:93]
    v_pk_add_f32 v[24:25], v[24:25], v[94:95]
    v_pk_add_f32 v[26:27], v[26:27], v[96:97]
    v_pk_add_f32 v[28:29], v[28:29], v[98:99]
    v_pk_add_f32 v[30:31], v[30:31], v[100:101]
    v_pk_add_f32 v[32:33], v[32:33], v[102:103]
    v_pk_add_f32 v[34:35], v[34:35], v[104:105]
    v_pk_add_f32 v[36:37], v[36:37], v[106:107]
    v_pk_add_f32 v[38:39], v[38:39], v[108:109]
    v_cvt_pk_bf16_f32 v70, v0, v1
    v_cvt_pk_bf16_f32 v71, v2, v3
    v_cvt_pk_bf16_f32 v72, v4, v5
    v_cvt_pk_bf16_f32 v73, v6, v7
    v_cvt_pk_bf16_f32 v74, v8, v9
    v_cvt_pk_bf16_f32 v75, v10, v11
    v_cvt_pk_bf16_f32 v76, v12, v13
    v_cvt_pk_bf16_f32 v77, v14, v15
    v_cvt_pk_bf16_f32 v78, v16, v17
    v_cvt_pk_bf16_f32 v79, v18, v19
    v_cvt_pk_bf16_f32 v80, v20, v21
    v_cvt_pk_bf16_f32 v81, v22, v23
    v_cvt_pk_bf16_f32 v82, v24, v25
    v_cvt_pk_bf16_f32 v83, v26, v27
    v_cvt_pk_bf16_f32 v84, v28, v29
    v_cvt_pk_bf16_f32 v85, v30, v31
    v_cvt_pk_bf16_f32 v86, v32, v33
    v_cvt_pk_bf16_f32 v87, v34, v35
    v_cvt_pk_bf16_f32 v88, v36, v37
    v_cvt_pk_bf16_f32 v89, v38, v39
    s_add_u32 s84, s43, 2871296
    s_mul_i32 s11, s7, 5
    s_lshr_b32 s11, s11, 1
    s_lshl_b32 s11, s11, 10
    s_add_u32 s11, s11, s84
    s_bitcmp1_b32 s7, 0
    s_cbranch_scc1 p_x1_odd
    buffer_store_dwordx4 v[70:73], v143, s[52:55], s11 offen sc1
    buffer_store_dwordx4 v[74:77], v143, s[52:55], s11 offen offset:1024 sc1
    buffer_store_dwordx2 v[78:79], v137, s[52:55], s11 offen offset:2048 sc1
    buffer_store_dwordx4 v[80:83], v136, s[52:55], s11 offen sc1
    buffer_store_dwordx4 v[84:87], v136, s[52:55], s11 offen offset:1024 sc1
    buffer_store_dwordx2 v[88:89], v138, s[52:55], s11 offen offset:2048 sc1
    s_branch p_x1_done
p_x1_odd:
    buffer_store_dwordx2 v[70:71], v137, s[52:55], s11 offen offset:512 sc1
    buffer_store_dwordx4 v[72:75], v143, s[52:55], s11 offen offset:1024 sc1
    buffer_store_dwordx4 v[76:79], v143, s[52:55], s11 offen offset:2048 sc1
    buffer_store_dwordx2 v[80:81], v138, s[52:55], s11 offen offset:512 sc1
    buffer_store_dwordx4 v[82:85], v136, s[52:55], s11 offen offset:1024 sc1
    buffer_store_dwordx4 v[86:89], v136, s[52:55], s11 offen offset:2048 sc1
p_x1_done:
    v_mov_b32 v90, 0
    v_mov_b32 v91, 0
    v_mov_b32 v92, 0
    v_mov_b32 v93, 0
    v_mov_b32 v94, 0
    v_mov_b32 v95, 0
    v_mov_b32 v96, 0
    v_mov_b32 v97, 0
    v_dot2_f32_bf16 v90, v70, s73, v90
    v_dot2_f32_bf16 v91, v70, v70, v91
    v_dot2_f32_bf16 v92, v40, v60, v92
    v_dot2_f32_bf16 v94, v80, s73, v94
    v_dot2_f32_bf16 v95, v80, v80, v95
    v_dot2_f32_bf16 v96, v50, v60, v96
    v_dot2_f32_bf16 v90, v71, s73, v90
    v_dot2_f32_bf16 v91, v71, v71, v91
    v_dot2_f32_bf16 v92, v41, v61, v92
    v_dot2_f32_bf16 v94, v81, s73, v94
    v_dot2_f32_bf16 v95, v81, v81, v95
    v_dot2_f32_bf16 v96, v51, v61, v96
    v_dot2_f32_bf16 v90, v72, s73, v90
    v_dot2_f32_bf16 v91, v72, v72, v91
    v_dot2_f32_bf16 v92, v42, v62, v92
    v_dot2_f32_bf16 v94, v82, s73, v94
    v_dot2_f32_bf16 v95, v82, v82, v95
    v_dot2_f32_bf16 v96, v52, v62, v96
    v_dot2_f32_bf16 v90, v73, s73, v90
    v_dot2_f32_bf16 v91, v73, v73, v91
    v_dot2_f32_bf16 v92, v43, v63, v92
    v_dot2_f32_bf16 v94, v83, s73, v94
    v_dot2_f32_bf16 v95, v83, v83, v95
    v_dot2_f32_bf16 v96, v53, v63, v96
    v_dot2_f32_bf16 v90, v74, s73, v90
    v_dot2_f32_bf16 v91, v74, v74, v91
    v_dot2_f32_bf16 v92, v44, v64, v92
    v_dot2_f32_bf16 v94, v84, s73, v94
    v_dot2_f32_bf16 v95, v84, v84, v95
    v_dot2_f32_bf16 v96, v54, v64, v96
    v_dot2_f32_bf16 v90, v75, s73, v90
    v_dot2_f32_bf16 v91, v75, v75, v91
    v_dot2_f32_bf16 v92, v45, v65, v92
    v_dot2_f32_bf16 v94, v85, s73, v94
    v_dot2_f32_bf16 v95, v85, v85, v95
    v_dot2_f32_bf16 v96, v55, v65, v96
    v_dot2_f32_bf16 v90, v76, s73, v90
    v_dot2_f32_bf16 v91, v76, v76, v91
    v_dot2_f32_bf16 v92, v46, v66, v92
    v_dot2_f32_bf16 v94, v86, s73, v94
    v_dot2_f32_bf16 v95, v86, v86, v95
    v_dot2_f32_bf16 v96, v56, v66, v96
    v_dot2_f32_bf16 v90, v77, s73, v90
    v_dot2_f32_bf16 v91, v77, v77, v91
    v_dot2_f32_bf16 v92, v47, v67, v92
    v_dot2_f32_bf16 v94, v87, s73, v94
    v_dot2_f32_bf16 v95, v87, v87, v95
    v_dot2_f32_bf16 v96, v57, v67, v96
    v_dot2_f32_bf16 v90, v78, s73, v90
    v_dot2_f32_bf16 v91, v78, v78, v91
    v_dot2_f32_bf16 v92, v48, v68, v92
    v_dot2_f32_bf16 v94, v88, s73, v94
    v_dot2_f32_bf16 v95, v88, v88, v95
    v_dot2_f32_bf16 v96, v58, v68, v96
    v_dot2_f32_bf16 v90, v79, s73, v90
    v_dot2_f32_bf16 v91, v79, v79, v91
    v_dot2_f32_bf16 v92, v49, v69, v92
    v_dot2_f32_bf16 v94, v89, s73, v94
    v_dot2_f32_bf16 v95, v89, v89, v95
    v_dot2_f32_bf16 v96, v59, v69, v96
    s_lshl_b32 s11, s7, 11
    s_add_u32 s11, s11, s60
    s_lshl_b32 s11, s11, 4
    s_add_u32 s11, s11, 5492736
    v_lshlrev_b32 v120, 4, v129
    v_lshl_add_u32 v120, v130, 2, v120
    s_nop 2
    v_permlane16_swap_b32 v90, v91
    v_permlane16_swap_b32 v92, v93
    v_add_f32 v90, v90, v91
    v_add_f32 v92, v92, v93
    s_nop 1
    v_permlane32_swap_b32 v90, v92
    v_add_f32 v90, v90, v92
    buffer_store_dword v90, v120, s[52:55], s11 offen offset:0 sc1
    v_permlane16_swap_b32 v94, v95
    v_permlane16_swap_b32 v96, v97
    v_add_f32 v94, v94, v95
    v_add_f32 v96, v96, v97
    s_nop 1
    v_permlane32_swap_b32 v94, v96
    v_add_f32 v94, v94, v96
    buffer_store_dword v94, v120, s[52:55], s11 offen offset:256 sc1
    s_waitcnt vmcnt(0)
    v_mov_b32 v0, 163812
    v_mov_b32 v1, 1
    s_mov_b64 exec, 1
    ds_add_rtn_u32 v1, v0, v1
    s_waitcnt lgkmcnt(0)
    v_readfirstlane_b32 s13, v1
    s_nop 0
    s_cmp_lg_u32 s13, 3
    s_cbranch_scc1 arr_9
    s_lshl_b32 s11, s5, 4
    s_lshl_b32 s12, s6, 3
    s_add_u32 s11, s11, s12
    s_add_u32 s11, s11, s7
    s_lshl_b32 s11, s11, 7
    s_add_u32 s11, s11, 36864
    v_mov_b32 v0, s9
    v_mov_b32 v1, 0
    buffer_store_dword v0, v1, s[52:55], s11 offen sc1
arr_9:
    s_mov_b64 exec, -1
    s_mov_b32 s56, s30
    s_mov_b32 s57, s31
    s_mov_b32 s58, 1966080
    s_mov_b32 s59, 0x20000
    s_lshl_b32 s84, s5, 3
    s_add_u32 s84, s84, s7
    s_mul_i32 s85, s84, 2731
    s_lshr_b32 s85, s85, 16
    s_mul_i32 s11, s85, 24
    s_sub_u32 s86, s84, s11
    s_lshl_b32 s11, s85, 2
    s_add_u32 s11, s11, s8
    s_mul_i32 s11, s11, 98304
    s_lshl_b32 s12, s86, 7
    s_add_u32 s11, s11, s12
    v_lshrrev_b32 v120, 3, v128
    v_mul_u32_u24 v121, 3072, v120
    v_and_b32 v122, 7, v128
    v_lshl_add_u32 v121, v122, 4, v121
    buffer_load_dwordx4 v[80:83], v121, s[56:59], s11 offen
    s_add_u32 s11, s11, 24576
    buffer_load_dwordx4 v[84:87], v121, s[56:59], s11 offen
    s_add_u32 s11, s11, 24576
    buffer_load_dwordx4 v[88:91], v121, s[56:59], s11 offen
    s_add_u32 s11, s11, 24576
    buffer_load_dwordx4 v[92:95], v121, s[56:59], s11 offen
    s_add_u32 s11, s11, 24576
    s_lshl_b32 s11, s8, 8
    s_add_u32 s11, s11, 161792
    v_lshlrev_b32 v122, 3, v122
    v_add_lshl_u32 v122, v122, v120, 2
    v_add_u32 v123, s11, v122
    s_waitcnt vmcnt(3)
    v_lshlrev_b32 v104, 16, v80
    v_and_b32 v105, 0xffff0000, v80
    v_lshlrev_b32 v106, 16, v81
    v_and_b32 v107, 0xffff0000, v81
    v_lshlrev_b32 v108, 16, v82
    v_and_b32 v109, 0xffff0000, v82
    v_lshlrev_b32 v110, 16, v83
    v_and_b32 v111, 0xffff0000, v83
    s_waitcnt vmcnt(2)
    v_lshlrev_b32 v96, 16, v84
    v_and_b32 v97, 0xffff0000, v84
    v_pk_add_f32 v[104:105], v[104:105], v[96:97]
    v_lshlrev_b32 v96, 16, v85
    v_and_b32 v97, 0xffff0000, v85
    v_pk_add_f32 v[106:107], v[106:107], v[96:97]
    v_lshlrev_b32 v96, 16, v86
    v_and_b32 v97, 0xffff0000, v86
    v_pk_add_f32 v[108:109], v[108:109], v[96:97]
    v_lshlrev_b32 v96, 16, v87
    v_and_b32 v97, 0xffff0000, v87
    v_pk_add_f32 v[110:111], v[110:111], v[96:97]
    s_waitcnt vmcnt(1)
    v_lshlrev_b32 v96, 16, v88
    v_and_b32 v97, 0xffff0000, v88
    v_pk_add_f32 v[104:105], v[104:105], v[96:97]
    v_lshlrev_b32 v96, 16, v89
    v_and_b32 v97, 0xffff0000, v89
    v_pk_add_f32 v[106:107], v[106:107], v[96:97]
    v_lshlrev_b32 v96, 16, v90
    v_and_b32 v97, 0xffff0000, v90
    v_pk_add_f32 v[108:109], v[108:109], v[96:97]
    v_lshlrev_b32 v96, 16, v91
    v_and_b32 v97, 0xffff0000, v91
    v_pk_add_f32 v[110:111], v[110:111], v[96:97]
    s_waitcnt vmcnt(0)
    v_lshlrev_b32 v96, 16, v92
    v_and_b32 v97, 0xffff0000, v92
    v_pk_add_f32 v[104:105], v[104:105], v[96:97]
    v_lshlrev_b32 v96, 16, v93
    v_and_b32 v97, 0xffff0000, v93
    v_pk_add_f32 v[106:107], v[106:107], v[96:97]
    v_lshlrev_b32 v96, 16, v94
    v_and_b32 v97, 0xffff0000, v94
    v_pk_add_f32 v[108:109], v[108:109], v[96:97]
    v_lshlrev_b32 v96, 16, v95
    v_and_b32 v97, 0xffff0000, v95
    v_pk_add_f32 v[110:111], v[110:111], v[96:97]
    v_add_f32_dpp v104, v104, v104 row_ror:8 row_mask:0xf bank_mask:0xf
    v_add_f32_dpp v105, v105, v105 row_ror:8 row_mask:0xf bank_mask:0xf
    v_add_f32_dpp v106, v106, v106 row_ror:8 row_mask:0xf bank_mask:0xf
    v_add_f32_dpp v107, v107, v107 row_ror:8 row_mask:0xf bank_mask:0xf
    v_add_f32_dpp v108, v108, v108 row_ror:8 row_mask:0xf bank_mask:0xf
    v_add_f32_dpp v109, v109, v109 row_ror:8 row_mask:0xf bank_mask:0xf
    v_add_f32_dpp v110, v110, v110 row_ror:8 row_mask:0xf bank_mask:0xf
    v_add_f32_dpp v111, v111, v111 row_ror:8 row_mask:0xf bank_mask:0xf
    v_mov_b32 v80, v104
    s_nop 1
    v_permlane16_swap_b32 v104, v80
    v_add_f32 v104, v104, v80
    v_mov_b32 v80, v104
    s_nop 1
    v_permlane32_swap_b32 v104, v80
    v_add_f32 v104, v104, v80
    v_mov_b32 v81, v105
    s_nop 1
    v_permlane16_swap_b32 v105, v81
    v_add_f32 v105, v105, v81
    v_mov_b32 v81, v105
    s_nop 1
    v_permlane32_swap_b32 v105, v81
    v_add_f32 v105, v105, v81
    v_mov_b32 v82, v106
    s_nop 1
    v_permlane16_swap_b32 v106, v82
    v_add_f32 v106, v106, v82
    v_mov_b32 v82, v106
    s_nop 1
    v_permlane32_swap_b32 v106, v82
    v_add_f32 v106, v106, v82
    v_mov_b32 v83, v107
    s_nop 1
    v_permlane16_swap_b32 v107, v83
    v_add_f32 v107, v107, v83
    v_mov_b32 v83, v107
    s_nop 1
    v_permlane32_swap_b32 v107, v83
    v_add_f32 v107, v107, v83
    v_mov_b32 v84, v108
    s_nop 1
    v_permlane16_swap_b32 v108, v84
    v_add_f32 v108, v108, v84
    v_mov_b32 v84, v108
    s_nop 1
    v_permlane32_swap_b32 v108, v84
    v_add_f32 v108, v108, v84
    v_mov_b32 v85, v109
    s_nop 1
    v_permlane16_swap_b32 v109, v85
    v_add_f32 v109, v109, v85
    v_mov_b32 v85, v109
    s_nop 1
    v_permlane32_swap_b32 v109, v85
    v_add_f32 v109, v109, v85
    v_mov_b32 v86, v110
    s_nop 1
    v_permlane16_swap_b32 v110, v86
    v_add_f32 v110, v110, v86
    v_mov_b32 v86, v110
    s_nop 1
    v_permlane32_swap_b32 v110, v86
    v_add_f32 v110, v110, v86
    v_mov_b32 v87, v111
    s_nop 1
    v_permlane16_swap_b32 v111, v87
    v_add_f32 v111, v111, v87
    v_mov_b32 v87, v111
    s_nop 1
    v_permlane32_swap_b32 v111, v87
    v_add_f32 v111, v111, v87
    v_cmp_eq_u32 vcc, 1, v120
    s_nop 1
    v_cndmask_b32 v104, v104, v105, vcc
    v_cmp_eq_u32 vcc, 2, v120
    s_nop 1
    v_cndmask_b32 v104, v104, v106, vcc
    v_cmp_eq_u32 vcc, 3, v120
    s_nop 1
    v_cndmask_b32 v104, v104, v107, vcc
    v_cmp_eq_u32 vcc, 4, v120
    s_nop 1
    v_cndmask_b32 v104, v104, v108, vcc
    v_cmp_eq_u32 vcc, 5, v120
    s_nop 1
    v_cndmask_b32 v104, v104, v109, vcc
    v_cmp_eq_u32 vcc, 6, v120
    s_nop 1
    v_cndmask_b32 v104, v104, v110, vcc
    v_cmp_eq_u32 vcc, 7, v120
    s_nop 1
    v_cndmask_b32 v104, v104, v111, vcc
    ds_write_b32 v123, v104
    s_waitcnt vmcnt(0) lgkmcnt(0)
    v_mov_b32 v120, 163820
    v_mov_b32 v121, 1
    s_mov_b64 exec, 1
    ds_add_rtn_u32 v121, v120, v121
    s_waitcnt lgkmcnt(0)
    v_readfirstlane_b32 s13, v121
    s_nop 0
    s_cmp_lg_u32 s13, 3
    s_cbranch_scc1 arr_10
    s_mov_b64 exec, -1
    v_lshlrev_b32 v122, 2, v128
    v_add_u32 v123, 161792, v122
    ds_read_b32 v80, v123 offset:0
    ds_read_b32 v81, v123 offset:256
    ds_read_b32 v82, v123 offset:512
    ds_read_b32 v83, v123 offset:768
    s_mul_i32 s11, s85, 6144
    s_lshl_b32 s12, s86, 8
    s_add_u32 s11, s11, s12
    s_add_u32 s11, s11, 17461248
    s_waitcnt lgkmcnt(0)
    v_add_f32 v80, v80, v81
    v_add_f32 v82, v82, v83
    v_add_f32 v80, v80, v82
    buffer_store_dword v80, v122, s[52:55], s11 offen sc1
    s_waitcnt vmcnt(0)
    s_mov_b64 exec, 1
    s_lshl_b32 s11, s5, 4
    s_lshl_b32 s12, s6, 3
    s_add_u32 s11, s11, s12
    s_add_u32 s11, s11, s7
    s_lshl_b32 s11, s11, 7
    s_add_u32 s11, s11, 102400
    v_mov_b32 v120, s9
    v_mov_b32 v121, 0
    buffer_store_dword v120, v121, s[52:55], s11 offen sc1
arr_10:
    s_mov_b64 exec, -1
    v_add_u32 v141, s61, v143
    v_lshlrev_b32 v96, 3, v128
    v_add_u32 v96, s61, v96
    v_lshl_add_u32 v120, v130, 2, v131
    v_bfe_u32 v121, v120, 1, 2
    v_lshlrev_b32 v120, 7, v120
    v_lshl_add_u32 v120, v132, 3, v120
    v_add_u32 v120, 65536, v120
    v_xor_b32 v122, 0, v121
    v_lshl_add_u32 v133, v122, 5, v120
    v_add_u32 v137, 65536, v133
    v_xor_b32 v122, 1, v121
    v_lshl_add_u32 v134, v122, 5, v120
    v_add_u32 v138, 65536, v134
    v_xor_b32 v122, 2, v121
    v_lshl_add_u32 v135, v122, 5, v120
    v_add_u32 v139, 65536, v135
    v_xor_b32 v122, 3, v121
    v_lshl_add_u32 v136, v122, 5, v120
    v_add_u32 v140, 65536, v136
    v_lshlrev_b32 v97, 4, v130
    v_add_u32 v97, 151552, v97
    s_lshl_b32 s84, s5, 3
    s_lshl_b32 s11, s8, 1
    s_add_u32 s84, s84, s11
    s_lshl_b32 s86, s84, 8
    s_add_u32 s86, s86, 5492736
    s_lshl_b32 s87, s84, 6
    s_add_u32 s87, s87, 17453056
    s_cmp_eq_u32 s7, 0
    s_cselect_b32 s87, s87, s79
    v_lshlrev_b32 v104, 4, v129
    v_lshl_add_u32 v104, v130, 15, v104
    v_add_u32 v105, 131072, v104
    v_mov_b32 v106, 163832
go3_11:
    ds_read_b32 v107, v106
    s_waitcnt lgkmcnt(0)
    v_readfirstlane_b32 s13, v107
    s_nop 0
    s_cmp_eq_u32 s13, 0
    s_cbranch_scc1 go3_11
    buffer_load_dwordx4 v[112:115], v104, s[52:55], s86 offen offset:0 sc1
    buffer_load_dwordx4 v[116:119], v105, s[52:55], s86 offen offset:0 sc1
    buffer_load_dwordx4 v[120:123], v104, s[52:55], s86 offen offset:256 sc1
    buffer_load_dwordx4 v[124:127], v105, s[52:55], s86 offen offset:256 sc1
    s_mul_i32 s84, s84, 49152
    s_mul_i32 s12, s7, 4096
    s_add_u32 s84, s84, s12
    s_add_u32 s84, s84, 8376320
    s_add_u32 s85, s84, 49152
    s_barrier
    ds_read_b128 a[0:3], v141 offset:0
    ds_read_b128 a[4:7], v141 offset:2048
    ds_read_b64_tr_b16 a[16:17], v133 offset:0
    ds_read_b64_tr_b16 a[18:19], v133 offset:2048
    ds_read_b64_tr_b16 a[20:21], v134 offset:0
    ds_read_b64_tr_b16 a[22:23], v134 offset:2048
    ds_read_b64_tr_b16 a[24:25], v135 offset:0
    ds_read_b64_tr_b16 a[26:27], v135 offset:2048
    ds_read_b64_tr_b16 a[28:29], v136 offset:0
    ds_read_b64_tr_b16 a[30:31], v136 offset:2048
    ds_read_b64_tr_b16 a[32:33], v133 offset:8192
    ds_read_b64_tr_b16 a[34:35], v133 offset:10240
    ds_read_b64_tr_b16 a[36:37], v134 offset:8192
    ds_read_b64_tr_b16 a[38:39], v134 offset:10240
    ds_read_b64_tr_b16 a[40:41], v135 offset:8192
    ds_read_b64_tr_b16 a[42:43], v135 offset:10240
    ds_read_b64_tr_b16 a[44:45], v136 offset:8192
    ds_read_b64_tr_b16 a[46:47], v136 offset:10240
    s_waitcnt lgkmcnt(8)
    v_mfma_f32_16x16x32_bf16 v[0:3], a[16:19], a[0:3], 0
    ds_read_b128 a[8:11], v141 offset:1024
    ds_read_b128 a[12:15], v141 offset:3072
    v_mfma_f32_16x16x32_bf16 v[32:35], a[16:19], a[4:7], 0
    ds_read_b64_tr_b16 a[48:49], v133 offset:4096
    v_mfma_f32_16x16x32_bf16 v[4:7], a[20:23], a[0:3], 0
    ds_read_b64_tr_b16 a[50:51], v133 offset:6144
    v_mfma_f32_16x16x32_bf16 v[36:39], a[20:23], a[4:7], 0
    ds_read_b64_tr_b16 a[52:53], v134 offset:4096
    v_mfma_f32_16x16x32_bf16 v[8:11], a[24:27], a[0:3], 0
    ds_read_b64_tr_b16 a[54:55], v134 offset:6144
    v_mfma_f32_16x16x32_bf16 v[40:43], a[24:27], a[4:7], 0
    ds_read_b64_tr_b16 a[56:57], v135 offset:4096
    v_mfma_f32_16x16x32_bf16 v[12:15], a[28:31], a[0:3], 0
    ds_read_b64_tr_b16 a[58:59], v135 offset:6144
    v_mfma_f32_16x16x32_bf16 v[44:47], a[28:31], a[4:7], 0
    ds_read_b64_tr_b16 a[60:61], v136 offset:4096
    s_waitcnt lgkmcnt(9)
    v_mfma_f32_16x16x32_bf16 v[16:19], a[32:35], a[0:3], 0
    ds_read_b64_tr_b16 a[62:63], v136 offset:6144
    ds_read_b64_tr_b16 a[64:65], v133 offset:12288
    v_mfma_f32_16x16x32_bf16 v[48:51], a[32:35], a[4:7], 0
    ds_read_b64_tr_b16 a[66:67], v133 offset:14336
    v_mfma_f32_16x16x32_bf16 v[20:23], a[36:39], a[0:3], 0
    ds_read_b64_tr_b16 a[68:69], v134 offset:12288
    v_mfma_f32_16x16x32_bf16 v[52:55], a[36:39], a[4:7], 0
    ds_read_b64_tr_b16 a[70:71], v134 offset:14336
    v_mfma_f32_16x16x32_bf16 v[24:27], a[40:43], a[0:3], 0
    ds_read_b64_tr_b16 a[72:73], v135 offset:12288
    v_mfma_f32_16x16x32_bf16 v[56:59], a[40:43], a[4:7], 0
    ds_read_b64_tr_b16 a[74:75], v135 offset:14336
    v_mfma_f32_16x16x32_bf16 v[28:31], a[44:47], a[0:3], 0
    ds_read_b64_tr_b16 a[76:77], v136 offset:12288
    v_mfma_f32_16x16x32_bf16 v[60:63], a[44:47], a[4:7], 0
    ds_read_b64_tr_b16 a[78:79], v136 offset:14336
    s_barrier
    s_waitcnt lgkmcnt(8)
    v_mfma_f32_16x16x32_bf16 v[0:3], a[48:51], a[8:11], v[0:3]
    ds_read_b64 a[0:1], v96 offset:16384
    ds_read_b64 a[2:3], v96 offset:16896
    v_mfma_f32_16x16x32_bf16 v[32:35], a[48:51], a[12:15], v[32:35]
    ds_read_b64 a[4:5], v96 offset:18432
    v_mfma_f32_16x16x32_bf16 v[4:7], a[52:55], a[8:11], v[4:7]
    ds_read_b64 a[6:7], v96 offset:18944
    v_mfma_f32_16x16x32_bf16 v[36:39], a[52:55], a[12:15], v[36:39]
    ds_read_b64_tr_b16 a[16:17], v133 offset:16384
    v_mfma_f32_16x16x32_bf16 v[8:11], a[56:59], a[8:11], v[8:11]
    ds_read_b64_tr_b16 a[18:19], v133 offset:18432
    ds_read_b64_tr_b16 a[20:21], v134 offset:16384
    v_mfma_f32_16x16x32_bf16 v[40:43], a[56:59], a[12:15], v[40:43]
    ds_read_b64_tr_b16 a[22:23], v134 offset:18432
    v_mfma_f32_16x16x32_bf16 v[12:15], a[60:63], a[8:11], v[12:15]
    ds_read_b64_tr_b16 a[24:25], v135 offset:16384
    v_mfma_f32_16x16x32_bf16 v[44:47], a[60:63], a[12:15], v[44:47]
    ds_read_b64_tr_b16 a[26:27], v135 offset:18432
    s_waitcnt lgkmcnt(10)
    v_mfma_f32_16x16x32_bf16 v[16:19], a[64:67], a[8:11], v[16:19]
    ds_read_b64_tr_b16 a[28:29], v136 offset:16384
    ds_read_b64_tr_b16 a[30:31], v136 offset:18432
    v_mfma_f32_16x16x32_bf16 v[48:51], a[64:67], a[12:15], v[48:51]
    ds_read_b64_tr_b16 a[32:33], v133 offset:24576
    v_mfma_f32_16x16x32_bf16 v[20:23], a[68:71], a[8:11], v[20:23]
    ds_read_b64_tr_b16 a[34:35], v133 offset:26624
    v_mfma_f32_16x16x32_bf16 v[52:55], a[68:71], a[12:15], v[52:55]
    ds_read_b64_tr_b16 a[36:37], v134 offset:24576
    v_mfma_f32_16x16x32_bf16 v[24:27], a[72:75], a[8:11], v[24:27]
    ds_read_b64_tr_b16 a[38:39], v134 offset:26624
    ds_read_b64_tr_b16 a[40:41], v135 offset:24576
    v_mfma_f32_16x16x32_bf16 v[56:59], a[72:75], a[12:15], v[56:59]
    ds_read_b64_tr_b16 a[42:43], v135 offset:26624
    v_mfma_f32_16x16x32_bf16 v[28:31], a[76:79], a[8:11], v[28:31]
    ds_read_b64_tr_b16 a[44:45], v136 offset:24576
    v_mfma_f32_16x16x32_bf16 v[60:63], a[76:79], a[12:15], v[60:63]
    ds_read_b64_tr_b16 a[46:47], v136 offset:26624
    s_waitcnt lgkmcnt(8)
    v_mfma_f32_16x16x32_bf16 v[0:3], a[16:19], a[0:3], v[0:3]
    ds_read_b128 a[8:11], v141 offset:17408
    ds_read_b128 a[12:15], v141 offset:19456
    v_mfma_f32_16x16x32_bf16 v[32:35], a[16:19], a[4:7], v[32:35]
    ds_read_b64_tr_b16 a[48:49], v133 offset:20480
    v_mfma_f32_16x16x32_bf16 v[4:7], a[20:23], a[0:3], v[4:7]
    ds_read_b64_tr_b16 a[50:51], v133 offset:22528
    v_mfma_f32_16x16x32_bf16 v[36:39], a[20:23], a[4:7], v[36:39]
    ds_read_b64_tr_b16 a[52:53], v134 offset:20480
    v_mfma_f32_16x16x32_bf16 v[8:11], a[24:27], a[0:3], v[8:11]
    ds_read_b64_tr_b16 a[54:55], v134 offset:22528
    v_mfma_f32_16x16x32_bf16 v[40:43], a[24:27], a[4:7], v[40:43]
    ds_read_b64_tr_b16 a[56:57], v135 offset:20480
    v_mfma_f32_16x16x32_bf16 v[12:15], a[28:31], a[0:3], v[12:15]
    ds_read_b64_tr_b16 a[58:59], v135 offset:22528
    v_mfma_f32_16x16x32_bf16 v[44:47], a[28:31], a[4:7], v[44:47]
    ds_read_b64_tr_b16 a[60:61], v136 offset:20480
    s_waitcnt lgkmcnt(9)
    v_mfma_f32_16x16x32_bf16 v[16:19], a[32:35], a[0:3], v[16:19]
    ds_read_b64_tr_b16 a[62:63], v136 offset:22528
    ds_read_b64_tr_b16 a[64:65], v133 offset:28672
    v_mfma_f32_16x16x32_bf16 v[48:51], a[32:35], a[4:7], v[48:51]
    ds_read_b64_tr_b16 a[66:67], v133 offset:30720
    v_mfma_f32_16x16x32_bf16 v[20:23], a[36:39], a[0:3], v[20:23]
    ds_read_b64_tr_b16 a[68:69], v134 offset:28672
    v_mfma_f32_16x16x32_bf16 v[52:55], a[36:39], a[4:7], v[52:55]
    ds_read_b64_tr_b16 a[70:71], v134 offset:30720
    v_mfma_f32_16x16x32_bf16 v[24:27], a[40:43], a[0:3], v[24:27]
    ds_read_b64_tr_b16 a[72:73], v135 offset:28672
    v_mfma_f32_16x16x32_bf16 v[56:59], a[40:43], a[4:7], v[56:59]
    ds_read_b64_tr_b16 a[74:75], v135 offset:30720
    v_mfma_f32_16x16x32_bf16 v[28:31], a[44:47], a[0:3], v[28:31]
    ds_read_b64_tr_b16 a[76:77], v136 offset:28672
    v_mfma_f32_16x16x32_bf16 v[60:63], a[44:47], a[4:7], v[60:63]
    ds_read_b64_tr_b16 a[78:79], v136 offset:30720
    s_barrier
    s_waitcnt lgkmcnt(8)
    v_mfma_f32_16x16x32_bf16 v[0:3], a[48:51], a[8:11], v[0:3]
    ds_read_b128 a[0:3], v141 offset:32768
    ds_read_b128 a[4:7], v141 offset:34816
    v_mfma_f32_16x16x32_bf16 v[32:35], a[48:51], a[12:15], v[32:35]
    ds_read_b64_tr_b16 a[16:17], v133 offset:32768
    v_mfma_f32_16x16x32_bf16 v[4:7], a[52:55], a[8:11], v[4:7]
    ds_read_b64_tr_b16 a[18:19], v133 offset:34816
    v_mfma_f32_16x16x32_bf16 v[36:39], a[52:55], a[12:15], v[36:39]
    ds_read_b64_tr_b16 a[20:21], v134 offset:32768
    v_mfma_f32_16x16x32_bf16 v[8:11], a[56:59], a[8:11], v[8:11]
    ds_read_b64_tr_b16 a[22:23], v134 offset:34816
    v_mfma_f32_16x16x32_bf16 v[40:43], a[56:59], a[12:15], v[40:43]
    ds_read_b64_tr_b16 a[24:25], v135 offset:32768
    v_mfma_f32_16x16x32_bf16 v[12:15], a[60:63], a[8:11], v[12:15]
    ds_read_b64_tr_b16 a[26:27], v135 offset:34816
    v_mfma_f32_16x16x32_bf16 v[44:47], a[60:63], a[12:15], v[44:47]
    ds_read_b64_tr_b16 a[28:29], v136 offset:32768
    s_waitcnt lgkmcnt(9)
    v_mfma_f32_16x16x32_bf16 v[16:19], a[64:67], a[8:11], v[16:19]
    ds_read_b64_tr_b16 a[30:31], v136 offset:34816
    ds_read_b64_tr_b16 a[32:33], v133 offset:40960
    v_mfma_f32_16x16x32_bf16 v[48:51], a[64:67], a[12:15], v[48:51]
    ds_read_b64_tr_b16 a[34:35], v133 offset:43008
    v_mfma_f32_16x16x32_bf16 v[20:23], a[68:71], a[8:11], v[20:23]
    ds_read_b64_tr_b16 a[36:37], v134 offset:40960
    v_mfma_f32_16x16x32_bf16 v[52:55], a[68:71], a[12:15], v[52:55]
    ds_read_b64_tr_b16 a[38:39], v134 offset:43008
    v_mfma_f32_16x16x32_bf16 v[24:27], a[72:75], a[8:11], v[24:27]
    ds_read_b64_tr_b16 a[40:41], v135 offset:40960
    v_mfma_f32_16x16x32_bf16 v[56:59], a[72:75], a[12:15], v[56:59]
    ds_read_b64_tr_b16 a[42:43], v135 offset:43008
    v_mfma_f32_16x16x32_bf16 v[28:31], a[76:79], a[8:11], v[28:31]
    ds_read_b64_tr_b16 a[44:45], v136 offset:40960
    v_mfma_f32_16x16x32_bf16 v[60:63], a[76:79], a[12:15], v[60:63]
    ds_read_b64_tr_b16 a[46:47], v136 offset:43008
    s_waitcnt lgkmcnt(8)
    v_mfma_f32_16x16x32_bf16 v[0:3], a[16:19], a[0:3], v[0:3]
    ds_read_b128 a[8:11], v141 offset:33792
    ds_read_b128 a[12:15], v141 offset:35840
    v_mfma_f32_16x16x32_bf16 v[32:35], a[16:19], a[4:7], v[32:35]
    ds_read_b64_tr_b16 a[48:49], v133 offset:36864
    v_mfma_f32_16x16x32_bf16 v[4:7], a[20:23], a[0:3], v[4:7]
    ds_read_b64_tr_b16 a[50:51], v133 offset:38912
    v_mfma_f32_16x16x32_bf16 v[36:39], a[20:23], a[4:7], v[36:39]
    ds_read_b64_tr_b16 a[52:53], v134 offset:36864
    v_mfma_f32_16x16x32_bf16 v[8:11], a[24:27], a[0:3], v[8:11]
    ds_read_b64_tr_b16 a[54:55], v134 offset:38912
    v_mfma_f32_16x16x32_bf16 v[40:43], a[24:27], a[4:7], v[40:43]
    ds_read_b64_tr_b16 a[56:57], v135 offset:36864
    v_mfma_f32_16x16x32_bf16 v[12:15], a[28:31], a[0:3], v[12:15]
    ds_read_b64_tr_b16 a[58:59], v135 offset:38912
    v_mfma_f32_16x16x32_bf16 v[44:47], a[28:31], a[4:7], v[44:47]
    ds_read_b64_tr_b16 a[60:61], v136 offset:36864
    s_waitcnt lgkmcnt(9)
    v_mfma_f32_16x16x32_bf16 v[16:19], a[32:35], a[0:3], v[16:19]
    ds_read_b64_tr_b16 a[62:63], v136 offset:38912
    ds_read_b64_tr_b16 a[64:65], v133 offset:45056
    v_mfma_f32_16x16x32_bf16 v[48:51], a[32:35], a[4:7], v[48:51]
    ds_read_b64_tr_b16 a[66:67], v133 offset:47104
    v_mfma_f32_16x16x32_bf16 v[20:23], a[36:39], a[0:3], v[20:23]
    ds_read_b64_tr_b16 a[68:69], v134 offset:45056
    v_mfma_f32_16x16x32_bf16 v[52:55], a[36:39], a[4:7], v[52:55]
    ds_read_b64_tr_b16 a[70:71], v134 offset:47104
    v_mfma_f32_16x16x32_bf16 v[24:27], a[40:43], a[0:3], v[24:27]
    ds_read_b64_tr_b16 a[72:73], v135 offset:45056
    v_mfma_f32_16x16x32_bf16 v[56:59], a[40:43], a[4:7], v[56:59]
    ds_read_b64_tr_b16 a[74:75], v135 offset:47104
    v_mfma_f32_16x16x32_bf16 v[28:31], a[44:47], a[0:3], v[28:31]
    ds_read_b64_tr_b16 a[76:77], v136 offset:45056
    v_mfma_f32_16x16x32_bf16 v[60:63], a[44:47], a[4:7], v[60:63]
    ds_read_b64_tr_b16 a[78:79], v136 offset:47104
    s_barrier
    s_waitcnt lgkmcnt(8)
    v_mfma_f32_16x16x32_bf16 v[0:3], a[48:51], a[8:11], v[0:3]
    ds_read_b128 a[0:3], v141 offset:49152
    ds_read_b128 a[4:7], v141 offset:51200
    v_mfma_f32_16x16x32_bf16 v[32:35], a[48:51], a[12:15], v[32:35]
    ds_read_b64_tr_b16 a[16:17], v133 offset:49152
    v_mfma_f32_16x16x32_bf16 v[4:7], a[52:55], a[8:11], v[4:7]
    ds_read_b64_tr_b16 a[18:19], v133 offset:51200
    v_mfma_f32_16x16x32_bf16 v[36:39], a[52:55], a[12:15], v[36:39]
    ds_read_b64_tr_b16 a[20:21], v134 offset:49152
    v_mfma_f32_16x16x32_bf16 v[8:11], a[56:59], a[8:11], v[8:11]
    ds_read_b64_tr_b16 a[22:23], v134 offset:51200
    v_mfma_f32_16x16x32_bf16 v[40:43], a[56:59], a[12:15], v[40:43]
    ds_read_b64_tr_b16 a[24:25], v135 offset:49152
    v_mfma_f32_16x16x32_bf16 v[12:15], a[60:63], a[8:11], v[12:15]
    ds_read_b64_tr_b16 a[26:27], v135 offset:51200
    v_mfma_f32_16x16x32_bf16 v[44:47], a[60:63], a[12:15], v[44:47]
    ds_read_b64_tr_b16 a[28:29], v136 offset:49152
    s_waitcnt lgkmcnt(9)
    v_mfma_f32_16x16x32_bf16 v[16:19], a[64:67], a[8:11], v[16:19]
    ds_read_b64_tr_b16 a[30:31], v136 offset:51200
    ds_read_b64_tr_b16 a[32:33], v133 offset:57344
    v_mfma_f32_16x16x32_bf16 v[48:51], a[64:67], a[12:15], v[48:51]
    ds_read_b64_tr_b16 a[34:35], v133 offset:59392
    v_mfma_f32_16x16x32_bf16 v[20:23], a[68:71], a[8:11], v[20:23]
    ds_read_b64_tr_b16 a[36:37], v134 offset:57344
    v_mfma_f32_16x16x32_bf16 v[52:55], a[68:71], a[12:15], v[52:55]
    ds_read_b64_tr_b16 a[38:39], v134 offset:59392
    v_mfma_f32_16x16x32_bf16 v[24:27], a[72:75], a[8:11], v[24:27]
    ds_read_b64_tr_b16 a[40:41], v135 offset:57344
    v_mfma_f32_16x16x32_bf16 v[56:59], a[72:75], a[12:15], v[56:59]
    ds_read_b64_tr_b16 a[42:43], v135 offset:59392
    v_mfma_f32_16x16x32_bf16 v[28:31], a[76:79], a[8:11], v[28:31]
    ds_read_b64_tr_b16 a[44:45], v136 offset:57344
    v_mfma_f32_16x16x32_bf16 v[60:63], a[76:79], a[12:15], v[60:63]
    ds_read_b64_tr_b16 a[46:47], v136 offset:59392
    s_waitcnt lgkmcnt(8)
    v_mfma_f32_16x16x32_bf16 v[0:3], a[16:19], a[0:3], v[0:3]
    ds_read_b64 a[8:9], v96 offset:50176
    ds_read_b64 a[10:11], v96 offset:50688
    v_mfma_f32_16x16x32_bf16 v[32:35], a[16:19], a[4:7], v[32:35]
    ds_read_b64 a[12:13], v96 offset:52224
    v_mfma_f32_16x16x32_bf16 v[4:7], a[20:23], a[0:3], v[4:7]
    ds_read_b64 a[14:15], v96 offset:52736
    v_mfma_f32_16x16x32_bf16 v[36:39], a[20:23], a[4:7], v[36:39]
    ds_read_b64_tr_b16 a[48:49], v133 offset:53248
    v_mfma_f32_16x16x32_bf16 v[8:11], a[24:27], a[0:3], v[8:11]
    ds_read_b64_tr_b16 a[50:51], v133 offset:55296
    ds_read_b64_tr_b16 a[52:53], v134 offset:53248
    v_mfma_f32_16x16x32_bf16 v[40:43], a[24:27], a[4:7], v[40:43]
    ds_read_b64_tr_b16 a[54:55], v134 offset:55296
    v_mfma_f32_16x16x32_bf16 v[12:15], a[28:31], a[0:3], v[12:15]
    ds_read_b64_tr_b16 a[56:57], v135 offset:53248
    v_mfma_f32_16x16x32_bf16 v[44:47], a[28:31], a[4:7], v[44:47]
    ds_read_b64_tr_b16 a[58:59], v135 offset:55296
    s_waitcnt lgkmcnt(10)
    v_mfma_f32_16x16x32_bf16 v[16:19], a[32:35], a[0:3], v[16:19]
    ds_read_b64_tr_b16 a[60:61], v136 offset:53248
    ds_read_b64_tr_b16 a[62:63], v136 offset:55296
    v_mfma_f32_16x16x32_bf16 v[48:51], a[32:35], a[4:7], v[48:51]
    ds_read_b64_tr_b16 a[64:65], v133 offset:61440
    v_mfma_f32_16x16x32_bf16 v[20:23], a[36:39], a[0:3], v[20:23]
    ds_read_b64_tr_b16 a[66:67], v133 offset:63488
    v_mfma_f32_16x16x32_bf16 v[52:55], a[36:39], a[4:7], v[52:55]
    ds_read_b64_tr_b16 a[68:69], v134 offset:61440
    v_mfma_f32_16x16x32_bf16 v[24:27], a[40:43], a[0:3], v[24:27]
    ds_read_b64_tr_b16 a[70:71], v134 offset:63488
    ds_read_b64_tr_b16 a[72:73], v135 offset:61440
    v_mfma_f32_16x16x32_bf16 v[56:59], a[40:43], a[4:7], v[56:59]
    ds_read_b64_tr_b16 a[74:75], v135 offset:63488
    v_mfma_f32_16x16x32_bf16 v[28:31], a[44:47], a[0:3], v[28:31]
    ds_read_b64_tr_b16 a[76:77], v136 offset:61440
    v_mfma_f32_16x16x32_bf16 v[60:63], a[44:47], a[4:7], v[60:63]
    ds_read_b64_tr_b16 a[78:79], v136 offset:63488
    s_barrier
    s_waitcnt lgkmcnt(8)
    v_mfma_f32_16x16x32_bf16 v[0:3], a[48:51], a[8:11], v[0:3]
    ds_read_b128 a[0:3], v141 offset:0
    ds_read_b128 a[4:7], v141 offset:2048
    v_mfma_f32_16x16x32_bf16 v[32:35], a[48:51], a[12:15], v[32:35]
    ds_read_b64_tr_b16 a[16:17], v137 offset:0
    v_mfma_f32_16x16x32_bf16 v[4:7], a[52:55], a[8:11], v[4:7]
    ds_read_b64_tr_b16 a[18:19], v137 offset:2048
    v_mfma_f32_16x16x32_bf16 v[36:39], a[52:55], a[12:15], v[36:39]
    ds_read_b64_tr_b16 a[20:21], v138 offset:0
    v_mfma_f32_16x16x32_bf16 v[8:11], a[56:59], a[8:11], v[8:11]
    ds_read_b64_tr_b16 a[22:23], v138 offset:2048
    v_mfma_f32_16x16x32_bf16 v[40:43], a[56:59], a[12:15], v[40:43]
    ds_read_b64_tr_b16 a[24:25], v139 offset:0
    v_mfma_f32_16x16x32_bf16 v[12:15], a[60:63], a[8:11], v[12:15]
    ds_read_b64_tr_b16 a[26:27], v139 offset:2048
    v_mfma_f32_16x16x32_bf16 v[44:47], a[60:63], a[12:15], v[44:47]
    ds_read_b64_tr_b16 a[28:29], v140 offset:0
    s_waitcnt lgkmcnt(9)
    v_mfma_f32_16x16x32_bf16 v[16:19], a[64:67], a[8:11], v[16:19]
    ds_read_b64_tr_b16 a[30:31], v140 offset:2048
    ds_read_b64_tr_b16 a[32:33], v137 offset:8192
    v_mfma_f32_16x16x32_bf16 v[48:51], a[64:67], a[12:15], v[48:51]
    ds_read_b64_tr_b16 a[34:35], v137 offset:10240
    v_mfma_f32_16x16x32_bf16 v[20:23], a[68:71], a[8:11], v[20:23]
    ds_read_b64_tr_b16 a[36:37], v138 offset:8192
    v_mfma_f32_16x16x32_bf16 v[52:55], a[68:71], a[12:15], v[52:55]
    ds_read_b64_tr_b16 a[38:39], v138 offset:10240
    v_mfma_f32_16x16x32_bf16 v[24:27], a[72:75], a[8:11], v[24:27]
    ds_read_b64_tr_b16 a[40:41], v139 offset:8192
    v_mfma_f32_16x16x32_bf16 v[56:59], a[72:75], a[12:15], v[56:59]
    ds_read_b64_tr_b16 a[42:43], v139 offset:10240
    v_mfma_f32_16x16x32_bf16 v[28:31], a[76:79], a[8:11], v[28:31]
    ds_read_b64_tr_b16 a[44:45], v140 offset:8192
    v_mfma_f32_16x16x32_bf16 v[60:63], a[76:79], a[12:15], v[60:63]
    ds_read_b64_tr_b16 a[46:47], v140 offset:10240
    s_waitcnt lgkmcnt(8)
    v_mfma_f32_16x16x32_bf16 v[0:3], a[16:19], a[0:3], v[0:3]
    ds_read_b128 a[8:11], v141 offset:1024
    ds_read_b128 a[12:15], v141 offset:3072
    v_mfma_f32_16x16x32_bf16 v[32:35], a[16:19], a[4:7], v[32:35]
    ds_read_b64_tr_b16 a[48:49], v137 offset:4096
    v_mfma_f32_16x16x32_bf16 v[4:7], a[20:23], a[0:3], v[4:7]
    ds_read_b64_tr_b16 a[50:51], v137 offset:6144
    v_mfma_f32_16x16x32_bf16 v[36:39], a[20:23], a[4:7], v[36:39]
    ds_read_b64_tr_b16 a[52:53], v138 offset:4096
    v_mfma_f32_16x16x32_bf16 v[8:11], a[24:27], a[0:3], v[8:11]
    ds_read_b64_tr_b16 a[54:55], v138 offset:6144
    v_mfma_f32_16x16x32_bf16 v[40:43], a[24:27], a[4:7], v[40:43]
    ds_read_b64_tr_b16 a[56:57], v139 offset:4096
    v_mfma_f32_16x16x32_bf16 v[12:15], a[28:31], a[0:3], v[12:15]
    ds_read_b64_tr_b16 a[58:59], v139 offset:6144
    v_mfma_f32_16x16x32_bf16 v[44:47], a[28:31], a[4:7], v[44:47]
    ds_read_b64_tr_b16 a[60:61], v140 offset:4096
    s_waitcnt lgkmcnt(9)
    v_mfma_f32_16x16x32_bf16 v[16:19], a[32:35], a[0:3], v[16:19]
    ds_read_b64_tr_b16 a[62:63], v140 offset:6144
    ds_read_b64_tr_b16 a[64:65], v137 offset:12288
    v_mfma_f32_16x16x32_bf16 v[48:51], a[32:35], a[4:7], v[48:51]
    ds_read_b64_tr_b16 a[66:67], v137 offset:14336
    v_mfma_f32_16x16x32_bf16 v[20:23], a[36:39], a[0:3], v[20:23]
    ds_read_b64_tr_b16 a[68:69], v138 offset:12288
    v_mfma_f32_16x16x32_bf16 v[52:55], a[36:39], a[4:7], v[52:55]
    ds_read_b64_tr_b16 a[70:71], v138 offset:14336
    v_mfma_f32_16x16x32_bf16 v[24:27], a[40:43], a[0:3], v[24:27]
    ds_read_b64_tr_b16 a[72:73], v139 offset:12288
    v_mfma_f32_16x16x32_bf16 v[56:59], a[40:43], a[4:7], v[56:59]
    ds_read_b64_tr_b16 a[74:75], v139 offset:14336
    v_mfma_f32_16x16x32_bf16 v[28:31], a[44:47], a[0:3], v[28:31]
    ds_read_b64_tr_b16 a[76:77], v140 offset:12288
    v_mfma_f32_16x16x32_bf16 v[60:63], a[44:47], a[4:7], v[60:63]
    ds_read_b64_tr_b16 a[78:79], v140 offset:14336
    s_barrier
    s_waitcnt lgkmcnt(8)
    v_mfma_f32_16x16x32_bf16 v[0:3], a[48:51], a[8:11], v[0:3]
    ds_read_b128 a[0:3], v141 offset:16384
    ds_read_b128 a[4:7], v141 offset:18432
    v_mfma_f32_16x16x32_bf16 v[32:35], a[48:51], a[12:15], v[32:35]
    ds_read_b64_tr_b16 a[16:17], v133 offset:0
    v_mfma_f32_16x16x32_bf16 v[4:7], a[52:55], a[8:11], v[4:7]
    ds_read_b64_tr_b16 a[18:19], v133 offset:2048
    v_mfma_f32_16x16x32_bf16 v[36:39], a[52:55], a[12:15], v[36:39]
    ds_read_b64_tr_b16 a[20:21], v134 offset:0
    v_mfma_f32_16x16x32_bf16 v[8:11], a[56:59], a[8:11], v[8:11]
    ds_read_b64_tr_b16 a[22:23], v134 offset:2048
    v_mfma_f32_16x16x32_bf16 v[40:43], a[56:59], a[12:15], v[40:43]
    ds_read_b64_tr_b16 a[24:25], v135 offset:0
    v_mfma_f32_16x16x32_bf16 v[12:15], a[60:63], a[8:11], v[12:15]
    ds_read_b64_tr_b16 a[26:27], v135 offset:2048
    v_mfma_f32_16x16x32_bf16 v[44:47], a[60:63], a[12:15], v[44:47]
    ds_read_b64_tr_b16 a[28:29], v136 offset:0
    s_waitcnt lgkmcnt(9)
    v_mfma_f32_16x16x32_bf16 v[16:19], a[64:67], a[8:11], v[16:19]
    ds_read_b64_tr_b16 a[30:31], v136 offset:2048
    ds_read_b64_tr_b16 a[32:33], v133 offset:8192
    v_mfma_f32_16x16x32_bf16 v[48:51], a[64:67], a[12:15], v[48:51]
    ds_read_b64_tr_b16 a[34:35], v133 offset:10240
    v_mfma_f32_16x16x32_bf16 v[20:23], a[68:71], a[8:11], v[20:23]
    ds_read_b64_tr_b16 a[36:37], v134 offset:8192
    v_mfma_f32_16x16x32_bf16 v[52:55], a[68:71], a[12:15], v[52:55]
    ds_read_b64_tr_b16 a[38:39], v134 offset:10240
    v_mfma_f32_16x16x32_bf16 v[24:27], a[72:75], a[8:11], v[24:27]
    ds_read_b64_tr_b16 a[40:41], v135 offset:8192
    v_mfma_f32_16x16x32_bf16 v[56:59], a[72:75], a[12:15], v[56:59]
    ds_read_b64_tr_b16 a[42:43], v135 offset:10240
    v_mfma_f32_16x16x32_bf16 v[28:31], a[76:79], a[8:11], v[28:31]
    ds_read_b64_tr_b16 a[44:45], v136 offset:8192
    v_mfma_f32_16x16x32_bf16 v[60:63], a[76:79], a[12:15], v[60:63]
    ds_read_b64_tr_b16 a[46:47], v136 offset:10240
    s_waitcnt lgkmcnt(8)
    v_mfma_f32_16x16x32_bf16 v[0:3], a[16:19], a[0:3], v[0:3]
    ds_read_b128 a[8:11], v141 offset:17408
    ds_read_b128 a[12:15], v141 offset:19456
    v_mfma_f32_16x16x32_bf16 v[32:35], a[16:19], a[4:7], v[32:35]
    ds_read_b64_tr_b16 a[48:49], v133 offset:4096
    v_mfma_f32_16x16x32_bf16 v[4:7], a[20:23], a[0:3], v[4:7]
    ds_read_b64_tr_b16 a[50:51], v133 offset:6144
    v_mfma_f32_16x16x32_bf16 v[36:39], a[20:23], a[4:7], v[36:39]
    ds_read_b64_tr_b16 a[52:53], v134 offset:4096
    v_mfma_f32_16x16x32_bf16 v[8:11], a[24:27], a[0:3], v[8:11]
    ds_read_b64_tr_b16 a[54:55], v134 offset:6144
    v_mfma_f32_16x16x32_bf16 v[40:43], a[24:27], a[4:7], v[40:43]
    ds_read_b64_tr_b16 a[56:57], v135 offset:4096
    v_mfma_f32_16x16x32_bf16 v[12:15], a[28:31], a[0:3], v[12:15]
    ds_read_b64_tr_b16 a[58:59], v135 offset:6144
    v_mfma_f32_16x16x32_bf16 v[44:47], a[28:31], a[4:7], v[44:47]
    ds_read_b64_tr_b16 a[60:61], v136 offset:4096
    s_waitcnt lgkmcnt(9)
    v_mfma_f32_16x16x32_bf16 v[16:19], a[32:35], a[0:3], v[16:19]
    ds_read_b64_tr_b16 a[62:63], v136 offset:6144
    ds_read_b64_tr_b16 a[64:65], v133 offset:12288
    v_mfma_f32_16x16x32_bf16 v[48:51], a[32:35], a[4:7], v[48:51]
    ds_read_b64_tr_b16 a[66:67], v133 offset:14336
    v_mfma_f32_16x16x32_bf16 v[20:23], a[36:39], a[0:3], v[20:23]
    ds_read_b64_tr_b16 a[68:69], v134 offset:12288
    v_mfma_f32_16x16x32_bf16 v[52:55], a[36:39], a[4:7], v[52:55]
    ds_read_b64_tr_b16 a[70:71], v134 offset:14336
    v_mfma_f32_16x16x32_bf16 v[24:27], a[40:43], a[0:3], v[24:27]
    ds_read_b64_tr_b16 a[72:73], v135 offset:12288
    v_mfma_f32_16x16x32_bf16 v[56:59], a[40:43], a[4:7], v[56:59]
    ds_read_b64_tr_b16 a[74:75], v135 offset:14336
    v_mfma_f32_16x16x32_bf16 v[28:31], a[44:47], a[0:3], v[28:31]
    ds_read_b64_tr_b16 a[76:77], v136 offset:12288
    v_mfma_f32_16x16x32_bf16 v[60:63], a[44:47], a[4:7], v[60:63]
    ds_read_b64_tr_b16 a[78:79], v136 offset:14336
    s_barrier
    s_waitcnt lgkmcnt(8)
    v_mfma_f32_16x16x32_bf16 v[0:3], a[48:51], a[8:11], v[0:3]
    ds_read_b64 a[0:1], v96 offset:32768
    ds_read_b64 a[2:3], v96 offset:33280
    v_mfma_f32_16x16x32_bf16 v[32:35], a[48:51], a[12:15], v[32:35]
    ds_read_b64 a[4:5], v96 offset:34816
    v_mfma_f32_16x16x32_bf16 v[4:7], a[52:55], a[8:11], v[4:7]
    ds_read_b64 a[6:7], v96 offset:35328
    v_mfma_f32_16x16x32_bf16 v[36:39], a[52:55], a[12:15], v[36:39]
    ds_read_b64_tr_b16 a[16:17], v133 offset:16384
    v_mfma_f32_16x16x32_bf16 v[8:11], a[56:59], a[8:11], v[8:11]
    ds_read_b64_tr_b16 a[18:19], v133 offset:18432
    ds_read_b64_tr_b16 a[20:21], v134 offset:16384
    v_mfma_f32_16x16x32_bf16 v[40:43], a[56:59], a[12:15], v[40:43]
    ds_read_b64_tr_b16 a[22:23], v134 offset:18432
    v_mfma_f32_16x16x32_bf16 v[12:15], a[60:63], a[8:11], v[12:15]
    ds_read_b64_tr_b16 a[24:25], v135 offset:16384
    v_mfma_f32_16x16x32_bf16 v[44:47], a[60:63], a[12:15], v[44:47]
    ds_read_b64_tr_b16 a[26:27], v135 offset:18432
    s_waitcnt lgkmcnt(10)
    v_mfma_f32_16x16x32_bf16 v[16:19], a[64:67], a[8:11], v[16:19]
    ds_read_b64_tr_b16 a[28:29], v136 offset:16384
    ds_read_b64_tr_b16 a[30:31], v136 offset:18432
    v_mfma_f32_16x16x32_bf16 v[48:51], a[64:67], a[12:15], v[48:51]
    ds_read_b64_tr_b16 a[32:33], v133 offset:24576
    v_mfma_f32_16x16x32_bf16 v[20:23], a[68:71], a[8:11], v[20:23]
    ds_read_b64_tr_b16 a[34:35], v133 offset:26624
    v_mfma_f32_16x16x32_bf16 v[52:55], a[68:71], a[12:15], v[52:55]
    ds_read_b64_tr_b16 a[36:37], v134 offset:24576
    v_mfma_f32_16x16x32_bf16 v[24:27], a[72:75], a[8:11], v[24:27]
    ds_read_b64_tr_b16 a[38:39], v134 offset:26624
    ds_read_b64_tr_b16 a[40:41], v135 offset:24576
    v_mfma_f32_16x16x32_bf16 v[56:59], a[72:75], a[12:15], v[56:59]
    ds_read_b64_tr_b16 a[42:43], v135 offset:26624
    v_mfma_f32_16x16x32_bf16 v[28:31], a[76:79], a[8:11], v[28:31]
    ds_read_b64_tr_b16 a[44:45], v136 offset:24576
    v_mfma_f32_16x16x32_bf16 v[60:63], a[76:79], a[12:15], v[60:63]
    ds_read_b64_tr_b16 a[46:47], v136 offset:26624
    s_waitcnt lgkmcnt(8)
    v_mfma_f32_16x16x32_bf16 v[0:3], a[16:19], a[0:3], v[0:3]
    ds_read_b128 a[8:11], v141 offset:33792
    ds_read_b128 a[12:15], v141 offset:35840
    v_mfma_f32_16x16x32_bf16 v[32:35], a[16:19], a[4:7], v[32:35]
    ds_read_b64_tr_b16 a[48:49], v133 offset:20480
    v_mfma_f32_16x16x32_bf16 v[4:7], a[20:23], a[0:3], v[4:7]
    ds_read_b64_tr_b16 a[50:51], v133 offset:22528
    v_mfma_f32_16x16x32_bf16 v[36:39], a[20:23], a[4:7], v[36:39]
    ds_read_b64_tr_b16 a[52:53], v134 offset:20480
    v_mfma_f32_16x16x32_bf16 v[8:11], a[24:27], a[0:3], v[8:11]
    ds_read_b64_tr_b16 a[54:55], v134 offset:22528
    v_mfma_f32_16x16x32_bf16 v[40:43], a[24:27], a[4:7], v[40:43]
    ds_read_b64_tr_b16 a[56:57], v135 offset:20480
    v_mfma_f32_16x16x32_bf16 v[12:15], a[28:31], a[0:3], v[12:15]
    ds_read_b64_tr_b16 a[58:59], v135 offset:22528
    v_mfma_f32_16x16x32_bf16 v[44:47], a[28:31], a[4:7], v[44:47]
    ds_read_b64_tr_b16 a[60:61], v136 offset:20480
    s_waitcnt lgkmcnt(9)
    v_mfma_f32_16x16x32_bf16 v[16:19], a[32:35], a[0:3], v[16:19]
    ds_read_b64_tr_b16 a[62:63], v136 offset:22528
    ds_read_b64_tr_b16 a[64:65], v133 offset:28672
    v_mfma_f32_16x16x32_bf16 v[48:51], a[32:35], a[4:7], v[48:51]
    ds_read_b64_tr_b16 a[66:67], v133 offset:30720
    v_mfma_f32_16x16x32_bf16 v[20:23], a[36:39], a[0:3], v[20:23]
    ds_read_b64_tr_b16 a[68:69], v134 offset:28672
    v_mfma_f32_16x16x32_bf16 v[52:55], a[36:39], a[4:7], v[52:55]
    ds_read_b64_tr_b16 a[70:71], v134 offset:30720
    v_mfma_f32_16x16x32_bf16 v[24:27], a[40:43], a[0:3], v[24:27]
    ds_read_b64_tr_b16 a[72:73], v135 offset:28672
    v_mfma_f32_16x16x32_bf16 v[56:59], a[40:43], a[4:7], v[56:59]
    ds_read_b64_tr_b16 a[74:75], v135 offset:30720
    v_mfma_f32_16x16x32_bf16 v[28:31], a[44:47], a[0:3], v[28:31]
    ds_read_b64_tr_b16 a[76:77], v136 offset:28672
    v_mfma_f32_16x16x32_bf16 v[60:63], a[44:47], a[4:7], v[60:63]
    ds_read_b64_tr_b16 a[78:79], v136 offset:30720
    s_barrier
    s_waitcnt lgkmcnt(8)
    v_mfma_f32_16x16x32_bf16 v[0:3], a[48:51], a[8:11], v[0:3]
    ds_read_b128 a[0:3], v141 offset:49152
    ds_read_b128 a[4:7], v141 offset:51200
    v_mfma_f32_16x16x32_bf16 v[32:35], a[48:51], a[12:15], v[32:35]
    ds_read_b64_tr_b16 a[16:17], v133 offset:32768
    v_mfma_f32_16x16x32_bf16 v[4:7], a[52:55], a[8:11], v[4:7]
    ds_read_b64_tr_b16 a[18:19], v133 offset:34816
    v_mfma_f32_16x16x32_bf16 v[36:39], a[52:55], a[12:15], v[36:39]
    ds_read_b64_tr_b16 a[20:21], v134 offset:32768
    v_mfma_f32_16x16x32_bf16 v[8:11], a[56:59], a[8:11], v[8:11]
    ds_read_b64_tr_b16 a[22:23], v134 offset:34816
    v_mfma_f32_16x16x32_bf16 v[40:43], a[56:59], a[12:15], v[40:43]
    ds_read_b64_tr_b16 a[24:25], v135 offset:32768
    v_mfma_f32_16x16x32_bf16 v[12:15], a[60:63], a[8:11], v[12:15]
    ds_read_b64_tr_b16 a[26:27], v135 offset:34816
    v_mfma_f32_16x16x32_bf16 v[44:47], a[60:63], a[12:15], v[44:47]
    ds_read_b64_tr_b16 a[28:29], v136 offset:32768
    s_waitcnt lgkmcnt(9)
    v_mfma_f32_16x16x32_bf16 v[16:19], a[64:67], a[8:11], v[16:19]
    ds_read_b64_tr_b16 a[30:31], v136 offset:34816
    ds_read_b64_tr_b16 a[32:33], v133 offset:40960
    v_mfma_f32_16x16x32_bf16 v[48:51], a[64:67], a[12:15], v[48:51]
    ds_read_b64_tr_b16 a[34:35], v133 offset:43008
    v_mfma_f32_16x16x32_bf16 v[20:23], a[68:71], a[8:11], v[20:23]
    ds_read_b64_tr_b16 a[36:37], v134 offset:40960
    v_mfma_f32_16x16x32_bf16 v[52:55], a[68:71], a[12:15], v[52:55]
    ds_read_b64_tr_b16 a[38:39], v134 offset:43008
    v_mfma_f32_16x16x32_bf16 v[24:27], a[72:75], a[8:11], v[24:27]
    ds_read_b64_tr_b16 a[40:41], v135 offset:40960
    v_mfma_f32_16x16x32_bf16 v[56:59], a[72:75], a[12:15], v[56:59]
    ds_read_b64_tr_b16 a[42:43], v135 offset:43008
    v_mfma_f32_16x16x32_bf16 v[28:31], a[76:79], a[8:11], v[28:31]
    ds_read_b64_tr_b16 a[44:45], v136 offset:40960
    v_mfma_f32_16x16x32_bf16 v[60:63], a[76:79], a[12:15], v[60:63]
    ds_read_b64_tr_b16 a[46:47], v136 offset:43008
    s_waitcnt lgkmcnt(8)
    v_mfma_f32_16x16x32_bf16 v[0:3], a[16:19], a[0:3], v[0:3]
    ds_read_b128 a[8:11], v141 offset:50176
    ds_read_b128 a[12:15], v141 offset:52224
    v_mfma_f32_16x16x32_bf16 v[32:35], a[16:19], a[4:7], v[32:35]
    ds_read_b64_tr_b16 a[48:49], v133 offset:36864
    v_mfma_f32_16x16x32_bf16 v[4:7], a[20:23], a[0:3], v[4:7]
    ds_read_b64_tr_b16 a[50:51], v133 offset:38912
    v_mfma_f32_16x16x32_bf16 v[36:39], a[20:23], a[4:7], v[36:39]
    ds_read_b64_tr_b16 a[52:53], v134 offset:36864
    v_mfma_f32_16x16x32_bf16 v[8:11], a[24:27], a[0:3], v[8:11]
    ds_read_b64_tr_b16 a[54:55], v134 offset:38912
    v_mfma_f32_16x16x32_bf16 v[40:43], a[24:27], a[4:7], v[40:43]
    ds_read_b64_tr_b16 a[56:57], v135 offset:36864
    v_mfma_f32_16x16x32_bf16 v[12:15], a[28:31], a[0:3], v[12:15]
    ds_read_b64_tr_b16 a[58:59], v135 offset:38912
    v_mfma_f32_16x16x32_bf16 v[44:47], a[28:31], a[4:7], v[44:47]
    ds_read_b64_tr_b16 a[60:61], v136 offset:36864
    s_waitcnt lgkmcnt(9)
    v_mfma_f32_16x16x32_bf16 v[16:19], a[32:35], a[0:3], v[16:19]
    ds_read_b64_tr_b16 a[62:63], v136 offset:38912
    ds_read_b64_tr_b16 a[64:65], v133 offset:45056
    v_mfma_f32_16x16x32_bf16 v[48:51], a[32:35], a[4:7], v[48:51]
    ds_read_b64_tr_b16 a[66:67], v133 offset:47104
    v_mfma_f32_16x16x32_bf16 v[20:23], a[36:39], a[0:3], v[20:23]
    ds_read_b64_tr_b16 a[68:69], v134 offset:45056
    v_mfma_f32_16x16x32_bf16 v[52:55], a[36:39], a[4:7], v[52:55]
    ds_read_b64_tr_b16 a[70:71], v134 offset:47104
    v_mfma_f32_16x16x32_bf16 v[24:27], a[40:43], a[0:3], v[24:27]
    ds_read_b64_tr_b16 a[72:73], v135 offset:45056
    v_mfma_f32_16x16x32_bf16 v[56:59], a[40:43], a[4:7], v[56:59]
    ds_read_b64_tr_b16 a[74:75], v135 offset:47104
    v_mfma_f32_16x16x32_bf16 v[28:31], a[44:47], a[0:3], v[28:31]
    ds_read_b64_tr_b16 a[76:77], v136 offset:45056
    v_mfma_f32_16x16x32_bf16 v[60:63], a[44:47], a[4:7], v[60:63]
    ds_read_b64_tr_b16 a[78:79], v136 offset:47104
    s_barrier
    s_waitcnt lgkmcnt(8)
    v_mfma_f32_16x16x32_bf16 v[0:3], a[48:51], a[8:11], v[0:3]
    ds_read_b128 a[0:3], v141 offset:0
    ds_read_b128 a[4:7], v141 offset:2048
    v_mfma_f32_16x16x32_bf16 v[32:35], a[48:51], a[12:15], v[32:35]
    ds_read_b64_tr_b16 a[16:17], v133 offset:49152
    v_mfma_f32_16x16x32_bf16 v[4:7], a[52:55], a[8:11], v[4:7]
    ds_read_b64_tr_b16 a[18:19], v133 offset:51200
    v_mfma_f32_16x16x32_bf16 v[36:39], a[52:55], a[12:15], v[36:39]
    ds_read_b64_tr_b16 a[20:21], v134 offset:49152
    v_mfma_f32_16x16x32_bf16 v[8:11], a[56:59], a[8:11], v[8:11]
    ds_read_b64_tr_b16 a[22:23], v134 offset:51200
    v_mfma_f32_16x16x32_bf16 v[40:43], a[56:59], a[12:15], v[40:43]
    ds_read_b64_tr_b16 a[24:25], v135 offset:49152
    v_mfma_f32_16x16x32_bf16 v[12:15], a[60:63], a[8:11], v[12:15]
    ds_read_b64_tr_b16 a[26:27], v135 offset:51200
    v_mfma_f32_16x16x32_bf16 v[44:47], a[60:63], a[12:15], v[44:47]
    ds_read_b64_tr_b16 a[28:29], v136 offset:49152
    s_waitcnt lgkmcnt(9)
    v_mfma_f32_16x16x32_bf16 v[16:19], a[64:67], a[8:11], v[16:19]
    ds_read_b64_tr_b16 a[30:31], v136 offset:51200
    ds_read_b64_tr_b16 a[32:33], v133 offset:57344
    v_mfma_f32_16x16x32_bf16 v[48:51], a[64:67], a[12:15], v[48:51]
    ds_read_b64_tr_b16 a[34:35], v133 offset:59392
    v_mfma_f32_16x16x32_bf16 v[20:23], a[68:71], a[8:11], v[20:23]
    ds_read_b64_tr_b16 a[36:37], v134 offset:57344
    v_mfma_f32_16x16x32_bf16 v[52:55], a[68:71], a[12:15], v[52:55]
    ds_read_b64_tr_b16 a[38:39], v134 offset:59392
    v_mfma_f32_16x16x32_bf16 v[24:27], a[72:75], a[8:11], v[24:27]
    ds_read_b64_tr_b16 a[40:41], v135 offset:57344
    v_mfma_f32_16x16x32_bf16 v[56:59], a[72:75], a[12:15], v[56:59]
    ds_read_b64_tr_b16 a[42:43], v135 offset:59392
    v_mfma_f32_16x16x32_bf16 v[28:31], a[76:79], a[8:11], v[28:31]
    ds_read_b64_tr_b16 a[44:45], v136 offset:57344
    v_mfma_f32_16x16x32_bf16 v[60:63], a[76:79], a[12:15], v[60:63]
    ds_read_b64_tr_b16 a[46:47], v136 offset:59392
    s_waitcnt lgkmcnt(8)
    v_mfma_f32_16x16x32_bf16 v[0:3], a[16:19], a[0:3], v[0:3]
    ds_read_b64 a[8:9], v96 offset:1024
    ds_read_b64 a[10:11], v96 offset:1536
    v_mfma_f32_16x16x32_bf16 v[32:35], a[16:19], a[4:7], v[32:35]
    ds_read_b64 a[12:13], v96 offset:3072
    v_mfma_f32_16x16x32_bf16 v[4:7], a[20:23], a[0:3], v[4:7]
    ds_read_b64 a[14:15], v96 offset:3584
    v_mfma_f32_16x16x32_bf16 v[36:39], a[20:23], a[4:7], v[36:39]
    ds_read_b64_tr_b16 a[48:49], v133 offset:53248
    v_mfma_f32_16x16x32_bf16 v[8:11], a[24:27], a[0:3], v[8:11]
    ds_read_b64_tr_b16 a[50:51], v133 offset:55296
    ds_read_b64_tr_b16 a[52:53], v134 offset:53248
    v_mfma_f32_16x16x32_bf16 v[40:43], a[24:27], a[4:7], v[40:43]
    ds_read_b64_tr_b16 a[54:55], v134 offset:55296
    v_mfma_f32_16x16x32_bf16 v[12:15], a[28:31], a[0:3], v[12:15]
    ds_read_b64_tr_b16 a[56:57], v135 offset:53248
    v_mfma_f32_16x16x32_bf16 v[44:47], a[28:31], a[4:7], v[44:47]
    ds_read_b64_tr_b16 a[58:59], v135 offset:55296
    s_waitcnt lgkmcnt(10)
    v_mfma_f32_16x16x32_bf16 v[16:19], a[32:35], a[0:3], v[16:19]
    ds_read_b64_tr_b16 a[60:61], v136 offset:53248
    ds_read_b64_tr_b16 a[62:63], v136 offset:55296
    v_mfma_f32_16x16x32_bf16 v[48:51], a[32:35], a[4:7], v[48:51]
    ds_read_b64_tr_b16 a[64:65], v133 offset:61440
    v_mfma_f32_16x16x32_bf16 v[20:23], a[36:39], a[0:3], v[20:23]
    ds_read_b64_tr_b16 a[66:67], v133 offset:63488
    v_mfma_f32_16x16x32_bf16 v[52:55], a[36:39], a[4:7], v[52:55]
    ds_read_b64_tr_b16 a[68:69], v134 offset:61440
    v_mfma_f32_16x16x32_bf16 v[24:27], a[40:43], a[0:3], v[24:27]
    ds_read_b64_tr_b16 a[70:71], v134 offset:63488
    ds_read_b64_tr_b16 a[72:73], v135 offset:61440
    v_mfma_f32_16x16x32_bf16 v[56:59], a[40:43], a[4:7], v[56:59]
    ds_read_b64_tr_b16 a[74:75], v135 offset:63488
    v_mfma_f32_16x16x32_bf16 v[28:31], a[44:47], a[0:3], v[28:31]
    ds_read_b64_tr_b16 a[76:77], v136 offset:61440
    v_mfma_f32_16x16x32_bf16 v[60:63], a[44:47], a[4:7], v[60:63]
    ds_read_b64_tr_b16 a[78:79], v136 offset:63488
    s_barrier
    s_waitcnt lgkmcnt(8)
    v_mfma_f32_16x16x32_bf16 v[0:3], a[48:51], a[8:11], v[0:3]
    ds_read_b128 a[0:3], v141 offset:16384
    ds_read_b128 a[4:7], v141 offset:18432
    v_mfma_f32_16x16x32_bf16 v[32:35], a[48:51], a[12:15], v[32:35]
    ds_read_b64_tr_b16 a[16:17], v137 offset:0
    v_mfma_f32_16x16x32_bf16 v[4:7], a[52:55], a[8:11], v[4:7]
    ds_read_b64_tr_b16 a[18:19], v137 offset:2048
    v_mfma_f32_16x16x32_bf16 v[36:39], a[52:55], a[12:15], v[36:39]
    ds_read_b64_tr_b16 a[20:21], v138 offset:0
    v_mfma_f32_16x16x32_bf16 v[8:11], a[56:59], a[8:11], v[8:11]
    ds_read_b64_tr_b16 a[22:23], v138 offset:2048
    v_mfma_f32_16x16x32_bf16 v[40:43], a[56:59], a[12:15], v[40:43]
    ds_read_b64_tr_b16 a[24:25], v139 offset:0
    v_mfma_f32_16x16x32_bf16 v[12:15], a[60:63], a[8:11], v[12:15]
    ds_read_b64_tr_b16 a[26:27], v139 offset:2048
    v_mfma_f32_16x16x32_bf16 v[44:47], a[60:63], a[12:15], v[44:47]
    ds_read_b64_tr_b16 a[28:29], v140 offset:0
    s_waitcnt lgkmcnt(9)
    v_mfma_f32_16x16x32_bf16 v[16:19], a[64:67], a[8:11], v[16:19]
    ds_read_b64_tr_b16 a[30:31], v140 offset:2048
    ds_read_b64_tr_b16 a[32:33], v137 offset:8192
    v_mfma_f32_16x16x32_bf16 v[48:51], a[64:67], a[12:15], v[48:51]
    ds_read_b64_tr_b16 a[34:35], v137 offset:10240
    v_mfma_f32_16x16x32_bf16 v[20:23], a[68:71], a[8:11], v[20:23]
    ds_read_b64_tr_b16 a[36:37], v138 offset:8192
    v_mfma_f32_16x16x32_bf16 v[52:55], a[68:71], a[12:15], v[52:55]
    ds_read_b64_tr_b16 a[38:39], v138 offset:10240
    v_mfma_f32_16x16x32_bf16 v[24:27], a[72:75], a[8:11], v[24:27]
    ds_read_b64_tr_b16 a[40:41], v139 offset:8192
    v_mfma_f32_16x16x32_bf16 v[56:59], a[72:75], a[12:15], v[56:59]
    ds_read_b64_tr_b16 a[42:43], v139 offset:10240
    v_mfma_f32_16x16x32_bf16 v[28:31], a[76:79], a[8:11], v[28:31]
    ds_read_b64_tr_b16 a[44:45], v140 offset:8192
    v_mfma_f32_16x16x32_bf16 v[60:63], a[76:79], a[12:15], v[60:63]
    ds_read_b64_tr_b16 a[46:47], v140 offset:10240
    s_waitcnt lgkmcnt(8)
    v_mfma_f32_16x16x32_bf16 v[0:3], a[16:19], a[0:3], v[0:3]
    ds_read_b128 a[8:11], v141 offset:17408
    ds_read_b128 a[12:15], v141 offset:19456
    v_mfma_f32_16x16x32_bf16 v[32:35], a[16:19], a[4:7], v[32:35]
    ds_read_b64_tr_b16 a[48:49], v137 offset:4096
    v_mfma_f32_16x16x32_bf16 v[4:7], a[20:23], a[0:3], v[4:7]
    ds_read_b64_tr_b16 a[50:51], v137 offset:6144
    v_mfma_f32_16x16x32_bf16 v[36:39], a[20:23], a[4:7], v[36:39]
    ds_read_b64_tr_b16 a[52:53], v138 offset:4096
    v_mfma_f32_16x16x32_bf16 v[8:11], a[24:27], a[0:3], v[8:11]
    ds_read_b64_tr_b16 a[54:55], v138 offset:6144
    v_mfma_f32_16x16x32_bf16 v[40:43], a[24:27], a[4:7], v[40:43]
    ds_read_b64_tr_b16 a[56:57], v139 offset:4096
    v_mfma_f32_16x16x32_bf16 v[12:15], a[28:31], a[0:3], v[12:15]
    ds_read_b64_tr_b16 a[58:59], v139 offset:6144
    v_mfma_f32_16x16x32_bf16 v[44:47], a[28:31], a[4:7], v[44:47]
    ds_read_b64_tr_b16 a[60:61], v140 offset:4096
    s_waitcnt lgkmcnt(9)
    v_mfma_f32_16x16x32_bf16 v[16:19], a[32:35], a[0:3], v[16:19]
    ds_read_b64_tr_b16 a[62:63], v140 offset:6144
    ds_read_b64_tr_b16 a[64:65], v137 offset:12288
    v_mfma_f32_16x16x32_bf16 v[48:51], a[32:35], a[4:7], v[48:51]
    ds_read_b64_tr_b16 a[66:67], v137 offset:14336
    v_mfma_f32_16x16x32_bf16 v[20:23], a[36:39], a[0:3], v[20:23]
    ds_read_b64_tr_b16 a[68:69], v138 offset:12288
    v_mfma_f32_16x16x32_bf16 v[52:55], a[36:39], a[4:7], v[52:55]
    ds_read_b64_tr_b16 a[70:71], v138 offset:14336
    v_mfma_f32_16x16x32_bf16 v[24:27], a[40:43], a[0:3], v[24:27]
    ds_read_b64_tr_b16 a[72:73], v139 offset:12288
    v_mfma_f32_16x16x32_bf16 v[56:59], a[40:43], a[4:7], v[56:59]
    ds_read_b64_tr_b16 a[74:75], v139 offset:14336
    v_mfma_f32_16x16x32_bf16 v[28:31], a[44:47], a[0:3], v[28:31]
    ds_read_b64_tr_b16 a[76:77], v140 offset:12288
    v_mfma_f32_16x16x32_bf16 v[60:63], a[44:47], a[4:7], v[60:63]
    ds_read_b64_tr_b16 a[78:79], v140 offset:14336
    s_waitcnt lgkmcnt(8)
    v_mfma_f32_16x16x32_bf16 v[0:3], a[48:51], a[8:11], v[0:3]
    v_mfma_f32_16x16x32_bf16 v[32:35], a[48:51], a[12:15], v[32:35]
    v_mfma_f32_16x16x32_bf16 v[4:7], a[52:55], a[8:11], v[4:7]
    v_mfma_f32_16x16x32_bf16 v[36:39], a[52:55], a[12:15], v[36:39]
    v_mfma_f32_16x16x32_bf16 v[8:11], a[56:59], a[8:11], v[8:11]
    v_mfma_f32_16x16x32_bf16 v[40:43], a[56:59], a[12:15], v[40:43]
    v_mfma_f32_16x16x32_bf16 v[12:15], a[60:63], a[8:11], v[12:15]
    v_mfma_f32_16x16x32_bf16 v[44:47], a[60:63], a[12:15], v[44:47]
    s_waitcnt lgkmcnt(0)
    v_mfma_f32_16x16x32_bf16 v[16:19], a[64:67], a[8:11], v[16:19]
    v_mfma_f32_16x16x32_bf16 v[48:51], a[64:67], a[12:15], v[48:51]
    v_mfma_f32_16x16x32_bf16 v[20:23], a[68:71], a[8:11], v[20:23]
    v_mfma_f32_16x16x32_bf16 v[52:55], a[68:71], a[12:15], v[52:55]
    v_mfma_f32_16x16x32_bf16 v[24:27], a[72:75], a[8:11], v[24:27]
    v_mfma_f32_16x16x32_bf16 v[56:59], a[72:75], a[12:15], v[56:59]
    v_mfma_f32_16x16x32_bf16 v[28:31], a[76:79], a[8:11], v[28:31]
    v_mfma_f32_16x16x32_bf16 v[60:63], a[76:79], a[12:15], v[60:63]
    s_waitcnt vmcnt(0)
    s_barrier
    ds_read_b128 v[64:67], v97 offset:0
    ds_read_b128 v[68:71], v97 offset:64
    ds_read_b128 v[72:75], v97 offset:128
    ds_read_b128 v[76:79], v97 offset:192
    ds_read_b128 v[80:83], v97 offset:256
    ds_read_b128 v[84:87], v97 offset:320
    ds_read_b128 v[88:91], v97 offset:384
    ds_read_b128 v[92:95], v97 offset:448
    v_add_f32 v112, v112, v116
    v_add_f32 v113, v113, v117
    v_add_f32 v114, v114, v118
    v_add_f32 v120, v120, v124
    v_add_f32 v121, v121, v125
    v_add_f32 v122, v122, v126
    v_mov_b32 v116, v112
    v_mov_b32 v117, v113
    v_mov_b32 v118, v114
    v_mov_b32 v124, v120
    v_mov_b32 v125, v121
    v_mov_b32 v126, v122
    v_permlane16_swap_b32 v112, v116
    v_permlane16_swap_b32 v113, v117
    v_permlane16_swap_b32 v114, v118
    v_permlane16_swap_b32 v120, v124
    v_permlane16_swap_b32 v121, v125
    v_permlane16_swap_b32 v122, v126
    v_add_f32 v112, v112, v116
    v_add_f32 v113, v113, v117
    v_add_f32 v114, v114, v118
    v_add_f32 v120, v120, v124
    v_add_f32 v121, v121, v125
    v_add_f32 v122, v122, v126
    v_mov_b32 v116, v112
    v_mov_b32 v117, v113
    v_mov_b32 v118, v114
    v_mov_b32 v124, v120
    v_mov_b32 v125, v121
    v_mov_b32 v126, v122
    v_permlane32_swap_b32 v112, v116
    v_permlane32_swap_b32 v113, v117
    v_permlane32_swap_b32 v114, v118
    v_permlane32_swap_b32 v120, v124
    v_permlane32_swap_b32 v121, v125
    v_permlane32_swap_b32 v122, v126
    v_add_f32 v112, v112, v116
    v_add_f32 v113, v113, v117
    v_add_f32 v114, v114, v118
    v_add_f32 v120, v120, v124
    v_add_f32 v121, v121, v125
    v_add_f32 v122, v122, v126
    v_mul_f32 v96, 986500301, v112
    v_mul_f32 v113, 986500301, v113
    v_fma_f32 v113, -v96, v96, v113
    v_max_f32 v113, 0, v113
    v_add_f32 v113, 925353388, v113
    v_rsq_f32 v98, v113
    s_nop 0
    v_mul_f32 v97, v113, v98
    v_mul_f32 v99, v98, v98
    v_mul_f32 v99, v99, v98
    v_mul_f32 v99, 3184710632, v99
    v_mul_f32 v98, 3222493025, v98
    v_mul_f32 v100, 986500301, v120
    v_mul_f32 v121, 986500301, v121
    v_fma_f32 v121, -v100, v100, v121
    v_max_f32 v121, 0, v121
    v_add_f32 v121, 925353388, v121
    v_rsq_f32 v102, v121
    s_nop 0
    v_mul_f32 v101, v121, v102
    v_mul_f32 v103, v102, v102
    v_mul_f32 v103, v103, v102
    v_mul_f32 v103, 3184710632, v103
    v_mul_f32 v102, 3222493025, v102
    v_and_b32 v115, 31, v128
    v_cmp_gt_u32 vcc, 16, v115
    s_nop 1
    v_cndmask_b32 v114, v122, v114, vcc
    v_cvt_pk_bf16_f32 v114, v114, v114
    v_and_b32 v114, s72, v114
    v_mul_f32 v114, 3216550459, v114
    v_exp_f32 v114, v114
    v_lshlrev_b32 v115, 2, v115
    v_add_f32 v114, 1.0, v114
    v_rcp_f32 v114, v114
    s_nop 0
    buffer_store_dword v114, v115, s[52:55], s87 offen sc1
    s_waitcnt lgkmcnt(0)
    v_pk_fma_f32 v[0:1], v[64:65], v[96:97], v[0:1] op_sel:[0,0,0] op_sel_hi:[1,0,1] neg_lo:[1,0,0] neg_hi:[1,0,0]
    v_pk_fma_f32 v[2:3], v[66:67], v[96:97], v[2:3] op_sel:[0,0,0] op_sel_hi:[1,0,1] neg_lo:[1,0,0] neg_hi:[1,0,0]
    v_pk_fma_f32 v[4:5], v[68:69], v[96:97], v[4:5] op_sel:[0,0,0] op_sel_hi:[1,0,1] neg_lo:[1,0,0] neg_hi:[1,0,0]
    v_pk_fma_f32 v[6:7], v[70:71], v[96:97], v[6:7] op_sel:[0,0,0] op_sel_hi:[1,0,1] neg_lo:[1,0,0] neg_hi:[1,0,0]
    v_pk_mul_f32 v[104:105], v[0:1], v[0:1]
    v_pk_mul_f32 v[106:107], v[2:3], v[2:3]
    v_pk_mul_f32 v[108:109], v[4:5], v[4:5]
    v_pk_mul_f32 v[110:111], v[6:7], v[6:7]
    v_pk_fma_f32 v[104:105], v[104:105], v[98:99], v[98:99] op_sel:[0,1,0] op_sel_hi:[1,1,0]
    v_pk_fma_f32 v[106:107], v[106:107], v[98:99], v[98:99] op_sel:[0,1,0] op_sel_hi:[1,1,0]
    v_pk_fma_f32 v[108:109], v[108:109], v[98:99], v[98:99] op_sel:[0,1,0] op_sel_hi:[1,1,0]
    v_pk_fma_f32 v[110:111], v[110:111], v[98:99], v[98:99] op_sel:[0,1,0] op_sel_hi:[1,1,0]
    v_pk_mul_f32 v[104:105], v[104:105], v[0:1]
    v_pk_mul_f32 v[106:107], v[106:107], v[2:3]
    v_pk_mul_f32 v[108:109], v[108:109], v[4:5]
    v_pk_mul_f32 v[110:111], v[110:111], v[6:7]
    v_exp_f32 v104, v104
    v_exp_f32 v105, v105
    v_exp_f32 v106, v106
    v_exp_f32 v107, v107
    v_exp_f32 v108, v108
    v_exp_f32 v109, v109
    v_exp_f32 v110, v110
    v_exp_f32 v111, v111
    v_pk_fma_f32 v[104:105], v[104:105], v[96:97], v[96:97] op_sel:[0,1,1] op_sel_hi:[1,1,1]
    v_pk_fma_f32 v[106:107], v[106:107], v[96:97], v[96:97] op_sel:[0,1,1] op_sel_hi:[1,1,1]
    v_pk_fma_f32 v[108:109], v[108:109], v[96:97], v[96:97] op_sel:[0,1,1] op_sel_hi:[1,1,1]
    v_pk_fma_f32 v[110:111], v[110:111], v[96:97], v[96:97] op_sel:[0,1,1] op_sel_hi:[1,1,1]
    v_rcp_f32 v104, v104
    v_rcp_f32 v105, v105
    v_rcp_f32 v106, v106
    v_rcp_f32 v107, v107
    v_rcp_f32 v108, v108
    v_rcp_f32 v109, v109
    v_rcp_f32 v110, v110
    v_rcp_f32 v111, v111
    v_pk_mul_f32 v[104:105], v[104:105], v[0:1]
    v_pk_mul_f32 v[106:107], v[106:107], v[2:3]
    v_pk_mul_f32 v[108:109], v[108:109], v[4:5]
    v_pk_mul_f32 v[110:111], v[110:111], v[6:7]
    v_cvt_pk_bf16_f32 v0, v104, v105
    v_cvt_pk_bf16_f32 v1, v106, v107
    v_cvt_pk_bf16_f32 v2, v108, v109
    v_cvt_pk_bf16_f32 v3, v110, v111
    buffer_store_dwordx4 v[0:3], v143, s[52:55], s84 offen offset:0 sc1
    v_pk_fma_f32 v[8:9], v[72:73], v[96:97], v[8:9] op_sel:[0,0,0] op_sel_hi:[1,0,1] neg_lo:[1,0,0] neg_hi:[1,0,0]
    v_pk_fma_f32 v[10:11], v[74:75], v[96:97], v[10:11] op_sel:[0,0,0] op_sel_hi:[1,0,1] neg_lo:[1,0,0] neg_hi:[1,0,0]
    v_pk_fma_f32 v[12:13], v[76:77], v[96:97], v[12:13] op_sel:[0,0,0] op_sel_hi:[1,0,1] neg_lo:[1,0,0] neg_hi:[1,0,0]
    v_pk_fma_f32 v[14:15], v[78:79], v[96:97], v[14:15] op_sel:[0,0,0] op_sel_hi:[1,0,1] neg_lo:[1,0,0] neg_hi:[1,0,0]
    v_pk_mul_f32 v[104:105], v[8:9], v[8:9]
    v_pk_mul_f32 v[106:107], v[10:11], v[10:11]
    v_pk_mul_f32 v[108:109], v[12:13], v[12:13]
    v_pk_mul_f32 v[110:111], v[14:15], v[14:15]
    v_pk_fma_f32 v[104:105], v[104:105], v[98:99], v[98:99] op_sel:[0,1,0] op_sel_hi:[1,1,0]
    v_pk_fma_f32 v[106:107], v[106:107], v[98:99], v[98:99] op_sel:[0,1,0] op_sel_hi:[1,1,0]
    v_pk_fma_f32 v[108:109], v[108:109], v[98:99], v[98:99] op_sel:[0,1,0] op_sel_hi:[1,1,0]
    v_pk_fma_f32 v[110:111], v[110:111], v[98:99], v[98:99] op_sel:[0,1,0] op_sel_hi:[1,1,0]
    v_pk_mul_f32 v[104:105], v[104:105], v[8:9]
    v_pk_mul_f32 v[106:107], v[106:107], v[10:11]
    v_pk_mul_f32 v[108:109], v[108:109], v[12:13]
    v_pk_mul_f32 v[110:111], v[110:111], v[14:15]
    v_exp_f32 v104, v104
    v_exp_f32 v105, v105
    v_exp_f32 v106, v106
    v_exp_f32 v107, v107
    v_exp_f32 v108, v108
    v_exp_f32 v109, v109
    v_exp_f32 v110, v110
    v_exp_f32 v111, v111
    v_pk_fma_f32 v[104:105], v[104:105], v[96:97], v[96:97] op_sel:[0,1,1] op_sel_hi:[1,1,1]
    v_pk_fma_f32 v[106:107], v[106:107], v[96:97], v[96:97] op_sel:[0,1,1] op_sel_hi:[1,1,1]
    v_pk_fma_f32 v[108:109], v[108:109], v[96:97], v[96:97] op_sel:[0,1,1] op_sel_hi:[1,1,1]
    v_pk_fma_f32 v[110:111], v[110:111], v[96:97], v[96:97] op_sel:[0,1,1] op_sel_hi:[1,1,1]
    v_rcp_f32 v104, v104
    v_rcp_f32 v105, v105
    v_rcp_f32 v106, v106
    v_rcp_f32 v107, v107
    v_rcp_f32 v108, v108
    v_rcp_f32 v109, v109
    v_rcp_f32 v110, v110
    v_rcp_f32 v111, v111
    v_pk_mul_f32 v[104:105], v[104:105], v[8:9]
    v_pk_mul_f32 v[106:107], v[106:107], v[10:11]
    v_pk_mul_f32 v[108:109], v[108:109], v[12:13]
    v_pk_mul_f32 v[110:111], v[110:111], v[14:15]
    v_cvt_pk_bf16_f32 v8, v104, v105
    v_cvt_pk_bf16_f32 v9, v106, v107
    v_cvt_pk_bf16_f32 v10, v108, v109
    v_cvt_pk_bf16_f32 v11, v110, v111
    buffer_store_dwordx4 v[8:11], v143, s[52:55], s84 offen offset:1024 sc1
    v_pk_fma_f32 v[16:17], v[80:81], v[96:97], v[16:17] op_sel:[0,0,0] op_sel_hi:[1,0,1] neg_lo:[1,0,0] neg_hi:[1,0,0]
    v_pk_fma_f32 v[18:19], v[82:83], v[96:97], v[18:19] op_sel:[0,0,0] op_sel_hi:[1,0,1] neg_lo:[1,0,0] neg_hi:[1,0,0]
    v_pk_fma_f32 v[20:21], v[84:85], v[96:97], v[20:21] op_sel:[0,0,0] op_sel_hi:[1,0,1] neg_lo:[1,0,0] neg_hi:[1,0,0]
    v_pk_fma_f32 v[22:23], v[86:87], v[96:97], v[22:23] op_sel:[0,0,0] op_sel_hi:[1,0,1] neg_lo:[1,0,0] neg_hi:[1,0,0]
    v_pk_mul_f32 v[104:105], v[16:17], v[16:17]
    v_pk_mul_f32 v[106:107], v[18:19], v[18:19]
    v_pk_mul_f32 v[108:109], v[20:21], v[20:21]
    v_pk_mul_f32 v[110:111], v[22:23], v[22:23]
    v_pk_fma_f32 v[104:105], v[104:105], v[98:99], v[98:99] op_sel:[0,1,0] op_sel_hi:[1,1,0]
    v_pk_fma_f32 v[106:107], v[106:107], v[98:99], v[98:99] op_sel:[0,1,0] op_sel_hi:[1,1,0]
    v_pk_fma_f32 v[108:109], v[108:109], v[98:99], v[98:99] op_sel:[0,1,0] op_sel_hi:[1,1,0]
    v_pk_fma_f32 v[110:111], v[110:111], v[98:99], v[98:99] op_sel:[0,1,0] op_sel_hi:[1,1,0]
    v_pk_mul_f32 v[104:105], v[104:105], v[16:17]
    v_pk_mul_f32 v[106:107], v[106:107], v[18:19]
    v_pk_mul_f32 v[108:109], v[108:109], v[20:21]
    v_pk_mul_f32 v[110:111], v[110:111], v[22:23]
    v_exp_f32 v104, v104
    v_exp_f32 v105, v105
    v_exp_f32 v106, v106
    v_exp_f32 v107, v107
    v_exp_f32 v108, v108
    v_exp_f32 v109, v109
    v_exp_f32 v110, v110
    v_exp_f32 v111, v111
    v_pk_fma_f32 v[104:105], v[104:105], v[96:97], v[96:97] op_sel:[0,1,1] op_sel_hi:[1,1,1]
    v_pk_fma_f32 v[106:107], v[106:107], v[96:97], v[96:97] op_sel:[0,1,1] op_sel_hi:[1,1,1]
    v_pk_fma_f32 v[108:109], v[108:109], v[96:97], v[96:97] op_sel:[0,1,1] op_sel_hi:[1,1,1]
    v_pk_fma_f32 v[110:111], v[110:111], v[96:97], v[96:97] op_sel:[0,1,1] op_sel_hi:[1,1,1]
    v_rcp_f32 v104, v104
    v_rcp_f32 v105, v105
    v_rcp_f32 v106, v106
    v_rcp_f32 v107, v107
    v_rcp_f32 v108, v108
    v_rcp_f32 v109, v109
    v_rcp_f32 v110, v110
    v_rcp_f32 v111, v111
    v_pk_mul_f32 v[104:105], v[104:105], v[16:17]
    v_pk_mul_f32 v[106:107], v[106:107], v[18:19]
    v_pk_mul_f32 v[108:109], v[108:109], v[20:21]
    v_pk_mul_f32 v[110:111], v[110:111], v[22:23]
    v_cvt_pk_bf16_f32 v16, v104, v105
    v_cvt_pk_bf16_f32 v17, v106, v107
    v_cvt_pk_bf16_f32 v18, v108, v109
    v_cvt_pk_bf16_f32 v19, v110, v111
    buffer_store_dwordx4 v[16:19], v143, s[52:55], s84 offen offset:2048 sc1
    v_pk_fma_f32 v[24:25], v[88:89], v[96:97], v[24:25] op_sel:[0,0,0] op_sel_hi:[1,0,1] neg_lo:[1,0,0] neg_hi:[1,0,0]
    v_pk_fma_f32 v[26:27], v[90:91], v[96:97], v[26:27] op_sel:[0,0,0] op_sel_hi:[1,0,1] neg_lo:[1,0,0] neg_hi:[1,0,0]
    v_pk_fma_f32 v[28:29], v[92:93], v[96:97], v[28:29] op_sel:[0,0,0] op_sel_hi:[1,0,1] neg_lo:[1,0,0] neg_hi:[1,0,0]
    v_pk_fma_f32 v[30:31], v[94:95], v[96:97], v[30:31] op_sel:[0,0,0] op_sel_hi:[1,0,1] neg_lo:[1,0,0] neg_hi:[1,0,0]
    v_pk_mul_f32 v[104:105], v[24:25], v[24:25]
    v_pk_mul_f32 v[106:107], v[26:27], v[26:27]
    v_pk_mul_f32 v[108:109], v[28:29], v[28:29]
    v_pk_mul_f32 v[110:111], v[30:31], v[30:31]
    v_pk_fma_f32 v[104:105], v[104:105], v[98:99], v[98:99] op_sel:[0,1,0] op_sel_hi:[1,1,0]
    v_pk_fma_f32 v[106:107], v[106:107], v[98:99], v[98:99] op_sel:[0,1,0] op_sel_hi:[1,1,0]
    v_pk_fma_f32 v[108:109], v[108:109], v[98:99], v[98:99] op_sel:[0,1,0] op_sel_hi:[1,1,0]
    v_pk_fma_f32 v[110:111], v[110:111], v[98:99], v[98:99] op_sel:[0,1,0] op_sel_hi:[1,1,0]
    v_pk_mul_f32 v[104:105], v[104:105], v[24:25]
    v_pk_mul_f32 v[106:107], v[106:107], v[26:27]
    v_pk_mul_f32 v[108:109], v[108:109], v[28:29]
    v_pk_mul_f32 v[110:111], v[110:111], v[30:31]
    v_exp_f32 v104, v104
    v_exp_f32 v105, v105
    v_exp_f32 v106, v106
    v_exp_f32 v107, v107
    v_exp_f32 v108, v108
    v_exp_f32 v109, v109
    v_exp_f32 v110, v110
    v_exp_f32 v111, v111
    v_pk_fma_f32 v[104:105], v[104:105], v[96:97], v[96:97] op_sel:[0,1,1] op_sel_hi:[1,1,1]
    v_pk_fma_f32 v[106:107], v[106:107], v[96:97], v[96:97] op_sel:[0,1,1] op_sel_hi:[1,1,1]
    v_pk_fma_f32 v[108:109], v[108:109], v[96:97], v[96:97] op_sel:[0,1,1] op_sel_hi:[1,1,1]
    v_pk_fma_f32 v[110:111], v[110:111], v[96:97], v[96:97] op_sel:[0,1,1] op_sel_hi:[1,1,1]
    v_rcp_f32 v104, v104
    v_rcp_f32 v105, v105
    v_rcp_f32 v106, v106
    v_rcp_f32 v107, v107
    v_rcp_f32 v108, v108
    v_rcp_f32 v109, v109
    v_rcp_f32 v110, v110
    v_rcp_f32 v111, v111
    v_pk_mul_f32 v[104:105], v[104:105], v[24:25]
    v_pk_mul_f32 v[106:107], v[106:107], v[26:27]
    v_pk_mul_f32 v[108:109], v[108:109], v[28:29]
    v_pk_mul_f32 v[110:111], v[110:111], v[30:31]
    v_cvt_pk_bf16_f32 v24, v104, v105
    v_cvt_pk_bf16_f32 v25, v106, v107
    v_cvt_pk_bf16_f32 v26, v108, v109
    v_cvt_pk_bf16_f32 v27, v110, v111
    buffer_store_dwordx4 v[24:27], v143, s[52:55], s84 offen offset:3072 sc1
    v_pk_fma_f32 v[32:33], v[64:65], v[100:101], v[32:33] op_sel:[0,0,0] op_sel_hi:[1,0,1] neg_lo:[1,0,0] neg_hi:[1,0,0]
    v_pk_fma_f32 v[34:35], v[66:67], v[100:101], v[34:35] op_sel:[0,0,0] op_sel_hi:[1,0,1] neg_lo:[1,0,0] neg_hi:[1,0,0]
    v_pk_fma_f32 v[36:37], v[68:69], v[100:101], v[36:37] op_sel:[0,0,0] op_sel_hi:[1,0,1] neg_lo:[1,0,0] neg_hi:[1,0,0]
    v_pk_fma_f32 v[38:39], v[70:71], v[100:101], v[38:39] op_sel:[0,0,0] op_sel_hi:[1,0,1] neg_lo:[1,0,0] neg_hi:[1,0,0]
    v_pk_mul_f32 v[104:105], v[32:33], v[32:33]
    v_pk_mul_f32 v[106:107], v[34:35], v[34:35]
    v_pk_mul_f32 v[108:109], v[36:37], v[36:37]
    v_pk_mul_f32 v[110:111], v[38:39], v[38:39]
    v_pk_fma_f32 v[104:105], v[104:105], v[102:103], v[102:103] op_sel:[0,1,0] op_sel_hi:[1,1,0]
    v_pk_fma_f32 v[106:107], v[106:107], v[102:103], v[102:103] op_sel:[0,1,0] op_sel_hi:[1,1,0]
    v_pk_fma_f32 v[108:109], v[108:109], v[102:103], v[102:103] op_sel:[0,1,0] op_sel_hi:[1,1,0]
    v_pk_fma_f32 v[110:111], v[110:111], v[102:103], v[102:103] op_sel:[0,1,0] op_sel_hi:[1,1,0]
    v_pk_mul_f32 v[104:105], v[104:105], v[32:33]
    v_pk_mul_f32 v[106:107], v[106:107], v[34:35]
    v_pk_mul_f32 v[108:109], v[108:109], v[36:37]
    v_pk_mul_f32 v[110:111], v[110:111], v[38:39]
    v_exp_f32 v104, v104
    v_exp_f32 v105, v105
    v_exp_f32 v106, v106
    v_exp_f32 v107, v107
    v_exp_f32 v108, v108
    v_exp_f32 v109, v109
    v_exp_f32 v110, v110
    v_exp_f32 v111, v111
    v_pk_fma_f32 v[104:105], v[104:105], v[100:101], v[100:101] op_sel:[0,1,1] op_sel_hi:[1,1,1]
    v_pk_fma_f32 v[106:107], v[106:107], v[100:101], v[100:101] op_sel:[0,1,1] op_sel_hi:[1,1,1]
    v_pk_fma_f32 v[108:109], v[108:109], v[100:101], v[100:101] op_sel:[0,1,1] op_sel_hi:[1,1,1]
    v_pk_fma_f32 v[110:111], v[110:111], v[100:101], v[100:101] op_sel:[0,1,1] op_sel_hi:[1,1,1]
    v_rcp_f32 v104, v104
    v_rcp_f32 v105, v105
    v_rcp_f32 v106, v106
    v_rcp_f32 v107, v107
    v_rcp_f32 v108, v108
    v_rcp_f32 v109, v109
    v_rcp_f32 v110, v110
    v_rcp_f32 v111, v111
    v_pk_mul_f32 v[104:105], v[104:105], v[32:33]
    v_pk_mul_f32 v[106:107], v[106:107], v[34:35]
    v_pk_mul_f32 v[108:109], v[108:109], v[36:37]
    v_pk_mul_f32 v[110:111], v[110:111], v[38:39]
    v_cvt_pk_bf16_f32 v32, v104, v105
    v_cvt_pk_bf16_f32 v33, v106, v107
    v_cvt_pk_bf16_f32 v34, v108, v109
    v_cvt_pk_bf16_f32 v35, v110, v111
    buffer_store_dwordx4 v[32:35], v143, s[52:55], s85 offen offset:0 sc1
    v_pk_fma_f32 v[40:41], v[72:73], v[100:101], v[40:41] op_sel:[0,0,0] op_sel_hi:[1,0,1] neg_lo:[1,0,0] neg_hi:[1,0,0]
    v_pk_fma_f32 v[42:43], v[74:75], v[100:101], v[42:43] op_sel:[0,0,0] op_sel_hi:[1,0,1] neg_lo:[1,0,0] neg_hi:[1,0,0]
    v_pk_fma_f32 v[44:45], v[76:77], v[100:101], v[44:45] op_sel:[0,0,0] op_sel_hi:[1,0,1] neg_lo:[1,0,0] neg_hi:[1,0,0]
    v_pk_fma_f32 v[46:47], v[78:79], v[100:101], v[46:47] op_sel:[0,0,0] op_sel_hi:[1,0,1] neg_lo:[1,0,0] neg_hi:[1,0,0]
    v_pk_mul_f32 v[104:105], v[40:41], v[40:41]
    v_pk_mul_f32 v[106:107], v[42:43], v[42:43]
    v_pk_mul_f32 v[108:109], v[44:45], v[44:45]
    v_pk_mul_f32 v[110:111], v[46:47], v[46:47]
    v_pk_fma_f32 v[104:105], v[104:105], v[102:103], v[102:103] op_sel:[0,1,0] op_sel_hi:[1,1,0]
    v_pk_fma_f32 v[106:107], v[106:107], v[102:103], v[102:103] op_sel:[0,1,0] op_sel_hi:[1,1,0]
    v_pk_fma_f32 v[108:109], v[108:109], v[102:103], v[102:103] op_sel:[0,1,0] op_sel_hi:[1,1,0]
    v_pk_fma_f32 v[110:111], v[110:111], v[102:103], v[102:103] op_sel:[0,1,0] op_sel_hi:[1,1,0]
    v_pk_mul_f32 v[104:105], v[104:105], v[40:41]
    v_pk_mul_f32 v[106:107], v[106:107], v[42:43]
    v_pk_mul_f32 v[108:109], v[108:109], v[44:45]
    v_pk_mul_f32 v[110:111], v[110:111], v[46:47]
    v_exp_f32 v104, v104
    v_exp_f32 v105, v105
    v_exp_f32 v106, v106
    v_exp_f32 v107, v107
    v_exp_f32 v108, v108
    v_exp_f32 v109, v109
    v_exp_f32 v110, v110
    v_exp_f32 v111, v111
    v_pk_fma_f32 v[104:105], v[104:105], v[100:101], v[100:101] op_sel:[0,1,1] op_sel_hi:[1,1,1]
    v_pk_fma_f32 v[106:107], v[106:107], v[100:101], v[100:101] op_sel:[0,1,1] op_sel_hi:[1,1,1]
    v_pk_fma_f32 v[108:109], v[108:109], v[100:101], v[100:101] op_sel:[0,1,1] op_sel_hi:[1,1,1]
    v_pk_fma_f32 v[110:111], v[110:111], v[100:101], v[100:101] op_sel:[0,1,1] op_sel_hi:[1,1,1]
    v_rcp_f32 v104, v104
    v_rcp_f32 v105, v105
    v_rcp_f32 v106, v106
    v_rcp_f32 v107, v107
    v_rcp_f32 v108, v108
    v_rcp_f32 v109, v109
    v_rcp_f32 v110, v110
    v_rcp_f32 v111, v111
    v_pk_mul_f32 v[104:105], v[104:105], v[40:41]
    v_pk_mul_f32 v[106:107], v[106:107], v[42:43]
    v_pk_mul_f32 v[108:109], v[108:109], v[44:45]
    v_pk_mul_f32 v[110:111], v[110:111], v[46:47]
    v_cvt_pk_bf16_f32 v40, v104, v105
    v_cvt_pk_bf16_f32 v41, v106, v107
    v_cvt_pk_bf16_f32 v42, v108, v109
    v_cvt_pk_bf16_f32 v43, v110, v111
    buffer_store_dwordx4 v[40:43], v143, s[52:55], s85 offen offset:1024 sc1
    v_pk_fma_f32 v[48:49], v[80:81], v[100:101], v[48:49] op_sel:[0,0,0] op_sel_hi:[1,0,1] neg_lo:[1,0,0] neg_hi:[1,0,0]
    v_pk_fma_f32 v[50:51], v[82:83], v[100:101], v[50:51] op_sel:[0,0,0] op_sel_hi:[1,0,1] neg_lo:[1,0,0] neg_hi:[1,0,0]
    v_pk_fma_f32 v[52:53], v[84:85], v[100:101], v[52:53] op_sel:[0,0,0] op_sel_hi:[1,0,1] neg_lo:[1,0,0] neg_hi:[1,0,0]
    v_pk_fma_f32 v[54:55], v[86:87], v[100:101], v[54:55] op_sel:[0,0,0] op_sel_hi:[1,0,1] neg_lo:[1,0,0] neg_hi:[1,0,0]
    v_pk_mul_f32 v[104:105], v[48:49], v[48:49]
    v_pk_mul_f32 v[106:107], v[50:51], v[50:51]
    v_pk_mul_f32 v[108:109], v[52:53], v[52:53]
    v_pk_mul_f32 v[110:111], v[54:55], v[54:55]
    v_pk_fma_f32 v[104:105], v[104:105], v[102:103], v[102:103] op_sel:[0,1,0] op_sel_hi:[1,1,0]
    v_pk_fma_f32 v[106:107], v[106:107], v[102:103], v[102:103] op_sel:[0,1,0] op_sel_hi:[1,1,0]
    v_pk_fma_f32 v[108:109], v[108:109], v[102:103], v[102:103] op_sel:[0,1,0] op_sel_hi:[1,1,0]
    v_pk_fma_f32 v[110:111], v[110:111], v[102:103], v[102:103] op_sel:[0,1,0] op_sel_hi:[1,1,0]
    v_pk_mul_f32 v[104:105], v[104:105], v[48:49]
    v_pk_mul_f32 v[106:107], v[106:107], v[50:51]
    v_pk_mul_f32 v[108:109], v[108:109], v[52:53]
    v_pk_mul_f32 v[110:111], v[110:111], v[54:55]
    v_exp_f32 v104, v104
    v_exp_f32 v105, v105
    v_exp_f32 v106, v106
    v_exp_f32 v107, v107
    v_exp_f32 v108, v108
    v_exp_f32 v109, v109
    v_exp_f32 v110, v110
    v_exp_f32 v111, v111
    v_pk_fma_f32 v[104:105], v[104:105], v[100:101], v[100:101] op_sel:[0,1,1] op_sel_hi:[1,1,1]
    v_pk_fma_f32 v[106:107], v[106:107], v[100:101], v[100:101] op_sel:[0,1,1] op_sel_hi:[1,1,1]
    v_pk_fma_f32 v[108:109], v[108:109], v[100:101], v[100:101] op_sel:[0,1,1] op_sel_hi:[1,1,1]
    v_pk_fma_f32 v[110:111], v[110:111], v[100:101], v[100:101] op_sel:[0,1,1] op_sel_hi:[1,1,1]
    v_rcp_f32 v104, v104
    v_rcp_f32 v105, v105
    v_rcp_f32 v106, v106
    v_rcp_f32 v107, v107
    v_rcp_f32 v108, v108
    v_rcp_f32 v109, v109
    v_rcp_f32 v110, v110
    v_rcp_f32 v111, v111
    v_pk_mul_f32 v[104:105], v[104:105], v[48:49]
    v_pk_mul_f32 v[106:107], v[106:107], v[50:51]
    v_pk_mul_f32 v[108:109], v[108:109], v[52:53]
    v_pk_mul_f32 v[110:111], v[110:111], v[54:55]
    v_cvt_pk_bf16_f32 v48, v104, v105
    v_cvt_pk_bf16_f32 v49, v106, v107
    v_cvt_pk_bf16_f32 v50, v108, v109
    v_cvt_pk_bf16_f32 v51, v110, v111
    buffer_store_dwordx4 v[48:51], v143, s[52:55], s85 offen offset:2048 sc1
    v_pk_fma_f32 v[56:57], v[88:89], v[100:101], v[56:57] op_sel:[0,0,0] op_sel_hi:[1,0,1] neg_lo:[1,0,0] neg_hi:[1,0,0]
    v_pk_fma_f32 v[58:59], v[90:91], v[100:101], v[58:59] op_sel:[0,0,0] op_sel_hi:[1,0,1] neg_lo:[1,0,0] neg_hi:[1,0,0]
    v_pk_fma_f32 v[60:61], v[92:93], v[100:101], v[60:61] op_sel:[0,0,0] op_sel_hi:[1,0,1] neg_lo:[1,0,0] neg_hi:[1,0,0]
    v_pk_fma_f32 v[62:63], v[94:95], v[100:101], v[62:63] op_sel:[0,0,0] op_sel_hi:[1,0,1] neg_lo:[1,0,0] neg_hi:[1,0,0]
    v_pk_mul_f32 v[104:105], v[56:57], v[56:57]
    v_pk_mul_f32 v[106:107], v[58:59], v[58:59]
    v_pk_mul_f32 v[108:109], v[60:61], v[60:61]
    v_pk_mul_f32 v[110:111], v[62:63], v[62:63]
    v_pk_fma_f32 v[104:105], v[104:105], v[102:103], v[102:103] op_sel:[0,1,0] op_sel_hi:[1,1,0]
    v_pk_fma_f32 v[106:107], v[106:107], v[102:103], v[102:103] op_sel:[0,1,0] op_sel_hi:[1,1,0]
    v_pk_fma_f32 v[108:109], v[108:109], v[102:103], v[102:103] op_sel:[0,1,0] op_sel_hi:[1,1,0]
    v_pk_fma_f32 v[110:111], v[110:111], v[102:103], v[102:103] op_sel:[0,1,0] op_sel_hi:[1,1,0]
    v_pk_mul_f32 v[104:105], v[104:105], v[56:57]
    v_pk_mul_f32 v[106:107], v[106:107], v[58:59]
    v_pk_mul_f32 v[108:109], v[108:109], v[60:61]
    v_pk_mul_f32 v[110:111], v[110:111], v[62:63]
    v_exp_f32 v104, v104
    v_exp_f32 v105, v105
    v_exp_f32 v106, v106
    v_exp_f32 v107, v107
    v_exp_f32 v108, v108
    v_exp_f32 v109, v109
    v_exp_f32 v110, v110
    v_exp_f32 v111, v111
    v_pk_fma_f32 v[104:105], v[104:105], v[100:101], v[100:101] op_sel:[0,1,1] op_sel_hi:[1,1,1]
    v_pk_fma_f32 v[106:107], v[106:107], v[100:101], v[100:101] op_sel:[0,1,1] op_sel_hi:[1,1,1]
    v_pk_fma_f32 v[108:109], v[108:109], v[100:101], v[100:101] op_sel:[0,1,1] op_sel_hi:[1,1,1]
    v_pk_fma_f32 v[110:111], v[110:111], v[100:101], v[100:101] op_sel:[0,1,1] op_sel_hi:[1,1,1]
    v_rcp_f32 v104, v104
    v_rcp_f32 v105, v105
    v_rcp_f32 v106, v106
    v_rcp_f32 v107, v107
    v_rcp_f32 v108, v108
    v_rcp_f32 v109, v109
    v_rcp_f32 v110, v110
    v_rcp_f32 v111, v111
    v_pk_mul_f32 v[104:105], v[104:105], v[56:57]
    v_pk_mul_f32 v[106:107], v[106:107], v[58:59]
    v_pk_mul_f32 v[108:109], v[108:109], v[60:61]
    v_pk_mul_f32 v[110:111], v[110:111], v[62:63]
    v_cvt_pk_bf16_f32 v56, v104, v105
    v_cvt_pk_bf16_f32 v57, v106, v107
    v_cvt_pk_bf16_f32 v58, v108, v109
    v_cvt_pk_bf16_f32 v59, v110, v111
    buffer_store_dwordx4 v[56:59], v143, s[52:55], s85 offen offset:3072 sc1
p_sig3:
    s_waitcnt vmcnt(0)
    v_mov_b32 v0, 163816
    v_mov_b32 v1, 1
    s_mov_b64 exec, 1
    ds_add_rtn_u32 v1, v0, v1
    s_waitcnt lgkmcnt(0)
    v_readfirstlane_b32 s13, v1
    s_nop 0
    s_cmp_lg_u32 s13, 3
    s_cbranch_scc1 arr_12
    s_lshl_b32 s11, s5, 4
    s_lshl_b32 s12, s6, 3
    s_add_u32 s11, s11, s12
    s_add_u32 s11, s11, s7
    s_lshl_b32 s11, s11, 7
    s_add_u32 s11, s11, 69632
    v_mov_b32 v0, s9
    v_mov_b32 v1, 0
    buffer_store_dword v0, v1, s[52:55], s11 offen sc1
arr_12:
    s_mov_b64 exec, -1
    s_lshl_b32 s83, s3, 2
    s_lshr_b32 s13, s4, 1
    s_add_u32 s83, s83, s13
    s_and_b32 s62, s8, 1
    s_lshr_b32 s63, s8, 1
    s_lshl_b32 s42, s62, 1
    s_add_u32 s42, s42, s63
    s_lshl_b32 s43, s5, 1
    s_and_b32 s11, s4, 1
    s_add_u32 s43, s43, s11
    s_lshl_b32 s43, s43, 2
    s_add_u32 s43, s43, s42
    s_mov_b32 s56, s36
    s_mov_b32 s57, s37
    s_mov_b32 s58, 2621440
    s_mov_b32 s59, 0x20000
    s_mul_i32 s12, s43, 20480
    s_lshl_b32 s11, s42, 12
    s_add_u32 s11, s11, 90112
    v_add_u32 v138, s11, v143
    v_lshlrev_b32 v139, 3, v128
    v_add_u32 v139, s11, v139
    s_lshl_b32 s11, s62, 13
    s_add_u32 s11, s11, 90112
    v_lshlrev_b32 v140, 2, v129
    v_add_u32 v140, s11, v140
    s_mul_i32 s11, s63, 5120
    s_add_u32 s11, s11, 49152
    v_lshl_add_u32 v96, v130, 2, v131
    v_mul_u32_u24 v96, 160, v96
    v_lshl_add_u32 v96, v132, 3, v96
    v_add_u32 v133, s11, v96
    v_add_u32 v134, 61440, v133
    s_lshl_b32 s11, s62, 13
    s_lshl_b32 s13, s63, 10
    s_add_u32 s11, s11, s13
    v_add_u32 v135, s11, v143
    s_mul_i32 s11, s8, 5120
    s_add_u32 s11, s11, 131072
    v_add_u32 v136, s11, v143
    s_xor_b32 s11, s8, 2
    s_mul_i32 s11, s11, 5120
    s_add_u32 s11, s11, 131072
    v_add_u32 v137, s11, v143
    s_mul_i32 s11, s8, 2816
    s_add_u32 s11, s11, 151552
    v_mul_u32_u24 v116, 176, v129
    v_lshl_add_u32 v116, v130, 3, v116
    v_add_u32 v116, s11, v116
    s_mul_i32 s15, s83, 160
    s_add_u32 s12, s12, s15
    v_add_u32 v96, 0, v128
    v_mul_u32_u24 v97, 6554, v96
    v_lshrrev_b32 v97, 16, v97
    v_mul_u32_u24 v98, 10, v97
    v_sub_u32 v98, v96, v98
    v_lshlrev_b32 v98, 4, v98
    v_mul_u32_u24 v117, 176, v97
    v_add3_u32 v117, v117, v98, s11
    v_mul_u32_u24 v120, 1280, v97
    v_add3_u32 v120, v120, v98, s12
    v_add_u32 v96, 64, v128
    v_mul_u32_u24 v97, 6554, v96
    v_lshrrev_b32 v97, 16, v97
    v_mul_u32_u24 v98, 10, v97
    v_sub_u32 v98, v96, v98
    v_lshlrev_b32 v98, 4, v98
    v_mul_u32_u24 v118, 176, v97
    v_add3_u32 v118, v118, v98, s11
    v_mul_u32_u24 v121, 1280, v97
    v_add3_u32 v121, v121, v98, s12
    v_add_u32 v96, 128, v128
    v_mul_u32_u24 v97, 6554, v96
    v_lshrrev_b32 v97, 16, v97
    v_mul_u32_u24 v98, 10, v97
    v_sub_u32 v98, v96, v98
    v_lshlrev_b32 v98, 4, v98
    v_mul_u32_u24 v119, 176, v97
    v_add3_u32 v119, v119, v98, s11
    v_mul_u32_u24 v122, 1280, v97
    v_add3_u32 v122, v122, v98, s12
    v_mov_b32 v97, s79
    v_cmp_gt_u32 vcc, 32, v128
    s_nop 1
    v_cndmask_b32 v122, v97, v122, vcc
    v_cndmask_b32 v119, v117, v119, vcc
    s_barrier
    ds_read_b128 a[0:3], v135 offset:0
    ds_read_b128 a[4:7], v135 offset:4096
    ds_read_b64_tr_b16 a[32:33], v133 offset:0
    ds_read_b64_tr_b16 a[34:35], v133 offset:2560
    ds_read_b64_tr_b16 a[36:37], v133 offset:32
    ds_read_b64_tr_b16 a[38:39], v133 offset:2592
    ds_read_b64_tr_b16 a[40:41], v133 offset:64
    ds_read_b64_tr_b16 a[42:43], v133 offset:2624
    ds_read_b64_tr_b16 a[44:45], v133 offset:96
    ds_read_b64_tr_b16 a[46:47], v133 offset:2656
    ds_read_b64_tr_b16 a[48:49], v133 offset:128
    ds_read_b64_tr_b16 a[50:51], v133 offset:2688
    s_waitcnt lgkmcnt(0)
    v_mfma_f32_16x16x32_bf16 v[40:43], a[32:35], a[0:3], 0
    ds_read_b128 a[8:11], v135 offset:2048
    ds_read_b128 a[12:15], v135 offset:6144
    v_mfma_f32_16x16x32_bf16 v[60:63], a[32:35], a[4:7], 0
    ds_read_b64_tr_b16 a[52:53], v133 offset:10240
    ds_read_b64_tr_b16 a[54:55], v133 offset:12800
    v_mfma_f32_16x16x32_bf16 v[44:47], a[36:39], a[0:3], 0
    ds_read_b64_tr_b16 a[56:57], v133 offset:10272
    ds_read_b64_tr_b16 a[58:59], v133 offset:12832
    v_mfma_f32_16x16x32_bf16 v[64:67], a[36:39], a[4:7], 0
    ds_read_b64_tr_b16 a[60:61], v133 offset:10304
    ds_read_b64_tr_b16 a[62:63], v133 offset:12864
    v_mfma_f32_16x16x32_bf16 v[48:51], a[40:43], a[0:3], 0
    ds_read_b64_tr_b16 a[64:65], v133 offset:10336
    ds_read_b64_tr_b16 a[66:67], v133 offset:12896
    v_mfma_f32_16x16x32_bf16 v[68:71], a[40:43], a[4:7], 0
    ds_read_b64_tr_b16 a[68:69], v133 offset:10368
    ds_read_b64_tr_b16 a[70:71], v133 offset:12928
    v_mfma_f32_16x16x32_bf16 v[52:55], a[44:47], a[0:3], 0
    v_mfma_f32_16x16x32_bf16 v[72:75], a[44:47], a[4:7], 0
    v_mfma_f32_16x16x32_bf16 v[56:59], a[48:51], a[0:3], 0
    v_mfma_f32_16x16x32_bf16 v[76:79], a[48:51], a[4:7], 0
    s_waitcnt lgkmcnt(0)
    s_barrier
    v_mfma_f32_16x16x32_bf16 v[40:43], a[52:55], a[8:11], v[40:43]
    ds_read_b128 a[0:3], v135 offset:16384
    ds_read_b128 a[4:7], v135 offset:20480
    v_mfma_f32_16x16x32_bf16 v[60:63], a[52:55], a[12:15], v[60:63]
    ds_read_b64_tr_b16 a[32:33], v133 offset:20480
    v_mfma_f32_16x16x32_bf16 v[44:47], a[56:59], a[8:11], v[44:47]
    ds_read_b64_tr_b16 a[34:35], v133 offset:23040
    v_mfma_f32_16x16x32_bf16 v[64:67], a[56:59], a[12:15], v[64:67]
    ds_read_b64_tr_b16 a[36:37], v133 offset:20512
    v_mfma_f32_16x16x32_bf16 v[48:51], a[60:63], a[8:11], v[48:51]
    ds_read_b64_tr_b16 a[38:39], v133 offset:23072
    v_mfma_f32_16x16x32_bf16 v[68:71], a[60:63], a[12:15], v[68:71]
    ds_read_b64_tr_b16 a[40:41], v133 offset:20544
    ds_read_b64_tr_b16 a[42:43], v133 offset:23104
    v_mfma_f32_16x16x32_bf16 v[52:55], a[64:67], a[8:11], v[52:55]
    ds_read_b64_tr_b16 a[44:45], v133 offset:20576
    v_mfma_f32_16x16x32_bf16 v[72:75], a[64:67], a[12:15], v[72:75]
    ds_read_b64_tr_b16 a[46:47], v133 offset:23136
    v_mfma_f32_16x16x32_bf16 v[56:59], a[68:71], a[8:11], v[56:59]
    ds_read_b64_tr_b16 a[48:49], v133 offset:20608
    v_mfma_f32_16x16x32_bf16 v[76:79], a[68:71], a[12:15], v[76:79]
    ds_read_b64_tr_b16 a[50:51], v133 offset:23168
    s_waitcnt lgkmcnt(0)
    v_mfma_f32_16x16x32_bf16 v[40:43], a[32:35], a[0:3], v[40:43]
    ds_read_b128 a[8:11], v135 offset:18432
    ds_read_b128 a[12:15], v135 offset:22528
    v_mfma_f32_16x16x32_bf16 v[60:63], a[32:35], a[4:7], v[60:63]
    ds_read_b64_tr_b16 a[52:53], v133 offset:30720
    ds_read_b64_tr_b16 a[54:55], v133 offset:33280
    v_mfma_f32_16x16x32_bf16 v[44:47], a[36:39], a[0:3], v[44:47]
    ds_read_b64_tr_b16 a[56:57], v133 offset:30752
    ds_read_b64_tr_b16 a[58:59], v133 offset:33312
    v_mfma_f32_16x16x32_bf16 v[64:67], a[36:39], a[4:7], v[64:67]
    ds_read_b64_tr_b16 a[60:61], v133 offset:30784
    ds_read_b64_tr_b16 a[62:63], v133 offset:33344
    v_mfma_f32_16x16x32_bf16 v[48:51], a[40:43], a[0:3], v[48:51]
    ds_read_b64_tr_b16 a[64:65], v133 offset:30816
    ds_read_b64_tr_b16 a[66:67], v133 offset:33376
    v_mfma_f32_16x16x32_bf16 v[68:71], a[40:43], a[4:7], v[68:71]
    ds_read_b64_tr_b16 a[68:69], v133 offset:30848
    ds_read_b64_tr_b16 a[70:71], v133 offset:33408
    v_mfma_f32_16x16x32_bf16 v[52:55], a[44:47], a[0:3], v[52:55]
    v_mfma_f32_16x16x32_bf16 v[72:75], a[44:47], a[4:7], v[72:75]
    v_mfma_f32_16x16x32_bf16 v[56:59], a[48:51], a[0:3], v[56:59]
    v_mfma_f32_16x16x32_bf16 v[76:79], a[48:51], a[4:7], v[76:79]
    s_waitcnt lgkmcnt(0)
    s_barrier
    v_mfma_f32_16x16x32_bf16 v[40:43], a[52:55], a[8:11], v[40:43]
    ds_read_b128 a[0:3], v135 offset:32768
    ds_read_b128 a[4:7], v135 offset:36864
    v_mfma_f32_16x16x32_bf16 v[60:63], a[52:55], a[12:15], v[60:63]
    ds_read_b64_tr_b16 a[32:33], v133 offset:40960
    v_mfma_f32_16x16x32_bf16 v[44:47], a[56:59], a[8:11], v[44:47]
    ds_read_b64_tr_b16 a[34:35], v133 offset:43520
    v_mfma_f32_16x16x32_bf16 v[64:67], a[56:59], a[12:15], v[64:67]
    ds_read_b64_tr_b16 a[36:37], v133 offset:40992
    v_mfma_f32_16x16x32_bf16 v[48:51], a[60:63], a[8:11], v[48:51]
    ds_read_b64_tr_b16 a[38:39], v133 offset:43552
    v_mfma_f32_16x16x32_bf16 v[68:71], a[60:63], a[12:15], v[68:71]
    ds_read_b64_tr_b16 a[40:41], v133 offset:41024
    ds_read_b64_tr_b16 a[42:43], v133 offset:43584
    v_mfma_f32_16x16x32_bf16 v[52:55], a[64:67], a[8:11], v[52:55]
    ds_read_b64_tr_b16 a[44:45], v133 offset:41056
    v_mfma_f32_16x16x32_bf16 v[72:75], a[64:67], a[12:15], v[72:75]
    ds_read_b64_tr_b16 a[46:47], v133 offset:43616
    v_mfma_f32_16x16x32_bf16 v[56:59], a[68:71], a[8:11], v[56:59]
    ds_read_b64_tr_b16 a[48:49], v133 offset:41088
    v_mfma_f32_16x16x32_bf16 v[76:79], a[68:71], a[12:15], v[76:79]
    ds_read_b64_tr_b16 a[50:51], v133 offset:43648
    s_waitcnt lgkmcnt(0)
    v_mfma_f32_16x16x32_bf16 v[40:43], a[32:35], a[0:3], v[40:43]
    ds_read_b128 a[8:11], v135 offset:34816
    ds_read_b128 a[12:15], v135 offset:38912
    v_mfma_f32_16x16x32_bf16 v[60:63], a[32:35], a[4:7], v[60:63]
    ds_read_b64_tr_b16 a[52:53], v133 offset:51200
    ds_read_b64_tr_b16 a[54:55], v133 offset:53760
    v_mfma_f32_16x16x32_bf16 v[44:47], a[36:39], a[0:3], v[44:47]
    ds_read_b64_tr_b16 a[56:57], v133 offset:51232
    ds_read_b64_tr_b16 a[58:59], v133 offset:53792
    v_mfma_f32_16x16x32_bf16 v[64:67], a[36:39], a[4:7], v[64:67]
    ds_read_b64_tr_b16 a[60:61], v133 offset:51264
    ds_read_b64_tr_b16 a[62:63], v133 offset:53824
    v_mfma_f32_16x16x32_bf16 v[48:51], a[40:43], a[0:3], v[48:51]
    ds_read_b64_tr_b16 a[64:65], v133 offset:51296
    ds_read_b64_tr_b16 a[66:67], v133 offset:53856
    v_mfma_f32_16x16x32_bf16 v[68:71], a[40:43], a[4:7], v[68:71]
    ds_read_b64_tr_b16 a[68:69], v133 offset:51328
    ds_read_b64_tr_b16 a[70:71], v133 offset:53888
    v_mfma_f32_16x16x32_bf16 v[52:55], a[44:47], a[0:3], v[52:55]
    v_mfma_f32_16x16x32_bf16 v[72:75], a[44:47], a[4:7], v[72:75]
    v_mfma_f32_16x16x32_bf16 v[56:59], a[48:51], a[0:3], v[56:59]
    v_mfma_f32_16x16x32_bf16 v[76:79], a[48:51], a[4:7], v[76:79]
    s_waitcnt lgkmcnt(0)
    s_barrier
    v_mfma_f32_16x16x32_bf16 v[40:43], a[52:55], a[8:11], v[40:43]
    ds_read_b128 a[0:3], v135 offset:0
    ds_read_b128 a[4:7], v135 offset:4096
    v_mfma_f32_16x16x32_bf16 v[60:63], a[52:55], a[12:15], v[60:63]
    ds_read_b64_tr_b16 a[32:33], v134 offset:0
    v_mfma_f32_16x16x32_bf16 v[44:47], a[56:59], a[8:11], v[44:47]
    ds_read_b64_tr_b16 a[34:35], v134 offset:2560
    v_mfma_f32_16x16x32_bf16 v[64:67], a[56:59], a[12:15], v[64:67]
    ds_read_b64_tr_b16 a[36:37], v134 offset:32
    v_mfma_f32_16x16x32_bf16 v[48:51], a[60:63], a[8:11], v[48:51]
    ds_read_b64_tr_b16 a[38:39], v134 offset:2592
    v_mfma_f32_16x16x32_bf16 v[68:71], a[60:63], a[12:15], v[68:71]
    ds_read_b64_tr_b16 a[40:41], v134 offset:64
    ds_read_b64_tr_b16 a[42:43], v134 offset:2624
    v_mfma_f32_16x16x32_bf16 v[52:55], a[64:67], a[8:11], v[52:55]
    ds_read_b64_tr_b16 a[44:45], v134 offset:96
    v_mfma_f32_16x16x32_bf16 v[72:75], a[64:67], a[12:15], v[72:75]
    ds_read_b64_tr_b16 a[46:47], v134 offset:2656
    v_mfma_f32_16x16x32_bf16 v[56:59], a[68:71], a[8:11], v[56:59]
    ds_read_b64_tr_b16 a[48:49], v134 offset:128
    v_mfma_f32_16x16x32_bf16 v[76:79], a[68:71], a[12:15], v[76:79]
    ds_read_b64_tr_b16 a[50:51], v134 offset:2688
    s_waitcnt lgkmcnt(0)
    v_mfma_f32_16x16x32_bf16 v[40:43], a[32:35], a[0:3], v[40:43]
    ds_read_b128 a[8:11], v135 offset:2048
    ds_read_b128 a[12:15], v135 offset:6144
    v_mfma_f32_16x16x32_bf16 v[60:63], a[32:35], a[4:7], v[60:63]
    ds_read_b64_tr_b16 a[52:53], v134 offset:10240
    ds_read_b64_tr_b16 a[54:55], v134 offset:12800
    v_mfma_f32_16x16x32_bf16 v[44:47], a[36:39], a[0:3], v[44:47]
    ds_read_b64_tr_b16 a[56:57], v134 offset:10272
    ds_read_b64_tr_b16 a[58:59], v134 offset:12832
    v_mfma_f32_16x16x32_bf16 v[64:67], a[36:39], a[4:7], v[64:67]
    ds_read_b64_tr_b16 a[60:61], v134 offset:10304
    ds_read_b64_tr_b16 a[62:63], v134 offset:12864
    v_mfma_f32_16x16x32_bf16 v[48:51], a[40:43], a[0:3], v[48:51]
    ds_read_b64_tr_b16 a[64:65], v134 offset:10336
    ds_read_b64_tr_b16 a[66:67], v134 offset:12896
    v_mfma_f32_16x16x32_bf16 v[68:71], a[40:43], a[4:7], v[68:71]
    ds_read_b64_tr_b16 a[68:69], v134 offset:10368
    ds_read_b64_tr_b16 a[70:71], v134 offset:12928
    v_mfma_f32_16x16x32_bf16 v[52:55], a[44:47], a[0:3], v[52:55]
    v_mfma_f32_16x16x32_bf16 v[72:75], a[44:47], a[4:7], v[72:75]
    v_mfma_f32_16x16x32_bf16 v[56:59], a[48:51], a[0:3], v[56:59]
    v_mfma_f32_16x16x32_bf16 v[76:79], a[48:51], a[4:7], v[76:79]
    s_waitcnt lgkmcnt(0)
    s_barrier
    v_mfma_f32_16x16x32_bf16 v[40:43], a[52:55], a[8:11], v[40:43]
    ds_read_b128 a[0:3], v135 offset:16384
    ds_read_b128 a[4:7], v135 offset:20480
    v_mfma_f32_16x16x32_bf16 v[60:63], a[52:55], a[12:15], v[60:63]
    ds_read_b64_tr_b16 a[32:33], v134 offset:20480
    v_mfma_f32_16x16x32_bf16 v[44:47], a[56:59], a[8:11], v[44:47]
    ds_read_b64_tr_b16 a[34:35], v134 offset:23040
    v_mfma_f32_16x16x32_bf16 v[64:67], a[56:59], a[12:15], v[64:67]
    ds_read_b64_tr_b16 a[36:37], v134 offset:20512
    v_mfma_f32_16x16x32_bf16 v[48:51], a[60:63], a[8:11], v[48:51]
    ds_read_b64_tr_b16 a[38:39], v134 offset:23072
    v_mfma_f32_16x16x32_bf16 v[68:71], a[60:63], a[12:15], v[68:71]
    ds_read_b64_tr_b16 a[40:41], v134 offset:20544
    ds_read_b64_tr_b16 a[42:43], v134 offset:23104
    v_mfma_f32_16x16x32_bf16 v[52:55], a[64:67], a[8:11], v[52:55]
    ds_read_b64_tr_b16 a[44:45], v134 offset:20576
    v_mfma_f32_16x16x32_bf16 v[72:75], a[64:67], a[12:15], v[72:75]
    ds_read_b64_tr_b16 a[46:47], v134 offset:23136
    v_mfma_f32_16x16x32_bf16 v[56:59], a[68:71], a[8:11], v[56:59]
    ds_read_b64_tr_b16 a[48:49], v134 offset:20608
    v_mfma_f32_16x16x32_bf16 v[76:79], a[68:71], a[12:15], v[76:79]
    ds_read_b64_tr_b16 a[50:51], v134 offset:23168
    s_waitcnt lgkmcnt(0)
    v_mfma_f32_16x16x32_bf16 v[40:43], a[32:35], a[0:3], v[40:43]
    ds_read_b128 a[8:11], v135 offset:18432
    ds_read_b128 a[12:15], v135 offset:22528
    v_mfma_f32_16x16x32_bf16 v[60:63], a[32:35], a[4:7], v[60:63]
    ds_read_b64_tr_b16 a[52:53], v134 offset:30720
    ds_read_b64_tr_b16 a[54:55], v134 offset:33280
    v_mfma_f32_16x16x32_bf16 v[44:47], a[36:39], a[0:3], v[44:47]
    ds_read_b64_tr_b16 a[56:57], v134 offset:30752
    ds_read_b64_tr_b16 a[58:59], v134 offset:33312
    v_mfma_f32_16x16x32_bf16 v[64:67], a[36:39], a[4:7], v[64:67]
    ds_read_b64_tr_b16 a[60:61], v134 offset:30784
    ds_read_b64_tr_b16 a[62:63], v134 offset:33344
    v_mfma_f32_16x16x32_bf16 v[48:51], a[40:43], a[0:3], v[48:51]
    ds_read_b64_tr_b16 a[64:65], v134 offset:30816
    ds_read_b64_tr_b16 a[66:67], v134 offset:33376
    v_mfma_f32_16x16x32_bf16 v[68:71], a[40:43], a[4:7], v[68:71]
    ds_read_b64_tr_b16 a[68:69], v134 offset:30848
    ds_read_b64_tr_b16 a[70:71], v134 offset:33408
    v_mfma_f32_16x16x32_bf16 v[52:55], a[44:47], a[0:3], v[52:55]
    v_mfma_f32_16x16x32_bf16 v[72:75], a[44:47], a[4:7], v[72:75]
    v_mfma_f32_16x16x32_bf16 v[56:59], a[48:51], a[0:3], v[56:59]
    v_mfma_f32_16x16x32_bf16 v[76:79], a[48:51], a[4:7], v[76:79]
    s_waitcnt lgkmcnt(0)
    v_mfma_f32_16x16x32_bf16 v[40:43], a[52:55], a[8:11], v[40:43]
    v_mfma_f32_16x16x32_bf16 v[60:63], a[52:55], a[12:15], v[60:63]
    v_mfma_f32_16x16x32_bf16 v[44:47], a[56:59], a[8:11], v[44:47]
    v_mfma_f32_16x16x32_bf16 v[64:67], a[56:59], a[12:15], v[64:67]
    v_mfma_f32_16x16x32_bf16 v[48:51], a[60:63], a[8:11], v[48:51]
    v_mfma_f32_16x16x32_bf16 v[68:71], a[60:63], a[12:15], v[68:71]
    v_mfma_f32_16x16x32_bf16 v[52:55], a[64:67], a[8:11], v[52:55]
    v_mfma_f32_16x16x32_bf16 v[72:75], a[64:67], a[12:15], v[72:75]
    v_mfma_f32_16x16x32_bf16 v[56:59], a[68:71], a[8:11], v[56:59]
    v_mfma_f32_16x16x32_bf16 v[76:79], a[68:71], a[12:15], v[76:79]
    s_barrier
    s_barrier
    ds_read_b128 a[0:3], v135 offset:32768
    ds_read_b128 a[4:7], v135 offset:36864
    ds_read_b64_tr_b16 a[32:33], v133 offset:0
    ds_read_b64_tr_b16 a[34:35], v133 offset:2560
    ds_read_b64_tr_b16 a[36:37], v133 offset:32
    ds_read_b64_tr_b16 a[38:39], v133 offset:2592
    ds_read_b64_tr_b16 a[40:41], v133 offset:64
    ds_read_b64_tr_b16 a[42:43], v133 offset:2624
    ds_read_b64_tr_b16 a[44:45], v133 offset:96
    ds_read_b64_tr_b16 a[46:47], v133 offset:2656
    ds_read_b64_tr_b16 a[48:49], v133 offset:128
    ds_read_b64_tr_b16 a[50:51], v133 offset:2688
    s_waitcnt lgkmcnt(0)
    v_mfma_f32_16x16x32_bf16 v[0:3], a[32:35], a[0:3], 0
    ds_read_b128 a[8:11], v135 offset:34816
    ds_read_b128 a[12:15], v135 offset:38912
    v_mfma_f32_16x16x32_bf16 v[20:23], a[32:35], a[4:7], 0
    ds_read_b64_tr_b16 a[52:53], v133 offset:10240
    ds_read_b64_tr_b16 a[54:55], v133 offset:12800
    v_mfma_f32_16x16x32_bf16 v[4:7], a[36:39], a[0:3], 0
    ds_read_b64_tr_b16 a[56:57], v133 offset:10272
    ds_read_b64_tr_b16 a[58:59], v133 offset:12832
    v_mfma_f32_16x16x32_bf16 v[24:27], a[36:39], a[4:7], 0
    ds_read_b64_tr_b16 a[60:61], v133 offset:10304
    ds_read_b64_tr_b16 a[62:63], v133 offset:12864
    v_mfma_f32_16x16x32_bf16 v[8:11], a[40:43], a[0:3], 0
    ds_read_b64_tr_b16 a[64:65], v133 offset:10336
    ds_read_b64_tr_b16 a[66:67], v133 offset:12896
    v_mfma_f32_16x16x32_bf16 v[28:31], a[40:43], a[4:7], 0
    ds_read_b64_tr_b16 a[68:69], v133 offset:10368
    ds_read_b64_tr_b16 a[70:71], v133 offset:12928
    v_mfma_f32_16x16x32_bf16 v[12:15], a[44:47], a[0:3], 0
    v_mfma_f32_16x16x32_bf16 v[32:35], a[44:47], a[4:7], 0
    v_mfma_f32_16x16x32_bf16 v[16:19], a[48:51], a[0:3], 0
    v_mfma_f32_16x16x32_bf16 v[36:39], a[48:51], a[4:7], 0
    s_waitcnt lgkmcnt(0)
    s_barrier
    v_mfma_f32_16x16x32_bf16 v[0:3], a[52:55], a[8:11], v[0:3]
    ds_read_b128 a[0:3], v135 offset:0
    ds_read_b128 a[4:7], v135 offset:4096
    v_mfma_f32_16x16x32_bf16 v[20:23], a[52:55], a[12:15], v[20:23]
    ds_read_b64_tr_b16 a[32:33], v133 offset:20480
    v_mfma_f32_16x16x32_bf16 v[4:7], a[56:59], a[8:11], v[4:7]
    ds_read_b64_tr_b16 a[34:35], v133 offset:23040
    v_mfma_f32_16x16x32_bf16 v[24:27], a[56:59], a[12:15], v[24:27]
    ds_read_b64_tr_b16 a[36:37], v133 offset:20512
    v_mfma_f32_16x16x32_bf16 v[8:11], a[60:63], a[8:11], v[8:11]
    ds_read_b64_tr_b16 a[38:39], v133 offset:23072
    v_mfma_f32_16x16x32_bf16 v[28:31], a[60:63], a[12:15], v[28:31]
    ds_read_b64_tr_b16 a[40:41], v133 offset:20544
    ds_read_b64_tr_b16 a[42:43], v133 offset:23104
    v_mfma_f32_16x16x32_bf16 v[12:15], a[64:67], a[8:11], v[12:15]
    ds_read_b64_tr_b16 a[44:45], v133 offset:20576
    v_mfma_f32_16x16x32_bf16 v[32:35], a[64:67], a[12:15], v[32:35]
    ds_read_b64_tr_b16 a[46:47], v133 offset:23136
    v_mfma_f32_16x16x32_bf16 v[16:19], a[68:71], a[8:11], v[16:19]
    ds_read_b64_tr_b16 a[48:49], v133 offset:20608
    v_mfma_f32_16x16x32_bf16 v[36:39], a[68:71], a[12:15], v[36:39]
    ds_read_b64_tr_b16 a[50:51], v133 offset:23168
    s_waitcnt lgkmcnt(0)
    v_mfma_f32_16x16x32_bf16 v[0:3], a[32:35], a[0:3], v[0:3]
    ds_read_b128 a[8:11], v135 offset:2048
    ds_read_b128 a[12:15], v135 offset:6144
    v_mfma_f32_16x16x32_bf16 v[20:23], a[32:35], a[4:7], v[20:23]
    ds_read_b64_tr_b16 a[52:53], v133 offset:30720
    ds_read_b64_tr_b16 a[54:55], v133 offset:33280
    v_mfma_f32_16x16x32_bf16 v[4:7], a[36:39], a[0:3], v[4:7]
    ds_read_b64_tr_b16 a[56:57], v133 offset:30752
    ds_read_b64_tr_b16 a[58:59], v133 offset:33312
    v_mfma_f32_16x16x32_bf16 v[24:27], a[36:39], a[4:7], v[24:27]
    ds_read_b64_tr_b16 a[60:61], v133 offset:30784
    ds_read_b64_tr_b16 a[62:63], v133 offset:33344
    v_mfma_f32_16x16x32_bf16 v[8:11], a[40:43], a[0:3], v[8:11]
    ds_read_b64_tr_b16 a[64:65], v133 offset:30816
    ds_read_b64_tr_b16 a[66:67], v133 offset:33376
    v_mfma_f32_16x16x32_bf16 v[28:31], a[40:43], a[4:7], v[28:31]
    ds_read_b64_tr_b16 a[68:69], v133 offset:30848
    ds_read_b64_tr_b16 a[70:71], v133 offset:33408
    v_mfma_f32_16x16x32_bf16 v[12:15], a[44:47], a[0:3], v[12:15]
    v_mfma_f32_16x16x32_bf16 v[32:35], a[44:47], a[4:7], v[32:35]
    v_mfma_f32_16x16x32_bf16 v[16:19], a[48:51], a[0:3], v[16:19]
    v_mfma_f32_16x16x32_bf16 v[36:39], a[48:51], a[4:7], v[36:39]
    s_waitcnt lgkmcnt(0)
    s_barrier
    v_mfma_f32_16x16x32_bf16 v[0:3], a[52:55], a[8:11], v[0:3]
    ds_read_b128 a[0:3], v135 offset:16384
    ds_read_b128 a[4:7], v135 offset:20480
    v_mfma_f32_16x16x32_bf16 v[20:23], a[52:55], a[12:15], v[20:23]
    ds_read_b64_tr_b16 a[32:33], v133 offset:40960
    v_mfma_f32_16x16x32_bf16 v[4:7], a[56:59], a[8:11], v[4:7]
    ds_read_b64_tr_b16 a[34:35], v133 offset:43520
    v_mfma_f32_16x16x32_bf16 v[24:27], a[56:59], a[12:15], v[24:27]
    ds_read_b64_tr_b16 a[36:37], v133 offset:40992
    v_mfma_f32_16x16x32_bf16 v[8:11], a[60:63], a[8:11], v[8:11]
    ds_read_b64_tr_b16 a[38:39], v133 offset:43552
    v_mfma_f32_16x16x32_bf16 v[28:31], a[60:63], a[12:15], v[28:31]
    ds_read_b64_tr_b16 a[40:41], v133 offset:41024
    ds_read_b64_tr_b16 a[42:43], v133 offset:43584
    v_mfma_f32_16x16x32_bf16 v[12:15], a[64:67], a[8:11], v[12:15]
    ds_read_b64_tr_b16 a[44:45], v133 offset:41056
    v_mfma_f32_16x16x32_bf16 v[32:35], a[64:67], a[12:15], v[32:35]
    ds_read_b64_tr_b16 a[46:47], v133 offset:43616
    v_mfma_f32_16x16x32_bf16 v[16:19], a[68:71], a[8:11], v[16:19]
    ds_read_b64_tr_b16 a[48:49], v133 offset:41088
    v_mfma_f32_16x16x32_bf16 v[36:39], a[68:71], a[12:15], v[36:39]
    ds_read_b64_tr_b16 a[50:51], v133 offset:43648
    s_waitcnt lgkmcnt(0)
    v_mfma_f32_16x16x32_bf16 v[0:3], a[32:35], a[0:3], v[0:3]
    ds_read_b128 a[8:11], v135 offset:18432
    ds_read_b128 a[12:15], v135 offset:22528
    v_mfma_f32_16x16x32_bf16 v[20:23], a[32:35], a[4:7], v[20:23]
    ds_read_b64_tr_b16 a[52:53], v133 offset:51200
    ds_read_b64_tr_b16 a[54:55], v133 offset:53760
    v_mfma_f32_16x16x32_bf16 v[4:7], a[36:39], a[0:3], v[4:7]
    ds_read_b64_tr_b16 a[56:57], v133 offset:51232
    ds_read_b64_tr_b16 a[58:59], v133 offset:53792
    v_mfma_f32_16x16x32_bf16 v[24:27], a[36:39], a[4:7], v[24:27]
    ds_read_b64_tr_b16 a[60:61], v133 offset:51264
    ds_read_b64_tr_b16 a[62:63], v133 offset:53824
    v_mfma_f32_16x16x32_bf16 v[8:11], a[40:43], a[0:3], v[8:11]
    ds_read_b64_tr_b16 a[64:65], v133 offset:51296
    ds_read_b64_tr_b16 a[66:67], v133 offset:53856
    v_mfma_f32_16x16x32_bf16 v[28:31], a[40:43], a[4:7], v[28:31]
    ds_read_b64_tr_b16 a[68:69], v133 offset:51328
    ds_read_b64_tr_b16 a[70:71], v133 offset:53888
    v_mfma_f32_16x16x32_bf16 v[12:15], a[44:47], a[0:3], v[12:15]
    v_mfma_f32_16x16x32_bf16 v[32:35], a[44:47], a[4:7], v[32:35]
    v_mfma_f32_16x16x32_bf16 v[16:19], a[48:51], a[0:3], v[16:19]
    v_mfma_f32_16x16x32_bf16 v[36:39], a[48:51], a[4:7], v[36:39]
    s_waitcnt lgkmcnt(0)
    s_barrier
    v_mfma_f32_16x16x32_bf16 v[0:3], a[52:55], a[8:11], v[0:3]
    ds_read_b128 a[0:3], v135 offset:32768
    ds_read_b128 a[4:7], v135 offset:36864
    v_mfma_f32_16x16x32_bf16 v[20:23], a[52:55], a[12:15], v[20:23]
    ds_read_b64_tr_b16 a[32:33], v134 offset:0
    v_mfma_f32_16x16x32_bf16 v[4:7], a[56:59], a[8:11], v[4:7]
    ds_read_b64_tr_b16 a[34:35], v134 offset:2560
    v_mfma_f32_16x16x32_bf16 v[24:27], a[56:59], a[12:15], v[24:27]
    ds_read_b64_tr_b16 a[36:37], v134 offset:32
    v_mfma_f32_16x16x32_bf16 v[8:11], a[60:63], a[8:11], v[8:11]
    ds_read_b64_tr_b16 a[38:39], v134 offset:2592
    v_mfma_f32_16x16x32_bf16 v[28:31], a[60:63], a[12:15], v[28:31]
    ds_read_b64_tr_b16 a[40:41], v134 offset:64
    ds_read_b64_tr_b16 a[42:43], v134 offset:2624
    v_mfma_f32_16x16x32_bf16 v[12:15], a[64:67], a[8:11], v[12:15]
    ds_read_b64_tr_b16 a[44:45], v134 offset:96
    v_mfma_f32_16x16x32_bf16 v[32:35], a[64:67], a[12:15], v[32:35]
    ds_read_b64_tr_b16 a[46:47], v134 offset:2656
    v_mfma_f32_16x16x32_bf16 v[16:19], a[68:71], a[8:11], v[16:19]
    ds_read_b64_tr_b16 a[48:49], v134 offset:128
    v_mfma_f32_16x16x32_bf16 v[36:39], a[68:71], a[12:15], v[36:39]
    ds_read_b64_tr_b16 a[50:51], v134 offset:2688
    s_waitcnt lgkmcnt(0)
    v_mfma_f32_16x16x32_bf16 v[0:3], a[32:35], a[0:3], v[0:3]
    ds_read_b128 a[8:11], v135 offset:34816
    ds_read_b128 a[12:15], v135 offset:38912
    v_mfma_f32_16x16x32_bf16 v[20:23], a[32:35], a[4:7], v[20:23]
    ds_read_b64_tr_b16 a[52:53], v134 offset:10240
    ds_read_b64_tr_b16 a[54:55], v134 offset:12800
    v_mfma_f32_16x16x32_bf16 v[4:7], a[36:39], a[0:3], v[4:7]
    ds_read_b64_tr_b16 a[56:57], v134 offset:10272
    ds_read_b64_tr_b16 a[58:59], v134 offset:12832
    v_mfma_f32_16x16x32_bf16 v[24:27], a[36:39], a[4:7], v[24:27]
    ds_read_b64_tr_b16 a[60:61], v134 offset:10304
    ds_read_b64_tr_b16 a[62:63], v134 offset:12864
    v_mfma_f32_16x16x32_bf16 v[8:11], a[40:43], a[0:3], v[8:11]
    ds_read_b64_tr_b16 a[64:65], v134 offset:10336
    ds_read_b64_tr_b16 a[66:67], v134 offset:12896
    v_mfma_f32_16x16x32_bf16 v[28:31], a[40:43], a[4:7], v[28:31]
    ds_read_b64_tr_b16 a[68:69], v134 offset:10368
    ds_read_b64_tr_b16 a[70:71], v134 offset:12928
    v_mfma_f32_16x16x32_bf16 v[12:15], a[44:47], a[0:3], v[12:15]
    v_mfma_f32_16x16x32_bf16 v[32:35], a[44:47], a[4:7], v[32:35]
    v_mfma_f32_16x16x32_bf16 v[16:19], a[48:51], a[0:3], v[16:19]
    v_mfma_f32_16x16x32_bf16 v[36:39], a[48:51], a[4:7], v[36:39]
    s_waitcnt lgkmcnt(0)
    s_barrier
    v_mfma_f32_16x16x32_bf16 v[0:3], a[52:55], a[8:11], v[0:3]
    ds_read_b128 a[0:3], v135 offset:0
    ds_read_b128 a[4:7], v135 offset:4096
    v_mfma_f32_16x16x32_bf16 v[20:23], a[52:55], a[12:15], v[20:23]
    ds_read_b64_tr_b16 a[32:33], v134 offset:20480
    v_mfma_f32_16x16x32_bf16 v[4:7], a[56:59], a[8:11], v[4:7]
    ds_read_b64_tr_b16 a[34:35], v134 offset:23040
    v_mfma_f32_16x16x32_bf16 v[24:27], a[56:59], a[12:15], v[24:27]
    ds_read_b64_tr_b16 a[36:37], v134 offset:20512
    v_mfma_f32_16x16x32_bf16 v[8:11], a[60:63], a[8:11], v[8:11]
    ds_read_b64_tr_b16 a[38:39], v134 offset:23072
    v_mfma_f32_16x16x32_bf16 v[28:31], a[60:63], a[12:15], v[28:31]
    ds_read_b64_tr_b16 a[40:41], v134 offset:20544
    ds_read_b64_tr_b16 a[42:43], v134 offset:23104
    v_mfma_f32_16x16x32_bf16 v[12:15], a[64:67], a[8:11], v[12:15]
    ds_read_b64_tr_b16 a[44:45], v134 offset:20576
    v_mfma_f32_16x16x32_bf16 v[32:35], a[64:67], a[12:15], v[32:35]
    ds_read_b64_tr_b16 a[46:47], v134 offset:23136
    v_mfma_f32_16x16x32_bf16 v[16:19], a[68:71], a[8:11], v[16:19]
    ds_read_b64_tr_b16 a[48:49], v134 offset:20608
    v_mfma_f32_16x16x32_bf16 v[36:39], a[68:71], a[12:15], v[36:39]
    ds_read_b64_tr_b16 a[50:51], v134 offset:23168
    s_waitcnt lgkmcnt(0)
    v_mfma_f32_16x16x32_bf16 v[0:3], a[32:35], a[0:3], v[0:3]
    ds_read_b128 a[8:11], v135 offset:2048
    ds_read_b128 a[12:15], v135 offset:6144
    v_mfma_f32_16x16x32_bf16 v[20:23], a[32:35], a[4:7], v[20:23]
    ds_read_b64_tr_b16 a[52:53], v134 offset:30720
    ds_read_b64_tr_b16 a[54:55], v134 offset:33280
    v_mfma_f32_16x16x32_bf16 v[4:7], a[36:39], a[0:3], v[4:7]
    ds_read_b64_tr_b16 a[56:57], v134 offset:30752
    ds_read_b64_tr_b16 a[58:59], v134 offset:33312
    v_mfma_f32_16x16x32_bf16 v[24:27], a[36:39], a[4:7], v[24:27]
    ds_read_b64_tr_b16 a[60:61], v134 offset:30784
    ds_read_b64_tr_b16 a[62:63], v134 offset:33344
    v_mfma_f32_16x16x32_bf16 v[8:11], a[40:43], a[0:3], v[8:11]
    ds_read_b64_tr_b16 a[64:65], v134 offset:30816
    ds_read_b64_tr_b16 a[66:67], v134 offset:33376
    v_mfma_f32_16x16x32_bf16 v[28:31], a[40:43], a[4:7], v[28:31]
    ds_read_b64_tr_b16 a[68:69], v134 offset:30848
    ds_read_b64_tr_b16 a[70:71], v134 offset:33408
    v_mfma_f32_16x16x32_bf16 v[12:15], a[44:47], a[0:3], v[12:15]
    v_mfma_f32_16x16x32_bf16 v[32:35], a[44:47], a[4:7], v[32:35]
    v_mfma_f32_16x16x32_bf16 v[16:19], a[48:51], a[0:3], v[16:19]
    v_mfma_f32_16x16x32_bf16 v[36:39], a[48:51], a[4:7], v[36:39]
    s_waitcnt lgkmcnt(0)
    s_barrier
    v_mfma_f32_16x16x32_bf16 v[0:3], a[52:55], a[8:11], v[0:3]
    ds_read_b128 a[0:3], v135 offset:16384
    ds_read_b128 a[4:7], v135 offset:20480
    v_mfma_f32_16x16x32_bf16 v[20:23], a[52:55], a[12:15], v[20:23]
    ds_read_b64_tr_b16 a[32:33], v133 offset:0
    v_mfma_f32_16x16x32_bf16 v[4:7], a[56:59], a[8:11], v[4:7]
    ds_read_b64_tr_b16 a[34:35], v133 offset:2560
    v_mfma_f32_16x16x32_bf16 v[24:27], a[56:59], a[12:15], v[24:27]
    ds_read_b64_tr_b16 a[36:37], v133 offset:32
    v_mfma_f32_16x16x32_bf16 v[8:11], a[60:63], a[8:11], v[8:11]
    ds_read_b64_tr_b16 a[38:39], v133 offset:2592
    v_mfma_f32_16x16x32_bf16 v[28:31], a[60:63], a[12:15], v[28:31]
    ds_read_b64_tr_b16 a[40:41], v133 offset:64
    ds_read_b64_tr_b16 a[42:43], v133 offset:2624
    v_mfma_f32_16x16x32_bf16 v[12:15], a[64:67], a[8:11], v[12:15]
    ds_read_b64_tr_b16 a[44:45], v133 offset:96
    v_mfma_f32_16x16x32_bf16 v[32:35], a[64:67], a[12:15], v[32:35]
    ds_read_b64_tr_b16 a[46:47], v133 offset:2656
    v_mfma_f32_16x16x32_bf16 v[16:19], a[68:71], a[8:11], v[16:19]
    ds_read_b64_tr_b16 a[48:49], v133 offset:128
    v_mfma_f32_16x16x32_bf16 v[36:39], a[68:71], a[12:15], v[36:39]
    ds_read_b64_tr_b16 a[50:51], v133 offset:2688
    s_waitcnt lgkmcnt(0)
    v_mfma_f32_16x16x32_bf16 v[0:3], a[32:35], a[0:3], v[0:3]
    ds_read_b128 a[8:11], v135 offset:18432
    ds_read_b128 a[12:15], v135 offset:22528
    v_mfma_f32_16x16x32_bf16 v[20:23], a[32:35], a[4:7], v[20:23]
    ds_read_b64_tr_b16 a[52:53], v133 offset:10240
    ds_read_b64_tr_b16 a[54:55], v133 offset:12800
    v_mfma_f32_16x16x32_bf16 v[4:7], a[36:39], a[0:3], v[4:7]
    ds_read_b64_tr_b16 a[56:57], v133 offset:10272
    ds_read_b64_tr_b16 a[58:59], v133 offset:12832
    v_mfma_f32_16x16x32_bf16 v[24:27], a[36:39], a[4:7], v[24:27]
    ds_read_b64_tr_b16 a[60:61], v133 offset:10304
    ds_read_b64_tr_b16 a[62:63], v133 offset:12864
    v_mfma_f32_16x16x32_bf16 v[8:11], a[40:43], a[0:3], v[8:11]
    ds_read_b64_tr_b16 a[64:65], v133 offset:10336
    ds_read_b64_tr_b16 a[66:67], v133 offset:12896
    v_mfma_f32_16x16x32_bf16 v[28:31], a[40:43], a[4:7], v[28:31]
    ds_read_b64_tr_b16 a[68:69], v133 offset:10368
    ds_read_b64_tr_b16 a[70:71], v133 offset:12928
    v_mfma_f32_16x16x32_bf16 v[12:15], a[44:47], a[0:3], v[12:15]
    v_mfma_f32_16x16x32_bf16 v[32:35], a[44:47], a[4:7], v[32:35]
    v_mfma_f32_16x16x32_bf16 v[16:19], a[48:51], a[0:3], v[16:19]
    v_mfma_f32_16x16x32_bf16 v[36:39], a[48:51], a[4:7], v[36:39]
    s_waitcnt lgkmcnt(0)
    s_barrier
    v_mfma_f32_16x16x32_bf16 v[0:3], a[52:55], a[8:11], v[0:3]
    ds_read_b128 a[0:3], v135 offset:32768
    ds_read_b128 a[4:7], v135 offset:36864
    v_mfma_f32_16x16x32_bf16 v[20:23], a[52:55], a[12:15], v[20:23]
    ds_read_b64_tr_b16 a[32:33], v133 offset:20480
    v_mfma_f32_16x16x32_bf16 v[4:7], a[56:59], a[8:11], v[4:7]
    ds_read_b64_tr_b16 a[34:35], v133 offset:23040
    v_mfma_f32_16x16x32_bf16 v[24:27], a[56:59], a[12:15], v[24:27]
    ds_read_b64_tr_b16 a[36:37], v133 offset:20512
    v_mfma_f32_16x16x32_bf16 v[8:11], a[60:63], a[8:11], v[8:11]
    ds_read_b64_tr_b16 a[38:39], v133 offset:23072
    v_mfma_f32_16x16x32_bf16 v[28:31], a[60:63], a[12:15], v[28:31]
    ds_read_b64_tr_b16 a[40:41], v133 offset:20544
    ds_read_b64_tr_b16 a[42:43], v133 offset:23104
    v_mfma_f32_16x16x32_bf16 v[12:15], a[64:67], a[8:11], v[12:15]
    ds_read_b64_tr_b16 a[44:45], v133 offset:20576
    v_mfma_f32_16x16x32_bf16 v[32:35], a[64:67], a[12:15], v[32:35]
    ds_read_b64_tr_b16 a[46:47], v133 offset:23136
    v_mfma_f32_16x16x32_bf16 v[16:19], a[68:71], a[8:11], v[16:19]
    ds_read_b64_tr_b16 a[48:49], v133 offset:20608
    v_mfma_f32_16x16x32_bf16 v[36:39], a[68:71], a[12:15], v[36:39]
    ds_read_b64_tr_b16 a[50:51], v133 offset:23168
    s_waitcnt lgkmcnt(0)
    v_mfma_f32_16x16x32_bf16 v[0:3], a[32:35], a[0:3], v[0:3]
    ds_read_b128 a[8:11], v135 offset:34816
    ds_read_b128 a[12:15], v135 offset:38912
    v_mfma_f32_16x16x32_bf16 v[20:23], a[32:35], a[4:7], v[20:23]
    ds_read_b64_tr_b16 a[52:53], v133 offset:30720
    ds_read_b64_tr_b16 a[54:55], v133 offset:33280
    v_mfma_f32_16x16x32_bf16 v[4:7], a[36:39], a[0:3], v[4:7]
    ds_read_b64_tr_b16 a[56:57], v133 offset:30752
    ds_read_b64_tr_b16 a[58:59], v133 offset:33312
    v_mfma_f32_16x16x32_bf16 v[24:27], a[36:39], a[4:7], v[24:27]
    ds_read_b64_tr_b16 a[60:61], v133 offset:30784
    ds_read_b64_tr_b16 a[62:63], v133 offset:33344
    v_mfma_f32_16x16x32_bf16 v[8:11], a[40:43], a[0:3], v[8:11]
    ds_read_b64_tr_b16 a[64:65], v133 offset:30816
    ds_read_b64_tr_b16 a[66:67], v133 offset:33376
    v_mfma_f32_16x16x32_bf16 v[28:31], a[40:43], a[4:7], v[28:31]
    ds_read_b64_tr_b16 a[68:69], v133 offset:30848
    ds_read_b64_tr_b16 a[70:71], v133 offset:33408
    v_mfma_f32_16x16x32_bf16 v[12:15], a[44:47], a[0:3], v[12:15]
    v_mfma_f32_16x16x32_bf16 v[32:35], a[44:47], a[4:7], v[32:35]
    v_mfma_f32_16x16x32_bf16 v[16:19], a[48:51], a[0:3], v[16:19]
    v_mfma_f32_16x16x32_bf16 v[36:39], a[48:51], a[4:7], v[36:39]
    s_waitcnt lgkmcnt(0)
    s_barrier
    v_mfma_f32_16x16x32_bf16 v[0:3], a[52:55], a[8:11], v[0:3]
    ds_read_b128 a[0:3], v135 offset:0
    ds_read_b128 a[4:7], v135 offset:4096
    v_mfma_f32_16x16x32_bf16 v[20:23], a[52:55], a[12:15], v[20:23]
    ds_read_b64_tr_b16 a[32:33], v133 offset:40960
    v_mfma_f32_16x16x32_bf16 v[4:7], a[56:59], a[8:11], v[4:7]
    ds_read_b64_tr_b16 a[34:35], v133 offset:43520
    v_mfma_f32_16x16x32_bf16 v[24:27], a[56:59], a[12:15], v[24:27]
    ds_read_b64_tr_b16 a[36:37], v133 offset:40992
    v_mfma_f32_16x16x32_bf16 v[8:11], a[60:63], a[8:11], v[8:11]
    ds_read_b64_tr_b16 a[38:39], v133 offset:43552
    v_mfma_f32_16x16x32_bf16 v[28:31], a[60:63], a[12:15], v[28:31]
    ds_read_b64_tr_b16 a[40:41], v133 offset:41024
    ds_read_b64_tr_b16 a[42:43], v133 offset:43584
    v_mfma_f32_16x16x32_bf16 v[12:15], a[64:67], a[8:11], v[12:15]
    ds_read_b64_tr_b16 a[44:45], v133 offset:41056
    v_mfma_f32_16x16x32_bf16 v[32:35], a[64:67], a[12:15], v[32:35]
    ds_read_b64_tr_b16 a[46:47], v133 offset:43616
    v_mfma_f32_16x16x32_bf16 v[16:19], a[68:71], a[8:11], v[16:19]
    ds_read_b64_tr_b16 a[48:49], v133 offset:41088
    v_mfma_f32_16x16x32_bf16 v[36:39], a[68:71], a[12:15], v[36:39]
    ds_read_b64_tr_b16 a[50:51], v133 offset:43648
    s_waitcnt lgkmcnt(0)
    v_mfma_f32_16x16x32_bf16 v[0:3], a[32:35], a[0:3], v[0:3]
    ds_read_b128 a[8:11], v135 offset:2048
    ds_read_b128 a[12:15], v135 offset:6144
    v_mfma_f32_16x16x32_bf16 v[20:23], a[32:35], a[4:7], v[20:23]
    ds_read_b64_tr_b16 a[52:53], v133 offset:51200
    ds_read_b64_tr_b16 a[54:55], v133 offset:53760
    v_mfma_f32_16x16x32_bf16 v[4:7], a[36:39], a[0:3], v[4:7]
    ds_read_b64_tr_b16 a[56:57], v133 offset:51232
    ds_read_b64_tr_b16 a[58:59], v133 offset:53792
    v_mfma_f32_16x16x32_bf16 v[24:27], a[36:39], a[4:7], v[24:27]
    ds_read_b64_tr_b16 a[60:61], v133 offset:51264
    ds_read_b64_tr_b16 a[62:63], v133 offset:53824
    v_mfma_f32_16x16x32_bf16 v[8:11], a[40:43], a[0:3], v[8:11]
    ds_read_b64_tr_b16 a[64:65], v133 offset:51296
    ds_read_b64_tr_b16 a[66:67], v133 offset:53856
    v_mfma_f32_16x16x32_bf16 v[28:31], a[40:43], a[4:7], v[28:31]
    ds_read_b64_tr_b16 a[68:69], v133 offset:51328
    ds_read_b64_tr_b16 a[70:71], v133 offset:53888
    v_mfma_f32_16x16x32_bf16 v[12:15], a[44:47], a[0:3], v[12:15]
    v_mfma_f32_16x16x32_bf16 v[32:35], a[44:47], a[4:7], v[32:35]
    v_mfma_f32_16x16x32_bf16 v[16:19], a[48:51], a[0:3], v[16:19]
    v_mfma_f32_16x16x32_bf16 v[36:39], a[48:51], a[4:7], v[36:39]
    s_waitcnt lgkmcnt(0)
    s_barrier
    v_mfma_f32_16x16x32_bf16 v[0:3], a[52:55], a[8:11], v[0:3]
    ds_read_b128 a[0:3], v135 offset:16384
    ds_read_b128 a[4:7], v135 offset:20480
    v_mfma_f32_16x16x32_bf16 v[20:23], a[52:55], a[12:15], v[20:23]
    ds_read_b64_tr_b16 a[32:33], v134 offset:0
    v_mfma_f32_16x16x32_bf16 v[4:7], a[56:59], a[8:11], v[4:7]
    ds_read_b64_tr_b16 a[34:35], v134 offset:2560
    v_mfma_f32_16x16x32_bf16 v[24:27], a[56:59], a[12:15], v[24:27]
    ds_read_b64_tr_b16 a[36:37], v134 offset:32
    v_mfma_f32_16x16x32_bf16 v[8:11], a[60:63], a[8:11], v[8:11]
    ds_read_b64_tr_b16 a[38:39], v134 offset:2592
    v_mfma_f32_16x16x32_bf16 v[28:31], a[60:63], a[12:15], v[28:31]
    ds_read_b64_tr_b16 a[40:41], v134 offset:64
    ds_read_b64_tr_b16 a[42:43], v134 offset:2624
    v_mfma_f32_16x16x32_bf16 v[12:15], a[64:67], a[8:11], v[12:15]
    ds_read_b64_tr_b16 a[44:45], v134 offset:96
    v_mfma_f32_16x16x32_bf16 v[32:35], a[64:67], a[12:15], v[32:35]
    ds_read_b64_tr_b16 a[46:47], v134 offset:2656
    v_mfma_f32_16x16x32_bf16 v[16:19], a[68:71], a[8:11], v[16:19]
    ds_read_b64_tr_b16 a[48:49], v134 offset:128
    v_mfma_f32_16x16x32_bf16 v[36:39], a[68:71], a[12:15], v[36:39]
    ds_read_b64_tr_b16 a[50:51], v134 offset:2688
    s_waitcnt lgkmcnt(0)
    v_mfma_f32_16x16x32_bf16 v[0:3], a[32:35], a[0:3], v[0:3]
    ds_read_b128 a[8:11], v135 offset:18432
    ds_read_b128 a[12:15], v135 offset:22528
    v_mfma_f32_16x16x32_bf16 v[20:23], a[32:35], a[4:7], v[20:23]
    ds_read_b64_tr_b16 a[52:53], v134 offset:10240
    ds_read_b64_tr_b16 a[54:55], v134 offset:12800
    v_mfma_f32_16x16x32_bf16 v[4:7], a[36:39], a[0:3], v[4:7]
    ds_read_b64_tr_b16 a[56:57], v134 offset:10272
    ds_read_b64_tr_b16 a[58:59], v134 offset:12832
    v_mfma_f32_16x16x32_bf16 v[24:27], a[36:39], a[4:7], v[24:27]
    ds_read_b64_tr_b16 a[60:61], v134 offset:10304
    ds_read_b64_tr_b16 a[62:63], v134 offset:12864
    v_mfma_f32_16x16x32_bf16 v[8:11], a[40:43], a[0:3], v[8:11]
    ds_read_b64_tr_b16 a[64:65], v134 offset:10336
    ds_read_b64_tr_b16 a[66:67], v134 offset:12896
    v_mfma_f32_16x16x32_bf16 v[28:31], a[40:43], a[4:7], v[28:31]
    ds_read_b64_tr_b16 a[68:69], v134 offset:10368
    ds_read_b64_tr_b16 a[70:71], v134 offset:12928
    v_mfma_f32_16x16x32_bf16 v[12:15], a[44:47], a[0:3], v[12:15]
    v_mfma_f32_16x16x32_bf16 v[32:35], a[44:47], a[4:7], v[32:35]
    v_mfma_f32_16x16x32_bf16 v[16:19], a[48:51], a[0:3], v[16:19]
    v_mfma_f32_16x16x32_bf16 v[36:39], a[48:51], a[4:7], v[36:39]
    s_waitcnt lgkmcnt(0)
    s_barrier
    v_mfma_f32_16x16x32_bf16 v[0:3], a[52:55], a[8:11], v[0:3]
    ds_read_b128 a[0:3], v135 offset:32768
    ds_read_b128 a[4:7], v135 offset:36864
    v_mfma_f32_16x16x32_bf16 v[20:23], a[52:55], a[12:15], v[20:23]
    ds_read_b64_tr_b16 a[32:33], v134 offset:20480
    v_mfma_f32_16x16x32_bf16 v[4:7], a[56:59], a[8:11], v[4:7]
    ds_read_b64_tr_b16 a[34:35], v134 offset:23040
    v_mfma_f32_16x16x32_bf16 v[24:27], a[56:59], a[12:15], v[24:27]
    ds_read_b64_tr_b16 a[36:37], v134 offset:20512
    v_mfma_f32_16x16x32_bf16 v[8:11], a[60:63], a[8:11], v[8:11]
    ds_read_b64_tr_b16 a[38:39], v134 offset:23072
    v_mfma_f32_16x16x32_bf16 v[28:31], a[60:63], a[12:15], v[28:31]
    ds_read_b64_tr_b16 a[40:41], v134 offset:20544
    ds_read_b64_tr_b16 a[42:43], v134 offset:23104
    v_mfma_f32_16x16x32_bf16 v[12:15], a[64:67], a[8:11], v[12:15]
    ds_read_b64_tr_b16 a[44:45], v134 offset:20576
    v_mfma_f32_16x16x32_bf16 v[32:35], a[64:67], a[12:15], v[32:35]
    ds_read_b64_tr_b16 a[46:47], v134 offset:23136
    v_mfma_f32_16x16x32_bf16 v[16:19], a[68:71], a[8:11], v[16:19]
    ds_read_b64_tr_b16 a[48:49], v134 offset:20608
    v_mfma_f32_16x16x32_bf16 v[36:39], a[68:71], a[12:15], v[36:39]
    ds_read_b64_tr_b16 a[50:51], v134 offset:23168
    s_waitcnt lgkmcnt(0)
    v_mfma_f32_16x16x32_bf16 v[0:3], a[32:35], a[0:3], v[0:3]
    ds_read_b128 a[8:11], v135 offset:34816
    ds_read_b128 a[12:15], v135 offset:38912
    v_mfma_f32_16x16x32_bf16 v[20:23], a[32:35], a[4:7], v[20:23]
    ds_read_b64_tr_b16 a[52:53], v134 offset:30720
    ds_read_b64_tr_b16 a[54:55], v134 offset:33280
    v_mfma_f32_16x16x32_bf16 v[4:7], a[36:39], a[0:3], v[4:7]
    ds_read_b64_tr_b16 a[56:57], v134 offset:30752
    ds_read_b64_tr_b16 a[58:59], v134 offset:33312
    v_mfma_f32_16x16x32_bf16 v[24:27], a[36:39], a[4:7], v[24:27]
    ds_read_b64_tr_b16 a[60:61], v134 offset:30784
    ds_read_b64_tr_b16 a[62:63], v134 offset:33344
    v_mfma_f32_16x16x32_bf16 v[8:11], a[40:43], a[0:3], v[8:11]
    ds_read_b64_tr_b16 a[64:65], v134 offset:30816
    ds_read_b64_tr_b16 a[66:67], v134 offset:33376
    v_mfma_f32_16x16x32_bf16 v[28:31], a[40:43], a[4:7], v[28:31]
    ds_read_b64_tr_b16 a[68:69], v134 offset:30848
    ds_read_b64_tr_b16 a[70:71], v134 offset:33408
    v_mfma_f32_16x16x32_bf16 v[12:15], a[44:47], a[0:3], v[12:15]
    v_mfma_f32_16x16x32_bf16 v[32:35], a[44:47], a[4:7], v[32:35]
    v_mfma_f32_16x16x32_bf16 v[16:19], a[48:51], a[0:3], v[16:19]
    v_mfma_f32_16x16x32_bf16 v[36:39], a[48:51], a[4:7], v[36:39]
    s_waitcnt lgkmcnt(0)
    s_barrier
    v_mfma_f32_16x16x32_bf16 v[0:3], a[52:55], a[8:11], v[0:3]
    ds_read_b128 a[0:3], v135 offset:0
    ds_read_b128 a[4:7], v135 offset:4096
    v_mfma_f32_16x16x32_bf16 v[20:23], a[52:55], a[12:15], v[20:23]
    ds_read_b64_tr_b16 a[32:33], v133 offset:0
    v_mfma_f32_16x16x32_bf16 v[4:7], a[56:59], a[8:11], v[4:7]
    ds_read_b64_tr_b16 a[34:35], v133 offset:2560
    v_mfma_f32_16x16x32_bf16 v[24:27], a[56:59], a[12:15], v[24:27]
    ds_read_b64_tr_b16 a[36:37], v133 offset:32
    v_mfma_f32_16x16x32_bf16 v[8:11], a[60:63], a[8:11], v[8:11]
    ds_read_b64_tr_b16 a[38:39], v133 offset:2592
    v_mfma_f32_16x16x32_bf16 v[28:31], a[60:63], a[12:15], v[28:31]
    ds_read_b64_tr_b16 a[40:41], v133 offset:64
    ds_read_b64_tr_b16 a[42:43], v133 offset:2624
    v_mfma_f32_16x16x32_bf16 v[12:15], a[64:67], a[8:11], v[12:15]
    ds_read_b64_tr_b16 a[44:45], v133 offset:96
    v_mfma_f32_16x16x32_bf16 v[32:35], a[64:67], a[12:15], v[32:35]
    ds_read_b64_tr_b16 a[46:47], v133 offset:2656
    v_mfma_f32_16x16x32_bf16 v[16:19], a[68:71], a[8:11], v[16:19]
    ds_read_b64_tr_b16 a[48:49], v133 offset:128
    v_mfma_f32_16x16x32_bf16 v[36:39], a[68:71], a[12:15], v[36:39]
    ds_read_b64_tr_b16 a[50:51], v133 offset:2688
    s_waitcnt lgkmcnt(0)
    v_mfma_f32_16x16x32_bf16 v[0:3], a[32:35], a[0:3], v[0:3]
    ds_read_b128 a[8:11], v135 offset:2048
    ds_read_b128 a[12:15], v135 offset:6144
    v_mfma_f32_16x16x32_bf16 v[20:23], a[32:35], a[4:7], v[20:23]
    ds_read_b64_tr_b16 a[52:53], v133 offset:10240
    ds_read_b64_tr_b16 a[54:55], v133 offset:12800
    v_mfma_f32_16x16x32_bf16 v[4:7], a[36:39], a[0:3], v[4:7]
    ds_read_b64_tr_b16 a[56:57], v133 offset:10272
    ds_read_b64_tr_b16 a[58:59], v133 offset:12832
    v_mfma_f32_16x16x32_bf16 v[24:27], a[36:39], a[4:7], v[24:27]
    ds_read_b64_tr_b16 a[60:61], v133 offset:10304
    ds_read_b64_tr_b16 a[62:63], v133 offset:12864
    v_mfma_f32_16x16x32_bf16 v[8:11], a[40:43], a[0:3], v[8:11]
    ds_read_b64_tr_b16 a[64:65], v133 offset:10336
    ds_read_b64_tr_b16 a[66:67], v133 offset:12896
    v_mfma_f32_16x16x32_bf16 v[28:31], a[40:43], a[4:7], v[28:31]
    ds_read_b64_tr_b16 a[68:69], v133 offset:10368
    ds_read_b64_tr_b16 a[70:71], v133 offset:12928
    v_mfma_f32_16x16x32_bf16 v[12:15], a[44:47], a[0:3], v[12:15]
    v_mfma_f32_16x16x32_bf16 v[32:35], a[44:47], a[4:7], v[32:35]
    v_mfma_f32_16x16x32_bf16 v[16:19], a[48:51], a[0:3], v[16:19]
    v_mfma_f32_16x16x32_bf16 v[36:39], a[48:51], a[4:7], v[36:39]
    s_waitcnt lgkmcnt(0)
    s_barrier
    v_mfma_f32_16x16x32_bf16 v[0:3], a[52:55], a[8:11], v[0:3]
    ds_read_b128 a[0:3], v135 offset:16384
    ds_read_b128 a[4:7], v135 offset:20480
    v_mfma_f32_16x16x32_bf16 v[20:23], a[52:55], a[12:15], v[20:23]
    ds_read_b64_tr_b16 a[32:33], v133 offset:20480
    v_mfma_f32_16x16x32_bf16 v[4:7], a[56:59], a[8:11], v[4:7]
    ds_read_b64_tr_b16 a[34:35], v133 offset:23040
    v_mfma_f32_16x16x32_bf16 v[24:27], a[56:59], a[12:15], v[24:27]
    ds_read_b64_tr_b16 a[36:37], v133 offset:20512
    v_mfma_f32_16x16x32_bf16 v[8:11], a[60:63], a[8:11], v[8:11]
    ds_read_b64_tr_b16 a[38:39], v133 offset:23072
    v_mfma_f32_16x16x32_bf16 v[28:31], a[60:63], a[12:15], v[28:31]
    ds_read_b64_tr_b16 a[40:41], v133 offset:20544
    ds_read_b64_tr_b16 a[42:43], v133 offset:23104
    v_mfma_f32_16x16x32_bf16 v[12:15], a[64:67], a[8:11], v[12:15]
    ds_read_b64_tr_b16 a[44:45], v133 offset:20576
    v_mfma_f32_16x16x32_bf16 v[32:35], a[64:67], a[12:15], v[32:35]
    ds_read_b64_tr_b16 a[46:47], v133 offset:23136
    v_mfma_f32_16x16x32_bf16 v[16:19], a[68:71], a[8:11], v[16:19]
    ds_read_b64_tr_b16 a[48:49], v133 offset:20608
    v_mfma_f32_16x16x32_bf16 v[36:39], a[68:71], a[12:15], v[36:39]
    ds_read_b64_tr_b16 a[50:51], v133 offset:23168
    s_waitcnt lgkmcnt(0)
    v_mfma_f32_16x16x32_bf16 v[0:3], a[32:35], a[0:3], v[0:3]
    ds_read_b128 a[8:11], v135 offset:18432
    ds_read_b128 a[12:15], v135 offset:22528
    v_mfma_f32_16x16x32_bf16 v[20:23], a[32:35], a[4:7], v[20:23]
    ds_read_b64_tr_b16 a[52:53], v133 offset:30720
    ds_read_b64_tr_b16 a[54:55], v133 offset:33280
    v_mfma_f32_16x16x32_bf16 v[4:7], a[36:39], a[0:3], v[4:7]
    ds_read_b64_tr_b16 a[56:57], v133 offset:30752
    ds_read_b64_tr_b16 a[58:59], v133 offset:33312
    v_mfma_f32_16x16x32_bf16 v[24:27], a[36:39], a[4:7], v[24:27]
    ds_read_b64_tr_b16 a[60:61], v133 offset:30784
    ds_read_b64_tr_b16 a[62:63], v133 offset:33344
    v_mfma_f32_16x16x32_bf16 v[8:11], a[40:43], a[0:3], v[8:11]
    ds_read_b64_tr_b16 a[64:65], v133 offset:30816
    ds_read_b64_tr_b16 a[66:67], v133 offset:33376
    v_mfma_f32_16x16x32_bf16 v[28:31], a[40:43], a[4:7], v[28:31]
    ds_read_b64_tr_b16 a[68:69], v133 offset:30848
    ds_read_b64_tr_b16 a[70:71], v133 offset:33408
    v_mfma_f32_16x16x32_bf16 v[12:15], a[44:47], a[0:3], v[12:15]
    v_mfma_f32_16x16x32_bf16 v[32:35], a[44:47], a[4:7], v[32:35]
    v_mfma_f32_16x16x32_bf16 v[16:19], a[48:51], a[0:3], v[16:19]
    v_mfma_f32_16x16x32_bf16 v[36:39], a[48:51], a[4:7], v[36:39]
    s_waitcnt lgkmcnt(0)
    v_mfma_f32_16x16x32_bf16 v[0:3], a[52:55], a[8:11], v[0:3]
    ds_read_b32 v92, v140 offset:3072
    v_mfma_f32_16x16x32_bf16 v[20:23], a[52:55], a[12:15], v[20:23]
    ds_read_b32 v96, v140 offset:7168
    v_mfma_f32_16x16x32_bf16 v[4:7], a[56:59], a[8:11], v[4:7]
    ds_read_b128 v[80:83], v138
    v_mfma_f32_16x16x32_bf16 v[24:27], a[56:59], a[12:15], v[24:27]
    ds_read_b128 v[84:87], v138 offset:1024
    v_mfma_f32_16x16x32_bf16 v[8:11], a[60:63], a[8:11], v[8:11]
    ds_read_b64 v[88:89], v139 offset:2048
    v_mfma_f32_16x16x32_bf16 v[28:31], a[60:63], a[12:15], v[28:31]
    v_mfma_f32_16x16x32_bf16 v[12:15], a[64:67], a[8:11], v[12:15]
    v_mfma_f32_16x16x32_bf16 v[32:35], a[64:67], a[12:15], v[32:35]
    v_mfma_f32_16x16x32_bf16 v[16:19], a[68:71], a[8:11], v[16:19]
    v_mfma_f32_16x16x32_bf16 v[36:39], a[68:71], a[12:15], v[36:39]
    s_waitcnt lgkmcnt(0)
    v_cvt_pk_bf16_f32 v92, v92, v92
    v_and_b32 v92, s72, v92
    v_sub_f32 v94, 1.0, v92
    v_cvt_pk_bf16_f32 v94, v94, v94
    v_and_b32 v94, s72, v94
    v_pk_mul_f32 v[40:41], v[40:41], v[92:93] op_sel_hi:[1,0]
    v_pk_mul_f32 v[42:43], v[42:43], v[92:93] op_sel_hi:[1,0]
    v_pk_mul_f32 v[44:45], v[44:45], v[92:93] op_sel_hi:[1,0]
    v_pk_mul_f32 v[46:47], v[46:47], v[92:93] op_sel_hi:[1,0]
    v_pk_mul_f32 v[48:49], v[48:49], v[92:93] op_sel_hi:[1,0]
    v_pk_mul_f32 v[50:51], v[50:51], v[92:93] op_sel_hi:[1,0]
    v_pk_mul_f32 v[52:53], v[52:53], v[92:93] op_sel_hi:[1,0]
    v_pk_mul_f32 v[54:55], v[54:55], v[92:93] op_sel_hi:[1,0]
    v_pk_mul_f32 v[56:57], v[56:57], v[92:93] op_sel_hi:[1,0]
    v_pk_mul_f32 v[58:59], v[58:59], v[92:93] op_sel_hi:[1,0]
    v_pk_fma_f32 v[0:1], v[0:1], v[94:95], v[40:41] op_sel_hi:[1,0,1]
    v_pk_fma_f32 v[2:3], v[2:3], v[94:95], v[42:43] op_sel_hi:[1,0,1]
    v_pk_fma_f32 v[4:5], v[4:5], v[94:95], v[44:45] op_sel_hi:[1,0,1]
    v_pk_fma_f32 v[6:7], v[6:7], v[94:95], v[46:47] op_sel_hi:[1,0,1]
    v_pk_fma_f32 v[8:9], v[8:9], v[94:95], v[48:49] op_sel_hi:[1,0,1]
    v_pk_fma_f32 v[10:11], v[10:11], v[94:95], v[50:51] op_sel_hi:[1,0,1]
    v_pk_fma_f32 v[12:13], v[12:13], v[94:95], v[52:53] op_sel_hi:[1,0,1]
    v_pk_fma_f32 v[14:15], v[14:15], v[94:95], v[54:55] op_sel_hi:[1,0,1]
    v_pk_fma_f32 v[16:17], v[16:17], v[94:95], v[56:57] op_sel_hi:[1,0,1]
    v_pk_fma_f32 v[18:19], v[18:19], v[94:95], v[58:59] op_sel_hi:[1,0,1]
    v_cvt_pk_bf16_f32 v96, v96, v96
    v_and_b32 v96, s72, v96
    v_sub_f32 v98, 1.0, v96
    v_cvt_pk_bf16_f32 v98, v98, v98
    v_and_b32 v98, s72, v98
    v_pk_mul_f32 v[60:61], v[60:61], v[96:97] op_sel_hi:[1,0]
    v_pk_mul_f32 v[62:63], v[62:63], v[96:97] op_sel_hi:[1,0]
    v_pk_mul_f32 v[64:65], v[64:65], v[96:97] op_sel_hi:[1,0]
    v_pk_mul_f32 v[66:67], v[66:67], v[96:97] op_sel_hi:[1,0]
    v_pk_mul_f32 v[68:69], v[68:69], v[96:97] op_sel_hi:[1,0]
    v_pk_mul_f32 v[70:71], v[70:71], v[96:97] op_sel_hi:[1,0]
    v_pk_mul_f32 v[72:73], v[72:73], v[96:97] op_sel_hi:[1,0]
    v_pk_mul_f32 v[74:75], v[74:75], v[96:97] op_sel_hi:[1,0]
    v_pk_mul_f32 v[76:77], v[76:77], v[96:97] op_sel_hi:[1,0]
    v_pk_mul_f32 v[78:79], v[78:79], v[96:97] op_sel_hi:[1,0]
    v_pk_fma_f32 v[20:21], v[20:21], v[98:99], v[60:61] op_sel_hi:[1,0,1]
    v_pk_fma_f32 v[22:23], v[22:23], v[98:99], v[62:63] op_sel_hi:[1,0,1]
    v_pk_fma_f32 v[24:25], v[24:25], v[98:99], v[64:65] op_sel_hi:[1,0,1]
    v_pk_fma_f32 v[26:27], v[26:27], v[98:99], v[66:67] op_sel_hi:[1,0,1]
    v_pk_fma_f32 v[28:29], v[28:29], v[98:99], v[68:69] op_sel_hi:[1,0,1]
    v_pk_fma_f32 v[30:31], v[30:31], v[98:99], v[70:71] op_sel_hi:[1,0,1]
    v_pk_fma_f32 v[32:33], v[32:33], v[98:99], v[72:73] op_sel_hi:[1,0,1]
    v_pk_fma_f32 v[34:35], v[34:35], v[98:99], v[74:75] op_sel_hi:[1,0,1]
    v_pk_fma_f32 v[36:37], v[36:37], v[98:99], v[76:77] op_sel_hi:[1,0,1]
    v_pk_fma_f32 v[38:39], v[38:39], v[98:99], v[78:79] op_sel_hi:[1,0,1]
    s_cmp_eq_u32 s63, 0
    s_cbranch_scc1 p_ex0
    ds_write_b128 v136, v[0:3] offset:0
    ds_write_b128 v136, v[4:7] offset:1024
    ds_write_b128 v136, v[8:11] offset:2048
    ds_write_b128 v136, v[12:15] offset:3072
    ds_write_b128 v136, v[16:19] offset:4096
    v_mov_b32 v0, v20
    v_mov_b32 v1, v21
    v_mov_b32 v2, v22
    v_mov_b32 v3, v23
    v_mov_b32 v4, v24
    v_mov_b32 v5, v25
    v_mov_b32 v6, v26
    v_mov_b32 v7, v27
    v_mov_b32 v8, v28
    v_mov_b32 v9, v29
    v_mov_b32 v10, v30
    v_mov_b32 v11, v31
    v_mov_b32 v12, v32
    v_mov_b32 v13, v33
    v_mov_b32 v14, v34
    v_mov_b32 v15, v35
    v_mov_b32 v16, v36
    v_mov_b32 v17, v37
    v_mov_b32 v18, v38
    v_mov_b32 v19, v39
    v_mov_b32 v94, v98
    s_branch p_ex1
p_ex0:
    ds_write_b128 v136, v[20:23] offset:0
    ds_write_b128 v136, v[24:27] offset:1024
    ds_write_b128 v136, v[28:31] offset:2048
    ds_write_b128 v136, v[32:35] offset:3072
    ds_write_b128 v136, v[36:39] offset:4096
p_ex1:
    s_bitcmp1_b32 s83, 0
    s_cbranch_scc1 p_odd4
    v_lshlrev_b32 v40, 16, v80
    v_and_b32 v41, s72, v80
    v_lshlrev_b32 v42, 16, v81
    v_and_b32 v43, s72, v81
    v_lshlrev_b32 v44, 16, v82
    v_and_b32 v45, s72, v82
    v_lshlrev_b32 v46, 16, v83
    v_and_b32 v47, s72, v83
    v_lshlrev_b32 v48, 16, v84
    v_and_b32 v49, s72, v84
    v_lshlrev_b32 v50, 16, v85
    v_and_b32 v51, s72, v85
    v_lshlrev_b32 v52, 16, v86
    v_and_b32 v53, s72, v86
    v_lshlrev_b32 v54, 16, v87
    v_and_b32 v55, s72, v87
    v_lshlrev_b32 v56, 16, v88
    v_and_b32 v57, s72, v88
    v_lshlrev_b32 v58, 16, v89
    v_and_b32 v59, s72, v89
    s_branch p_join4
p_odd4:
    v_lshlrev_b32 v40, 16, v88
    v_and_b32 v41, s72, v88
    v_lshlrev_b32 v42, 16, v89
    v_and_b32 v43, s72, v89
    v_lshlrev_b32 v44, 16, v80
    v_and_b32 v45, s72, v80
    v_lshlrev_b32 v46, 16, v81
    v_and_b32 v47, s72, v81
    v_lshlrev_b32 v48, 16, v82
    v_and_b32 v49, s72, v82
    v_lshlrev_b32 v50, 16, v83
    v_and_b32 v51, s72, v83
    v_lshlrev_b32 v52, 16, v84
    v_and_b32 v53, s72, v84
    v_lshlrev_b32 v54, 16, v85
    v_and_b32 v55, s72, v85
    v_lshlrev_b32 v56, 16, v86
    v_and_b32 v57, s72, v86
    v_lshlrev_b32 v58, 16, v87
    v_and_b32 v59, s72, v87
p_join4:
    s_waitcnt lgkmcnt(0)
    s_barrier
    ds_read_b128 v[20:23], v137 offset:0
    ds_read_b128 v[24:27], v137 offset:1024
    ds_read_b128 v[28:31], v137 offset:2048
    ds_read_b128 v[32:35], v137 offset:3072
    ds_read_b128 v[36:39], v137 offset:4096
    v_pk_fma_f32 v[0:1], v[40:41], v[94:95], v[0:1] op_sel_hi:[1,0,1]
    v_pk_fma_f32 v[2:3], v[42:43], v[94:95], v[2:3] op_sel_hi:[1,0,1]
    v_pk_fma_f32 v[4:5], v[44:45], v[94:95], v[4:5] op_sel_hi:[1,0,1]
    v_pk_fma_f32 v[6:7], v[46:47], v[94:95], v[6:7] op_sel_hi:[1,0,1]
    v_pk_fma_f32 v[8:9], v[48:49], v[94:95], v[8:9] op_sel_hi:[1,0,1]
    v_pk_fma_f32 v[10:11], v[50:51], v[94:95], v[10:11] op_sel_hi:[1,0,1]
    v_pk_fma_f32 v[12:13], v[52:53], v[94:95], v[12:13] op_sel_hi:[1,0,1]
    v_pk_fma_f32 v[14:15], v[54:55], v[94:95], v[14:15] op_sel_hi:[1,0,1]
    v_pk_fma_f32 v[16:17], v[56:57], v[94:95], v[16:17] op_sel_hi:[1,0,1]
    v_pk_fma_f32 v[18:19], v[58:59], v[94:95], v[18:19] op_sel_hi:[1,0,1]
    s_waitcnt lgkmcnt(0)
    v_pk_add_f32 v[0:1], v[0:1], v[20:21]
    v_pk_add_f32 v[2:3], v[2:3], v[22:23]
    v_pk_add_f32 v[4:5], v[4:5], v[24:25]
    v_pk_add_f32 v[6:7], v[6:7], v[26:27]
    v_pk_add_f32 v[8:9], v[8:9], v[28:29]
    v_pk_add_f32 v[10:11], v[10:11], v[30:31]
    v_pk_add_f32 v[12:13], v[12:13], v[32:33]
    v_pk_add_f32 v[14:15], v[14:15], v[34:35]
    v_pk_add_f32 v[16:17], v[16:17], v[36:37]
    v_pk_add_f32 v[18:19], v[18:19], v[38:39]
    v_cvt_pk_bf16_f32 v60, v0, v1
    v_cvt_pk_bf16_f32 v61, v2, v3
    v_cvt_pk_bf16_f32 v62, v4, v5
    v_cvt_pk_bf16_f32 v63, v6, v7
    v_cvt_pk_bf16_f32 v64, v8, v9
    v_cvt_pk_bf16_f32 v65, v10, v11
    v_cvt_pk_bf16_f32 v66, v12, v13
    v_cvt_pk_bf16_f32 v67, v14, v15
    v_cvt_pk_bf16_f32 v68, v16, v17
    v_cvt_pk_bf16_f32 v69, v18, v19
    ds_write_b64 v116, v[60:61] offset:0
    ds_write_b64 v116, v[62:63] offset:32
    ds_write_b64 v116, v[64:65] offset:64
    ds_write_b64 v116, v[66:67] offset:96
    ds_write_b64 v116, v[68:69] offset:128
    s_waitcnt lgkmcnt(0)
    ds_read_b128 v[76:79], v117
    ds_read_b128 v[80:83], v118
    ds_read_b128 v[84:87], v119
    s_waitcnt lgkmcnt(2)
    buffer_store_dwordx4 v[76:79], v120, s[56:59], 0 offen
    s_waitcnt lgkmcnt(1)
    buffer_store_dwordx4 v[80:83], v121, s[56:59], 0 offen
    s_waitcnt lgkmcnt(0)
    buffer_store_dwordx4 v[84:87], v122, s[56:59], 0 offen
    s_endpgm
p_loader:
    s_sub_u32 s8, s8, 4
    v_subrev_u32 v20, 256, v0
    s_and_b32 s42, s10, 3
    s_mul_i32 s42, s42, 3
    s_mul_i32 s11, s4, 1
    s_add_u32 s42, s42, s11
    s_mul_i32 s11, s3, 5
    s_add_u32 s42, s42, s11
    s_mul_i32 s11, s42, 6554
    s_lshr_b32 s11, s11, 16
    s_mul_i32 s11, s11, 10
    s_sub_u32 s42, s42, s11
    s_lshl_b32 s61, s8, 12
    s_mul_i32 s62, s8, 5120
    s_lshl_b32 s60, s8, 11
    s_lshl_b32 s11, s5, 7
    s_lshl_b32 s12, s8, 5
    s_and_b32 s13, s4, 1
    s_lshl_b32 s13, s13, 2
    s_add_u32 s13, s13, s8
    s_lshl_b32 s13, s13, 4
    s_cmp_eq_u32 s6, 0
    s_cselect_b32 s12, s12, s13
    s_add_u32 s11, s11, s12
    v_lshrrev_b32 v120, 3, v128
    v_add_u32 v120, s11, v120
    v_mul_u32_u24 v120, 1280, v120
    v_and_b32 v121, 7, v128
    v_xor_b32 v121, v121, v130
    v_lshl_add_u32 v0, v121, 4, v120
    v_xor_b32 v121, 4, v121
    v_lshl_add_u32 v1, v121, 4, v120
    v_add_u32 v1, 9216, v1
    v_add_u32 v2, 18432, v0
    v_add_u32 v3, 18432, v1
    s_mul_i32 s11, s7, 160
    s_add_u32 s11, s11, 1280
    s_lshr_b32 s12, s7, 1
    s_mul_i32 s12, s12, 320
    s_movk_i32 s84, 1280
    s_cmp_eq_u32 s6, 0
    s_cselect_b32 s85, s11, s12
    s_cselect_b32 s86, 1120, 0
    s_cselect_b32 s84, 3840, s84
    s_lshl_b32 s87, s84, 6
    s_waitcnt lgkmcnt(0)
    s_mov_b32 s44, s16
    s_mov_b32 s45, s17
    s_mov_b32 s46, 2621440
    s_mov_b32 s47, 0x20000
    s_cmp_eq_u32 s6, 1
    s_cbranch_scc1 p_ld_w
    s_lshl_b32 s14, s42, 7
    s_add_u32 m0, s61, 0
    s_mul_i32 s15, s42, s87
    buffer_load_dwordx4 v0, s[44:47], s14 offen offset:0  lds
    buffer_load_dwordx4 v1, s[44:47], s14 offen offset:1024  lds
    buffer_load_dwordx4 v2, s[44:47], s14 offen offset:2048  lds
    buffer_load_dwordx4 v3, s[44:47], s14 offen offset:3072  lds
    s_mul_i32 s12, s8, 320
    v_add_u32 v126, s12, v128
    v_add_u32 v120, 0, v126
    v_mul_u32_u24 v121, 3277, v120
    v_lshrrev_b32 v121, 16, v121
    v_mul_u32_u24 v122, 20, v121
    v_sub_u32 v120, v120, v122
    v_lshrrev_b32 v122, 1, v121
    v_and_b32 v122, 2, v122
    v_xor_b32 v120, v120, v122
    v_and_b32 v123, 35, v121
    v_and_b32 v122, 12, v121
    v_lshl_or_b32 v123, v122, 1, v123
    v_bfe_u32 v122, v121, 4, 1
    v_lshl_or_b32 v123, v122, 2, v123
    v_mul_lo_u32 v123, v123, s84
    v_lshl_add_u32 v123, v120, 4, v123
    v_cmp_le_u32 vcc, 10, v120
    v_mov_b32 v122, s86
    s_nop 0
    v_cndmask_b32 v122, 0, v122, vcc
    v_add3_u32 v4, v123, v122, s85
    v_add_u32 v120, 64, v126
    v_mul_u32_u24 v121, 3277, v120
    v_lshrrev_b32 v121, 16, v121
    v_mul_u32_u24 v122, 20, v121
    v_sub_u32 v120, v120, v122
    v_lshrrev_b32 v122, 1, v121
    v_and_b32 v122, 2, v122
    v_xor_b32 v120, v120, v122
    v_and_b32 v123, 35, v121
    v_and_b32 v122, 12, v121
    v_lshl_or_b32 v123, v122, 1, v123
    v_bfe_u32 v122, v121, 4, 1
    v_lshl_or_b32 v123, v122, 2, v123
    v_mul_lo_u32 v123, v123, s84
    v_lshl_add_u32 v123, v120, 4, v123
    v_cmp_le_u32 vcc, 10, v120
    v_mov_b32 v122, s86
    s_nop 0
    v_cndmask_b32 v122, 0, v122, vcc
    v_add3_u32 v5, v123, v122, s85
    v_subrev_u32 v5, 1024, v5
    v_add_u32 v120, 128, v126
    v_mul_u32_u24 v121, 3277, v120
    v_lshrrev_b32 v121, 16, v121
    v_mul_u32_u24 v122, 20, v121
    v_sub_u32 v120, v120, v122
    v_lshrrev_b32 v122, 1, v121
    v_and_b32 v122, 2, v122
    v_xor_b32 v120, v120, v122
    v_and_b32 v123, 35, v121
    v_and_b32 v122, 12, v121
    v_lshl_or_b32 v123, v122, 1, v123
    v_bfe_u32 v122, v121, 4, 1
    v_lshl_or_b32 v123, v122, 2, v123
    v_mul_lo_u32 v123, v123, s84
    v_lshl_add_u32 v123, v120, 4, v123
    v_cmp_le_u32 vcc, 10, v120
    v_mov_b32 v122, s86
    s_nop 0
    v_cndmask_b32 v122, 0, v122, vcc
    v_add3_u32 v6, v123, v122, s85
    v_subrev_u32 v6, 2048, v6
    v_add_u32 v120, 192, v126
    v_mul_u32_u24 v121, 3277, v120
    v_lshrrev_b32 v121, 16, v121
    v_mul_u32_u24 v122, 20, v121
    v_sub_u32 v120, v120, v122
    v_lshrrev_b32 v122, 1, v121
    v_and_b32 v122, 2, v122
    v_xor_b32 v120, v120, v122
    v_and_b32 v123, 35, v121
    v_and_b32 v122, 12, v121
    v_lshl_or_b32 v123, v122, 1, v123
    v_bfe_u32 v122, v121, 4, 1
    v_lshl_or_b32 v123, v122, 2, v123
    v_mul_lo_u32 v123, v123, s84
    v_lshl_add_u32 v123, v120, 4, v123
    v_cmp_le_u32 vcc, 10, v120
    v_mov_b32 v122, s86
    s_nop 0
    v_cndmask_b32 v122, 0, v122, vcc
    v_add3_u32 v7, v123, v122, s85
    v_subrev_u32 v7, 3072, v7
    v_add_u32 v120, 256, v126
    v_mul_u32_u24 v121, 3277, v120
    v_lshrrev_b32 v121, 16, v121
    v_mul_u32_u24 v122, 20, v121
    v_sub_u32 v120, v120, v122
    v_lshrrev_b32 v122, 1, v121
    v_and_b32 v122, 2, v122
    v_xor_b32 v120, v120, v122
    v_and_b32 v123, 35, v121
    v_and_b32 v122, 12, v121
    v_lshl_or_b32 v123, v122, 1, v123
    v_bfe_u32 v122, v121, 4, 1
    v_lshl_or_b32 v123, v122, 2, v123
    v_mul_lo_u32 v123, v123, s84
    v_lshl_add_u32 v123, v120, 4, v123
    v_cmp_le_u32 vcc, 10, v120
    v_mov_b32 v122, s86
    s_nop 0
    v_cndmask_b32 v122, 0, v122, vcc
    v_add3_u32 v8, v123, v122, s85
    s_mov_b32 s48, s18
    s_mov_b32 s49, s19
    s_mov_b32 s50, 2457600
    s_mov_b32 s51, 0x20000
    s_add_u32 m0, s62, 16384
    s_add_u32 s42, s42, 1
    buffer_load_dwordx4 v4, s[48:51], s15 offen offset:0  lds
    buffer_load_dwordx4 v5, s[48:51], s15 offen offset:1024  lds
    buffer_load_dwordx4 v6, s[48:51], s15 offen offset:2048  lds
    buffer_load_dwordx4 v7, s[48:51], s15 offen offset:3072  lds
    s_add_u32 m0, m0, 4096
    s_nop 0
    buffer_load_dwordx4 v8, s[48:51], s15 offen  lds
    s_cmp_eq_u32 s42, 10
    s_cselect_b32 s42, 0, s42
    s_lshl_b32 s14, s42, 7
    s_add_u32 m0, s61, 36864
    s_mul_i32 s15, s42, s87
    buffer_load_dwordx4 v0, s[44:47], s14 offen offset:0  lds
    buffer_load_dwordx4 v1, s[44:47], s14 offen offset:1024  lds
    buffer_load_dwordx4 v2, s[44:47], s14 offen offset:2048  lds
    buffer_load_dwordx4 v3, s[44:47], s14 offen offset:3072  lds
    s_add_u32 m0, s62, 53248
    s_add_u32 s42, s42, 1
    buffer_load_dwordx4 v4, s[48:51], s15 offen offset:0  lds
    buffer_load_dwordx4 v5, s[48:51], s15 offen offset:1024  lds
    buffer_load_dwordx4 v6, s[48:51], s15 offen offset:2048  lds
    buffer_load_dwordx4 v7, s[48:51], s15 offen offset:3072  lds
    s_add_u32 m0, m0, 4096
    s_nop 0
    buffer_load_dwordx4 v8, s[48:51], s15 offen  lds
    s_cmp_eq_u32 s42, 10
    s_cselect_b32 s42, 0, s42
    v_mov_b32 v120, 163808
    s_mov_b32 s78, 87040
    v_mov_b32 v44, 0
    v_mov_b32 v45, 0
    v_mov_b32 v46, 0
    v_mov_b32 v47, 0
    ds_write_b128 v120, v[44:47]
    ds_write_b128 v120, v[44:47] offset:16
    s_mov_b32 s88, s38
    s_mov_b32 s89, s39
    s_mov_b32 s90, 256
    s_mov_b32 s91, 0x20000
    s_mov_b32 s56, s20
    s_mov_b32 s57, s21
    s_mov_b32 s58, 25600
    s_mov_b32 s59, 0x20000
    v_add_u32 v120, 0, v20
    v_mul_u32_u24 v121, 13108, v120
    v_lshrrev_b32 v121, 16, v121
    v_mul_u32_u24 v123, 5, v121
    v_sub_u32 v122, v120, v123
    v_mul_u32_u24 v123, 3277, v121
    v_lshrrev_b32 v123, 16, v123
    v_lshlrev_b32 v123, 3, v123
    v_lshl_add_u32 v123, v122, 5, v123
    v_mul_u32_u24 v18, 160, v121
    v_add_u32 v18, v18, v123
    v_add_u32 v18, 73728, v18
    v_lshlrev_b32 v124, 3, v120
    v_add_u32 v120, 256, v20
    v_mul_u32_u24 v121, 13108, v120
    v_lshrrev_b32 v121, 16, v121
    v_mul_u32_u24 v123, 5, v121
    v_sub_u32 v122, v120, v123
    v_mul_u32_u24 v123, 3277, v121
    v_lshrrev_b32 v123, 16, v123
    v_lshlrev_b32 v123, 3, v123
    v_lshl_add_u32 v123, v122, 5, v123
    v_mul_u32_u24 v19, 160, v121
    v_add_u32 v19, v19, v123
    v_add_u32 v19, 73728, v19
    v_lshlrev_b32 v125, 3, v120
    v_cmp_gt_u32 vcc, 400, v120
    v_mov_b32 v123, s79
    s_nop 0
    v_cndmask_b32 v125, v123, v125, vcc
    v_mov_b32 v123, 86528
    v_cndmask_b32 v19, v123, v19, vcc
    s_waitcnt lgkmcnt(0)
    s_waitcnt vmcnt(9)
    s_barrier
    s_lshl_b32 s14, s42, 7
    s_add_u32 m0, s61, 73728
    s_mul_i32 s15, s42, s87
    buffer_load_dwordx4 v0, s[44:47], s14 offen offset:0  lds
    buffer_load_dwordx4 v1, s[44:47], s14 offen offset:1024  lds
    buffer_load_dwordx4 v2, s[44:47], s14 offen offset:2048  lds
    buffer_load_dwordx4 v3, s[44:47], s14 offen offset:3072  lds
    s_add_u32 m0, s62, 90112
    s_add_u32 s42, s42, 1
    buffer_load_dwordx4 v4, s[48:51], s15 offen offset:0  lds
    buffer_load_dwordx4 v5, s[48:51], s15 offen offset:1024  lds
    buffer_load_dwordx4 v6, s[48:51], s15 offen offset:2048  lds
    buffer_load_dwordx4 v7, s[48:51], s15 offen offset:3072  lds
    s_add_u32 m0, m0, 4096
    s_nop 0
    buffer_load_dwordx4 v8, s[48:51], s15 offen  lds
    s_cmp_eq_u32 s42, 10
    s_cselect_b32 s42, 0, s42
    s_mul_i32 s12, s7, 3200
    buffer_load_dwordx2 v[10:11], v124, s[56:59], s12 offen
    buffer_load_dwordx2 v[12:13], v125, s[56:59], s12 offen
    s_getpc_b64 s[52:53]
pc_13:
    s_add_u32 s52, s52, text_begin-pc_13
    s_addc_u32 s53, s53, -1
    s_mov_b32 s54, text_end-text_begin
    s_mov_b32 s55, 0x20000
    s_lshl_b32 s101, s10, 2
    s_add_u32 s101, s101, s8
    s_lshl_b32 s101, s101, 10
    buffer_load_dwordx4 v[116:119], v143, s[52:55], s101 offen
    s_mov_b32 s52, s40
    s_mov_b32 s53, s41
    s_mov_b32 s54, 17498112
    s_mov_b32 s55, 0x20000
    s_lshl_b32 s11, s5, 3
    s_add_u32 s11, s11, s7
    s_lshl_b32 s11, s11, 2
    s_add_u32 s11, s11, s8
    s_mov_b32 s96, s18
    s_mov_b32 s97, s19
    s_mov_b32 s98, 2457600
    s_mov_b32 s99, 0x20000
    s_cmp_lt_u32 s11, 128
    s_mul_i32 s11, s11, 3840
    s_cselect_b32 s12, 1966080, s79
    s_add_u32 s12, s12, s11
    buffer_load_dwordx4 v[112:115], v143, s[96:99], s11 offen offset:0
    buffer_load_dwordx4 v[116:119], v143, s[96:99], s11 offen offset:256
    buffer_load_dwordx4 v[112:115], v143, s[96:99], s12 offen offset:0
    buffer_load_dwordx4 v[116:119], v143, s[96:99], s12 offen offset:256
    s_waitcnt vmcnt(16)
    s_barrier
    s_lshl_b32 s14, s42, 7
    s_add_u32 m0, s61, 110592
    s_mul_i32 s15, s42, s87
    buffer_load_dwordx4 v0, s[44:47], s14 offen offset:0  lds
    buffer_load_dwordx4 v1, s[44:47], s14 offen offset:1024  lds
    buffer_load_dwordx4 v2, s[44:47], s14 offen offset:2048  lds
    buffer_load_dwordx4 v3, s[44:47], s14 offen offset:3072  lds
    s_add_u32 m0, s62, 126976
    s_add_u32 s42, s42, 1
    buffer_load_dwordx4 v4, s[48:51], s15 offen offset:0  lds
    buffer_load_dwordx4 v5, s[48:51], s15 offen offset:1024  lds
    buffer_load_dwordx4 v6, s[48:51], s15 offen offset:2048  lds
    buffer_load_dwordx4 v7, s[48:51], s15 offen offset:3072  lds
    s_add_u32 m0, m0, 4096
    s_nop 0
    buffer_load_dwordx4 v8, s[48:51], s15 offen  lds
    s_cmp_eq_u32 s42, 10
    s_cselect_b32 s42, 0, s42
    s_and_b32 s13, s10, 3
    s_and_b32 s12, s4, 3
    s_add_u32 s92, s13, s12
    s_and_b32 s92, s92, 3
    s_mul_i32 s81, s92, 5
    s_mul_i32 s80, s13, 3
    s_lshl_b32 s12, s12, 1
    s_add_u32 s80, s80, s12
    s_mul_i32 s11, s80, 6554
    s_lshr_b32 s11, s11, 16
    s_mul_i32 s11, s11, 10
    s_sub_u32 s80, s80, s11
    s_lshl_b32 s82, s13, 1
    s_and_b32 s11, s4, 1
    s_add_u32 s82, s82, s11
    s_mul_i32 s82, s82, 3
    s_lshr_b32 s82, s82, 1
    s_lshr_b32 s11, s4, 1
    s_mul_i32 s11, s11, 3
    s_add_u32 s82, s82, s11
    s_mul_i32 s11, s82, 5462
    s_lshr_b32 s11, s11, 16
    s_mul_i32 s11, s11, 12
    s_sub_u32 s82, s82, s11
    s_lshl_b32 s12, s8, 6
    v_add_u32 v127, s12, v128
    v_add_u32 v66, s62, v143
    v_add_u32 v67, 4096, v66
    v_add_u32 v68, 18432, v143
    v_add_u32 v69, 20480, v143
    s_lshl_b32 s93, s3, 2
    s_lshr_b32 s13, s4, 1
    s_add_u32 s93, s93, s13
    s_mul_i32 s93, s93, 348160
    s_add_u32 s93, s93, 14667776
    s_lshl_b32 s43, s5, 3
    s_lshl_b32 s11, s8, 1
    s_add_u32 s43, s43, s11
    s_mul_i32 s43, s43, 20480
    s_add_u32 s43, s43, 2871296
    s_lshl_b32 s94, s5, 1
    s_and_b32 s11, s4, 1
    s_add_u32 s94, s94, s11
    s_lshl_b32 s94, s94, 2
    s_add_u32 s94, s94, s8
    s_mul_i32 s95, s94, 20480
    s_add_u32 s95, s95, 5754880
    s_mul_i32 s94, s94, 49152
    s_add_u32 s94, s94, 8376320
    s_mul_i32 s83, s82, 27
    s_lshr_b32 s83, s83, 6
    s_lshl_b32 s11, s8, 3
    v_lshrrev_b32 v120, 3, v128
    v_add_u32 v120, s11, v120
    v_mul_u32_u24 v120, 3072, v120
    s_mul_i32 s11, s7, 128
    s_add_u32 s11, s11, 2048
    v_add_u32 v120, s11, v120
    v_and_b32 v121, 7, v128
    v_lshlrev_b32 v122, 1, v130
    v_xor_b32 v122, v121, v122
    v_lshl_add_u32 v56, v122, 4, v120
    s_mul_i32 s11, s7, 160
    v_add_u32 v120, 0, v127
    v_mul_u32_u24 v121, 6554, v120
    v_lshrrev_b32 v121, 16, v121
    v_mul_u32_u24 v122, 10, v121
    v_sub_u32 v120, v120, v122
    v_lshlrev_b32 v120, 4, v120
    v_add_u32 v120, s11, v120
    v_and_b32 v123, 35, v121
    v_and_b32 v122, 12, v121
    v_lshl_or_b32 v123, v122, 1, v123
    v_bfe_u32 v122, v121, 4, 1
    v_lshl_or_b32 v123, v122, 2, v123
    v_mul_u32_u24 v123, 3840, v123
    v_add_u32 v48, v123, v120
    v_add_u32 v120, 256, v127
    v_mul_u32_u24 v121, 6554, v120
    v_lshrrev_b32 v121, 16, v121
    v_mul_u32_u24 v122, 10, v121
    v_sub_u32 v120, v120, v122
    v_lshlrev_b32 v120, 4, v120
    v_add_u32 v120, s11, v120
    v_and_b32 v123, 35, v121
    v_and_b32 v122, 12, v121
    v_lshl_or_b32 v123, v122, 1, v123
    v_bfe_u32 v122, v121, 4, 1
    v_lshl_or_b32 v123, v122, 2, v123
    v_mul_u32_u24 v123, 3840, v123
    v_add_u32 v49, v123, v120
    v_add_u32 v120, 512, v127
    v_mul_u32_u24 v121, 6554, v120
    v_lshrrev_b32 v121, 16, v121
    v_mul_u32_u24 v122, 10, v121
    v_sub_u32 v120, v120, v122
    v_lshlrev_b32 v120, 4, v120
    v_add_u32 v120, s11, v120
    v_and_b32 v123, 35, v121
    v_and_b32 v122, 12, v121
    v_lshl_or_b32 v123, v122, 1, v123
    v_bfe_u32 v122, v121, 4, 1
    v_lshl_or_b32 v123, v122, 2, v123
    v_mul_u32_u24 v123, 3840, v123
    v_add_u32 v50, v123, v120
    s_cmp_lt_u32 s8, 2
    s_cselect_b32 s12, 0, s79
    v_add_u32 v50, s12, v50
    s_mul_i32 s11, s7, 160
    v_add_u32 v124, 0, v20
    v_mov_b32 v120, v124
    v_mul_u32_u24 v121, 6554, v120
    v_lshrrev_b32 v121, 16, v121
    v_mul_u32_u24 v122, 10, v121
    v_sub_u32 v120, v120, v122
    v_lshlrev_b32 v120, 4, v120
    v_add_u32 v120, s11, v120
    s_mul_i32 s12, s5, 40
    v_add_u32 v121, s12, v121
    v_and_b32 v123, 3, v121
    v_bfe_u32 v122, v121, 4, 1
    v_lshl_add_u32 v123, v122, 2, v123
    v_bfe_u32 v122, v121, 2, 1
    v_lshl_add_u32 v123, v122, 3, v123
    v_bfe_u32 v122, v121, 3, 1
    v_mad_u32_u24 v123, v122, 20, v123
    v_lshrrev_b32 v122, 5, v121
    v_mad_u32_u24 v125, v122, 40, v123
    v_and_b32 v123, 3, v121
    v_add_u32 v123, 16, v123
    v_bfe_u32 v122, v121, 4, 1
    v_mad_u32_u24 v123, v122, 20, v123
    v_bfe_u32 v122, v121, 2, 2
    v_mad_u32_u24 v123, v122, 40, v123
    v_bfe_u32 v122, v121, 5, 2
    v_mul_u32_u24 v122, 160, v122
    v_add_u32 v123, v123, v122
    v_cmp_gt_u32 vcc, 512, v121
    s_nop 1
    v_cndmask_b32 v121, v123, v125, vcc
    v_mul_u32_u24 v121, 1280, v121
    v_add_u32 v58, v121, v120
    v_lshlrev_b32 v72, 4, v124
    v_add_u32 v124, 256, v20
    v_mov_b32 v120, v124
    v_mul_u32_u24 v121, 6554, v120
    v_lshrrev_b32 v121, 16, v121
    v_mul_u32_u24 v122, 10, v121
    v_sub_u32 v120, v120, v122
    v_lshlrev_b32 v120, 4, v120
    v_add_u32 v120, s11, v120
    s_mul_i32 s12, s5, 40
    v_add_u32 v121, s12, v121
    v_and_b32 v123, 3, v121
    v_bfe_u32 v122, v121, 4, 1
    v_lshl_add_u32 v123, v122, 2, v123
    v_bfe_u32 v122, v121, 2, 1
    v_lshl_add_u32 v123, v122, 3, v123
    v_bfe_u32 v122, v121, 3, 1
    v_mad_u32_u24 v123, v122, 20, v123
    v_lshrrev_b32 v122, 5, v121
    v_mad_u32_u24 v125, v122, 40, v123
    v_and_b32 v123, 3, v121
    v_add_u32 v123, 16, v123
    v_bfe_u32 v122, v121, 4, 1
    v_mad_u32_u24 v123, v122, 20, v123
    v_bfe_u32 v122, v121, 2, 2
    v_mad_u32_u24 v123, v122, 40, v123
    v_bfe_u32 v122, v121, 5, 2
    v_mul_u32_u24 v122, 160, v122
    v_add_u32 v123, v123, v122
    v_cmp_gt_u32 vcc, 512, v121
    s_nop 1
    v_cndmask_b32 v121, v123, v125, vcc
    v_mul_u32_u24 v121, 1280, v121
    v_add_u32 v59, v121, v120
    v_lshlrev_b32 v73, 4, v124
    v_mov_b32 v122, s79
    v_cmp_gt_u32 vcc, 400, v124
    s_nop 1
    v_cndmask_b32 v59, v122, v59, vcc
    v_cndmask_b32 v73, v122, v73, vcc
    v_add_u32 v124, 0, v20
    v_mov_b32 v120, v124
    v_mul_u32_u24 v121, 6554, v120
    v_lshrrev_b32 v121, 16, v121
    v_mul_u32_u24 v122, 10, v121
    v_sub_u32 v120, v120, v122
    v_lshlrev_b32 v120, 4, v120
    v_add_u32 v120, s11, v120
    v_mul_u32_u24 v121, 1280, v121
    v_add_u32 v60, v121, v120
    v_lshlrev_b32 v74, 4, v124
    v_add_u32 v124, 256, v20
    v_mov_b32 v120, v124
    v_mul_u32_u24 v121, 6554, v120
    v_lshrrev_b32 v121, 16, v121
    v_mul_u32_u24 v122, 10, v121
    v_sub_u32 v120, v120, v122
    v_lshlrev_b32 v120, 4, v120
    v_add_u32 v120, s11, v120
    v_mul_u32_u24 v121, 1280, v121
    v_add_u32 v61, v121, v120
    v_lshlrev_b32 v75, 4, v124
    v_add_u32 v124, 512, v20
    v_mov_b32 v120, v124
    v_mul_u32_u24 v121, 6554, v120
    v_lshrrev_b32 v121, 16, v121
    v_mul_u32_u24 v122, 10, v121
    v_sub_u32 v120, v120, v122
    v_lshlrev_b32 v120, 4, v120
    v_add_u32 v120, s11, v120
    v_mul_u32_u24 v121, 1280, v121
    v_add_u32 v62, v121, v120
    v_lshlrev_b32 v76, 4, v124
    v_add_u32 v124, 768, v20
    v_mov_b32 v120, v124
    v_mul_u32_u24 v121, 6554, v120
    v_lshrrev_b32 v121, 16, v121
    v_mul_u32_u24 v122, 10, v121
    v_sub_u32 v120, v120, v122
    v_lshlrev_b32 v120, 4, v120
    v_add_u32 v120, s11, v120
    v_mul_u32_u24 v121, 1280, v121
    v_add_u32 v63, v121, v120
    v_lshlrev_b32 v77, 4, v124
    v_mov_b32 v122, s79
    v_cmp_gt_u32 vcc, 960, v124
    s_nop 1
    v_cndmask_b32 v63, v122, v63, vcc
    v_cndmask_b32 v77, v122, v77, vcc
    s_waitcnt vmcnt(16)
    s_barrier
    s_lshl_b32 s14, s42, 7
    s_add_u32 m0, s61, 0
    s_mul_i32 s15, s42, s87
    buffer_load_dwordx4 v0, s[44:47], s14 offen offset:0  lds
    buffer_load_dwordx4 v1, s[44:47], s14 offen offset:1024  lds
    buffer_load_dwordx4 v2, s[44:47], s14 offen offset:2048  lds
    buffer_load_dwordx4 v3, s[44:47], s14 offen offset:3072  lds
    s_add_u32 m0, s62, 16384
    s_add_u32 s42, s42, 1
    buffer_load_dwordx4 v4, s[48:51], s15 offen offset:0  lds
    buffer_load_dwordx4 v5, s[48:51], s15 offen offset:1024  lds
    buffer_load_dwordx4 v6, s[48:51], s15 offen offset:2048  lds
    buffer_load_dwordx4 v7, s[48:51], s15 offen offset:3072  lds
    s_add_u32 m0, m0, 4096
    s_nop 0
    buffer_load_dwordx4 v8, s[48:51], s15 offen  lds
    s_cmp_eq_u32 s42, 10
    s_cselect_b32 s42, 0, s42
    s_waitcnt vmcnt(9)
    s_barrier
    s_lshl_b32 s14, s42, 7
    s_add_u32 m0, s61, 36864
    s_mul_i32 s15, s42, s87
    buffer_load_dwordx4 v0, s[44:47], s14 offen offset:0  lds
    buffer_load_dwordx4 v1, s[44:47], s14 offen offset:1024  lds
    buffer_load_dwordx4 v2, s[44:47], s14 offen offset:2048  lds
    buffer_load_dwordx4 v3, s[44:47], s14 offen offset:3072  lds
    s_add_u32 m0, s62, 53248
    s_add_u32 s42, s42, 1
    buffer_load_dwordx4 v4, s[48:51], s15 offen offset:0  lds
    buffer_load_dwordx4 v5, s[48:51], s15 offen offset:1024  lds
    buffer_load_dwordx4 v6, s[48:51], s15 offen offset:2048  lds
    buffer_load_dwordx4 v7, s[48:51], s15 offen offset:3072  lds
    s_add_u32 m0, m0, 4096
    s_nop 0
    buffer_load_dwordx4 v8, s[48:51], s15 offen  lds
    s_cmp_eq_u32 s42, 10
    s_cselect_b32 s42, 0, s42
    s_waitcnt vmcnt(9)
    s_barrier
    s_lshl_b32 s14, s42, 7
    s_add_u32 m0, s61, 73728
    s_mul_i32 s15, s42, s87
    buffer_load_dwordx4 v0, s[44:47], s14 offen offset:0  lds
    buffer_load_dwordx4 v1, s[44:47], s14 offen offset:1024  lds
    buffer_load_dwordx4 v2, s[44:47], s14 offen offset:2048  lds
    buffer_load_dwordx4 v3, s[44:47], s14 offen offset:3072  lds
    s_add_u32 m0, s62, 90112
    s_add_u32 s42, s42, 1
    buffer_load_dwordx4 v4, s[48:51], s15 offen offset:0  lds
    buffer_load_dwordx4 v5, s[48:51], s15 offen offset:1024  lds
    buffer_load_dwordx4 v6, s[48:51], s15 offen offset:2048  lds
    buffer_load_dwordx4 v7, s[48:51], s15 offen offset:3072  lds
    s_add_u32 m0, m0, 4096
    s_nop 0
    buffer_load_dwordx4 v8, s[48:51], s15 offen  lds
    s_cmp_eq_u32 s42, 10
    s_cselect_b32 s42, 0, s42
    s_waitcnt vmcnt(9)
    s_barrier
    s_lshl_b32 s14, s42, 7
    s_add_u32 m0, s61, 110592
    s_mul_i32 s15, s42, s87
    buffer_load_dwordx4 v0, s[44:47], s14 offen offset:0  lds
    buffer_load_dwordx4 v1, s[44:47], s14 offen offset:1024  lds
    buffer_load_dwordx4 v2, s[44:47], s14 offen offset:2048  lds
    buffer_load_dwordx4 v3, s[44:47], s14 offen offset:3072  lds
    s_add_u32 m0, s62, 126976
    s_add_u32 s42, s42, 1
    buffer_load_dwordx4 v4, s[48:51], s15 offen offset:0  lds
    buffer_load_dwordx4 v5, s[48:51], s15 offen offset:1024  lds
    buffer_load_dwordx4 v6, s[48:51], s15 offen offset:2048  lds
    buffer_load_dwordx4 v7, s[48:51], s15 offen offset:3072  lds
    s_add_u32 m0, m0, 4096
    s_nop 0
    buffer_load_dwordx4 v8, s[48:51], s15 offen  lds
    s_cmp_eq_u32 s42, 10
    s_cselect_b32 s42, 0, s42
    s_waitcnt vmcnt(9)
    s_barrier
    s_lshl_b32 s14, s42, 7
    s_add_u32 m0, s61, 0
    s_mul_i32 s15, s42, s87
    buffer_load_dwordx4 v0, s[44:47], s14 offen offset:0  lds
    buffer_load_dwordx4 v1, s[44:47], s14 offen offset:1024  lds
    buffer_load_dwordx4 v2, s[44:47], s14 offen offset:2048  lds
    buffer_load_dwordx4 v3, s[44:47], s14 offen offset:3072  lds
    s_add_u32 m0, s62, 16384
    s_add_u32 s42, s42, 1
    buffer_load_dwordx4 v4, s[48:51], s15 offen offset:0  lds
    buffer_load_dwordx4 v5, s[48:51], s15 offen offset:1024  lds
    buffer_load_dwordx4 v6, s[48:51], s15 offen offset:2048  lds
    buffer_load_dwordx4 v7, s[48:51], s15 offen offset:3072  lds
    s_add_u32 m0, m0, 4096
    s_nop 0
    buffer_load_dwordx4 v8, s[48:51], s15 offen  lds
    s_cmp_eq_u32 s42, 10
    s_cselect_b32 s42, 0, s42
    s_waitcnt vmcnt(9)
    s_barrier
    s_lshl_b32 s14, s42, 7
    s_add_u32 m0, s61, 36864
    s_mul_i32 s15, s42, s87
    buffer_load_dwordx4 v0, s[44:47], s14 offen offset:0  lds
    buffer_load_dwordx4 v1, s[44:47], s14 offen offset:1024  lds
    buffer_load_dwordx4 v2, s[44:47], s14 offen offset:2048  lds
    buffer_load_dwordx4 v3, s[44:47], s14 offen offset:3072  lds
    s_add_u32 m0, s62, 53248
    s_add_u32 s42, s42, 1
    buffer_load_dwordx4 v4, s[48:51], s15 offen offset:0  lds
    buffer_load_dwordx4 v5, s[48:51], s15 offen offset:1024  lds
    buffer_load_dwordx4 v6, s[48:51], s15 offen offset:2048  lds
    buffer_load_dwordx4 v7, s[48:51], s15 offen offset:3072  lds
    s_add_u32 m0, m0, 4096
    s_nop 0
    buffer_load_dwordx4 v8, s[48:51], s15 offen  lds
    s_cmp_eq_u32 s42, 10
    s_cselect_b32 s42, 0, s42
    v_mov_b32 v105, 0
    buffer_load_dword v104, v105, s[88:91], 0 offen sc1
    buffer_load_dword v107, v105, s[88:91], 0 offen offset:64 sc1
    s_mov_b32 s56, s30
    s_mov_b32 s57, s31
    s_mov_b32 s58, 1966080
    s_mov_b32 s59, 0x20000
    s_waitcnt vmcnt(11)
    s_barrier
    v_lshlrev_b32 v120, 4, v20
    v_add_u32 v120, 73728, v120
    ds_write_b128 v120, v[44:47] offset:0
    ds_write_b128 v120, v[44:47] offset:4096
    ds_write_b128 v120, v[44:47] offset:8192
    ds_write_b128 v120, v[44:47] offset:12288
    s_waitcnt vmcnt(2)
    s_waitcnt vmcnt(0)
    s_mov_b32 s13, 0
nz_14:
    v_readfirstlane_b32 s9, v104
    s_add_u32 s13, s13, 1
    s_cmp_lg_u32 s9, 0
    s_cbranch_scc1 nd_15
    s_cmp_gt_u32 s13, 131072
    s_cbranch_scc1 nd_15
    s_sleep 4
    buffer_load_dword v104, v105, s[88:91], 0 offen sc1
    s_waitcnt vmcnt(0)
    s_branch nz_14
nd_15:
    s_mov_b32 s13, 0
zl_16:
    v_readfirstlane_b32 s11, v107
    s_add_u32 s13, s13, 1
    s_cmp_ge_u32 s11, 128
    s_cbranch_scc1 zok_17
    s_cmp_gt_u32 s13, 131072
    s_cbranch_scc1 zok_17
    s_sleep 10
    buffer_load_dword v107, v105, s[88:91], 0 offen offset:64 sc1
    s_waitcnt vmcnt(0)
    s_branch zl_16
zok_17:
    s_waitcnt lgkmcnt(0)
    s_barrier
    ds_write_b64 v18, v[10:11]
    ds_write_b64 v19, v[12:13]
    s_waitcnt lgkmcnt(0)
    s_barrier
    s_add_u32 s15, s80, 0
    s_cmp_ge_u32 s15, 10
    s_cselect_b32 s13, 10, 0
    s_sub_u32 s15, s15, s13
    s_mul_i32 s15, s15, 245760
    s_lshl_b32 s12, s8, 10
    s_add_u32 m0, s12, 90112
    s_nop 0
    buffer_load_dwordx4 v48, s[48:51], s15 offen lds
    s_add_u32 m0, s12, 94208
    s_nop 0
    buffer_load_dwordx4 v49, s[48:51], s15 offen lds
    s_add_u32 s12, s12, 98304
    s_cmp_lt_u32 s8, 2
    s_cselect_b32 m0, s12, s78
    s_nop 0
    buffer_load_dwordx4 v50, s[48:51], s15 offen lds
    s_add_u32 s15, s80, 1
    s_cmp_ge_u32 s15, 10
    s_cselect_b32 s13, 10, 0
    s_sub_u32 s15, s15, s13
    s_mul_i32 s15, s15, 245760
    s_lshl_b32 s12, s8, 10
    s_add_u32 m0, s12, 100352
    s_nop 0
    buffer_load_dwordx4 v48, s[48:51], s15 offen lds
    s_add_u32 m0, s12, 104448
    s_nop 0
    buffer_load_dwordx4 v49, s[48:51], s15 offen lds
    s_add_u32 s12, s12, 108544
    s_cmp_lt_u32 s8, 2
    s_cselect_b32 m0, s12, s78
    s_nop 0
    buffer_load_dwordx4 v50, s[48:51], s15 offen lds
    s_barrier
    s_add_u32 s15, s80, 0
    s_cmp_ge_u32 s15, 10
    s_cselect_b32 s13, 10, 0
    s_sub_u32 s15, s15, s13
    s_add_u32 m0, s61, 53248
    s_lshl_b32 s15, s15, 7
    buffer_load_dwordx4 v0, s[44:47], s15 offen offset:0 lds
    buffer_load_dwordx4 v1, s[44:47], s15 offen offset:1024 lds
    buffer_load_dwordx4 v2, s[44:47], s15 offen offset:2048 lds
    buffer_load_dwordx4 v3, s[44:47], s15 offen offset:3072 lds
    s_mov_b32 s96, s30
    s_mov_b32 s97, s31
    s_mov_b32 s98, 1966080
    s_mov_b32 s99, 0x20000
    s_lshl_b32 s11, s5, 3
    s_add_u32 s11, s11, s7
    s_lshl_b32 s11, s11, 2
    s_add_u32 s11, s11, s8
    s_mul_i32 s12, s11, 1600
    s_mul_i32 s11, s11, 3840
    buffer_load_dwordx4 v[112:115], v143, s[96:99], s11 offen offset:0
    buffer_load_dwordx4 v[116:119], v143, s[96:99], s11 offen offset:1024
    buffer_load_dwordx4 v[112:115], v143, s[96:99], s11 offen offset:2048
    buffer_load_dwordx4 v[116:119], v143, s[96:99], s11 offen offset:2816
    s_mov_b32 s96, s22
    s_mov_b32 s97, s23
    s_mov_b32 s98, 819200
    s_mov_b32 s99, 0x20000
    buffer_load_dwordx4 v[80:83], v58, s[96:99], 0 offen nt
    buffer_load_dwordx4 v[84:87], v59, s[96:99], 0 offen nt
    s_mov_b32 s96, s32
    s_mov_b32 s97, s33
    s_mov_b32 s98, 1966080
    s_mov_b32 s99, 0x20000
    s_mul_i32 s11, s5, 122880
    buffer_load_dwordx4 v[88:91], v60, s[96:99], s11 offen nt
    buffer_load_dwordx4 v[92:95], v61, s[96:99], s11 offen nt
    buffer_load_dwordx4 v[96:99], v62, s[96:99], s11 offen nt
    buffer_load_dwordx4 v[24:27], v63, s[96:99], s11 offen nt
    s_barrier
    s_add_u32 s15, s80, 1
    s_cmp_ge_u32 s15, 10
    s_cselect_b32 s13, 10, 0
    s_sub_u32 s15, s15, s13
    s_add_u32 m0, s61, 0
    s_lshl_b32 s15, s15, 7
    buffer_load_dwordx4 v0, s[44:47], s15 offen offset:0 lds
    buffer_load_dwordx4 v1, s[44:47], s15 offen offset:1024 lds
    buffer_load_dwordx4 v2, s[44:47], s15 offen offset:2048 lds
    buffer_load_dwordx4 v3, s[44:47], s15 offen offset:3072 lds
    s_add_u32 s15, s80, 2
    s_cmp_ge_u32 s15, 10
    s_cselect_b32 s13, 10, 0
    s_sub_u32 s15, s15, s13
    s_add_u32 m0, s61, 16384
    s_lshl_b32 s15, s15, 7
    buffer_load_dwordx4 v0, s[44:47], s15 offen offset:0 lds
    buffer_load_dwordx4 v1, s[44:47], s15 offen offset:1024 lds
    buffer_load_dwordx4 v2, s[44:47], s15 offen offset:2048 lds
    buffer_load_dwordx4 v3, s[44:47], s15 offen offset:3072 lds
    s_add_u32 s15, s80, 2
    s_cmp_ge_u32 s15, 10
    s_cselect_b32 s13, 10, 0
    s_sub_u32 s15, s15, s13
    s_mul_i32 s15, s15, 245760
    s_lshl_b32 s12, s8, 10
    s_add_u32 m0, s12, 110592
    s_nop 0
    buffer_load_dwordx4 v48, s[48:51], s15 offen lds
    s_add_u32 m0, s12, 114688
    s_nop 0
    buffer_load_dwordx4 v49, s[48:51], s15 offen lds
    s_add_u32 s12, s12, 118784
    s_cmp_lt_u32 s8, 2
    s_cselect_b32 m0, s12, s78
    s_nop 0
    buffer_load_dwordx4 v50, s[48:51], s15 offen lds
    s_waitcnt vmcnt(21)
    s_barrier
    s_add_u32 s15, s80, 3
    s_cmp_ge_u32 s15, 10
    s_cselect_b32 s13, 10, 0
    s_sub_u32 s15, s15, s13
    s_add_u32 m0, s61, 32768
    s_lshl_b32 s15, s15, 7
    buffer_load_dwordx4 v0, s[44:47], s15 offen offset:0 lds
    buffer_load_dwordx4 v1, s[44:47], s15 offen offset:1024 lds
    buffer_load_dwordx4 v2, s[44:47], s15 offen offset:2048 lds
    buffer_load_dwordx4 v3, s[44:47], s15 offen offset:3072 lds
    s_add_u32 s15, s80, 3
    s_cmp_ge_u32 s15, 10
    s_cselect_b32 s13, 10, 0
    s_sub_u32 s15, s15, s13
    s_mul_i32 s15, s15, 245760
    s_lshl_b32 s12, s8, 10
    s_add_u32 m0, s12, 120832
    s_nop 0
    buffer_load_dwordx4 v48, s[48:51], s15 offen lds
    s_add_u32 m0, s12, 124928
    s_nop 0
    buffer_load_dwordx4 v49, s[48:51], s15 offen lds
    s_add_u32 s12, s12, 129024
    s_cmp_lt_u32 s8, 2
    s_cselect_b32 m0, s12, s78
    s_nop 0
    buffer_load_dwordx4 v50, s[48:51], s15 offen lds
    s_mul_i32 s12, s7, 348160
    s_add_u32 s12, s12, 14667776
    s_mul_i32 s11, s5, 6400
    s_add_u32 s11, s11, s12
    s_mul_i32 s15, s5, 15360
    s_add_u32 s12, s12, s15
    s_add_u32 s12, s12, 102400
    s_waitcnt vmcnt(18)
    buffer_store_dwordx4 v[80:83], v72, s[52:55], s11 offen sc1
    buffer_store_dwordx4 v[84:87], v73, s[52:55], s11 offen sc1
    buffer_store_dwordx4 v[88:91], v74, s[52:55], s12 offen sc1
    buffer_store_dwordx4 v[92:95], v75, s[52:55], s12 offen sc1
    buffer_store_dwordx4 v[96:99], v76, s[52:55], s12 offen sc1
    buffer_store_dwordx4 v[24:27], v77, s[52:55], s12 offen sc1
    s_waitcnt vmcnt(20)
    s_barrier
    s_waitcnt vmcnt(13)
    s_barrier
    s_add_u32 s15, s80, 4
    s_cmp_ge_u32 s15, 10
    s_cselect_b32 s13, 10, 0
    s_sub_u32 s15, s15, s13
    s_add_u32 m0, s61, 53248
    s_lshl_b32 s15, s15, 7
    buffer_load_dwordx4 v0, s[44:47], s15 offen offset:0 lds
    buffer_load_dwordx4 v1, s[44:47], s15 offen offset:1024 lds
    buffer_load_dwordx4 v2, s[44:47], s15 offen offset:2048 lds
    buffer_load_dwordx4 v3, s[44:47], s15 offen offset:3072 lds
    s_add_u32 s15, s80, 4
    s_cmp_ge_u32 s15, 10
    s_cselect_b32 s13, 10, 0
    s_sub_u32 s15, s15, s13
    s_mul_i32 s15, s15, 245760
    s_lshl_b32 s12, s8, 10
    s_add_u32 m0, s12, 90112
    s_nop 0
    buffer_load_dwordx4 v48, s[48:51], s15 offen lds
    s_add_u32 m0, s12, 94208
    s_nop 0
    buffer_load_dwordx4 v49, s[48:51], s15 offen lds
    s_add_u32 s12, s12, 98304
    s_cmp_lt_u32 s8, 2
    s_cselect_b32 m0, s12, s78
    s_nop 0
    buffer_load_dwordx4 v50, s[48:51], s15 offen lds
    s_waitcnt vmcnt(13)
    s_barrier
    s_add_u32 s15, s80, 5
    s_cmp_ge_u32 s15, 10
    s_cselect_b32 s13, 10, 0
    s_sub_u32 s15, s15, s13
    s_add_u32 m0, s61, 0
    s_lshl_b32 s15, s15, 7
    buffer_load_dwordx4 v0, s[44:47], s15 offen offset:0 lds
    buffer_load_dwordx4 v1, s[44:47], s15 offen offset:1024 lds
    buffer_load_dwordx4 v2, s[44:47], s15 offen offset:2048 lds
    buffer_load_dwordx4 v3, s[44:47], s15 offen offset:3072 lds
    s_add_u32 s15, s80, 5
    s_cmp_ge_u32 s15, 10
    s_cselect_b32 s13, 10, 0
    s_sub_u32 s15, s15, s13
    s_mul_i32 s15, s15, 245760
    s_lshl_b32 s12, s8, 10
    s_add_u32 m0, s12, 100352
    s_nop 0
    buffer_load_dwordx4 v48, s[48:51], s15 offen lds
    s_add_u32 m0, s12, 104448
    s_nop 0
    buffer_load_dwordx4 v49, s[48:51], s15 offen lds
    s_add_u32 s12, s12, 108544
    s_cmp_lt_u32 s8, 2
    s_cselect_b32 m0, s12, s78
    s_nop 0
    buffer_load_dwordx4 v50, s[48:51], s15 offen lds
    s_waitcnt vmcnt(7)
    v_mov_b32 v120, 163820
    v_mov_b32 v121, 1
    s_mov_b64 exec, 1
    ds_add_rtn_u32 v121, v120, v121
    s_waitcnt lgkmcnt(0)
    v_readfirstlane_b32 s13, v121
    s_nop 0
    s_cmp_lg_u32 s13, 3
    s_cbranch_scc1 arr_18
    s_lshl_b32 s11, s5, 4
    s_lshl_b32 s12, s6, 3
    s_add_u32 s11, s11, s12
    s_add_u32 s11, s11, s7
    s_lshl_b32 s11, s11, 7
    s_add_u32 s11, s11, 102400
    v_mov_b32 v120, s9
    v_mov_b32 v121, 0
    buffer_store_dword v120, v121, s[52:55], s11 offen sc1
arr_18:
    s_mov_b64 exec, -1
    s_barrier
    s_add_u32 s15, s80, 6
    s_cmp_ge_u32 s15, 10
    s_cselect_b32 s13, 10, 0
    s_sub_u32 s15, s15, s13
    s_add_u32 m0, s61, 16384
    s_lshl_b32 s15, s15, 7
    buffer_load_dwordx4 v0, s[44:47], s15 offen offset:0 lds
    buffer_load_dwordx4 v1, s[44:47], s15 offen offset:1024 lds
    buffer_load_dwordx4 v2, s[44:47], s15 offen offset:2048 lds
    buffer_load_dwordx4 v3, s[44:47], s15 offen offset:3072 lds
    s_add_u32 s15, s80, 6
    s_cmp_ge_u32 s15, 10
    s_cselect_b32 s13, 10, 0
    s_sub_u32 s15, s15, s13
    s_mul_i32 s15, s15, 245760
    s_lshl_b32 s12, s8, 10
    s_add_u32 m0, s12, 110592
    s_nop 0
    buffer_load_dwordx4 v48, s[48:51], s15 offen lds
    s_add_u32 m0, s12, 114688
    s_nop 0
    buffer_load_dwordx4 v49, s[48:51], s15 offen lds
    s_add_u32 s12, s12, 118784
    s_cmp_lt_u32 s8, 2
    s_cselect_b32 m0, s12, s78
    s_nop 0
    buffer_load_dwordx4 v50, s[48:51], s15 offen lds
    s_waitcnt vmcnt(7)
    s_barrier
    s_add_u32 s15, s80, 7
    s_cmp_ge_u32 s15, 10
    s_cselect_b32 s13, 10, 0
    s_sub_u32 s15, s15, s13
    s_add_u32 m0, s61, 32768
    s_lshl_b32 s15, s15, 7
    buffer_load_dwordx4 v0, s[44:47], s15 offen offset:0 lds
    buffer_load_dwordx4 v1, s[44:47], s15 offen offset:1024 lds
    buffer_load_dwordx4 v2, s[44:47], s15 offen offset:2048 lds
    buffer_load_dwordx4 v3, s[44:47], s15 offen offset:3072 lds
    s_add_u32 s15, s80, 7
    s_cmp_ge_u32 s15, 10
    s_cselect_b32 s13, 10, 0
    s_sub_u32 s15, s15, s13
    s_mul_i32 s15, s15, 245760
    s_lshl_b32 s12, s8, 10
    s_add_u32 m0, s12, 120832
    s_nop 0
    buffer_load_dwordx4 v48, s[48:51], s15 offen lds
    s_add_u32 m0, s12, 124928
    s_nop 0
    buffer_load_dwordx4 v49, s[48:51], s15 offen lds
    s_add_u32 s12, s12, 129024
    s_cmp_lt_u32 s8, 2
    s_cselect_b32 m0, s12, s78
    s_nop 0
    buffer_load_dwordx4 v50, s[48:51], s15 offen lds
    s_waitcnt vmcnt(7)
    s_barrier
    s_add_u32 s15, s80, 8
    s_cmp_ge_u32 s15, 10
    s_cselect_b32 s13, 10, 0
    s_sub_u32 s15, s15, s13
    s_add_u32 m0, s61, 53248
    s_lshl_b32 s15, s15, 7
    buffer_load_dwordx4 v0, s[44:47], s15 offen offset:0 lds
    buffer_load_dwordx4 v1, s[44:47], s15 offen offset:1024 lds
    buffer_load_dwordx4 v2, s[44:47], s15 offen offset:2048 lds
    buffer_load_dwordx4 v3, s[44:47], s15 offen offset:3072 lds
    s_add_u32 s15, s80, 8
    s_cmp_ge_u32 s15, 10
    s_cselect_b32 s13, 10, 0
    s_sub_u32 s15, s15, s13
    s_mul_i32 s15, s15, 245760
    s_lshl_b32 s12, s8, 10
    s_add_u32 m0, s12, 90112
    s_nop 0
    buffer_load_dwordx4 v48, s[48:51], s15 offen lds
    s_add_u32 m0, s12, 94208
    s_nop 0
    buffer_load_dwordx4 v49, s[48:51], s15 offen lds
    s_add_u32 s12, s12, 98304
    s_cmp_lt_u32 s8, 2
    s_cselect_b32 m0, s12, s78
    s_nop 0
    buffer_load_dwordx4 v50, s[48:51], s15 offen lds
    s_waitcnt vmcnt(7)
    s_barrier
    s_add_u32 s15, s80, 9
    s_cmp_ge_u32 s15, 10
    s_cselect_b32 s13, 10, 0
    s_sub_u32 s15, s15, s13
    s_add_u32 m0, s61, 0
    s_lshl_b32 s15, s15, 7
    buffer_load_dwordx4 v0, s[44:47], s15 offen offset:0 lds
    buffer_load_dwordx4 v1, s[44:47], s15 offen offset:1024 lds
    buffer_load_dwordx4 v2, s[44:47], s15 offen offset:2048 lds
    buffer_load_dwordx4 v3, s[44:47], s15 offen offset:3072 lds
    s_add_u32 s15, s80, 9
    s_cmp_ge_u32 s15, 10
    s_cselect_b32 s13, 10, 0
    s_sub_u32 s15, s15, s13
    s_mul_i32 s15, s15, 245760
    s_lshl_b32 s12, s8, 10
    s_add_u32 m0, s12, 100352
    s_nop 0
    buffer_load_dwordx4 v48, s[48:51], s15 offen lds
    s_add_u32 m0, s12, 104448
    s_nop 0
    buffer_load_dwordx4 v49, s[48:51], s15 offen lds
    s_add_u32 s12, s12, 108544
    s_cmp_lt_u32 s8, 2
    s_cselect_b32 m0, s12, s78
    s_nop 0
    buffer_load_dwordx4 v50, s[48:51], s15 offen lds
    s_waitcnt vmcnt(7)
    s_barrier
    s_lshl_b32 s12, s8, 10
    s_add_u32 s15, s81, 0
    s_cmp_ge_u32 s15, 20
    s_cselect_b32 s13, 20, 0
    s_sub_u32 s15, s15, s13
    s_mul_i32 s15, s15, 98304
    s_add_u32 m0, s12, 139264
    s_add_u32 s15, s15, 0
    buffer_load_dwordx4 v56, s[56:59], s15 offen lds
    s_add_u32 s15, s81, 1
    s_cmp_ge_u32 s15, 20
    s_cselect_b32 s13, 20, 0
    s_sub_u32 s15, s15, s13
    s_mul_i32 s15, s15, 98304
    s_add_u32 m0, s12, 143360
    s_add_u32 s15, s15, 0
    buffer_load_dwordx4 v56, s[56:59], s15 offen lds
    s_lshl_b32 s12, s8, 10
    s_add_u32 s15, s81, 2
    s_cmp_ge_u32 s15, 20
    s_cselect_b32 s13, 20, 0
    s_sub_u32 s15, s15, s13
    s_mul_i32 s15, s15, 98304
    s_add_u32 m0, s12, 131072
    s_add_u32 s15, s15, 0
    buffer_load_dwordx4 v56, s[56:59], s15 offen lds
    s_add_u32 s15, s81, 3
    s_cmp_ge_u32 s15, 20
    s_cselect_b32 s13, 20, 0
    s_sub_u32 s15, s15, s13
    s_mul_i32 s15, s15, 98304
    s_add_u32 m0, s12, 135168
    s_add_u32 s15, s15, 0
    buffer_load_dwordx4 v56, s[56:59], s15 offen lds
    s_waitcnt vmcnt(4)
    s_barrier
    s_lshl_b32 s12, s8, 10
    s_add_u32 s15, s81, 4
    s_cmp_ge_u32 s15, 20
    s_cselect_b32 s13, 20, 0
    s_sub_u32 s15, s15, s13
    s_mul_i32 s15, s15, 98304
    s_add_u32 m0, s12, 122880
    s_add_u32 s15, s15, 0
    buffer_load_dwordx4 v56, s[56:59], s15 offen lds
    s_add_u32 s15, s81, 5
    s_cmp_ge_u32 s15, 20
    s_cselect_b32 s13, 20, 0
    s_sub_u32 s15, s15, s13
    s_mul_i32 s15, s15, 98304
    s_add_u32 m0, s12, 126976
    s_add_u32 s15, s15, 0
    buffer_load_dwordx4 v56, s[56:59], s15 offen lds
    s_lshl_b32 s12, s8, 10
    s_add_u32 s15, s81, 6
    s_cmp_ge_u32 s15, 20
    s_cselect_b32 s13, 20, 0
    s_sub_u32 s15, s15, s13
    s_mul_i32 s15, s15, 98304
    s_add_u32 m0, s12, 114688
    s_add_u32 s15, s15, 0
    buffer_load_dwordx4 v56, s[56:59], s15 offen lds
    s_add_u32 s15, s81, 7
    s_cmp_ge_u32 s15, 20
    s_cselect_b32 s13, 20, 0
    s_sub_u32 s15, s15, s13
    s_mul_i32 s15, s15, 98304
    s_add_u32 m0, s12, 118784
    s_add_u32 s15, s15, 0
    buffer_load_dwordx4 v56, s[56:59], s15 offen lds
    v_mov_b32 v102, 163828
    s_cmp_lg_u32 s8, 0
    s_cbranch_scc1 poth_22
    v_lshlrev_b32 v100, 4, v128
    v_add_u32 v100, s7, v100
    v_lshlrev_b32 v100, 7, v100
    s_mov_b32 s11, 4096
    s_mov_b32 s13, 0
    s_mov_b32 exec_lo, 0xffff
    s_mov_b32 exec_hi, 0x0
ploop_20:
    buffer_load_dword v101, v100, s[52:55], s11 offen sc1
    s_add_u32 s13, s13, 1
    s_cmp_gt_u32 s13, 131072
    s_cbranch_scc1 pout_21
    s_waitcnt vmcnt(0)
    v_cmp_ne_u32 vcc, s9, v101
    s_cbranch_vccnz ploop_20
pout_21:
    s_waitcnt vmcnt(0)
    s_mov_b64 exec, -1
    ds_write_b32 v102, v102
    s_branch pskip_19
poth_22:
    ds_read_b32 v101, v102
    s_waitcnt lgkmcnt(0)
    v_readfirstlane_b32 s13, v101
    s_nop 0
    s_cmp_eq_u32 s13, 0
    s_cbranch_scc1 poth_22
pskip_19:
    s_mul_i32 s11, s7, 14336
    s_add_u32 s11, s11, 2756608
    v_lshlrev_b32 v120, 4, v20
    v_mov_b32 v121, s79
    v_cmp_gt_u32 vcc, 96, v20
    s_nop 1
    v_cndmask_b32 v121, v121, v120, vcc
    buffer_load_dwordx4 v[24:27], v120, s[52:55], s11 offen sc1
    s_add_u32 s11, s11, 4096
    buffer_load_dwordx4 v[28:31], v120, s[52:55], s11 offen sc1
    s_add_u32 s11, s11, 4096
    buffer_load_dwordx4 v[32:35], v120, s[52:55], s11 offen sc1
    s_add_u32 s11, s11, 4096
    buffer_load_dwordx4 v[36:39], v121, s[52:55], s11 offen sc1
    s_add_u32 s11, s11, 4096
    v_lshlrev_b32 v122, 3, v20
    v_add_u32 v122, 151552, v122
    v_mov_b32 v40, 0
    v_mov_b32 v41, 0
    ds_write_b64 v122, v[40:41] offset:8192
    s_waitcnt vmcnt(3)
    v_cvt_pk_bf16_f32 v24, v24, v25
    v_cvt_pk_bf16_f32 v25, v26, v27
    ds_write_b64 v122, v[24:25] offset:0
    s_waitcnt vmcnt(2)
    v_cvt_pk_bf16_f32 v28, v28, v29
    v_cvt_pk_bf16_f32 v29, v30, v31
    ds_write_b64 v122, v[28:29] offset:2048
    s_waitcnt vmcnt(1)
    v_cvt_pk_bf16_f32 v32, v32, v33
    v_cvt_pk_bf16_f32 v33, v34, v35
    ds_write_b64 v122, v[32:33] offset:4096
    s_waitcnt vmcnt(0)
    v_cvt_pk_bf16_f32 v36, v36, v37
    v_cvt_pk_bf16_f32 v37, v38, v39
    ds_write_b64 v122, v[36:37] offset:6144
    s_waitcnt lgkmcnt(0)
    s_barrier
    v_mov_b32 v102, 163832
    s_cmp_lg_u32 s8, 0
    s_cbranch_scc1 poth_26
    s_lshl_b32 s11, s5, 4
    s_add_u32 s11, s11, 264
    v_add_u32 v100, s11, v128
    v_lshlrev_b32 v100, 7, v100
    s_mov_b32 s11, 4096
    s_mov_b32 s13, 0
    s_mov_b32 exec_lo, 0xff
    s_mov_b32 exec_hi, 0x0
ploop_24:
    buffer_load_dword v101, v100, s[52:55], s11 offen sc1
    s_add_u32 s13, s13, 1
    s_cmp_gt_u32 s13, 131072
    s_cbranch_scc1 pout_25
    s_waitcnt vmcnt(0)
    v_cmp_ne_u32 vcc, s9, v101
    s_cbranch_vccnz ploop_24
pout_25:
    s_waitcnt vmcnt(0)
    s_mov_b64 exec, -1
    ds_write_b32 v102, v102
    s_branch pskip_23
poth_26:
    ds_read_b32 v101, v102
    s_waitcnt lgkmcnt(0)
    v_readfirstlane_b32 s13, v101
    s_nop 0
    s_cmp_eq_u32 s13, 0
    s_cbranch_scc1 poth_26
pskip_23:
    s_add_u32 s15, s81, 0
    s_cmp_ge_u32 s15, 20
    s_cselect_b32 s13, 20, 0
    s_sub_u32 s15, s15, s13
    s_add_u32 m0, s61, 0
    s_lshl_b32 s15, s15, 10
    s_add_u32 s15, s15, s43
    buffer_load_dwordx4 v143, s[52:55], s15 offen sc1 lds
    buffer_load_dwordx4 v68, s[52:55], s15 offen offset:2048 sc1 lds
    s_add_u32 s15, s81, 1
    s_cmp_ge_u32 s15, 20
    s_cselect_b32 s13, 20, 0
    s_sub_u32 s15, s15, s13
    s_add_u32 m0, s61, 1024
    s_lshl_b32 s15, s15, 10
    s_add_u32 s15, s15, s43
    buffer_load_dwordx4 v143, s[52:55], s15 offen sc1 lds
    buffer_load_dwordx4 v68, s[52:55], s15 offen offset:2048 sc1 lds
    s_add_u32 s15, s81, 2
    s_cmp_ge_u32 s15, 20
    s_cselect_b32 s13, 20, 0
    s_sub_u32 s15, s15, s13
    s_add_u32 m0, s61, 16384
    s_lshl_b32 s15, s15, 10
    s_add_u32 s15, s15, s43
    buffer_load_dwordx4 v143, s[52:55], s15 offen sc1 lds
    buffer_load_dwordx4 v68, s[52:55], s15 offen offset:2048 sc1 lds
    s_add_u32 s15, s81, 3
    s_cmp_ge_u32 s15, 20
    s_cselect_b32 s13, 20, 0
    s_sub_u32 s15, s15, s13
    s_add_u32 m0, s61, 17408
    s_lshl_b32 s15, s15, 10
    s_add_u32 s15, s15, s43
    buffer_load_dwordx4 v143, s[52:55], s15 offen sc1 lds
    buffer_load_dwordx4 v68, s[52:55], s15 offen offset:2048 sc1 lds
    v_mov_b32 v100, 163812
own_27:
    s_sleep 1
    ds_read_b32 v101, v100
    s_waitcnt lgkmcnt(0)
    v_readfirstlane_b32 s13, v101
    s_nop 0
    s_cmp_lt_u32 s13, 4
    s_cbranch_scc1 own_27
    s_waitcnt vmcnt(4)
    s_barrier
    s_add_u32 s15, s81, 4
    s_cmp_ge_u32 s15, 20
    s_cselect_b32 s13, 20, 0
    s_sub_u32 s15, s15, s13
    s_add_u32 m0, s61, 32768
    s_lshl_b32 s15, s15, 10
    s_add_u32 s15, s15, s43
    buffer_load_dwordx4 v143, s[52:55], s15 offen sc1 lds
    buffer_load_dwordx4 v68, s[52:55], s15 offen offset:2048 sc1 lds
    s_add_u32 s15, s81, 5
    s_cmp_ge_u32 s15, 20
    s_cselect_b32 s13, 20, 0
    s_sub_u32 s15, s15, s13
    s_add_u32 m0, s61, 33792
    s_lshl_b32 s15, s15, 10
    s_add_u32 s15, s15, s43
    buffer_load_dwordx4 v143, s[52:55], s15 offen sc1 lds
    buffer_load_dwordx4 v68, s[52:55], s15 offen offset:2048 sc1 lds
    s_add_u32 s15, s81, 6
    s_cmp_ge_u32 s15, 20
    s_cselect_b32 s13, 20, 0
    s_sub_u32 s15, s15, s13
    s_add_u32 m0, s61, 49152
    s_lshl_b32 s15, s15, 10
    s_add_u32 s15, s15, s43
    buffer_load_dwordx4 v143, s[52:55], s15 offen sc1 lds
    buffer_load_dwordx4 v68, s[52:55], s15 offen offset:2048 sc1 lds
    s_add_u32 s15, s81, 7
    s_cmp_ge_u32 s15, 20
    s_cselect_b32 s13, 20, 0
    s_sub_u32 s15, s15, s13
    s_add_u32 m0, s61, 50176
    s_lshl_b32 s15, s15, 10
    s_add_u32 s15, s15, s43
    buffer_load_dwordx4 v143, s[52:55], s15 offen sc1 lds
    buffer_load_dwordx4 v68, s[52:55], s15 offen offset:2048 sc1 lds
    s_lshl_b32 s12, s8, 10
    s_add_u32 s15, s81, 8
    s_cmp_ge_u32 s15, 20
    s_cselect_b32 s13, 20, 0
    s_sub_u32 s15, s15, s13
    s_mul_i32 s15, s15, 98304
    s_add_u32 m0, s12, 106496
    s_add_u32 s15, s15, 0
    buffer_load_dwordx4 v56, s[56:59], s15 offen lds
    s_add_u32 s15, s81, 9
    s_cmp_ge_u32 s15, 20
    s_cselect_b32 s13, 20, 0
    s_sub_u32 s15, s15, s13
    s_mul_i32 s15, s15, 98304
    s_add_u32 m0, s12, 110592
    s_add_u32 s15, s15, 0
    buffer_load_dwordx4 v56, s[56:59], s15 offen lds
    s_lshl_b32 s12, s8, 10
    s_add_u32 s15, s81, 10
    s_cmp_ge_u32 s15, 20
    s_cselect_b32 s13, 20, 0
    s_sub_u32 s15, s15, s13
    s_mul_i32 s15, s15, 98304
    s_add_u32 m0, s12, 98304
    s_add_u32 s15, s15, 0
    buffer_load_dwordx4 v56, s[56:59], s15 offen lds
    s_add_u32 s15, s81, 11
    s_cmp_ge_u32 s15, 20
    s_cselect_b32 s13, 20, 0
    s_sub_u32 s15, s15, s13
    s_mul_i32 s15, s15, 98304
    s_add_u32 m0, s12, 102400
    s_add_u32 s15, s15, 0
    buffer_load_dwordx4 v56, s[56:59], s15 offen lds
    s_waitcnt vmcnt(12)
    s_barrier
    s_lshl_b32 s12, s8, 10
    s_add_u32 s15, s81, 12
    s_cmp_ge_u32 s15, 20
    s_cselect_b32 s13, 20, 0
    s_sub_u32 s15, s15, s13
    s_mul_i32 s15, s15, 98304
    s_add_u32 m0, s12, 90112
    s_add_u32 s15, s15, 0
    buffer_load_dwordx4 v56, s[56:59], s15 offen lds
    s_add_u32 s15, s81, 13
    s_cmp_ge_u32 s15, 20
    s_cselect_b32 s13, 20, 0
    s_sub_u32 s15, s15, s13
    s_mul_i32 s15, s15, 98304
    s_add_u32 m0, s12, 94208
    s_add_u32 s15, s15, 0
    buffer_load_dwordx4 v56, s[56:59], s15 offen lds
    s_lshl_b32 s12, s8, 10
    s_add_u32 s15, s81, 14
    s_cmp_ge_u32 s15, 20
    s_cselect_b32 s13, 20, 0
    s_sub_u32 s15, s15, s13
    s_mul_i32 s15, s15, 98304
    s_add_u32 m0, s12, 81920
    s_add_u32 s15, s15, 0
    buffer_load_dwordx4 v56, s[56:59], s15 offen lds
    s_add_u32 s15, s81, 15
    s_cmp_ge_u32 s15, 20
    s_cselect_b32 s13, 20, 0
    s_sub_u32 s15, s15, s13
    s_mul_i32 s15, s15, 98304
    s_add_u32 m0, s12, 86016
    s_add_u32 s15, s15, 0
    buffer_load_dwordx4 v56, s[56:59], s15 offen lds
    s_lshl_b32 s12, s8, 10
    s_add_u32 s15, s81, 16
    s_cmp_ge_u32 s15, 20
    s_cselect_b32 s13, 20, 0
    s_sub_u32 s15, s15, s13
    s_mul_i32 s15, s15, 98304
    s_add_u32 m0, s12, 73728
    s_add_u32 s15, s15, 0
    buffer_load_dwordx4 v56, s[56:59], s15 offen lds
    s_add_u32 s15, s81, 17
    s_cmp_ge_u32 s15, 20
    s_cselect_b32 s13, 20, 0
    s_sub_u32 s15, s15, s13
    s_mul_i32 s15, s15, 98304
    s_add_u32 m0, s12, 77824
    s_add_u32 s15, s15, 0
    buffer_load_dwordx4 v56, s[56:59], s15 offen lds
    s_lshl_b32 s12, s8, 10
    s_add_u32 s15, s81, 18
    s_cmp_ge_u32 s15, 20
    s_cselect_b32 s13, 20, 0
    s_sub_u32 s15, s15, s13
    s_mul_i32 s15, s15, 98304
    s_add_u32 m0, s12, 65536
    s_add_u32 s15, s15, 0
    buffer_load_dwordx4 v56, s[56:59], s15 offen lds
    s_add_u32 s15, s81, 19
    s_cmp_ge_u32 s15, 20
    s_cselect_b32 s13, 20, 0
    s_sub_u32 s15, s15, s13
    s_mul_i32 s15, s15, 98304
    s_add_u32 m0, s12, 69632
    s_add_u32 s15, s15, 0
    buffer_load_dwordx4 v56, s[56:59], s15 offen lds
    s_waitcnt vmcnt(16)
    s_barrier
    s_add_u32 s15, s81, 8
    s_cmp_ge_u32 s15, 20
    s_cselect_b32 s13, 20, 0
    s_sub_u32 s15, s15, s13
    s_add_u32 m0, s61, 0
    s_lshl_b32 s15, s15, 10
    s_add_u32 s15, s15, s43
    buffer_load_dwordx4 v143, s[52:55], s15 offen sc1 lds
    buffer_load_dwordx4 v68, s[52:55], s15 offen offset:2048 sc1 lds
    s_add_u32 s15, s81, 9
    s_cmp_ge_u32 s15, 20
    s_cselect_b32 s13, 20, 0
    s_sub_u32 s15, s15, s13
    s_add_u32 m0, s61, 1024
    s_lshl_b32 s15, s15, 10
    s_add_u32 s15, s15, s43
    buffer_load_dwordx4 v143, s[52:55], s15 offen sc1 lds
    buffer_load_dwordx4 v68, s[52:55], s15 offen offset:2048 sc1 lds
    s_waitcnt vmcnt(16)
    s_barrier
    s_add_u32 s15, s81, 10
    s_cmp_ge_u32 s15, 20
    s_cselect_b32 s13, 20, 0
    s_sub_u32 s15, s15, s13
    s_add_u32 m0, s61, 16384
    s_lshl_b32 s15, s15, 10
    s_add_u32 s15, s15, s43
    buffer_load_dwordx4 v143, s[52:55], s15 offen sc1 lds
    buffer_load_dwordx4 v68, s[52:55], s15 offen offset:2048 sc1 lds
    s_add_u32 s15, s81, 11
    s_cmp_ge_u32 s15, 20
    s_cselect_b32 s13, 20, 0
    s_sub_u32 s15, s15, s13
    s_add_u32 m0, s61, 17408
    s_lshl_b32 s15, s15, 10
    s_add_u32 s15, s15, s43
    buffer_load_dwordx4 v143, s[52:55], s15 offen sc1 lds
    buffer_load_dwordx4 v68, s[52:55], s15 offen offset:2048 sc1 lds
    s_waitcnt vmcnt(4)
    s_barrier
    s_add_u32 s15, s81, 12
    s_cmp_ge_u32 s15, 20
    s_cselect_b32 s13, 20, 0
    s_sub_u32 s15, s15, s13
    s_add_u32 m0, s61, 32768
    s_lshl_b32 s15, s15, 10
    s_add_u32 s15, s15, s43
    buffer_load_dwordx4 v143, s[52:55], s15 offen sc1 lds
    buffer_load_dwordx4 v68, s[52:55], s15 offen offset:2048 sc1 lds
    s_add_u32 s15, s81, 13
    s_cmp_ge_u32 s15, 20
    s_cselect_b32 s13, 20, 0
    s_sub_u32 s15, s15, s13
    s_add_u32 m0, s61, 33792
    s_lshl_b32 s15, s15, 10
    s_add_u32 s15, s15, s43
    buffer_load_dwordx4 v143, s[52:55], s15 offen sc1 lds
    buffer_load_dwordx4 v68, s[52:55], s15 offen offset:2048 sc1 lds
    s_waitcnt vmcnt(4)
    s_barrier
    s_add_u32 s15, s81, 14
    s_cmp_ge_u32 s15, 20
    s_cselect_b32 s13, 20, 0
    s_sub_u32 s15, s15, s13
    s_add_u32 m0, s61, 49152
    s_lshl_b32 s15, s15, 10
    s_add_u32 s15, s15, s43
    buffer_load_dwordx4 v143, s[52:55], s15 offen sc1 lds
    buffer_load_dwordx4 v68, s[52:55], s15 offen offset:2048 sc1 lds
    s_add_u32 s15, s81, 15
    s_cmp_ge_u32 s15, 20
    s_cselect_b32 s13, 20, 0
    s_sub_u32 s15, s15, s13
    s_add_u32 m0, s61, 50176
    s_lshl_b32 s15, s15, 10
    s_add_u32 s15, s15, s43
    buffer_load_dwordx4 v143, s[52:55], s15 offen sc1 lds
    buffer_load_dwordx4 v68, s[52:55], s15 offen offset:2048 sc1 lds
    s_waitcnt vmcnt(4)
    s_barrier
    s_add_u32 s15, s81, 16
    s_cmp_ge_u32 s15, 20
    s_cselect_b32 s13, 20, 0
    s_sub_u32 s15, s15, s13
    s_add_u32 m0, s61, 0
    s_lshl_b32 s15, s15, 10
    s_add_u32 s15, s15, s43
    buffer_load_dwordx4 v143, s[52:55], s15 offen sc1 lds
    buffer_load_dwordx4 v68, s[52:55], s15 offen offset:2048 sc1 lds
    s_add_u32 s15, s81, 17
    s_cmp_ge_u32 s15, 20
    s_cselect_b32 s13, 20, 0
    s_sub_u32 s15, s15, s13
    s_add_u32 m0, s61, 1024
    s_lshl_b32 s15, s15, 10
    s_add_u32 s15, s15, s43
    buffer_load_dwordx4 v143, s[52:55], s15 offen sc1 lds
    buffer_load_dwordx4 v68, s[52:55], s15 offen offset:2048 sc1 lds
    s_waitcnt vmcnt(4)
    s_barrier
    s_add_u32 s15, s81, 18
    s_cmp_ge_u32 s15, 20
    s_cselect_b32 s13, 20, 0
    s_sub_u32 s15, s15, s13
    s_add_u32 m0, s61, 16384
    s_lshl_b32 s15, s15, 10
    s_add_u32 s15, s15, s43
    buffer_load_dwordx4 v143, s[52:55], s15 offen sc1 lds
    buffer_load_dwordx4 v68, s[52:55], s15 offen offset:2048 sc1 lds
    s_add_u32 s15, s81, 19
    s_cmp_ge_u32 s15, 20
    s_cselect_b32 s13, 20, 0
    s_sub_u32 s15, s15, s13
    s_add_u32 m0, s61, 17408
    s_lshl_b32 s15, s15, 10
    s_add_u32 s15, s15, s43
    buffer_load_dwordx4 v143, s[52:55], s15 offen sc1 lds
    buffer_load_dwordx4 v68, s[52:55], s15 offen offset:2048 sc1 lds
    s_lshl_b32 s11, s3, 2
    s_lshr_b32 s13, s4, 1
    s_add_u32 s11, s11, s13
    v_lshlrev_b32 v108, 4, v128
    v_add_u32 v108, s11, v108
    v_add_u32 v108, 768, v108
    s_lshl_b32 s11, s5, 4
    s_add_u32 s11, s11, 240
    v_add_u32 v109, s11, v128
    v_cmp_gt_u32 vcc, 16, v128
    s_nop 1
    v_cndmask_b32 v108, v109, v108, vcc
    v_subrev_u32 v109, 24, v128
    v_mul_u32_u24 v109, 24, v109
    s_add_u32 s11, s7, 16
    v_add_u32 v109, s11, v109
    v_and_b32 v111, 0xf8, v109
    v_add3_u32 v109, v109, v111, 8
    v_add_u32 v109, 768, v109
    v_cmp_gt_u32 vcc, 24, v128
    s_nop 1
    v_cndmask_b32 v108, v109, v108, vcc
    v_lshlrev_b32 v108, 7, v108
    s_mov_b32 s11, 4096
    s_cmp_eq_u32 s8, 0
    s_cselect_b32 s11, s11, s79
    s_mov_b32 exec_lo, 0x1fffffff
    s_mov_b32 exec_hi, 0x0
    buffer_load_dword v110, v108, s[52:55], s11 offen sc1
    s_mov_b64 exec, -1
    s_waitcnt vmcnt(5)
    s_barrier
    s_waitcnt vmcnt(1)
    s_barrier
    s_waitcnt vmcnt(0)
    s_mov_b32 exec_lo, 0x1fffffff
    s_mov_b32 exec_hi, 0x0
    v_cmp_ne_u32 vcc, s9, v110
    s_mov_b64 exec, -1
    s_cbranch_vccz aok_28
    s_cmp_lg_u32 s8, 0
    s_cbranch_scc1 pskip_29
    s_lshl_b32 s11, s3, 2
    s_lshr_b32 s13, s4, 1
    s_add_u32 s11, s11, s13
    v_lshlrev_b32 v100, 4, v128
    v_add_u32 v100, s11, v100
    v_add_u32 v100, 768, v100
    s_lshl_b32 s11, s5, 4
    s_add_u32 s11, s11, 240
    v_add_u32 v101, s11, v128
    v_cmp_gt_u32 vcc, 16, v128
    s_nop 1
    v_cndmask_b32 v100, v101, v100, vcc
    v_subrev_u32 v101, 24, v128
    v_mul_u32_u24 v101, 24, v101
    s_add_u32 s11, s7, 16
    v_add_u32 v101, s11, v101
    v_and_b32 v103, 0xf8, v101
    v_add3_u32 v101, v101, v103, 8
    v_add_u32 v101, 768, v101
    v_cmp_gt_u32 vcc, 24, v128
    s_nop 1
    v_cndmask_b32 v100, v101, v100, vcc
    v_lshlrev_b32 v100, 7, v100
    s_mov_b32 s11, 4096
    s_mov_b32 s13, 0
    s_mov_b32 exec_lo, 0x1fffffff
    s_mov_b32 exec_hi, 0x0
ploop_30:
    buffer_load_dword v101, v100, s[52:55], s11 offen sc1
    s_add_u32 s13, s13, 1
    s_cmp_gt_u32 s13, 131072
    s_cbranch_scc1 pout_31
    s_waitcnt vmcnt(0)
    v_cmp_ne_u32 vcc, s9, v101
    s_cbranch_vccnz ploop_30
pout_31:
    s_waitcnt vmcnt(0)
    s_mov_b64 exec, -1
pskip_29:
aok_28:
    s_mul_i32 s12, s7, 256
    s_add_u32 s12, s12, 17465344
    s_cmp_eq_u32 s8, 0
    s_cselect_b32 s12, s12, s79
    s_cselect_b32 s11, 151552, s78
    v_add_u32 v3, s11, v143
    buffer_load_dwordx4 v[24:27], v143, s[52:55], s12 offen sc1
    s_add_u32 s12, s12, 6144
    buffer_load_dwordx4 v[28:31], v143, s[52:55], s12 offen sc1
    s_add_u32 s12, s12, 6144
    buffer_load_dwordx4 v[32:35], v143, s[52:55], s12 offen sc1
    s_add_u32 s12, s12, 6144
    buffer_load_dwordx4 v[36:39], v143, s[52:55], s12 offen sc1
    s_add_u32 s12, s12, 6144
    buffer_load_dwordx4 v[40:43], v143, s[52:55], s12 offen sc1
    s_add_u32 s12, s12, 6144
    s_waitcnt vmcnt(0)
    v_add_f32 v24, v24, v28
    v_add_f32 v25, v25, v29
    v_add_f32 v26, v26, v30
    v_add_f32 v27, v27, v31
    v_add_f32 v24, v24, v32
    v_add_f32 v25, v25, v33
    v_add_f32 v26, v26, v34
    v_add_f32 v27, v27, v35
    v_add_f32 v24, v24, v36
    v_add_f32 v25, v25, v37
    v_add_f32 v26, v26, v38
    v_add_f32 v27, v27, v39
    v_add_f32 v24, v24, v40
    v_add_f32 v25, v25, v41
    v_add_f32 v26, v26, v42
    v_add_f32 v27, v27, v43
    ds_write_b128 v3, v[24:27]
    s_waitcnt lgkmcnt(0)
    s_barrier
    s_add_u32 s15, s83, 0
    s_cmp_ge_u32 s15, 5
    s_cselect_b32 s13, 5, 0
    s_sub_u32 s15, s15, s13
    s_add_u32 m0, s62, 49152
    s_mul_i32 s15, s15, 20480
    s_add_u32 s15, s15, s93
    buffer_load_dwordx4 v66, s[52:55], s15 offen offset:0 sc1 lds
    buffer_load_dwordx4 v66, s[52:55], s15 offen offset:1024 sc1 lds
    buffer_load_dwordx4 v66, s[52:55], s15 offen offset:2048 sc1 lds
    buffer_load_dwordx4 v66, s[52:55], s15 offen offset:3072 sc1 lds
    s_add_u32 m0, m0, 4096
    s_nop 0
    buffer_load_dwordx4 v67, s[52:55], s15 offen sc1 lds
    s_add_u32 s15, s83, 0
    s_cmp_ge_u32 s15, 5
    s_cselect_b32 s13, 5, 0
    s_sub_u32 s15, s15, s13
    s_add_u32 m0, s61, 0
    s_lshl_b32 s15, s15, 12
    s_add_u32 s15, s15, s95
    buffer_load_dwordx4 v143, s[52:55], s15 offen offset:0 sc1 lds
    buffer_load_dwordx4 v143, s[52:55], s15 offen offset:1024 sc1 lds
    buffer_load_dwordx4 v143, s[52:55], s15 offen offset:2048 sc1 lds
    buffer_load_dwordx4 v143, s[52:55], s15 offen offset:3072 sc1 lds
    s_add_u32 s15, s83, 1
    s_cmp_ge_u32 s15, 5
    s_cselect_b32 s13, 5, 0
    s_sub_u32 s15, s15, s13
    s_add_u32 m0, s62, 69632
    s_mul_i32 s15, s15, 20480
    s_add_u32 s15, s15, s93
    buffer_load_dwordx4 v66, s[52:55], s15 offen offset:0 sc1 lds
    buffer_load_dwordx4 v66, s[52:55], s15 offen offset:1024 sc1 lds
    buffer_load_dwordx4 v66, s[52:55], s15 offen offset:2048 sc1 lds
    buffer_load_dwordx4 v66, s[52:55], s15 offen offset:3072 sc1 lds
    s_add_u32 m0, m0, 4096
    s_nop 0
    buffer_load_dwordx4 v67, s[52:55], s15 offen sc1 lds
    s_add_u32 s15, s83, 1
    s_cmp_ge_u32 s15, 5
    s_cselect_b32 s13, 5, 0
    s_sub_u32 s15, s15, s13
    s_add_u32 m0, s61, 16384
    s_lshl_b32 s15, s15, 12
    s_add_u32 s15, s15, s95
    buffer_load_dwordx4 v143, s[52:55], s15 offen offset:0 sc1 lds
    buffer_load_dwordx4 v143, s[52:55], s15 offen offset:1024 sc1 lds
    buffer_load_dwordx4 v143, s[52:55], s15 offen offset:2048 sc1 lds
    buffer_load_dwordx4 v143, s[52:55], s15 offen offset:3072 sc1 lds
    v_mov_b32 v100, 163816
own_33:
    s_sleep 1
    ds_read_b32 v101, v100
    s_waitcnt lgkmcnt(0)
    v_readfirstlane_b32 s13, v101
    s_nop 0
    s_cmp_lt_u32 s13, 4
    s_cbranch_scc1 own_33
    s_add_u32 s15, s83, 2
    s_cmp_ge_u32 s15, 5
    s_cselect_b32 s13, 5, 0
    s_sub_u32 s15, s15, s13
    s_add_u32 m0, s62, 90112
    s_mul_i32 s15, s15, 20480
    s_add_u32 s15, s15, s93
    buffer_load_dwordx4 v66, s[52:55], s15 offen offset:0 sc1 lds
    buffer_load_dwordx4 v66, s[52:55], s15 offen offset:1024 sc1 lds
    buffer_load_dwordx4 v66, s[52:55], s15 offen offset:2048 sc1 lds
    buffer_load_dwordx4 v66, s[52:55], s15 offen offset:3072 sc1 lds
    s_add_u32 m0, m0, 4096
    s_nop 0
    buffer_load_dwordx4 v67, s[52:55], s15 offen sc1 lds
    s_add_u32 s15, s83, 2
    s_cmp_ge_u32 s15, 5
    s_cselect_b32 s13, 5, 0
    s_sub_u32 s15, s15, s13
    s_add_u32 m0, s61, 32768
    s_lshl_b32 s15, s15, 12
    s_add_u32 s15, s15, s95
    buffer_load_dwordx4 v143, s[52:55], s15 offen offset:0 sc1 lds
    buffer_load_dwordx4 v143, s[52:55], s15 offen offset:1024 sc1 lds
    buffer_load_dwordx4 v143, s[52:55], s15 offen offset:2048 sc1 lds
    buffer_load_dwordx4 v143, s[52:55], s15 offen offset:3072 sc1 lds
    s_add_u32 s15, s83, 3
    s_cmp_ge_u32 s15, 5
    s_cselect_b32 s13, 5, 0
    s_sub_u32 s15, s15, s13
    s_add_u32 m0, s62, 110592
    s_mul_i32 s15, s15, 20480
    s_add_u32 s15, s15, s93
    buffer_load_dwordx4 v66, s[52:55], s15 offen offset:0 sc1 lds
    buffer_load_dwordx4 v66, s[52:55], s15 offen offset:1024 sc1 lds
    buffer_load_dwordx4 v66, s[52:55], s15 offen offset:2048 sc1 lds
    buffer_load_dwordx4 v66, s[52:55], s15 offen offset:3072 sc1 lds
    s_add_u32 m0, m0, 4096
    s_nop 0
    buffer_load_dwordx4 v67, s[52:55], s15 offen sc1 lds
    s_add_u32 s15, s83, 4
    s_cmp_ge_u32 s15, 5
    s_cselect_b32 s13, 5, 0
    s_sub_u32 s15, s15, s13
    s_add_u32 m0, s62, 131072
    s_mul_i32 s15, s15, 20480
    s_add_u32 s15, s15, s93
    buffer_load_dwordx4 v66, s[52:55], s15 offen offset:0 sc1 lds
    buffer_load_dwordx4 v66, s[52:55], s15 offen offset:1024 sc1 lds
    buffer_load_dwordx4 v66, s[52:55], s15 offen offset:2048 sc1 lds
    buffer_load_dwordx4 v66, s[52:55], s15 offen offset:3072 sc1 lds
    s_add_u32 m0, m0, 4096
    s_nop 0
    buffer_load_dwordx4 v67, s[52:55], s15 offen sc1 lds
    s_waitcnt vmcnt(28)
    s_barrier
    s_waitcnt vmcnt(19)
    s_barrier
    s_add_u32 s15, s83, 3
    s_cmp_ge_u32 s15, 5
    s_cselect_b32 s13, 5, 0
    s_sub_u32 s15, s15, s13
    s_add_u32 m0, s61, 0
    s_lshl_b32 s15, s15, 12
    s_add_u32 s15, s15, s95
    buffer_load_dwordx4 v143, s[52:55], s15 offen offset:0 sc1 lds
    buffer_load_dwordx4 v143, s[52:55], s15 offen offset:1024 sc1 lds
    buffer_load_dwordx4 v143, s[52:55], s15 offen offset:2048 sc1 lds
    buffer_load_dwordx4 v143, s[52:55], s15 offen offset:3072 sc1 lds
    s_add_u32 s15, s82, 0
    s_cmp_ge_u32 s15, 12
    s_cselect_b32 s13, 12, 0
    s_sub_u32 s15, s15, s13
    s_add_u32 m0, s62, 49152
    s_mul_i32 s15, s15, 20480
    s_add_u32 s15, s15, s93
    s_add_u32 s15, s15, 102400
    buffer_load_dwordx4 v66, s[52:55], s15 offen offset:0 sc1 lds
    buffer_load_dwordx4 v66, s[52:55], s15 offen offset:1024 sc1 lds
    buffer_load_dwordx4 v66, s[52:55], s15 offen offset:2048 sc1 lds
    buffer_load_dwordx4 v66, s[52:55], s15 offen offset:3072 sc1 lds
    s_add_u32 m0, m0, 4096
    s_nop 0
    buffer_load_dwordx4 v67, s[52:55], s15 offen sc1 lds
    s_waitcnt vmcnt(19)
    s_barrier
    s_add_u32 s15, s83, 4
    s_cmp_ge_u32 s15, 5
    s_cselect_b32 s13, 5, 0
    s_sub_u32 s15, s15, s13
    s_add_u32 m0, s61, 16384
    s_lshl_b32 s15, s15, 12
    s_add_u32 s15, s15, s95
    buffer_load_dwordx4 v143, s[52:55], s15 offen offset:0 sc1 lds
    buffer_load_dwordx4 v143, s[52:55], s15 offen offset:1024 sc1 lds
    buffer_load_dwordx4 v143, s[52:55], s15 offen offset:2048 sc1 lds
    buffer_load_dwordx4 v143, s[52:55], s15 offen offset:3072 sc1 lds
    s_add_u32 s15, s82, 1
    s_cmp_ge_u32 s15, 12
    s_cselect_b32 s13, 12, 0
    s_sub_u32 s15, s15, s13
    s_add_u32 m0, s62, 69632
    s_mul_i32 s15, s15, 20480
    s_add_u32 s15, s15, s93
    s_add_u32 s15, s15, 102400
    buffer_load_dwordx4 v66, s[52:55], s15 offen offset:0 sc1 lds
    buffer_load_dwordx4 v66, s[52:55], s15 offen offset:1024 sc1 lds
    buffer_load_dwordx4 v66, s[52:55], s15 offen offset:2048 sc1 lds
    buffer_load_dwordx4 v66, s[52:55], s15 offen offset:3072 sc1 lds
    s_add_u32 m0, m0, 4096
    s_nop 0
    buffer_load_dwordx4 v67, s[52:55], s15 offen sc1 lds
    s_waitcnt vmcnt(14)
    s_barrier
    s_lshl_b32 s11, s5, 4
    s_add_u32 s11, s11, 512
    v_add_u32 v108, s11, v128
    v_lshlrev_b32 v108, 7, v108
    s_mov_b32 s11, 4096
    s_cmp_eq_u32 s8, 0
    s_cselect_b32 s11, s11, s79
    s_mov_b32 exec_lo, 0xffff
    s_mov_b32 exec_hi, 0x0
    buffer_load_dword v110, v108, s[52:55], s11 offen sc1
    s_mov_b64 exec, -1
    s_add_u32 s15, s82, 2
    s_cmp_ge_u32 s15, 12
    s_cselect_b32 s13, 12, 0
    s_sub_u32 s15, s15, s13
    s_add_u32 m0, s62, 90112
    s_mul_i32 s15, s15, 20480
    s_add_u32 s15, s15, s93
    s_add_u32 s15, s15, 102400
    buffer_load_dwordx4 v66, s[52:55], s15 offen offset:0 sc1 lds
    buffer_load_dwordx4 v66, s[52:55], s15 offen offset:1024 sc1 lds
    buffer_load_dwordx4 v66, s[52:55], s15 offen offset:2048 sc1 lds
    buffer_load_dwordx4 v66, s[52:55], s15 offen offset:3072 sc1 lds
    s_add_u32 m0, m0, 4096
    s_nop 0
    buffer_load_dwordx4 v67, s[52:55], s15 offen sc1 lds
    s_waitcnt vmcnt(11)
    s_barrier
    s_add_u32 s15, s82, 3
    s_cmp_ge_u32 s15, 12
    s_cselect_b32 s13, 12, 0
    s_sub_u32 s15, s15, s13
    s_add_u32 m0, s62, 110592
    s_mul_i32 s15, s15, 20480
    s_add_u32 s15, s15, s93
    s_add_u32 s15, s15, 102400
    buffer_load_dwordx4 v66, s[52:55], s15 offen offset:0 sc1 lds
    buffer_load_dwordx4 v66, s[52:55], s15 offen offset:1024 sc1 lds
    buffer_load_dwordx4 v66, s[52:55], s15 offen offset:2048 sc1 lds
    buffer_load_dwordx4 v66, s[52:55], s15 offen offset:3072 sc1 lds
    s_add_u32 m0, m0, 4096
    s_nop 0
    buffer_load_dwordx4 v67, s[52:55], s15 offen sc1 lds
    s_waitcnt vmcnt(10)
    s_mov_b32 exec_lo, 0xffff
    s_mov_b32 exec_hi, 0x0
    v_cmp_ne_u32 vcc, s9, v110
    s_mov_b64 exec, -1
    s_cbranch_vccz aok_34
    s_cmp_lg_u32 s8, 0
    s_cbranch_scc1 pskip_35
    s_lshl_b32 s11, s5, 4
    s_add_u32 s11, s11, 512
    v_add_u32 v100, s11, v128
    v_lshlrev_b32 v100, 7, v100
    s_mov_b32 s11, 4096
    s_mov_b32 s13, 0
    s_mov_b32 exec_lo, 0xffff
    s_mov_b32 exec_hi, 0x0
ploop_36:
    buffer_load_dword v101, v100, s[52:55], s11 offen sc1
    s_add_u32 s13, s13, 1
    s_cmp_gt_u32 s13, 131072
    s_cbranch_scc1 pout_37
    s_waitcnt vmcnt(0)
    v_cmp_ne_u32 vcc, s9, v101
    s_cbranch_vccnz ploop_36
pout_37:
    s_waitcnt vmcnt(0)
    s_mov_b64 exec, -1
pskip_35:
aok_34:
    s_barrier
    s_add_u32 s15, s82, 0
    s_cmp_ge_u32 s15, 12
    s_cselect_b32 s13, 12, 0
    s_sub_u32 s15, s15, s13
    s_add_u32 m0, s61, 32768
    s_lshl_b32 s15, s15, 12
    s_add_u32 s15, s15, s94
    buffer_load_dwordx4 v143, s[52:55], s15 offen offset:0 sc1 lds
    buffer_load_dwordx4 v143, s[52:55], s15 offen offset:1024 sc1 lds
    buffer_load_dwordx4 v143, s[52:55], s15 offen offset:2048 sc1 lds
    buffer_load_dwordx4 v143, s[52:55], s15 offen offset:3072 sc1 lds
    s_add_u32 s15, s82, 1
    s_cmp_ge_u32 s15, 12
    s_cselect_b32 s13, 12, 0
    s_sub_u32 s15, s15, s13
    s_add_u32 m0, s61, 0
    s_lshl_b32 s15, s15, 12
    s_add_u32 s15, s15, s94
    buffer_load_dwordx4 v143, s[52:55], s15 offen offset:0 sc1 lds
    buffer_load_dwordx4 v143, s[52:55], s15 offen offset:1024 sc1 lds
    buffer_load_dwordx4 v143, s[52:55], s15 offen offset:2048 sc1 lds
    buffer_load_dwordx4 v143, s[52:55], s15 offen offset:3072 sc1 lds
    s_add_u32 s15, s82, 4
    s_cmp_ge_u32 s15, 12
    s_cselect_b32 s13, 12, 0
    s_sub_u32 s15, s15, s13
    s_add_u32 m0, s62, 131072
    s_mul_i32 s15, s15, 20480
    s_add_u32 s15, s15, s93
    s_add_u32 s15, s15, 102400
    buffer_load_dwordx4 v66, s[52:55], s15 offen offset:0 sc1 lds
    buffer_load_dwordx4 v66, s[52:55], s15 offen offset:1024 sc1 lds
    buffer_load_dwordx4 v66, s[52:55], s15 offen offset:2048 sc1 lds
    buffer_load_dwordx4 v66, s[52:55], s15 offen offset:3072 sc1 lds
    s_add_u32 m0, m0, 4096
    s_nop 0
    buffer_load_dwordx4 v67, s[52:55], s15 offen sc1 lds
    s_add_u32 s15, s82, 2
    s_cmp_ge_u32 s15, 12
    s_cselect_b32 s13, 12, 0
    s_sub_u32 s15, s15, s13
    s_add_u32 m0, s61, 16384
    s_lshl_b32 s15, s15, 12
    s_add_u32 s15, s15, s94
    buffer_load_dwordx4 v143, s[52:55], s15 offen offset:0 sc1 lds
    buffer_load_dwordx4 v143, s[52:55], s15 offen offset:1024 sc1 lds
    buffer_load_dwordx4 v143, s[52:55], s15 offen offset:2048 sc1 lds
    buffer_load_dwordx4 v143, s[52:55], s15 offen offset:3072 sc1 lds
    s_waitcnt vmcnt(13)
    s_barrier
    s_waitcnt vmcnt(9)
    s_barrier
    s_add_u32 s15, s82, 3
    s_cmp_ge_u32 s15, 12
    s_cselect_b32 s13, 12, 0
    s_sub_u32 s15, s15, s13
    s_add_u32 m0, s61, 32768
    s_lshl_b32 s15, s15, 12
    s_add_u32 s15, s15, s94
    buffer_load_dwordx4 v143, s[52:55], s15 offen offset:0 sc1 lds
    buffer_load_dwordx4 v143, s[52:55], s15 offen offset:1024 sc1 lds
    buffer_load_dwordx4 v143, s[52:55], s15 offen offset:2048 sc1 lds
    buffer_load_dwordx4 v143, s[52:55], s15 offen offset:3072 sc1 lds
    s_add_u32 s15, s82, 5
    s_cmp_ge_u32 s15, 12
    s_cselect_b32 s13, 12, 0
    s_sub_u32 s15, s15, s13
    s_add_u32 m0, s62, 49152
    s_mul_i32 s15, s15, 20480
    s_add_u32 s15, s15, s93
    s_add_u32 s15, s15, 102400
    buffer_load_dwordx4 v66, s[52:55], s15 offen offset:0 sc1 lds
    buffer_load_dwordx4 v66, s[52:55], s15 offen offset:1024 sc1 lds
    buffer_load_dwordx4 v66, s[52:55], s15 offen offset:2048 sc1 lds
    buffer_load_dwordx4 v66, s[52:55], s15 offen offset:3072 sc1 lds
    s_add_u32 m0, m0, 4096
    s_nop 0
    buffer_load_dwordx4 v67, s[52:55], s15 offen sc1 lds
    s_waitcnt vmcnt(9)
    s_barrier
    s_add_u32 s15, s82, 4
    s_cmp_ge_u32 s15, 12
    s_cselect_b32 s13, 12, 0
    s_sub_u32 s15, s15, s13
    s_add_u32 m0, s61, 0
    s_lshl_b32 s15, s15, 12
    s_add_u32 s15, s15, s94
    buffer_load_dwordx4 v143, s[52:55], s15 offen offset:0 sc1 lds
    buffer_load_dwordx4 v143, s[52:55], s15 offen offset:1024 sc1 lds
    buffer_load_dwordx4 v143, s[52:55], s15 offen offset:2048 sc1 lds
    buffer_load_dwordx4 v143, s[52:55], s15 offen offset:3072 sc1 lds
    s_add_u32 s15, s82, 6
    s_cmp_ge_u32 s15, 12
    s_cselect_b32 s13, 12, 0
    s_sub_u32 s15, s15, s13
    s_add_u32 m0, s62, 69632
    s_mul_i32 s15, s15, 20480
    s_add_u32 s15, s15, s93
    s_add_u32 s15, s15, 102400
    buffer_load_dwordx4 v66, s[52:55], s15 offen offset:0 sc1 lds
    buffer_load_dwordx4 v66, s[52:55], s15 offen offset:1024 sc1 lds
    buffer_load_dwordx4 v66, s[52:55], s15 offen offset:2048 sc1 lds
    buffer_load_dwordx4 v66, s[52:55], s15 offen offset:3072 sc1 lds
    s_add_u32 m0, m0, 4096
    s_nop 0
    buffer_load_dwordx4 v67, s[52:55], s15 offen sc1 lds
    s_waitcnt vmcnt(14)
    s_barrier
    s_add_u32 s15, s82, 5
    s_cmp_ge_u32 s15, 12
    s_cselect_b32 s13, 12, 0
    s_sub_u32 s15, s15, s13
    s_add_u32 m0, s61, 16384
    s_lshl_b32 s15, s15, 12
    s_add_u32 s15, s15, s94
    buffer_load_dwordx4 v143, s[52:55], s15 offen offset:0 sc1 lds
    buffer_load_dwordx4 v143, s[52:55], s15 offen offset:1024 sc1 lds
    buffer_load_dwordx4 v143, s[52:55], s15 offen offset:2048 sc1 lds
    buffer_load_dwordx4 v143, s[52:55], s15 offen offset:3072 sc1 lds
    s_add_u32 s15, s82, 7
    s_cmp_ge_u32 s15, 12
    s_cselect_b32 s13, 12, 0
    s_sub_u32 s15, s15, s13
    s_add_u32 m0, s62, 90112
    s_mul_i32 s15, s15, 20480
    s_add_u32 s15, s15, s93
    s_add_u32 s15, s15, 102400
    buffer_load_dwordx4 v66, s[52:55], s15 offen offset:0 sc1 lds
    buffer_load_dwordx4 v66, s[52:55], s15 offen offset:1024 sc1 lds
    buffer_load_dwordx4 v66, s[52:55], s15 offen offset:2048 sc1 lds
    buffer_load_dwordx4 v66, s[52:55], s15 offen offset:3072 sc1 lds
    s_add_u32 m0, m0, 4096
    s_nop 0
    buffer_load_dwordx4 v67, s[52:55], s15 offen sc1 lds
    s_waitcnt vmcnt(14)
    s_barrier
    s_add_u32 s15, s82, 6
    s_cmp_ge_u32 s15, 12
    s_cselect_b32 s13, 12, 0
    s_sub_u32 s15, s15, s13
    s_add_u32 m0, s61, 32768
    s_lshl_b32 s15, s15, 12
    s_add_u32 s15, s15, s94
    buffer_load_dwordx4 v143, s[52:55], s15 offen offset:0 sc1 lds
    buffer_load_dwordx4 v143, s[52:55], s15 offen offset:1024 sc1 lds
    buffer_load_dwordx4 v143, s[52:55], s15 offen offset:2048 sc1 lds
    buffer_load_dwordx4 v143, s[52:55], s15 offen offset:3072 sc1 lds
    s_add_u32 s15, s82, 8
    s_cmp_ge_u32 s15, 12
    s_cselect_b32 s13, 12, 0
    s_sub_u32 s15, s15, s13
    s_add_u32 m0, s62, 110592
    s_mul_i32 s15, s15, 20480
    s_add_u32 s15, s15, s93
    s_add_u32 s15, s15, 102400
    buffer_load_dwordx4 v66, s[52:55], s15 offen offset:0 sc1 lds
    buffer_load_dwordx4 v66, s[52:55], s15 offen offset:1024 sc1 lds
    buffer_load_dwordx4 v66, s[52:55], s15 offen offset:2048 sc1 lds
    buffer_load_dwordx4 v66, s[52:55], s15 offen offset:3072 sc1 lds
    s_add_u32 m0, m0, 4096
    s_nop 0
    buffer_load_dwordx4 v67, s[52:55], s15 offen sc1 lds
    s_waitcnt vmcnt(14)
    s_barrier
    s_add_u32 s15, s82, 7
    s_cmp_ge_u32 s15, 12
    s_cselect_b32 s13, 12, 0
    s_sub_u32 s15, s15, s13
    s_add_u32 m0, s61, 0
    s_lshl_b32 s15, s15, 12
    s_add_u32 s15, s15, s94
    buffer_load_dwordx4 v143, s[52:55], s15 offen offset:0 sc1 lds
    buffer_load_dwordx4 v143, s[52:55], s15 offen offset:1024 sc1 lds
    buffer_load_dwordx4 v143, s[52:55], s15 offen offset:2048 sc1 lds
    buffer_load_dwordx4 v143, s[52:55], s15 offen offset:3072 sc1 lds
    s_add_u32 s15, s82, 9
    s_cmp_ge_u32 s15, 12
    s_cselect_b32 s13, 12, 0
    s_sub_u32 s15, s15, s13
    s_add_u32 m0, s62, 131072
    s_mul_i32 s15, s15, 20480
    s_add_u32 s15, s15, s93
    s_add_u32 s15, s15, 102400
    buffer_load_dwordx4 v66, s[52:55], s15 offen offset:0 sc1 lds
    buffer_load_dwordx4 v66, s[52:55], s15 offen offset:1024 sc1 lds
    buffer_load_dwordx4 v66, s[52:55], s15 offen offset:2048 sc1 lds
    buffer_load_dwordx4 v66, s[52:55], s15 offen offset:3072 sc1 lds
    s_add_u32 m0, m0, 4096
    s_nop 0
    buffer_load_dwordx4 v67, s[52:55], s15 offen sc1 lds
    s_waitcnt vmcnt(14)
    s_barrier
    s_add_u32 s15, s82, 8
    s_cmp_ge_u32 s15, 12
    s_cselect_b32 s13, 12, 0
    s_sub_u32 s15, s15, s13
    s_add_u32 m0, s61, 16384
    s_lshl_b32 s15, s15, 12
    s_add_u32 s15, s15, s94
    buffer_load_dwordx4 v143, s[52:55], s15 offen offset:0 sc1 lds
    buffer_load_dwordx4 v143, s[52:55], s15 offen offset:1024 sc1 lds
    buffer_load_dwordx4 v143, s[52:55], s15 offen offset:2048 sc1 lds
    buffer_load_dwordx4 v143, s[52:55], s15 offen offset:3072 sc1 lds
    s_add_u32 s15, s82, 10
    s_cmp_ge_u32 s15, 12
    s_cselect_b32 s13, 12, 0
    s_sub_u32 s15, s15, s13
    s_add_u32 m0, s62, 49152
    s_mul_i32 s15, s15, 20480
    s_add_u32 s15, s15, s93
    s_add_u32 s15, s15, 102400
    buffer_load_dwordx4 v66, s[52:55], s15 offen offset:0 sc1 lds
    buffer_load_dwordx4 v66, s[52:55], s15 offen offset:1024 sc1 lds
    buffer_load_dwordx4 v66, s[52:55], s15 offen offset:2048 sc1 lds
    buffer_load_dwordx4 v66, s[52:55], s15 offen offset:3072 sc1 lds
    s_add_u32 m0, m0, 4096
    s_nop 0
    buffer_load_dwordx4 v67, s[52:55], s15 offen sc1 lds
    s_waitcnt vmcnt(14)
    s_barrier
    s_add_u32 s15, s82, 9
    s_cmp_ge_u32 s15, 12
    s_cselect_b32 s13, 12, 0
    s_sub_u32 s15, s15, s13
    s_add_u32 m0, s61, 32768
    s_lshl_b32 s15, s15, 12
    s_add_u32 s15, s15, s94
    buffer_load_dwordx4 v143, s[52:55], s15 offen offset:0 sc1 lds
    buffer_load_dwordx4 v143, s[52:55], s15 offen offset:1024 sc1 lds
    buffer_load_dwordx4 v143, s[52:55], s15 offen offset:2048 sc1 lds
    buffer_load_dwordx4 v143, s[52:55], s15 offen offset:3072 sc1 lds
    s_add_u32 s15, s82, 11
    s_cmp_ge_u32 s15, 12
    s_cselect_b32 s13, 12, 0
    s_sub_u32 s15, s15, s13
    s_add_u32 m0, s62, 69632
    s_mul_i32 s15, s15, 20480
    s_add_u32 s15, s15, s93
    s_add_u32 s15, s15, 102400
    buffer_load_dwordx4 v66, s[52:55], s15 offen offset:0 sc1 lds
    buffer_load_dwordx4 v66, s[52:55], s15 offen offset:1024 sc1 lds
    buffer_load_dwordx4 v66, s[52:55], s15 offen offset:2048 sc1 lds
    buffer_load_dwordx4 v66, s[52:55], s15 offen offset:3072 sc1 lds
    s_add_u32 m0, m0, 4096
    s_nop 0
    buffer_load_dwordx4 v67, s[52:55], s15 offen sc1 lds
    s_waitcnt vmcnt(14)
    s_barrier
    s_add_u32 s15, s82, 10
    s_cmp_ge_u32 s15, 12
    s_cselect_b32 s13, 12, 0
    s_sub_u32 s15, s15, s13
    s_add_u32 m0, s61, 0
    s_lshl_b32 s15, s15, 12
    s_add_u32 s15, s15, s94
    buffer_load_dwordx4 v143, s[52:55], s15 offen offset:0 sc1 lds
    buffer_load_dwordx4 v143, s[52:55], s15 offen offset:1024 sc1 lds
    buffer_load_dwordx4 v143, s[52:55], s15 offen offset:2048 sc1 lds
    buffer_load_dwordx4 v143, s[52:55], s15 offen offset:3072 sc1 lds
    s_lshl_b32 s11, s3, 2
    s_lshr_b32 s13, s4, 1
    s_add_u32 s11, s11, s13
    s_lshl_b32 s84, s5, 1
    s_and_b32 s12, s4, 1
    s_add_u32 s84, s84, s12
    s_lshl_b32 s84, s84, 2
    s_add_u32 s84, s84, s8
    s_mul_i32 s12, s11, 5
    s_lshr_b32 s12, s12, 1
    s_lshl_b32 s12, s12, 10
    s_mul_i32 s85, s84, 20480
    s_add_u32 s85, s85, s12
    s_bitcmp1_b32 s11, 0
    s_cselect_b32 s11, 1024, 0
    s_movk_i32 s12, 2048
    s_cselect_b32 s12, 512, s12
    s_add_u32 s86, s85, s12
    s_add_u32 s85, s85, s11
    s_lshl_b32 s84, s84, 6
    s_add_u32 s84, s84, 17453056
    s_lshl_b32 s87, s8, 12
    s_add_u32 s87, s87, 90112
    v_mov_b32 v120, s79
    v_cmp_gt_u32 vcc, 32, v128
    s_nop 1
    v_cndmask_b32 v121, v120, v143, vcc
    v_cmp_gt_u32 vcc, 4, v128
    s_nop 1
    v_cndmask_b32 v120, v120, v143, vcc
    s_add_u32 m0, s87, 0
    s_add_u32 s15, s85, 2871296
    buffer_load_dwordx4 v143, s[52:55], s15 offen offset:0 sc1 lds
    buffer_load_dwordx4 v143, s[52:55], s15 offen offset:1024 sc1 lds
    s_add_u32 m0, s87, 2048
    s_add_u32 s15, s86, 2871296
    buffer_load_dwordx4 v121, s[52:55], s15 offen sc1 lds
    s_add_u32 m0, s87, 3072
    s_nop 0
    buffer_load_dwordx4 v120, s[52:55], s84 offen sc1 lds
    s_waitcnt vmcnt(13)
    s_barrier
    s_add_u32 s15, s82, 11
    s_cmp_ge_u32 s15, 12
    s_cselect_b32 s13, 12, 0
    s_sub_u32 s15, s15, s13
    s_add_u32 m0, s61, 16384
    s_lshl_b32 s15, s15, 12
    s_add_u32 s15, s15, s94
    buffer_load_dwordx4 v143, s[52:55], s15 offen offset:0 sc1 lds
    buffer_load_dwordx4 v143, s[52:55], s15 offen offset:1024 sc1 lds
    buffer_load_dwordx4 v143, s[52:55], s15 offen offset:2048 sc1 lds
    buffer_load_dwordx4 v143, s[52:55], s15 offen offset:3072 sc1 lds
    s_waitcnt vmcnt(8)
    s_barrier
    s_waitcnt vmcnt(0)
    s_barrier
    s_endpgm
p_ld_w:
    s_lshl_b32 s14, s42, 7
    s_add_u32 m0, s60, 0
    s_mul_i32 s15, s42, s87
    buffer_load_dwordx4 v0, s[44:47], s14 offen offset:0  lds
    buffer_load_dwordx4 v1, s[44:47], s14 offen offset:1024  lds
    s_mul_i32 s12, s8, 320
    v_add_u32 v126, s12, v128
    v_add_u32 v120, 0, v126
    v_mul_u32_u24 v121, 3277, v120
    v_lshrrev_b32 v121, 16, v121
    v_mul_u32_u24 v122, 20, v121
    v_sub_u32 v120, v120, v122
    v_lshrrev_b32 v122, 1, v121
    v_and_b32 v122, 2, v122
    v_xor_b32 v120, v120, v122
    v_and_b32 v123, 35, v121
    v_and_b32 v122, 12, v121
    v_lshl_or_b32 v123, v122, 1, v123
    v_bfe_u32 v122, v121, 4, 1
    v_lshl_or_b32 v123, v122, 2, v123
    v_mul_lo_u32 v123, v123, s84
    v_lshl_add_u32 v123, v120, 4, v123
    v_cmp_le_u32 vcc, 10, v120
    v_mov_b32 v122, s86
    s_nop 0
    v_cndmask_b32 v122, 0, v122, vcc
    v_add3_u32 v4, v123, v122, s85
    v_add_u32 v120, 64, v126
    v_mul_u32_u24 v121, 3277, v120
    v_lshrrev_b32 v121, 16, v121
    v_mul_u32_u24 v122, 20, v121
    v_sub_u32 v120, v120, v122
    v_lshrrev_b32 v122, 1, v121
    v_and_b32 v122, 2, v122
    v_xor_b32 v120, v120, v122
    v_and_b32 v123, 35, v121
    v_and_b32 v122, 12, v121
    v_lshl_or_b32 v123, v122, 1, v123
    v_bfe_u32 v122, v121, 4, 1
    v_lshl_or_b32 v123, v122, 2, v123
    v_mul_lo_u32 v123, v123, s84
    v_lshl_add_u32 v123, v120, 4, v123
    v_cmp_le_u32 vcc, 10, v120
    v_mov_b32 v122, s86
    s_nop 0
    v_cndmask_b32 v122, 0, v122, vcc
    v_add3_u32 v5, v123, v122, s85
    v_subrev_u32 v5, 1024, v5
    v_add_u32 v120, 128, v126
    v_mul_u32_u24 v121, 3277, v120
    v_lshrrev_b32 v121, 16, v121
    v_mul_u32_u24 v122, 20, v121
    v_sub_u32 v120, v120, v122
    v_lshrrev_b32 v122, 1, v121
    v_and_b32 v122, 2, v122
    v_xor_b32 v120, v120, v122
    v_and_b32 v123, 35, v121
    v_and_b32 v122, 12, v121
    v_lshl_or_b32 v123, v122, 1, v123
    v_bfe_u32 v122, v121, 4, 1
    v_lshl_or_b32 v123, v122, 2, v123
    v_mul_lo_u32 v123, v123, s84
    v_lshl_add_u32 v123, v120, 4, v123
    v_cmp_le_u32 vcc, 10, v120
    v_mov_b32 v122, s86
    s_nop 0
    v_cndmask_b32 v122, 0, v122, vcc
    v_add3_u32 v6, v123, v122, s85
    v_subrev_u32 v6, 2048, v6
    v_add_u32 v120, 192, v126
    v_mul_u32_u24 v121, 3277, v120
    v_lshrrev_b32 v121, 16, v121
    v_mul_u32_u24 v122, 20, v121
    v_sub_u32 v120, v120, v122
    v_lshrrev_b32 v122, 1, v121
    v_and_b32 v122, 2, v122
    v_xor_b32 v120, v120, v122
    v_and_b32 v123, 35, v121
    v_and_b32 v122, 12, v121
    v_lshl_or_b32 v123, v122, 1, v123
    v_bfe_u32 v122, v121, 4, 1
    v_lshl_or_b32 v123, v122, 2, v123
    v_mul_lo_u32 v123, v123, s84
    v_lshl_add_u32 v123, v120, 4, v123
    v_cmp_le_u32 vcc, 10, v120
    v_mov_b32 v122, s86
    s_nop 0
    v_cndmask_b32 v122, 0, v122, vcc
    v_add3_u32 v7, v123, v122, s85
    v_subrev_u32 v7, 3072, v7
    v_add_u32 v120, 256, v126
    v_mul_u32_u24 v121, 3277, v120
    v_lshrrev_b32 v121, 16, v121
    v_mul_u32_u24 v122, 20, v121
    v_sub_u32 v120, v120, v122
    v_lshrrev_b32 v122, 1, v121
    v_and_b32 v122, 2, v122
    v_xor_b32 v120, v120, v122
    v_and_b32 v123, 35, v121
    v_and_b32 v122, 12, v121
    v_lshl_or_b32 v123, v122, 1, v123
    v_bfe_u32 v122, v121, 4, 1
    v_lshl_or_b32 v123, v122, 2, v123
    v_mul_lo_u32 v123, v123, s84
    v_lshl_add_u32 v123, v120, 4, v123
    v_cmp_le_u32 vcc, 10, v120
    v_mov_b32 v122, s86
    s_nop 0
    v_cndmask_b32 v122, 0, v122, vcc
    v_add3_u32 v8, v123, v122, s85
    s_mov_b32 s48, s26
    s_mov_b32 s49, s27
    s_mov_b32 s50, 819200
    s_mov_b32 s51, 0x20000
    s_add_u32 m0, s62, 8192
    s_add_u32 s42, s42, 1
    buffer_load_dwordx4 v4, s[48:51], s15 offen offset:0  lds
    buffer_load_dwordx4 v5, s[48:51], s15 offen offset:1024  lds
    buffer_load_dwordx4 v6, s[48:51], s15 offen offset:2048  lds
    buffer_load_dwordx4 v7, s[48:51], s15 offen offset:3072  lds
    s_add_u32 m0, m0, 4096
    s_nop 0
    buffer_load_dwordx4 v8, s[48:51], s15 offen  lds
    s_cmp_eq_u32 s42, 10
    s_cselect_b32 s42, 0, s42
    s_lshl_b32 s14, s42, 7
    s_add_u32 m0, s60, 28672
    s_mul_i32 s15, s42, s87
    buffer_load_dwordx4 v0, s[44:47], s14 offen offset:0  lds
    buffer_load_dwordx4 v1, s[44:47], s14 offen offset:1024  lds
    s_add_u32 m0, s62, 36864
    s_add_u32 s42, s42, 1
    buffer_load_dwordx4 v4, s[48:51], s15 offen offset:0  lds
    buffer_load_dwordx4 v5, s[48:51], s15 offen offset:1024  lds
    buffer_load_dwordx4 v6, s[48:51], s15 offen offset:2048  lds
    buffer_load_dwordx4 v7, s[48:51], s15 offen offset:3072  lds
    s_add_u32 m0, m0, 4096
    s_nop 0
    buffer_load_dwordx4 v8, s[48:51], s15 offen  lds
    s_cmp_eq_u32 s42, 10
    s_cselect_b32 s42, 0, s42
    v_mov_b32 v120, 163808
    s_mov_b32 s78, 162784
    v_mov_b32 v44, 0
    v_mov_b32 v45, 0
    v_mov_b32 v46, 0
    v_mov_b32 v47, 0
    ds_write_b128 v120, v[44:47]
    ds_write_b128 v120, v[44:47] offset:16
    s_mov_b32 s88, s38
    s_mov_b32 s89, s39
    s_mov_b32 s90, 256
    s_mov_b32 s91, 0x20000
    s_waitcnt lgkmcnt(0)
    s_waitcnt vmcnt(7)
    s_barrier
    s_lshl_b32 s14, s42, 7
    s_add_u32 m0, s60, 57344
    s_mul_i32 s15, s42, s87
    buffer_load_dwordx4 v0, s[44:47], s14 offen offset:0  lds
    buffer_load_dwordx4 v1, s[44:47], s14 offen offset:1024  lds
    s_add_u32 m0, s62, 65536
    s_add_u32 s42, s42, 1
    buffer_load_dwordx4 v4, s[48:51], s15 offen offset:0  lds
    buffer_load_dwordx4 v5, s[48:51], s15 offen offset:1024  lds
    buffer_load_dwordx4 v6, s[48:51], s15 offen offset:2048  lds
    buffer_load_dwordx4 v7, s[48:51], s15 offen offset:3072  lds
    s_add_u32 m0, m0, 4096
    s_nop 0
    buffer_load_dwordx4 v8, s[48:51], s15 offen  lds
    s_cmp_eq_u32 s42, 10
    s_cselect_b32 s42, 0, s42
    s_getpc_b64 s[52:53]
pc_39:
    s_add_u32 s52, s52, text_begin-pc_39
    s_addc_u32 s53, s53, -1
    s_mov_b32 s54, text_end-text_begin
    s_mov_b32 s55, 0x20000
    s_lshl_b32 s101, s10, 2
    s_add_u32 s101, s101, s8
    s_lshl_b32 s101, s101, 10
    buffer_load_dwordx4 v[116:119], v143, s[52:55], s101 offen
    s_mov_b32 s52, s40
    s_mov_b32 s53, s41
    s_mov_b32 s54, 17498112
    s_mov_b32 s55, 0x20000
    s_lshl_b32 s11, s5, 3
    s_add_u32 s11, s11, s7
    s_lshl_b32 s11, s11, 2
    s_add_u32 s11, s11, s8
    s_mov_b32 s96, s28
    s_mov_b32 s97, s29
    s_mov_b32 s98, 819200
    s_mov_b32 s99, 0x20000
    s_mul_i32 s11, s11, 1600
    buffer_load_dwordx4 v[112:115], v143, s[96:99], s11 offen offset:0
    buffer_load_dwordx4 v[116:119], v143, s[96:99], s11 offen offset:576
    s_waitcnt vmcnt(10)
    s_barrier
    s_lshl_b32 s14, s42, 7
    s_add_u32 m0, s60, 86016
    s_mul_i32 s15, s42, s87
    buffer_load_dwordx4 v0, s[44:47], s14 offen offset:0  lds
    buffer_load_dwordx4 v1, s[44:47], s14 offen offset:1024  lds
    s_add_u32 m0, s62, 94208
    s_add_u32 s42, s42, 1
    buffer_load_dwordx4 v4, s[48:51], s15 offen offset:0  lds
    buffer_load_dwordx4 v5, s[48:51], s15 offen offset:1024  lds
    buffer_load_dwordx4 v6, s[48:51], s15 offen offset:2048  lds
    buffer_load_dwordx4 v7, s[48:51], s15 offen offset:3072  lds
    s_add_u32 m0, m0, 4096
    s_nop 0
    buffer_load_dwordx4 v8, s[48:51], s15 offen  lds
    s_cmp_eq_u32 s42, 10
    s_cselect_b32 s42, 0, s42
    s_and_b32 s13, s10, 3
    s_and_b32 s12, s4, 3
    s_add_u32 s92, s13, s12
    s_and_b32 s92, s92, 3
    s_mul_i32 s81, s92, 5
    s_mul_i32 s80, s13, 3
    s_lshl_b32 s12, s12, 1
    s_add_u32 s80, s80, s12
    s_mul_i32 s11, s80, 6554
    s_lshr_b32 s11, s11, 16
    s_mul_i32 s11, s11, 10
    s_sub_u32 s80, s80, s11
    s_lshl_b32 s82, s13, 1
    s_and_b32 s11, s4, 1
    s_add_u32 s82, s82, s11
    s_mul_i32 s82, s82, 3
    s_lshr_b32 s82, s82, 1
    s_lshr_b32 s11, s4, 1
    s_mul_i32 s11, s11, 3
    s_add_u32 s82, s82, s11
    s_mul_i32 s11, s82, 5462
    s_lshr_b32 s11, s11, 16
    s_mul_i32 s11, s11, 12
    s_sub_u32 s82, s82, s11
    s_lshl_b32 s12, s8, 6
    v_add_u32 v127, s12, v128
    v_add_u32 v66, s62, v143
    v_add_u32 v67, 4096, v66
    v_add_u32 v68, 18432, v143
    v_add_u32 v69, 20480, v143
    s_lshl_b32 s93, s3, 2
    s_lshr_b32 s13, s4, 1
    s_add_u32 s93, s93, s13
    s_mul_i32 s93, s93, 348160
    s_add_u32 s93, s93, 14667776
    s_lshl_b32 s43, s5, 3
    s_lshl_b32 s11, s8, 1
    s_add_u32 s43, s43, s11
    s_mul_i32 s43, s43, 20480
    s_add_u32 s43, s43, 2871296
    s_lshl_b32 s94, s5, 1
    s_and_b32 s11, s4, 1
    s_add_u32 s94, s94, s11
    s_lshl_b32 s94, s94, 2
    s_add_u32 s94, s94, s8
    s_mul_i32 s95, s94, 20480
    s_add_u32 s95, s95, 5754880
    s_mul_i32 s94, s94, 49152
    s_add_u32 s94, s94, 8376320
    s_mul_i32 s83, s82, 27
    s_lshr_b32 s83, s83, 6
    s_lshl_b32 s11, s8, 3
    v_lshrrev_b32 v120, 3, v128
    v_add_u32 v120, s11, v120
    v_mul_u32_u24 v120, 3072, v120
    s_mul_i32 s11, s7, 256
    s_add_u32 s11, s11, 0
    v_add_u32 v120, s11, v120
    v_and_b32 v121, 7, v128
    v_lshlrev_b32 v122, 1, v130
    v_xor_b32 v122, v121, v122
    v_lshl_add_u32 v56, v122, 4, v120
    s_mul_i32 s11, s7, 160
    v_add_u32 v120, 0, v126
    v_mul_u32_u24 v121, 6554, v120
    v_lshrrev_b32 v121, 16, v121
    v_mul_u32_u24 v122, 10, v121
    v_sub_u32 v120, v120, v122
    v_lshlrev_b32 v120, 4, v120
    v_add_u32 v120, s11, v120
    v_mul_u32_u24 v121, 1280, v121
    v_add_u32 v72, v121, v120
    v_add_u32 v120, 64, v126
    v_mul_u32_u24 v121, 6554, v120
    v_lshrrev_b32 v121, 16, v121
    v_mul_u32_u24 v122, 10, v121
    v_sub_u32 v120, v120, v122
    v_lshlrev_b32 v120, 4, v120
    v_add_u32 v120, s11, v120
    v_mul_u32_u24 v121, 1280, v121
    v_add_u32 v73, v121, v120
    v_subrev_u32 v73, 1024, v73
    v_add_u32 v120, 128, v126
    v_mul_u32_u24 v121, 6554, v120
    v_lshrrev_b32 v121, 16, v121
    v_mul_u32_u24 v122, 10, v121
    v_sub_u32 v120, v120, v122
    v_lshlrev_b32 v120, 4, v120
    v_add_u32 v120, s11, v120
    v_mul_u32_u24 v121, 1280, v121
    v_add_u32 v74, v121, v120
    v_subrev_u32 v74, 2048, v74
    v_add_u32 v120, 192, v126
    v_mul_u32_u24 v121, 6554, v120
    v_lshrrev_b32 v121, 16, v121
    v_mul_u32_u24 v122, 10, v121
    v_sub_u32 v120, v120, v122
    v_lshlrev_b32 v120, 4, v120
    v_add_u32 v120, s11, v120
    v_mul_u32_u24 v121, 1280, v121
    v_add_u32 v75, v121, v120
    v_subrev_u32 v75, 3072, v75
    v_add_u32 v120, 256, v126
    v_mul_u32_u24 v121, 6554, v120
    v_lshrrev_b32 v121, 16, v121
    v_mul_u32_u24 v122, 10, v121
    v_sub_u32 v120, v120, v122
    v_lshlrev_b32 v120, 4, v120
    v_add_u32 v120, s11, v120
    v_mul_u32_u24 v121, 1280, v121
    v_add_u32 v76, v121, v120
    v_add_u32 v120, 0, v127
    v_mul_u32_u24 v121, 6554, v120
    v_lshrrev_b32 v121, 16, v121
    v_mul_u32_u24 v122, 10, v121
    v_sub_u32 v120, v120, v122
    v_lshlrev_b32 v120, 4, v120
    v_add_u32 v120, s11, v120
    v_mul_u32_u24 v121, 1280, v121
    v_add_u32 v48, v121, v120
    v_add_u32 v120, 256, v127
    v_mul_u32_u24 v121, 6554, v120
    v_lshrrev_b32 v121, 16, v121
    v_mul_u32_u24 v122, 10, v121
    v_sub_u32 v120, v120, v122
    v_lshlrev_b32 v120, 4, v120
    v_add_u32 v120, s11, v120
    v_mul_u32_u24 v121, 1280, v121
    v_add_u32 v49, v121, v120
    v_add_u32 v120, 512, v127
    v_mul_u32_u24 v121, 6554, v120
    v_lshrrev_b32 v121, 16, v121
    v_mul_u32_u24 v122, 10, v121
    v_sub_u32 v120, v120, v122
    v_lshlrev_b32 v120, 4, v120
    v_add_u32 v120, s11, v120
    v_mul_u32_u24 v121, 1280, v121
    v_add_u32 v50, v121, v120
    v_add_u32 v120, 768, v127
    v_mul_u32_u24 v121, 6554, v120
    v_lshrrev_b32 v121, 16, v121
    v_mul_u32_u24 v122, 10, v121
    v_sub_u32 v120, v120, v122
    v_lshlrev_b32 v120, 4, v120
    v_add_u32 v120, s11, v120
    v_mul_u32_u24 v121, 1280, v121
    v_add_u32 v51, v121, v120
    v_add_u32 v120, 1024, v127
    v_mul_u32_u24 v121, 6554, v120
    v_lshrrev_b32 v121, 16, v121
    v_mul_u32_u24 v122, 10, v121
    v_sub_u32 v120, v120, v122
    v_lshlrev_b32 v120, 4, v120
    v_add_u32 v120, s11, v120
    v_mul_u32_u24 v121, 1280, v121
    v_add_u32 v52, v121, v120
    v_add_u32 v120, 1280, v127
    v_mul_u32_u24 v121, 6554, v120
    v_lshrrev_b32 v121, 16, v121
    v_mul_u32_u24 v122, 10, v121
    v_sub_u32 v120, v120, v122
    v_lshlrev_b32 v120, 4, v120
    v_add_u32 v120, s11, v120
    v_mul_u32_u24 v121, 1280, v121
    v_add_u32 v53, v121, v120
    v_add_u32 v120, 1536, v127
    v_mul_u32_u24 v121, 6554, v120
    v_lshrrev_b32 v121, 16, v121
    v_mul_u32_u24 v122, 10, v121
    v_sub_u32 v120, v120, v122
    v_lshlrev_b32 v120, 4, v120
    v_add_u32 v120, s11, v120
    v_mul_u32_u24 v121, 1280, v121
    v_add_u32 v54, v121, v120
    s_cmp_eq_u32 s8, 0
    s_cselect_b32 s11, 0, s79
    v_add_u32 v54, s11, v54
    s_lshl_b32 s12, s5, 3
    s_lshl_b32 s11, s8, 1
    s_add_u32 s12, s12, s11
    s_lshl_b32 s12, s12, 4
    v_add_u32 v79, s12, v129
    s_waitcnt vmcnt(10)
    s_barrier
    s_lshl_b32 s14, s42, 7
    s_add_u32 m0, s60, 0
    s_mul_i32 s15, s42, s87
    buffer_load_dwordx4 v0, s[44:47], s14 offen offset:0  lds
    buffer_load_dwordx4 v1, s[44:47], s14 offen offset:1024  lds
    s_add_u32 m0, s62, 8192
    s_add_u32 s42, s42, 1
    buffer_load_dwordx4 v4, s[48:51], s15 offen offset:0  lds
    buffer_load_dwordx4 v5, s[48:51], s15 offen offset:1024  lds
    buffer_load_dwordx4 v6, s[48:51], s15 offen offset:2048  lds
    buffer_load_dwordx4 v7, s[48:51], s15 offen offset:3072  lds
    s_add_u32 m0, m0, 4096
    s_nop 0
    buffer_load_dwordx4 v8, s[48:51], s15 offen  lds
    s_cmp_eq_u32 s42, 10
    s_cselect_b32 s42, 0, s42
    s_waitcnt vmcnt(7)
    s_barrier
    s_lshl_b32 s14, s42, 7
    s_add_u32 m0, s60, 28672
    s_mul_i32 s15, s42, s87
    buffer_load_dwordx4 v0, s[44:47], s14 offen offset:0  lds
    buffer_load_dwordx4 v1, s[44:47], s14 offen offset:1024  lds
    s_add_u32 m0, s62, 36864
    s_add_u32 s42, s42, 1
    buffer_load_dwordx4 v4, s[48:51], s15 offen offset:0  lds
    buffer_load_dwordx4 v5, s[48:51], s15 offen offset:1024  lds
    buffer_load_dwordx4 v6, s[48:51], s15 offen offset:2048  lds
    buffer_load_dwordx4 v7, s[48:51], s15 offen offset:3072  lds
    s_add_u32 m0, m0, 4096
    s_nop 0
    buffer_load_dwordx4 v8, s[48:51], s15 offen  lds
    s_cmp_eq_u32 s42, 10
    s_cselect_b32 s42, 0, s42
    s_waitcnt vmcnt(7)
    s_barrier
    s_lshl_b32 s14, s42, 7
    s_add_u32 m0, s60, 57344
    s_mul_i32 s15, s42, s87
    buffer_load_dwordx4 v0, s[44:47], s14 offen offset:0  lds
    buffer_load_dwordx4 v1, s[44:47], s14 offen offset:1024  lds
    s_add_u32 m0, s62, 65536
    s_add_u32 s42, s42, 1
    buffer_load_dwordx4 v4, s[48:51], s15 offen offset:0  lds
    buffer_load_dwordx4 v5, s[48:51], s15 offen offset:1024  lds
    buffer_load_dwordx4 v6, s[48:51], s15 offen offset:2048  lds
    buffer_load_dwordx4 v7, s[48:51], s15 offen offset:3072  lds
    s_add_u32 m0, m0, 4096
    s_nop 0
    buffer_load_dwordx4 v8, s[48:51], s15 offen  lds
    s_cmp_eq_u32 s42, 10
    s_cselect_b32 s42, 0, s42
    s_waitcnt vmcnt(7)
    s_barrier
    s_lshl_b32 s14, s42, 7
    s_add_u32 m0, s60, 86016
    s_mul_i32 s15, s42, s87
    buffer_load_dwordx4 v0, s[44:47], s14 offen offset:0  lds
    buffer_load_dwordx4 v1, s[44:47], s14 offen offset:1024  lds
    s_add_u32 m0, s62, 94208
    s_add_u32 s42, s42, 1
    buffer_load_dwordx4 v4, s[48:51], s15 offen offset:0  lds
    buffer_load_dwordx4 v5, s[48:51], s15 offen offset:1024  lds
    buffer_load_dwordx4 v6, s[48:51], s15 offen offset:2048  lds
    buffer_load_dwordx4 v7, s[48:51], s15 offen offset:3072  lds
    s_add_u32 m0, m0, 4096
    s_nop 0
    buffer_load_dwordx4 v8, s[48:51], s15 offen  lds
    s_cmp_eq_u32 s42, 10
    s_cselect_b32 s42, 0, s42
    s_waitcnt vmcnt(7)
    s_barrier
    s_lshl_b32 s14, s42, 7
    s_add_u32 m0, s60, 0
    s_mul_i32 s15, s42, s87
    buffer_load_dwordx4 v0, s[44:47], s14 offen offset:0  lds
    buffer_load_dwordx4 v1, s[44:47], s14 offen offset:1024  lds
    s_add_u32 m0, s62, 8192
    s_add_u32 s42, s42, 1
    buffer_load_dwordx4 v4, s[48:51], s15 offen offset:0  lds
    buffer_load_dwordx4 v5, s[48:51], s15 offen offset:1024  lds
    buffer_load_dwordx4 v6, s[48:51], s15 offen offset:2048  lds
    buffer_load_dwordx4 v7, s[48:51], s15 offen offset:3072  lds
    s_add_u32 m0, m0, 4096
    s_nop 0
    buffer_load_dwordx4 v8, s[48:51], s15 offen  lds
    s_cmp_eq_u32 s42, 10
    s_cselect_b32 s42, 0, s42
    s_waitcnt vmcnt(7)
    s_barrier
    s_lshl_b32 s14, s42, 7
    s_add_u32 m0, s60, 28672
    s_mul_i32 s15, s42, s87
    buffer_load_dwordx4 v0, s[44:47], s14 offen offset:0  lds
    buffer_load_dwordx4 v1, s[44:47], s14 offen offset:1024  lds
    s_add_u32 m0, s62, 36864
    s_add_u32 s42, s42, 1
    buffer_load_dwordx4 v4, s[48:51], s15 offen offset:0  lds
    buffer_load_dwordx4 v5, s[48:51], s15 offen offset:1024  lds
    buffer_load_dwordx4 v6, s[48:51], s15 offen offset:2048  lds
    buffer_load_dwordx4 v7, s[48:51], s15 offen offset:3072  lds
    s_add_u32 m0, m0, 4096
    s_nop 0
    buffer_load_dwordx4 v8, s[48:51], s15 offen  lds
    s_cmp_eq_u32 s42, 10
    s_cselect_b32 s42, 0, s42
    v_mov_b32 v105, 0
    buffer_load_dword v104, v105, s[88:91], 0 offen sc1
    buffer_load_dword v107, v105, s[88:91], 0 offen offset:64 sc1
    s_mov_b32 s56, s30
    s_mov_b32 s57, s31
    s_mov_b32 s58, 1966080
    s_mov_b32 s59, 0x20000
    s_mov_b32 s48, s28
    s_mov_b32 s49, s29
    s_mov_b32 s50, 819200
    s_mov_b32 s51, 0x20000
    s_waitcnt vmcnt(9)
    s_barrier
    s_add_u32 s15, s92, 0
    s_and_b32 s15, s15, 3
    s_mul_i32 s15, s15, 204800
    s_lshl_b32 s12, s8, 10
    s_add_u32 m0, s12, 114688
    s_nop 0
    buffer_load_dwordx4 v48, s[48:51], s15 offen lds
    s_add_u32 m0, s12, 118784
    s_nop 0
    buffer_load_dwordx4 v49, s[48:51], s15 offen lds
    s_add_u32 m0, s12, 122880
    s_nop 0
    buffer_load_dwordx4 v50, s[48:51], s15 offen lds
    s_add_u32 m0, s12, 126976
    s_nop 0
    buffer_load_dwordx4 v51, s[48:51], s15 offen lds
    s_add_u32 m0, s12, 131072
    s_nop 0
    buffer_load_dwordx4 v52, s[48:51], s15 offen lds
    s_add_u32 m0, s12, 135168
    s_nop 0
    buffer_load_dwordx4 v53, s[48:51], s15 offen lds
    s_add_u32 s12, s12, 139264
    s_cmp_lt_u32 s8, 1
    s_cselect_b32 m0, s12, s78
    s_nop 0
    buffer_load_dwordx4 v54, s[48:51], s15 offen lds
    s_waitcnt vmcnt(9)
    s_waitcnt vmcnt(7)
    s_mov_b32 s13, 0
nz_40:
    v_readfirstlane_b32 s9, v104
    s_add_u32 s13, s13, 1
    s_cmp_lg_u32 s9, 0
    s_cbranch_scc1 nd_41
    s_cmp_gt_u32 s13, 131072
    s_cbranch_scc1 nd_41
    s_sleep 4
    buffer_load_dword v104, v105, s[88:91], 0 offen sc1
    s_waitcnt vmcnt(0)
    s_branch nz_40
nd_41:
    s_barrier
    s_add_u32 s15, s92, 1
    s_and_b32 s15, s15, 3
    s_mul_i32 s15, s15, 204800
    s_lshl_b32 s12, s8, 10
    s_add_u32 m0, s12, 57344
    s_nop 0
    buffer_load_dwordx4 v48, s[48:51], s15 offen lds
    s_add_u32 m0, s12, 61440
    s_nop 0
    buffer_load_dwordx4 v49, s[48:51], s15 offen lds
    s_add_u32 m0, s12, 65536
    s_nop 0
    buffer_load_dwordx4 v50, s[48:51], s15 offen lds
    s_add_u32 m0, s12, 69632
    s_nop 0
    buffer_load_dwordx4 v51, s[48:51], s15 offen lds
    s_add_u32 m0, s12, 73728
    s_nop 0
    buffer_load_dwordx4 v52, s[48:51], s15 offen lds
    s_add_u32 m0, s12, 77824
    s_nop 0
    buffer_load_dwordx4 v53, s[48:51], s15 offen lds
    s_add_u32 s12, s12, 81920
    s_cmp_lt_u32 s8, 1
    s_cselect_b32 m0, s12, s78
    s_nop 0
    buffer_load_dwordx4 v54, s[48:51], s15 offen lds
    s_barrier
    s_add_u32 s15, s92, 2
    s_and_b32 s15, s15, 3
    s_mul_i32 s15, s15, 204800
    s_lshl_b32 s12, s8, 10
    s_add_u32 m0, s12, 86016
    s_nop 0
    buffer_load_dwordx4 v48, s[48:51], s15 offen lds
    s_add_u32 m0, s12, 90112
    s_nop 0
    buffer_load_dwordx4 v49, s[48:51], s15 offen lds
    s_add_u32 m0, s12, 94208
    s_nop 0
    buffer_load_dwordx4 v50, s[48:51], s15 offen lds
    s_add_u32 m0, s12, 98304
    s_nop 0
    buffer_load_dwordx4 v51, s[48:51], s15 offen lds
    s_add_u32 m0, s12, 102400
    s_nop 0
    buffer_load_dwordx4 v52, s[48:51], s15 offen lds
    s_add_u32 m0, s12, 106496
    s_nop 0
    buffer_load_dwordx4 v53, s[48:51], s15 offen lds
    s_add_u32 s12, s12, 110592
    s_cmp_lt_u32 s8, 1
    s_cselect_b32 m0, s12, s78
    s_nop 0
    buffer_load_dwordx4 v54, s[48:51], s15 offen lds
    v_mov_b32 v122, s79
    s_add_u32 s84, s92, 0
    s_and_b32 s84, s84, 3
    s_lshr_b32 s85, s84, 1
    s_add_u32 s85, s85, 1
    s_sub_u32 s86, 0, s85
    s_bitcmp1_b32 s84, 0
    s_cselect_b32 s85, s86, s85
    s_mul_i32 s84, s84, 320
    v_subrev_u32 v120, s85, v79
    v_lshrrev_b32 v121, 4, v120
    v_cmp_gt_u32 vcc, 0x800, v120
    v_and_b32 v120, 15, v120
    v_mul_u32_u24 v121, 1280, v121
    v_lshl_add_u32 v120, v130, 4, v120
    v_add3_u32 v120, v120, v121, s84
    v_lshlrev_b32 v120, 4, v120
    v_cndmask_b32 v80, v122, v120, vcc
    v_subrev_u32 v120, s85, v79
    v_add_u32 v120, 16, v120
    v_lshrrev_b32 v121, 4, v120
    v_cmp_gt_u32 vcc, 0x800, v120
    v_and_b32 v120, 15, v120
    v_mul_u32_u24 v121, 1280, v121
    v_lshl_add_u32 v120, v130, 4, v120
    v_add3_u32 v120, v120, v121, s84
    v_lshlrev_b32 v120, 4, v120
    v_cndmask_b32 v81, v122, v120, vcc
    s_add_u32 s84, s92, 1
    s_and_b32 s84, s84, 3
    s_lshr_b32 s85, s84, 1
    s_add_u32 s85, s85, 1
    s_sub_u32 s86, 0, s85
    s_bitcmp1_b32 s84, 0
    s_cselect_b32 s85, s86, s85
    s_mul_i32 s84, s84, 320
    v_subrev_u32 v120, s85, v79
    v_lshrrev_b32 v121, 4, v120
    v_cmp_gt_u32 vcc, 0x800, v120
    v_and_b32 v120, 15, v120
    v_mul_u32_u24 v121, 1280, v121
    v_lshl_add_u32 v120, v130, 4, v120
    v_add3_u32 v120, v120, v121, s84
    v_lshlrev_b32 v120, 4, v120
    v_cndmask_b32 v82, v122, v120, vcc
    v_subrev_u32 v120, s85, v79
    v_add_u32 v120, 16, v120
    v_lshrrev_b32 v121, 4, v120
    v_cmp_gt_u32 vcc, 0x800, v120
    v_and_b32 v120, 15, v120
    v_mul_u32_u24 v121, 1280, v121
    v_lshl_add_u32 v120, v130, 4, v120
    v_add3_u32 v120, v120, v121, s84
    v_lshlrev_b32 v120, 4, v120
    v_cndmask_b32 v83, v122, v120, vcc
    s_add_u32 s84, s92, 2
    s_and_b32 s84, s84, 3
    s_lshr_b32 s85, s84, 1
    s_add_u32 s85, s85, 1
    s_sub_u32 s86, 0, s85
    s_bitcmp1_b32 s84, 0
    s_cselect_b32 s85, s86, s85
    s_mul_i32 s84, s84, 320
    v_subrev_u32 v120, s85, v79
    v_lshrrev_b32 v121, 4, v120
    v_cmp_gt_u32 vcc, 0x800, v120
    v_and_b32 v120, 15, v120
    v_mul_u32_u24 v121, 1280, v121
    v_lshl_add_u32 v120, v130, 4, v120
    v_add3_u32 v120, v120, v121, s84
    v_lshlrev_b32 v120, 4, v120
    v_cndmask_b32 v84, v122, v120, vcc
    v_subrev_u32 v120, s85, v79
    v_add_u32 v120, 16, v120
    v_lshrrev_b32 v121, 4, v120
    v_cmp_gt_u32 vcc, 0x800, v120
    v_and_b32 v120, 15, v120
    v_mul_u32_u24 v121, 1280, v121
    v_lshl_add_u32 v120, v130, 4, v120
    v_add3_u32 v120, v120, v121, s84
    v_lshlrev_b32 v120, 4, v120
    v_cndmask_b32 v85, v122, v120, vcc
    s_add_u32 s84, s92, 3
    s_and_b32 s84, s84, 3
    s_lshr_b32 s85, s84, 1
    s_add_u32 s85, s85, 1
    s_sub_u32 s86, 0, s85
    s_bitcmp1_b32 s84, 0
    s_cselect_b32 s85, s86, s85
    s_mul_i32 s84, s84, 320
    v_subrev_u32 v120, s85, v79
    v_lshrrev_b32 v121, 4, v120
    v_cmp_gt_u32 vcc, 0x800, v120
    v_and_b32 v120, 15, v120
    v_mul_u32_u24 v121, 1280, v121
    v_lshl_add_u32 v120, v130, 4, v120
    v_add3_u32 v120, v120, v121, s84
    v_lshlrev_b32 v120, 4, v120
    v_cndmask_b32 v86, v122, v120, vcc
    v_subrev_u32 v120, s85, v79
    v_add_u32 v120, 16, v120
    v_lshrrev_b32 v121, 4, v120
    v_cmp_gt_u32 vcc, 0x800, v120
    v_and_b32 v120, 15, v120
    v_mul_u32_u24 v121, 1280, v121
    v_lshl_add_u32 v120, v130, 4, v120
    v_add3_u32 v120, v120, v121, s84
    v_lshlrev_b32 v120, 4, v120
    v_cndmask_b32 v87, v122, v120, vcc
    v_mov_b32 v100, 163808
own_42:
    s_sleep 1
    ds_read_b32 v101, v100
    s_waitcnt lgkmcnt(0)
    v_readfirstlane_b32 s13, v101
    s_nop 0
    s_cmp_lt_u32 s13, 4
    s_cbranch_scc1 own_42
    v_mov_b32 v102, 163828
    s_cmp_lg_u32 s8, 0
    s_cbranch_scc1 poth_46
    v_lshrrev_b32 v100, 3, v128
    v_add_u32 v100, s5, v100
    v_add_u32 v100, 15, v100
    v_and_b32 v100, 15, v100
    v_lshlrev_b32 v100, 4, v100
    v_and_b32 v101, 7, v128
    v_add3_u32 v100, v100, v101, 8
    v_lshlrev_b32 v100, 7, v100
    s_mov_b32 s11, 4096
    s_mov_b32 s13, 0
    s_mov_b32 exec_lo, 0xffffff
    s_mov_b32 exec_hi, 0x0
ploop_44:
    buffer_load_dword v101, v100, s[52:55], s11 offen sc1
    s_add_u32 s13, s13, 1
    s_cmp_gt_u32 s13, 131072
    s_cbranch_scc1 pout_45
    s_waitcnt vmcnt(0)
    v_cmp_ne_u32 vcc, s9, v101
    s_cbranch_vccnz ploop_44
pout_45:
    s_waitcnt vmcnt(0)
    s_mov_b64 exec, -1
    ds_write_b32 v102, v102
    s_branch pskip_43
poth_46:
    ds_read_b32 v101, v102
    s_waitcnt lgkmcnt(0)
    v_readfirstlane_b32 s13, v101
    s_nop 0
    s_cmp_eq_u32 s13, 0
    s_cbranch_scc1 poth_46
pskip_43:
    s_add_u32 m0, s60, 0
    s_mov_b32 s15, 135168
    buffer_load_dwordx4 v80, s[52:55], s15 offen sc1 lds
    s_add_u32 m0, m0, 1024
    s_nop 0
    buffer_load_dwordx4 v81, s[52:55], s15 offen sc1 lds
    s_add_u32 m0, s60, 8192
    s_mov_b32 s15, 136192
    buffer_load_dwordx4 v80, s[52:55], s15 offen sc1 lds
    s_add_u32 m0, m0, 1024
    s_nop 0
    buffer_load_dwordx4 v81, s[52:55], s15 offen sc1 lds
    s_waitcnt vmcnt(0)
    s_barrier
    s_add_u32 m0, s60, 16384
    s_mov_b32 s15, 137216
    buffer_load_dwordx4 v80, s[52:55], s15 offen sc1 lds
    s_add_u32 m0, m0, 1024
    s_nop 0
    buffer_load_dwordx4 v81, s[52:55], s15 offen sc1 lds
    s_add_u32 m0, s60, 24576
    s_mov_b32 s15, 138240
    buffer_load_dwordx4 v80, s[52:55], s15 offen sc1 lds
    s_add_u32 m0, m0, 1024
    s_nop 0
    buffer_load_dwordx4 v81, s[52:55], s15 offen sc1 lds
    s_add_u32 m0, s60, 32768
    s_mov_b32 s15, 139264
    buffer_load_dwordx4 v80, s[52:55], s15 offen sc1 lds
    s_add_u32 m0, m0, 1024
    s_nop 0
    buffer_load_dwordx4 v81, s[52:55], s15 offen sc1 lds
    s_add_u32 m0, s60, 40960
    s_mov_b32 s15, 135168
    buffer_load_dwordx4 v82, s[52:55], s15 offen sc1 lds
    s_add_u32 m0, m0, 1024
    s_nop 0
    buffer_load_dwordx4 v83, s[52:55], s15 offen sc1 lds
    s_add_u32 m0, s60, 49152
    s_mov_b32 s15, 136192
    buffer_load_dwordx4 v82, s[52:55], s15 offen sc1 lds
    s_add_u32 m0, m0, 1024
    s_nop 0
    buffer_load_dwordx4 v83, s[52:55], s15 offen sc1 lds
    s_waitcnt vmcnt(6)
    s_barrier
    s_add_u32 m0, s60, 0
    s_mov_b32 s15, 137216
    buffer_load_dwordx4 v82, s[52:55], s15 offen sc1 lds
    s_add_u32 m0, m0, 1024
    s_nop 0
    buffer_load_dwordx4 v83, s[52:55], s15 offen sc1 lds
    s_add_u32 m0, s60, 8192
    s_mov_b32 s15, 138240
    buffer_load_dwordx4 v82, s[52:55], s15 offen sc1 lds
    s_add_u32 m0, m0, 1024
    s_nop 0
    buffer_load_dwordx4 v83, s[52:55], s15 offen sc1 lds
    s_waitcnt vmcnt(6)
    s_barrier
    s_add_u32 m0, s60, 16384
    s_mov_b32 s15, 139264
    buffer_load_dwordx4 v82, s[52:55], s15 offen sc1 lds
    s_add_u32 m0, m0, 1024
    s_nop 0
    buffer_load_dwordx4 v83, s[52:55], s15 offen sc1 lds
    s_add_u32 m0, s60, 24576
    s_mov_b32 s15, 135168
    buffer_load_dwordx4 v84, s[52:55], s15 offen sc1 lds
    s_add_u32 m0, m0, 1024
    s_nop 0
    buffer_load_dwordx4 v85, s[52:55], s15 offen sc1 lds
    s_waitcnt vmcnt(6)
    s_barrier
    s_add_u32 m0, s60, 32768
    s_mov_b32 s15, 136192
    buffer_load_dwordx4 v84, s[52:55], s15 offen sc1 lds
    s_add_u32 m0, m0, 1024
    s_nop 0
    buffer_load_dwordx4 v85, s[52:55], s15 offen sc1 lds
    s_add_u32 s15, s92, 3
    s_and_b32 s15, s15, 3
    s_mul_i32 s15, s15, 204800
    s_lshl_b32 s12, s8, 10
    s_add_u32 m0, s12, 114688
    s_nop 0
    buffer_load_dwordx4 v48, s[48:51], s15 offen lds
    s_add_u32 m0, s12, 118784
    s_nop 0
    buffer_load_dwordx4 v49, s[48:51], s15 offen lds
    s_add_u32 m0, s12, 122880
    s_nop 0
    buffer_load_dwordx4 v50, s[48:51], s15 offen lds
    s_add_u32 m0, s12, 126976
    s_nop 0
    buffer_load_dwordx4 v51, s[48:51], s15 offen lds
    s_add_u32 m0, s12, 131072
    s_nop 0
    buffer_load_dwordx4 v52, s[48:51], s15 offen lds
    s_add_u32 m0, s12, 135168
    s_nop 0
    buffer_load_dwordx4 v53, s[48:51], s15 offen lds
    s_add_u32 s12, s12, 139264
    s_cmp_lt_u32 s8, 1
    s_cselect_b32 m0, s12, s78
    s_nop 0
    buffer_load_dwordx4 v54, s[48:51], s15 offen lds
    s_add_u32 m0, s60, 40960
    s_mov_b32 s15, 137216
    buffer_load_dwordx4 v84, s[52:55], s15 offen sc1 lds
    s_add_u32 m0, m0, 1024
    s_nop 0
    buffer_load_dwordx4 v85, s[52:55], s15 offen sc1 lds
    s_waitcnt vmcnt(13)
    s_barrier
    s_add_u32 m0, s60, 49152
    s_mov_b32 s15, 138240
    buffer_load_dwordx4 v84, s[52:55], s15 offen sc1 lds
    s_add_u32 m0, m0, 1024
    s_nop 0
    buffer_load_dwordx4 v85, s[52:55], s15 offen sc1 lds
    s_add_u32 m0, s60, 0
    s_mov_b32 s15, 139264
    buffer_load_dwordx4 v84, s[52:55], s15 offen sc1 lds
    s_add_u32 m0, m0, 1024
    s_nop 0
    buffer_load_dwordx4 v85, s[52:55], s15 offen sc1 lds
    s_waitcnt vmcnt(13)
    s_barrier
    s_add_u32 m0, s60, 8192
    s_mov_b32 s15, 135168
    buffer_load_dwordx4 v86, s[52:55], s15 offen sc1 lds
    s_add_u32 m0, m0, 1024
    s_nop 0
    buffer_load_dwordx4 v87, s[52:55], s15 offen sc1 lds
    s_add_u32 m0, s62, 57344
    s_mul_i32 s15, s5, 163840
    buffer_load_dwordx4 v72, s[44:47], s15 offen offset:0  lds
    buffer_load_dwordx4 v73, s[44:47], s15 offen offset:1024  lds
    buffer_load_dwordx4 v74, s[44:47], s15 offen offset:2048  lds
    buffer_load_dwordx4 v75, s[44:47], s15 offen offset:3072  lds
    s_add_u32 m0, m0, 4096
    s_nop 0
    buffer_load_dwordx4 v76, s[44:47], s15 offen  lds
    s_add_u32 m0, s60, 16384
    s_mov_b32 s15, 136192
    buffer_load_dwordx4 v86, s[52:55], s15 offen sc1 lds
    s_add_u32 m0, m0, 1024
    s_nop 0
    buffer_load_dwordx4 v87, s[52:55], s15 offen sc1 lds
    s_waitcnt vmcnt(11)
    s_barrier
    s_add_u32 m0, s60, 24576
    s_mov_b32 s15, 137216
    buffer_load_dwordx4 v86, s[52:55], s15 offen sc1 lds
    s_add_u32 m0, m0, 1024
    s_nop 0
    buffer_load_dwordx4 v87, s[52:55], s15 offen sc1 lds
    s_add_u32 m0, s60, 32768
    s_mov_b32 s15, 138240
    buffer_load_dwordx4 v86, s[52:55], s15 offen sc1 lds
    s_add_u32 m0, m0, 1024
    s_nop 0
    buffer_load_dwordx4 v87, s[52:55], s15 offen sc1 lds
    s_waitcnt vmcnt(11)
    s_barrier
    s_add_u32 m0, s60, 40960
    s_mov_b32 s15, 139264
    buffer_load_dwordx4 v86, s[52:55], s15 offen sc1 lds
    s_add_u32 m0, m0, 1024
    s_nop 0
    buffer_load_dwordx4 v87, s[52:55], s15 offen sc1 lds
    s_waitcnt vmcnt(4)
    s_barrier
    s_waitcnt vmcnt(0)
    s_barrier
    s_barrier
    v_mov_b32 v100, 163812
own_47:
    s_sleep 1
    ds_read_b32 v101, v100
    s_waitcnt lgkmcnt(0)
    v_readfirstlane_b32 s13, v101
    s_nop 0
    s_cmp_lt_u32 s13, 4
    s_cbranch_scc1 own_47
    s_lshl_b32 s12, s8, 10
    s_add_u32 s15, s81, 0
    s_cmp_ge_u32 s15, 20
    s_cselect_b32 s13, 20, 0
    s_sub_u32 s15, s15, s13
    s_mul_i32 s15, s15, 98304
    s_add_u32 m0, s12, 65536
    s_add_u32 s15, s15, 0
    buffer_load_dwordx4 v56, s[56:59], s15 offen lds
    s_add_u32 m0, s12, 73728
    s_add_u32 s15, s15, 128
    buffer_load_dwordx4 v56, s[56:59], s15 offen lds
    s_add_u32 s15, s81, 1
    s_cmp_ge_u32 s15, 20
    s_cselect_b32 s13, 20, 0
    s_sub_u32 s15, s15, s13
    s_mul_i32 s15, s15, 98304
    s_add_u32 m0, s12, 69632
    s_add_u32 s15, s15, 0
    buffer_load_dwordx4 v56, s[56:59], s15 offen lds
    s_add_u32 m0, s12, 77824
    s_add_u32 s15, s15, 128
    buffer_load_dwordx4 v56, s[56:59], s15 offen lds
    s_lshl_b32 s12, s8, 10
    s_add_u32 s15, s81, 2
    s_cmp_ge_u32 s15, 20
    s_cselect_b32 s13, 20, 0
    s_sub_u32 s15, s15, s13
    s_mul_i32 s15, s15, 98304
    s_add_u32 m0, s12, 81920
    s_add_u32 s15, s15, 0
    buffer_load_dwordx4 v56, s[56:59], s15 offen lds
    s_add_u32 m0, s12, 90112
    s_add_u32 s15, s15, 128
    buffer_load_dwordx4 v56, s[56:59], s15 offen lds
    s_add_u32 s15, s81, 3
    s_cmp_ge_u32 s15, 20
    s_cselect_b32 s13, 20, 0
    s_sub_u32 s15, s15, s13
    s_mul_i32 s15, s15, 98304
    s_add_u32 m0, s12, 86016
    s_add_u32 s15, s15, 0
    buffer_load_dwordx4 v56, s[56:59], s15 offen lds
    s_add_u32 m0, s12, 94208
    s_add_u32 s15, s15, 128
    buffer_load_dwordx4 v56, s[56:59], s15 offen lds
    s_lshl_b32 s12, s8, 10
    s_add_u32 s15, s81, 4
    s_cmp_ge_u32 s15, 20
    s_cselect_b32 s13, 20, 0
    s_sub_u32 s15, s15, s13
    s_mul_i32 s15, s15, 98304
    s_add_u32 m0, s12, 98304
    s_add_u32 s15, s15, 0
    buffer_load_dwordx4 v56, s[56:59], s15 offen lds
    s_add_u32 m0, s12, 106496
    s_add_u32 s15, s15, 128
    buffer_load_dwordx4 v56, s[56:59], s15 offen lds
    s_add_u32 s15, s81, 5
    s_cmp_ge_u32 s15, 20
    s_cselect_b32 s13, 20, 0
    s_sub_u32 s15, s15, s13
    s_mul_i32 s15, s15, 98304
    s_add_u32 m0, s12, 102400
    s_add_u32 s15, s15, 0
    buffer_load_dwordx4 v56, s[56:59], s15 offen lds
    s_add_u32 m0, s12, 110592
    s_add_u32 s15, s15, 128
    buffer_load_dwordx4 v56, s[56:59], s15 offen lds
    v_mov_b32 v102, 163832
    s_cmp_lg_u32 s8, 0
    s_cbranch_scc1 poth_51
    s_lshl_b32 s11, s5, 4
    s_add_u32 s11, s11, 264
    v_add_u32 v100, s11, v128
    v_lshlrev_b32 v100, 7, v100
    s_mov_b32 s11, 4096
    s_mov_b32 s13, 0
    s_mov_b32 exec_lo, 0xff
    s_mov_b32 exec_hi, 0x0
ploop_49:
    buffer_load_dword v101, v100, s[52:55], s11 offen sc1
    s_add_u32 s13, s13, 1
    s_cmp_gt_u32 s13, 131072
    s_cbranch_scc1 pout_50
    s_waitcnt vmcnt(0)
    v_cmp_ne_u32 vcc, s9, v101
    s_cbranch_vccnz ploop_49
pout_50:
    s_waitcnt vmcnt(0)
    s_mov_b64 exec, -1
    ds_write_b32 v102, v102
    s_branch pskip_48
poth_51:
    ds_read_b32 v101, v102
    s_waitcnt lgkmcnt(0)
    v_readfirstlane_b32 s13, v101
    s_nop 0
    s_cmp_eq_u32 s13, 0
    s_cbranch_scc1 poth_51
pskip_48:
    s_add_u32 s15, s81, 0
    s_cmp_ge_u32 s15, 20
    s_cselect_b32 s13, 20, 0
    s_sub_u32 s15, s15, s13
    s_add_u32 m0, s61, 0
    s_lshl_b32 s15, s15, 10
    s_add_u32 s15, s15, s43
    buffer_load_dwordx4 v143, s[52:55], s15 offen sc1 lds
    buffer_load_dwordx4 v68, s[52:55], s15 offen offset:2048 sc1 lds
    s_add_u32 s15, s81, 1
    s_cmp_ge_u32 s15, 20
    s_cselect_b32 s13, 20, 0
    s_sub_u32 s15, s15, s13
    s_add_u32 m0, s61, 1024
    s_lshl_b32 s15, s15, 10
    s_add_u32 s15, s15, s43
    buffer_load_dwordx4 v143, s[52:55], s15 offen sc1 lds
    buffer_load_dwordx4 v68, s[52:55], s15 offen offset:2048 sc1 lds
    s_add_u32 s15, s81, 2
    s_cmp_ge_u32 s15, 20
    s_cselect_b32 s13, 20, 0
    s_sub_u32 s15, s15, s13
    s_add_u32 m0, s61, 16384
    s_lshl_b32 s15, s15, 10
    s_add_u32 s15, s15, s43
    buffer_load_dwordx4 v143, s[52:55], s15 offen sc1 lds
    buffer_load_dwordx4 v68, s[52:55], s15 offen offset:2048 sc1 lds
    s_add_u32 s15, s81, 3
    s_cmp_ge_u32 s15, 20
    s_cselect_b32 s13, 20, 0
    s_sub_u32 s15, s15, s13
    s_add_u32 m0, s61, 17408
    s_lshl_b32 s15, s15, 10
    s_add_u32 s15, s15, s43
    buffer_load_dwordx4 v143, s[52:55], s15 offen sc1 lds
    buffer_load_dwordx4 v68, s[52:55], s15 offen offset:2048 sc1 lds
    s_waitcnt vmcnt(4)
    s_barrier
    s_add_u32 s15, s81, 4
    s_cmp_ge_u32 s15, 20
    s_cselect_b32 s13, 20, 0
    s_sub_u32 s15, s15, s13
    s_add_u32 m0, s61, 32768
    s_lshl_b32 s15, s15, 10
    s_add_u32 s15, s15, s43
    buffer_load_dwordx4 v143, s[52:55], s15 offen sc1 lds
    buffer_load_dwordx4 v68, s[52:55], s15 offen offset:2048 sc1 lds
    s_add_u32 s15, s81, 5
    s_cmp_ge_u32 s15, 20
    s_cselect_b32 s13, 20, 0
    s_sub_u32 s15, s15, s13
    s_add_u32 m0, s61, 33792
    s_lshl_b32 s15, s15, 10
    s_add_u32 s15, s15, s43
    buffer_load_dwordx4 v143, s[52:55], s15 offen sc1 lds
    buffer_load_dwordx4 v68, s[52:55], s15 offen offset:2048 sc1 lds
    s_lshl_b32 s12, s8, 10
    s_add_u32 s15, s81, 6
    s_cmp_ge_u32 s15, 20
    s_cselect_b32 s13, 20, 0
    s_sub_u32 s15, s15, s13
    s_mul_i32 s15, s15, 98304
    s_add_u32 m0, s12, 114688
    s_add_u32 s15, s15, 0
    buffer_load_dwordx4 v56, s[56:59], s15 offen lds
    s_add_u32 m0, s12, 122880
    s_add_u32 s15, s15, 128
    buffer_load_dwordx4 v56, s[56:59], s15 offen lds
    s_add_u32 s15, s81, 7
    s_cmp_ge_u32 s15, 20
    s_cselect_b32 s13, 20, 0
    s_sub_u32 s15, s15, s13
    s_mul_i32 s15, s15, 98304
    s_add_u32 m0, s12, 118784
    s_add_u32 s15, s15, 0
    buffer_load_dwordx4 v56, s[56:59], s15 offen lds
    s_add_u32 m0, s12, 126976
    s_add_u32 s15, s15, 128
    buffer_load_dwordx4 v56, s[56:59], s15 offen lds
    s_add_u32 s15, s81, 6
    s_cmp_ge_u32 s15, 20
    s_cselect_b32 s13, 20, 0
    s_sub_u32 s15, s15, s13
    s_add_u32 m0, s61, 49152
    s_lshl_b32 s15, s15, 10
    s_add_u32 s15, s15, s43
    buffer_load_dwordx4 v143, s[52:55], s15 offen sc1 lds
    buffer_load_dwordx4 v68, s[52:55], s15 offen offset:2048 sc1 lds
    s_add_u32 s15, s81, 7
    s_cmp_ge_u32 s15, 20
    s_cselect_b32 s13, 20, 0
    s_sub_u32 s15, s15, s13
    s_add_u32 m0, s61, 50176
    s_lshl_b32 s15, s15, 10
    s_add_u32 s15, s15, s43
    buffer_load_dwordx4 v143, s[52:55], s15 offen sc1 lds
    buffer_load_dwordx4 v68, s[52:55], s15 offen offset:2048 sc1 lds
    s_lshl_b32 s12, s8, 10
    s_add_u32 s15, s81, 8
    s_cmp_ge_u32 s15, 20
    s_cselect_b32 s13, 20, 0
    s_sub_u32 s15, s15, s13
    s_mul_i32 s15, s15, 98304
    s_add_u32 m0, s12, 131072
    s_add_u32 s15, s15, 0
    buffer_load_dwordx4 v56, s[56:59], s15 offen lds
    s_add_u32 m0, s12, 139264
    s_add_u32 s15, s15, 128
    buffer_load_dwordx4 v56, s[56:59], s15 offen lds
    s_add_u32 s15, s81, 9
    s_cmp_ge_u32 s15, 20
    s_cselect_b32 s13, 20, 0
    s_sub_u32 s15, s15, s13
    s_mul_i32 s15, s15, 98304
    s_add_u32 m0, s12, 135168
    s_add_u32 s15, s15, 0
    buffer_load_dwordx4 v56, s[56:59], s15 offen lds
    s_add_u32 m0, s12, 143360
    s_add_u32 s15, s15, 128
    buffer_load_dwordx4 v56, s[56:59], s15 offen lds
    s_waitcnt vmcnt(16)
    s_barrier
    s_waitcnt vmcnt(12)
    s_barrier
    s_add_u32 s15, s81, 8
    s_cmp_ge_u32 s15, 20
    s_cselect_b32 s13, 20, 0
    s_sub_u32 s15, s15, s13
    s_add_u32 m0, s61, 0
    s_lshl_b32 s15, s15, 10
    s_add_u32 s15, s15, s43
    buffer_load_dwordx4 v143, s[52:55], s15 offen sc1 lds
    buffer_load_dwordx4 v68, s[52:55], s15 offen offset:2048 sc1 lds
    s_add_u32 s15, s81, 9
    s_cmp_ge_u32 s15, 20
    s_cselect_b32 s13, 20, 0
    s_sub_u32 s15, s15, s13
    s_add_u32 m0, s61, 1024
    s_lshl_b32 s15, s15, 10
    s_add_u32 s15, s15, s43
    buffer_load_dwordx4 v143, s[52:55], s15 offen sc1 lds
    buffer_load_dwordx4 v68, s[52:55], s15 offen offset:2048 sc1 lds
    s_lshl_b32 s12, s8, 10
    s_add_u32 s15, s81, 10
    s_cmp_ge_u32 s15, 20
    s_cselect_b32 s13, 20, 0
    s_sub_u32 s15, s15, s13
    s_mul_i32 s15, s15, 98304
    s_add_u32 m0, s12, 65536
    s_add_u32 s15, s15, 0
    buffer_load_dwordx4 v56, s[56:59], s15 offen lds
    s_add_u32 m0, s12, 73728
    s_add_u32 s15, s15, 128
    buffer_load_dwordx4 v56, s[56:59], s15 offen lds
    s_add_u32 s15, s81, 11
    s_cmp_ge_u32 s15, 20
    s_cselect_b32 s13, 20, 0
    s_sub_u32 s15, s15, s13
    s_mul_i32 s15, s15, 98304
    s_add_u32 m0, s12, 69632
    s_add_u32 s15, s15, 0
    buffer_load_dwordx4 v56, s[56:59], s15 offen lds
    s_add_u32 m0, s12, 77824
    s_add_u32 s15, s15, 128
    buffer_load_dwordx4 v56, s[56:59], s15 offen lds
    s_waitcnt vmcnt(12)
    s_barrier
    s_add_u32 s15, s81, 10
    s_cmp_ge_u32 s15, 20
    s_cselect_b32 s13, 20, 0
    s_sub_u32 s15, s15, s13
    s_add_u32 m0, s61, 16384
    s_lshl_b32 s15, s15, 10
    s_add_u32 s15, s15, s43
    buffer_load_dwordx4 v143, s[52:55], s15 offen sc1 lds
    buffer_load_dwordx4 v68, s[52:55], s15 offen offset:2048 sc1 lds
    s_add_u32 s15, s81, 11
    s_cmp_ge_u32 s15, 20
    s_cselect_b32 s13, 20, 0
    s_sub_u32 s15, s15, s13
    s_add_u32 m0, s61, 17408
    s_lshl_b32 s15, s15, 10
    s_add_u32 s15, s15, s43
    buffer_load_dwordx4 v143, s[52:55], s15 offen sc1 lds
    buffer_load_dwordx4 v68, s[52:55], s15 offen offset:2048 sc1 lds
    s_lshl_b32 s12, s8, 10
    s_add_u32 s15, s81, 12
    s_cmp_ge_u32 s15, 20
    s_cselect_b32 s13, 20, 0
    s_sub_u32 s15, s15, s13
    s_mul_i32 s15, s15, 98304
    s_add_u32 m0, s12, 81920
    s_add_u32 s15, s15, 0
    buffer_load_dwordx4 v56, s[56:59], s15 offen lds
    s_add_u32 m0, s12, 90112
    s_add_u32 s15, s15, 128
    buffer_load_dwordx4 v56, s[56:59], s15 offen lds
    s_add_u32 s15, s81, 13
    s_cmp_ge_u32 s15, 20
    s_cselect_b32 s13, 20, 0
    s_sub_u32 s15, s15, s13
    s_mul_i32 s15, s15, 98304
    s_add_u32 m0, s12, 86016
    s_add_u32 s15, s15, 0
    buffer_load_dwordx4 v56, s[56:59], s15 offen lds
    s_add_u32 m0, s12, 94208
    s_add_u32 s15, s15, 128
    buffer_load_dwordx4 v56, s[56:59], s15 offen lds
    s_waitcnt vmcnt(12)
    s_barrier
    s_add_u32 s15, s81, 12
    s_cmp_ge_u32 s15, 20
    s_cselect_b32 s13, 20, 0
    s_sub_u32 s15, s15, s13
    s_add_u32 m0, s61, 32768
    s_lshl_b32 s15, s15, 10
    s_add_u32 s15, s15, s43
    buffer_load_dwordx4 v143, s[52:55], s15 offen sc1 lds
    buffer_load_dwordx4 v68, s[52:55], s15 offen offset:2048 sc1 lds
    s_add_u32 s15, s81, 13
    s_cmp_ge_u32 s15, 20
    s_cselect_b32 s13, 20, 0
    s_sub_u32 s15, s15, s13
    s_add_u32 m0, s61, 33792
    s_lshl_b32 s15, s15, 10
    s_add_u32 s15, s15, s43
    buffer_load_dwordx4 v143, s[52:55], s15 offen sc1 lds
    buffer_load_dwordx4 v68, s[52:55], s15 offen offset:2048 sc1 lds
    s_lshl_b32 s12, s8, 10
    s_add_u32 s15, s81, 14
    s_cmp_ge_u32 s15, 20
    s_cselect_b32 s13, 20, 0
    s_sub_u32 s15, s15, s13
    s_mul_i32 s15, s15, 98304
    s_add_u32 m0, s12, 98304
    s_add_u32 s15, s15, 0
    buffer_load_dwordx4 v56, s[56:59], s15 offen lds
    s_add_u32 m0, s12, 106496
    s_add_u32 s15, s15, 128
    buffer_load_dwordx4 v56, s[56:59], s15 offen lds
    s_add_u32 s15, s81, 15
    s_cmp_ge_u32 s15, 20
    s_cselect_b32 s13, 20, 0
    s_sub_u32 s15, s15, s13
    s_mul_i32 s15, s15, 98304
    s_add_u32 m0, s12, 102400
    s_add_u32 s15, s15, 0
    buffer_load_dwordx4 v56, s[56:59], s15 offen lds
    s_add_u32 m0, s12, 110592
    s_add_u32 s15, s15, 128
    buffer_load_dwordx4 v56, s[56:59], s15 offen lds
    s_waitcnt vmcnt(12)
    s_barrier
    s_add_u32 s15, s81, 14
    s_cmp_ge_u32 s15, 20
    s_cselect_b32 s13, 20, 0
    s_sub_u32 s15, s15, s13
    s_add_u32 m0, s61, 49152
    s_lshl_b32 s15, s15, 10
    s_add_u32 s15, s15, s43
    buffer_load_dwordx4 v143, s[52:55], s15 offen sc1 lds
    buffer_load_dwordx4 v68, s[52:55], s15 offen offset:2048 sc1 lds
    s_add_u32 s15, s81, 15
    s_cmp_ge_u32 s15, 20
    s_cselect_b32 s13, 20, 0
    s_sub_u32 s15, s15, s13
    s_add_u32 m0, s61, 50176
    s_lshl_b32 s15, s15, 10
    s_add_u32 s15, s15, s43
    buffer_load_dwordx4 v143, s[52:55], s15 offen sc1 lds
    buffer_load_dwordx4 v68, s[52:55], s15 offen offset:2048 sc1 lds
    s_lshl_b32 s12, s8, 10
    s_add_u32 s15, s81, 16
    s_cmp_ge_u32 s15, 20
    s_cselect_b32 s13, 20, 0
    s_sub_u32 s15, s15, s13
    s_mul_i32 s15, s15, 98304
    s_add_u32 m0, s12, 114688
    s_add_u32 s15, s15, 0
    buffer_load_dwordx4 v56, s[56:59], s15 offen lds
    s_add_u32 m0, s12, 122880
    s_add_u32 s15, s15, 128
    buffer_load_dwordx4 v56, s[56:59], s15 offen lds
    s_add_u32 s15, s81, 17
    s_cmp_ge_u32 s15, 20
    s_cselect_b32 s13, 20, 0
    s_sub_u32 s15, s15, s13
    s_mul_i32 s15, s15, 98304
    s_add_u32 m0, s12, 118784
    s_add_u32 s15, s15, 0
    buffer_load_dwordx4 v56, s[56:59], s15 offen lds
    s_add_u32 m0, s12, 126976
    s_add_u32 s15, s15, 128
    buffer_load_dwordx4 v56, s[56:59], s15 offen lds
    s_waitcnt vmcnt(12)
    s_barrier
    s_add_u32 s15, s81, 16
    s_cmp_ge_u32 s15, 20
    s_cselect_b32 s13, 20, 0
    s_sub_u32 s15, s15, s13
    s_add_u32 m0, s61, 0
    s_lshl_b32 s15, s15, 10
    s_add_u32 s15, s15, s43
    buffer_load_dwordx4 v143, s[52:55], s15 offen sc1 lds
    buffer_load_dwordx4 v68, s[52:55], s15 offen offset:2048 sc1 lds
    s_add_u32 s15, s81, 17
    s_cmp_ge_u32 s15, 20
    s_cselect_b32 s13, 20, 0
    s_sub_u32 s15, s15, s13
    s_add_u32 m0, s61, 1024
    s_lshl_b32 s15, s15, 10
    s_add_u32 s15, s15, s43
    buffer_load_dwordx4 v143, s[52:55], s15 offen sc1 lds
    buffer_load_dwordx4 v68, s[52:55], s15 offen offset:2048 sc1 lds
    s_lshl_b32 s12, s8, 10
    s_add_u32 s15, s81, 18
    s_cmp_ge_u32 s15, 20
    s_cselect_b32 s13, 20, 0
    s_sub_u32 s15, s15, s13
    s_mul_i32 s15, s15, 98304
    s_add_u32 m0, s12, 131072
    s_add_u32 s15, s15, 0
    buffer_load_dwordx4 v56, s[56:59], s15 offen lds
    s_add_u32 m0, s12, 139264
    s_add_u32 s15, s15, 128
    buffer_load_dwordx4 v56, s[56:59], s15 offen lds
    s_add_u32 s15, s81, 19
    s_cmp_ge_u32 s15, 20
    s_cselect_b32 s13, 20, 0
    s_sub_u32 s15, s15, s13
    s_mul_i32 s15, s15, 98304
    s_add_u32 m0, s12, 135168
    s_add_u32 s15, s15, 0
    buffer_load_dwordx4 v56, s[56:59], s15 offen lds
    s_add_u32 m0, s12, 143360
    s_add_u32 s15, s15, 128
    buffer_load_dwordx4 v56, s[56:59], s15 offen lds
    s_waitcnt vmcnt(12)
    s_barrier
    s_add_u32 s15, s81, 18
    s_cmp_ge_u32 s15, 20
    s_cselect_b32 s13, 20, 0
    s_sub_u32 s15, s15, s13
    s_add_u32 m0, s61, 16384
    s_lshl_b32 s15, s15, 10
    s_add_u32 s15, s15, s43
    buffer_load_dwordx4 v143, s[52:55], s15 offen sc1 lds
    buffer_load_dwordx4 v68, s[52:55], s15 offen offset:2048 sc1 lds
    s_add_u32 s15, s81, 19
    s_cmp_ge_u32 s15, 20
    s_cselect_b32 s13, 20, 0
    s_sub_u32 s15, s15, s13
    s_add_u32 m0, s61, 17408
    s_lshl_b32 s15, s15, 10
    s_add_u32 s15, s15, s43
    buffer_load_dwordx4 v143, s[52:55], s15 offen sc1 lds
    buffer_load_dwordx4 v68, s[52:55], s15 offen offset:2048 sc1 lds
    s_lshl_b32 s11, s3, 2
    s_lshr_b32 s13, s4, 1
    s_add_u32 s11, s11, s13
    v_lshlrev_b32 v108, 4, v128
    v_add_u32 v108, s11, v108
    v_add_u32 v108, 768, v108
    s_lshl_b32 s11, s5, 4
    s_add_u32 s11, s11, 240
    v_add_u32 v109, s11, v128
    v_cmp_gt_u32 vcc, 16, v128
    s_nop 1
    v_cndmask_b32 v108, v109, v108, vcc
    v_subrev_u32 v109, 24, v128
    v_bfe_u32 v111, v109, 1, 4
    v_mul_u32_u24 v111, 22, v111
    s_lshl_b32 s11, s7, 1
    v_add3_u32 v109, v109, v111, s11
    v_and_b32 v111, 0xf8, v109
    v_add3_u32 v109, v109, v111, 8
    v_add_u32 v109, 768, v109
    v_cmp_gt_u32 vcc, 24, v128
    s_nop 1
    v_cndmask_b32 v108, v109, v108, vcc
    v_lshlrev_b32 v108, 7, v108
    s_mov_b32 s11, 4096
    s_cmp_eq_u32 s8, 0
    s_cselect_b32 s11, s11, s79
    s_mov_b32 exec_lo, 0xffffffff
    s_mov_b32 exec_hi, 0x3
    buffer_load_dword v110, v108, s[52:55], s11 offen sc1
    s_mov_b64 exec, -1
    s_waitcnt vmcnt(9)
    s_barrier
    s_waitcnt vmcnt(0)
    s_mov_b32 exec_lo, 0xffffffff
    s_mov_b32 exec_hi, 0x3
    v_cmp_ne_u32 vcc, s9, v110
    s_mov_b64 exec, -1
    s_cbranch_vccz aok_52
    s_cmp_lg_u32 s8, 0
    s_cbranch_scc1 pskip_53
    s_lshl_b32 s11, s3, 2
    s_lshr_b32 s13, s4, 1
    s_add_u32 s11, s11, s13
    v_lshlrev_b32 v100, 4, v128
    v_add_u32 v100, s11, v100
    v_add_u32 v100, 768, v100
    s_lshl_b32 s11, s5, 4
    s_add_u32 s11, s11, 240
    v_add_u32 v101, s11, v128
    v_cmp_gt_u32 vcc, 16, v128
    s_nop 1
    v_cndmask_b32 v100, v101, v100, vcc
    v_subrev_u32 v101, 24, v128
    v_bfe_u32 v103, v101, 1, 4
    v_mul_u32_u24 v103, 22, v103
    s_lshl_b32 s11, s7, 1
    v_add3_u32 v101, v101, v103, s11
    v_and_b32 v103, 0xf8, v101
    v_add3_u32 v101, v101, v103, 8
    v_add_u32 v101, 768, v101
    v_cmp_gt_u32 vcc, 24, v128
    s_nop 1
    v_cndmask_b32 v100, v101, v100, vcc
    v_lshlrev_b32 v100, 7, v100
    s_mov_b32 s11, 4096
    s_mov_b32 s13, 0
    s_mov_b32 exec_lo, 0xffffffff
    s_mov_b32 exec_hi, 0x3
ploop_54:
    buffer_load_dword v101, v100, s[52:55], s11 offen sc1
    s_add_u32 s13, s13, 1
    s_cmp_gt_u32 s13, 131072
    s_cbranch_scc1 pout_55
    s_waitcnt vmcnt(0)
    v_cmp_ne_u32 vcc, s9, v101
    s_cbranch_vccnz ploop_54
pout_55:
    s_waitcnt vmcnt(0)
    s_mov_b64 exec, -1
pskip_53:
aok_52:
    s_mul_i32 s12, s7, 512
    s_add_u32 s12, s12, 17461248
    s_cmp_eq_u32 s8, 0
    s_cselect_b32 s12, s12, s79
    s_cselect_b32 s11, 151552, s78
    v_add_u32 v3, s11, v143
    buffer_load_dwordx4 v[24:27], v143, s[52:55], s12 offen sc1
    s_add_u32 s12, s12, 6144
    buffer_load_dwordx4 v[28:31], v143, s[52:55], s12 offen sc1
    s_add_u32 s12, s12, 6144
    buffer_load_dwordx4 v[32:35], v143, s[52:55], s12 offen sc1
    s_add_u32 s12, s12, 6144
    buffer_load_dwordx4 v[36:39], v143, s[52:55], s12 offen sc1
    s_add_u32 s12, s12, 6144
    buffer_load_dwordx4 v[40:43], v143, s[52:55], s12 offen sc1
    s_add_u32 s12, s12, 6144
    s_barrier
    s_waitcnt vmcnt(0)
    v_add_f32 v24, v24, v28
    v_add_f32 v25, v25, v29
    v_add_f32 v26, v26, v30
    v_add_f32 v27, v27, v31
    v_add_f32 v24, v24, v32
    v_add_f32 v25, v25, v33
    v_add_f32 v26, v26, v34
    v_add_f32 v27, v27, v35
    v_add_f32 v24, v24, v36
    v_add_f32 v25, v25, v37
    v_add_f32 v26, v26, v38
    v_add_f32 v27, v27, v39
    v_add_f32 v24, v24, v40
    v_add_f32 v25, v25, v41
    v_add_f32 v26, v26, v42
    v_add_f32 v27, v27, v43
    ds_write_b128 v3, v[24:27]
    s_waitcnt lgkmcnt(0)
    s_barrier
    s_add_u32 s15, s83, 0
    s_cmp_ge_u32 s15, 5
    s_cselect_b32 s13, 5, 0
    s_sub_u32 s15, s15, s13
    s_add_u32 m0, s62, 49152
    s_mul_i32 s15, s15, 20480
    s_add_u32 s15, s15, s93
    buffer_load_dwordx4 v66, s[52:55], s15 offen offset:0 sc1 lds
    buffer_load_dwordx4 v66, s[52:55], s15 offen offset:1024 sc1 lds
    buffer_load_dwordx4 v66, s[52:55], s15 offen offset:2048 sc1 lds
    buffer_load_dwordx4 v66, s[52:55], s15 offen offset:3072 sc1 lds
    s_add_u32 m0, m0, 4096
    s_nop 0
    buffer_load_dwordx4 v67, s[52:55], s15 offen sc1 lds
    s_add_u32 s15, s83, 0
    s_cmp_ge_u32 s15, 5
    s_cselect_b32 s13, 5, 0
    s_sub_u32 s15, s15, s13
    s_add_u32 m0, s61, 0
    s_lshl_b32 s15, s15, 12
    s_add_u32 s15, s15, s95
    buffer_load_dwordx4 v143, s[52:55], s15 offen offset:0 sc1 lds
    buffer_load_dwordx4 v143, s[52:55], s15 offen offset:1024 sc1 lds
    buffer_load_dwordx4 v143, s[52:55], s15 offen offset:2048 sc1 lds
    buffer_load_dwordx4 v143, s[52:55], s15 offen offset:3072 sc1 lds
    s_add_u32 s15, s83, 1
    s_cmp_ge_u32 s15, 5
    s_cselect_b32 s13, 5, 0
    s_sub_u32 s15, s15, s13
    s_add_u32 m0, s62, 69632
    s_mul_i32 s15, s15, 20480
    s_add_u32 s15, s15, s93
    buffer_load_dwordx4 v66, s[52:55], s15 offen offset:0 sc1 lds
    buffer_load_dwordx4 v66, s[52:55], s15 offen offset:1024 sc1 lds
    buffer_load_dwordx4 v66, s[52:55], s15 offen offset:2048 sc1 lds
    buffer_load_dwordx4 v66, s[52:55], s15 offen offset:3072 sc1 lds
    s_add_u32 m0, m0, 4096
    s_nop 0
    buffer_load_dwordx4 v67, s[52:55], s15 offen sc1 lds
    s_add_u32 s15, s83, 1
    s_cmp_ge_u32 s15, 5
    s_cselect_b32 s13, 5, 0
    s_sub_u32 s15, s15, s13
    s_add_u32 m0, s61, 16384
    s_lshl_b32 s15, s15, 12
    s_add_u32 s15, s15, s95
    buffer_load_dwordx4 v143, s[52:55], s15 offen offset:0 sc1 lds
    buffer_load_dwordx4 v143, s[52:55], s15 offen offset:1024 sc1 lds
    buffer_load_dwordx4 v143, s[52:55], s15 offen offset:2048 sc1 lds
    buffer_load_dwordx4 v143, s[52:55], s15 offen offset:3072 sc1 lds
    s_add_u32 s15, s83, 2
    s_cmp_ge_u32 s15, 5
    s_cselect_b32 s13, 5, 0
    s_sub_u32 s15, s15, s13
    s_add_u32 m0, s62, 90112
    s_mul_i32 s15, s15, 20480
    s_add_u32 s15, s15, s93
    buffer_load_dwordx4 v66, s[52:55], s15 offen offset:0 sc1 lds
    buffer_load_dwordx4 v66, s[52:55], s15 offen offset:1024 sc1 lds
    buffer_load_dwordx4 v66, s[52:55], s15 offen offset:2048 sc1 lds
    buffer_load_dwordx4 v66, s[52:55], s15 offen offset:3072 sc1 lds
    s_add_u32 m0, m0, 4096
    s_nop 0
    buffer_load_dwordx4 v67, s[52:55], s15 offen sc1 lds
    s_add_u32 s15, s83, 2
    s_cmp_ge_u32 s15, 5
    s_cselect_b32 s13, 5, 0
    s_sub_u32 s15, s15, s13
    s_add_u32 m0, s61, 32768
    s_lshl_b32 s15, s15, 12
    s_add_u32 s15, s15, s95
    buffer_load_dwordx4 v143, s[52:55], s15 offen offset:0 sc1 lds
    buffer_load_dwordx4 v143, s[52:55], s15 offen offset:1024 sc1 lds
    buffer_load_dwordx4 v143, s[52:55], s15 offen offset:2048 sc1 lds
    buffer_load_dwordx4 v143, s[52:55], s15 offen offset:3072 sc1 lds
    v_mov_b32 v100, 163816
own_57:
    s_sleep 1
    ds_read_b32 v101, v100
    s_waitcnt lgkmcnt(0)
    v_readfirstlane_b32 s13, v101
    s_nop 0
    s_cmp_lt_u32 s13, 4
    s_cbranch_scc1 own_57
    s_add_u32 s15, s83, 3
    s_cmp_ge_u32 s15, 5
    s_cselect_b32 s13, 5, 0
    s_sub_u32 s15, s15, s13
    s_add_u32 m0, s62, 110592
    s_mul_i32 s15, s15, 20480
    s_add_u32 s15, s15, s93
    buffer_load_dwordx4 v66, s[52:55], s15 offen offset:0 sc1 lds
    buffer_load_dwordx4 v66, s[52:55], s15 offen offset:1024 sc1 lds
    buffer_load_dwordx4 v66, s[52:55], s15 offen offset:2048 sc1 lds
    buffer_load_dwordx4 v66, s[52:55], s15 offen offset:3072 sc1 lds
    s_add_u32 m0, m0, 4096
    s_nop 0
    buffer_load_dwordx4 v67, s[52:55], s15 offen sc1 lds
    s_add_u32 s15, s83, 4
    s_cmp_ge_u32 s15, 5
    s_cselect_b32 s13, 5, 0
    s_sub_u32 s15, s15, s13
    s_add_u32 m0, s62, 131072
    s_mul_i32 s15, s15, 20480
    s_add_u32 s15, s15, s93
    buffer_load_dwordx4 v66, s[52:55], s15 offen offset:0 sc1 lds
    buffer_load_dwordx4 v66, s[52:55], s15 offen offset:1024 sc1 lds
    buffer_load_dwordx4 v66, s[52:55], s15 offen offset:2048 sc1 lds
    buffer_load_dwordx4 v66, s[52:55], s15 offen offset:3072 sc1 lds
    s_add_u32 m0, m0, 4096
    s_nop 0
    buffer_load_dwordx4 v67, s[52:55], s15 offen sc1 lds
    s_waitcnt vmcnt(28)
    s_barrier
    s_waitcnt vmcnt(19)
    s_barrier
    s_add_u32 s15, s83, 3
    s_cmp_ge_u32 s15, 5
    s_cselect_b32 s13, 5, 0
    s_sub_u32 s15, s15, s13
    s_add_u32 m0, s61, 0
    s_lshl_b32 s15, s15, 12
    s_add_u32 s15, s15, s95
    buffer_load_dwordx4 v143, s[52:55], s15 offen offset:0 sc1 lds
    buffer_load_dwordx4 v143, s[52:55], s15 offen offset:1024 sc1 lds
    buffer_load_dwordx4 v143, s[52:55], s15 offen offset:2048 sc1 lds
    buffer_load_dwordx4 v143, s[52:55], s15 offen offset:3072 sc1 lds
    s_add_u32 s15, s82, 0
    s_cmp_ge_u32 s15, 12
    s_cselect_b32 s13, 12, 0
    s_sub_u32 s15, s15, s13
    s_add_u32 m0, s62, 49152
    s_mul_i32 s15, s15, 20480
    s_add_u32 s15, s15, s93
    s_add_u32 s15, s15, 102400
    buffer_load_dwordx4 v66, s[52:55], s15 offen offset:0 sc1 lds
    buffer_load_dwordx4 v66, s[52:55], s15 offen offset:1024 sc1 lds
    buffer_load_dwordx4 v66, s[52:55], s15 offen offset:2048 sc1 lds
    buffer_load_dwordx4 v66, s[52:55], s15 offen offset:3072 sc1 lds
    s_add_u32 m0, m0, 4096
    s_nop 0
    buffer_load_dwordx4 v67, s[52:55], s15 offen sc1 lds
    s_waitcnt vmcnt(19)
    s_barrier
    s_add_u32 s15, s83, 4
    s_cmp_ge_u32 s15, 5
    s_cselect_b32 s13, 5, 0
    s_sub_u32 s15, s15, s13
    s_add_u32 m0, s61, 16384
    s_lshl_b32 s15, s15, 12
    s_add_u32 s15, s15, s95
    buffer_load_dwordx4 v143, s[52:55], s15 offen offset:0 sc1 lds
    buffer_load_dwordx4 v143, s[52:55], s15 offen offset:1024 sc1 lds
    buffer_load_dwordx4 v143, s[52:55], s15 offen offset:2048 sc1 lds
    buffer_load_dwordx4 v143, s[52:55], s15 offen offset:3072 sc1 lds
    s_add_u32 s15, s82, 1
    s_cmp_ge_u32 s15, 12
    s_cselect_b32 s13, 12, 0
    s_sub_u32 s15, s15, s13
    s_add_u32 m0, s62, 69632
    s_mul_i32 s15, s15, 20480
    s_add_u32 s15, s15, s93
    s_add_u32 s15, s15, 102400
    buffer_load_dwordx4 v66, s[52:55], s15 offen offset:0 sc1 lds
    buffer_load_dwordx4 v66, s[52:55], s15 offen offset:1024 sc1 lds
    buffer_load_dwordx4 v66, s[52:55], s15 offen offset:2048 sc1 lds
    buffer_load_dwordx4 v66, s[52:55], s15 offen offset:3072 sc1 lds
    s_add_u32 m0, m0, 4096
    s_nop 0
    buffer_load_dwordx4 v67, s[52:55], s15 offen sc1 lds
    s_waitcnt vmcnt(14)
    s_barrier
    s_lshl_b32 s11, s5, 4
    s_add_u32 s11, s11, 512
    v_add_u32 v108, s11, v128
    v_lshlrev_b32 v108, 7, v108
    s_mov_b32 s11, 4096
    s_cmp_eq_u32 s8, 0
    s_cselect_b32 s11, s11, s79
    s_mov_b32 exec_lo, 0xffff
    s_mov_b32 exec_hi, 0x0
    buffer_load_dword v110, v108, s[52:55], s11 offen sc1
    s_mov_b64 exec, -1
    s_add_u32 s15, s82, 2
    s_cmp_ge_u32 s15, 12
    s_cselect_b32 s13, 12, 0
    s_sub_u32 s15, s15, s13
    s_add_u32 m0, s62, 90112
    s_mul_i32 s15, s15, 20480
    s_add_u32 s15, s15, s93
    s_add_u32 s15, s15, 102400
    buffer_load_dwordx4 v66, s[52:55], s15 offen offset:0 sc1 lds
    buffer_load_dwordx4 v66, s[52:55], s15 offen offset:1024 sc1 lds
    buffer_load_dwordx4 v66, s[52:55], s15 offen offset:2048 sc1 lds
    buffer_load_dwordx4 v66, s[52:55], s15 offen offset:3072 sc1 lds
    s_add_u32 m0, m0, 4096
    s_nop 0
    buffer_load_dwordx4 v67, s[52:55], s15 offen sc1 lds
    s_waitcnt vmcnt(11)
    s_barrier
    s_add_u32 s15, s82, 3
    s_cmp_ge_u32 s15, 12
    s_cselect_b32 s13, 12, 0
    s_sub_u32 s15, s15, s13
    s_add_u32 m0, s62, 110592
    s_mul_i32 s15, s15, 20480
    s_add_u32 s15, s15, s93
    s_add_u32 s15, s15, 102400
    buffer_load_dwordx4 v66, s[52:55], s15 offen offset:0 sc1 lds
    buffer_load_dwordx4 v66, s[52:55], s15 offen offset:1024 sc1 lds
    buffer_load_dwordx4 v66, s[52:55], s15 offen offset:2048 sc1 lds
    buffer_load_dwordx4 v66, s[52:55], s15 offen offset:3072 sc1 lds
    s_add_u32 m0, m0, 4096
    s_nop 0
    buffer_load_dwordx4 v67, s[52:55], s15 offen sc1 lds
    s_waitcnt vmcnt(10)
    s_mov_b32 exec_lo, 0xffff
    s_mov_b32 exec_hi, 0x0
    v_cmp_ne_u32 vcc, s9, v110
    s_mov_b64 exec, -1
    s_cbranch_vccz aok_58
    s_cmp_lg_u32 s8, 0
    s_cbranch_scc1 pskip_59
    s_lshl_b32 s11, s5, 4
    s_add_u32 s11, s11, 512
    v_add_u32 v100, s11, v128
    v_lshlrev_b32 v100, 7, v100
    s_mov_b32 s11, 4096
    s_mov_b32 s13, 0
    s_mov_b32 exec_lo, 0xffff
    s_mov_b32 exec_hi, 0x0
ploop_60:
    buffer_load_dword v101, v100, s[52:55], s11 offen sc1
    s_add_u32 s13, s13, 1
    s_cmp_gt_u32 s13, 131072
    s_cbranch_scc1 pout_61
    s_waitcnt vmcnt(0)
    v_cmp_ne_u32 vcc, s9, v101
    s_cbranch_vccnz ploop_60
pout_61:
    s_waitcnt vmcnt(0)
    s_mov_b64 exec, -1
pskip_59:
aok_58:
    s_barrier
    s_add_u32 s15, s82, 0
    s_cmp_ge_u32 s15, 12
    s_cselect_b32 s13, 12, 0
    s_sub_u32 s15, s15, s13
    s_add_u32 m0, s61, 32768
    s_lshl_b32 s15, s15, 12
    s_add_u32 s15, s15, s94
    buffer_load_dwordx4 v143, s[52:55], s15 offen offset:0 sc1 lds
    buffer_load_dwordx4 v143, s[52:55], s15 offen offset:1024 sc1 lds
    buffer_load_dwordx4 v143, s[52:55], s15 offen offset:2048 sc1 lds
    buffer_load_dwordx4 v143, s[52:55], s15 offen offset:3072 sc1 lds
    s_add_u32 s15, s82, 1
    s_cmp_ge_u32 s15, 12
    s_cselect_b32 s13, 12, 0
    s_sub_u32 s15, s15, s13
    s_add_u32 m0, s61, 0
    s_lshl_b32 s15, s15, 12
    s_add_u32 s15, s15, s94
    buffer_load_dwordx4 v143, s[52:55], s15 offen offset:0 sc1 lds
    buffer_load_dwordx4 v143, s[52:55], s15 offen offset:1024 sc1 lds
    buffer_load_dwordx4 v143, s[52:55], s15 offen offset:2048 sc1 lds
    buffer_load_dwordx4 v143, s[52:55], s15 offen offset:3072 sc1 lds
    s_add_u32 s15, s82, 4
    s_cmp_ge_u32 s15, 12
    s_cselect_b32 s13, 12, 0
    s_sub_u32 s15, s15, s13
    s_add_u32 m0, s62, 131072
    s_mul_i32 s15, s15, 20480
    s_add_u32 s15, s15, s93
    s_add_u32 s15, s15, 102400
    buffer_load_dwordx4 v66, s[52:55], s15 offen offset:0 sc1 lds
    buffer_load_dwordx4 v66, s[52:55], s15 offen offset:1024 sc1 lds
    buffer_load_dwordx4 v66, s[52:55], s15 offen offset:2048 sc1 lds
    buffer_load_dwordx4 v66, s[52:55], s15 offen offset:3072 sc1 lds
    s_add_u32 m0, m0, 4096
    s_nop 0
    buffer_load_dwordx4 v67, s[52:55], s15 offen sc1 lds
    s_add_u32 s15, s82, 2
    s_cmp_ge_u32 s15, 12
    s_cselect_b32 s13, 12, 0
    s_sub_u32 s15, s15, s13
    s_add_u32 m0, s61, 16384
    s_lshl_b32 s15, s15, 12
    s_add_u32 s15, s15, s94
    buffer_load_dwordx4 v143, s[52:55], s15 offen offset:0 sc1 lds
    buffer_load_dwordx4 v143, s[52:55], s15 offen offset:1024 sc1 lds
    buffer_load_dwordx4 v143, s[52:55], s15 offen offset:2048 sc1 lds
    buffer_load_dwordx4 v143, s[52:55], s15 offen offset:3072 sc1 lds
    s_waitcnt vmcnt(13)
    s_barrier
    s_waitcnt vmcnt(9)
    s_barrier
    s_add_u32 s15, s82, 3
    s_cmp_ge_u32 s15, 12
    s_cselect_b32 s13, 12, 0
    s_sub_u32 s15, s15, s13
    s_add_u32 m0, s61, 32768
    s_lshl_b32 s15, s15, 12
    s_add_u32 s15, s15, s94
    buffer_load_dwordx4 v143, s[52:55], s15 offen offset:0 sc1 lds
    buffer_load_dwordx4 v143, s[52:55], s15 offen offset:1024 sc1 lds
    buffer_load_dwordx4 v143, s[52:55], s15 offen offset:2048 sc1 lds
    buffer_load_dwordx4 v143, s[52:55], s15 offen offset:3072 sc1 lds
    s_add_u32 s15, s82, 5
    s_cmp_ge_u32 s15, 12
    s_cselect_b32 s13, 12, 0
    s_sub_u32 s15, s15, s13
    s_add_u32 m0, s62, 49152
    s_mul_i32 s15, s15, 20480
    s_add_u32 s15, s15, s93
    s_add_u32 s15, s15, 102400
    buffer_load_dwordx4 v66, s[52:55], s15 offen offset:0 sc1 lds
    buffer_load_dwordx4 v66, s[52:55], s15 offen offset:1024 sc1 lds
    buffer_load_dwordx4 v66, s[52:55], s15 offen offset:2048 sc1 lds
    buffer_load_dwordx4 v66, s[52:55], s15 offen offset:3072 sc1 lds
    s_add_u32 m0, m0, 4096
    s_nop 0
    buffer_load_dwordx4 v67, s[52:55], s15 offen sc1 lds
    s_waitcnt vmcnt(9)
    s_barrier
    s_add_u32 s15, s82, 4
    s_cmp_ge_u32 s15, 12
    s_cselect_b32 s13, 12, 0
    s_sub_u32 s15, s15, s13
    s_add_u32 m0, s61, 0
    s_lshl_b32 s15, s15, 12
    s_add_u32 s15, s15, s94
    buffer_load_dwordx4 v143, s[52:55], s15 offen offset:0 sc1 lds
    buffer_load_dwordx4 v143, s[52:55], s15 offen offset:1024 sc1 lds
    buffer_load_dwordx4 v143, s[52:55], s15 offen offset:2048 sc1 lds
    buffer_load_dwordx4 v143, s[52:55], s15 offen offset:3072 sc1 lds
    s_add_u32 s15, s82, 6
    s_cmp_ge_u32 s15, 12
    s_cselect_b32 s13, 12, 0
    s_sub_u32 s15, s15, s13
    s_add_u32 m0, s62, 69632
    s_mul_i32 s15, s15, 20480
    s_add_u32 s15, s15, s93
    s_add_u32 s15, s15, 102400
    buffer_load_dwordx4 v66, s[52:55], s15 offen offset:0 sc1 lds
    buffer_load_dwordx4 v66, s[52:55], s15 offen offset:1024 sc1 lds
    buffer_load_dwordx4 v66, s[52:55], s15 offen offset:2048 sc1 lds
    buffer_load_dwordx4 v66, s[52:55], s15 offen offset:3072 sc1 lds
    s_add_u32 m0, m0, 4096
    s_nop 0
    buffer_load_dwordx4 v67, s[52:55], s15 offen sc1 lds
    s_waitcnt vmcnt(14)
    s_barrier
    s_add_u32 s15, s82, 5
    s_cmp_ge_u32 s15, 12
    s_cselect_b32 s13, 12, 0
    s_sub_u32 s15, s15, s13
    s_add_u32 m0, s61, 16384
    s_lshl_b32 s15, s15, 12
    s_add_u32 s15, s15, s94
    buffer_load_dwordx4 v143, s[52:55], s15 offen offset:0 sc1 lds
    buffer_load_dwordx4 v143, s[52:55], s15 offen offset:1024 sc1 lds
    buffer_load_dwordx4 v143, s[52:55], s15 offen offset:2048 sc1 lds
    buffer_load_dwordx4 v143, s[52:55], s15 offen offset:3072 sc1 lds
    s_add_u32 s15, s82, 7
    s_cmp_ge_u32 s15, 12
    s_cselect_b32 s13, 12, 0
    s_sub_u32 s15, s15, s13
    s_add_u32 m0, s62, 90112
    s_mul_i32 s15, s15, 20480
    s_add_u32 s15, s15, s93
    s_add_u32 s15, s15, 102400
    buffer_load_dwordx4 v66, s[52:55], s15 offen offset:0 sc1 lds
    buffer_load_dwordx4 v66, s[52:55], s15 offen offset:1024 sc1 lds
    buffer_load_dwordx4 v66, s[52:55], s15 offen offset:2048 sc1 lds
    buffer_load_dwordx4 v66, s[52:55], s15 offen offset:3072 sc1 lds
    s_add_u32 m0, m0, 4096
    s_nop 0
    buffer_load_dwordx4 v67, s[52:55], s15 offen sc1 lds
    s_waitcnt vmcnt(14)
    s_barrier
    s_add_u32 s15, s82, 6
    s_cmp_ge_u32 s15, 12
    s_cselect_b32 s13, 12, 0
    s_sub_u32 s15, s15, s13
    s_add_u32 m0, s61, 32768
    s_lshl_b32 s15, s15, 12
    s_add_u32 s15, s15, s94
    buffer_load_dwordx4 v143, s[52:55], s15 offen offset:0 sc1 lds
    buffer_load_dwordx4 v143, s[52:55], s15 offen offset:1024 sc1 lds
    buffer_load_dwordx4 v143, s[52:55], s15 offen offset:2048 sc1 lds
    buffer_load_dwordx4 v143, s[52:55], s15 offen offset:3072 sc1 lds
    s_add_u32 s15, s82, 8
    s_cmp_ge_u32 s15, 12
    s_cselect_b32 s13, 12, 0
    s_sub_u32 s15, s15, s13
    s_add_u32 m0, s62, 110592
    s_mul_i32 s15, s15, 20480
    s_add_u32 s15, s15, s93
    s_add_u32 s15, s15, 102400
    buffer_load_dwordx4 v66, s[52:55], s15 offen offset:0 sc1 lds
    buffer_load_dwordx4 v66, s[52:55], s15 offen offset:1024 sc1 lds
    buffer_load_dwordx4 v66, s[52:55], s15 offen offset:2048 sc1 lds
    buffer_load_dwordx4 v66, s[52:55], s15 offen offset:3072 sc1 lds
    s_add_u32 m0, m0, 4096
    s_nop 0
    buffer_load_dwordx4 v67, s[52:55], s15 offen sc1 lds
    s_waitcnt vmcnt(14)
    s_barrier
    s_add_u32 s15, s82, 7
    s_cmp_ge_u32 s15, 12
    s_cselect_b32 s13, 12, 0
    s_sub_u32 s15, s15, s13
    s_add_u32 m0, s61, 0
    s_lshl_b32 s15, s15, 12
    s_add_u32 s15, s15, s94
    buffer_load_dwordx4 v143, s[52:55], s15 offen offset:0 sc1 lds
    buffer_load_dwordx4 v143, s[52:55], s15 offen offset:1024 sc1 lds
    buffer_load_dwordx4 v143, s[52:55], s15 offen offset:2048 sc1 lds
    buffer_load_dwordx4 v143, s[52:55], s15 offen offset:3072 sc1 lds
    s_add_u32 s15, s82, 9
    s_cmp_ge_u32 s15, 12
    s_cselect_b32 s13, 12, 0
    s_sub_u32 s15, s15, s13
    s_add_u32 m0, s62, 131072
    s_mul_i32 s15, s15, 20480
    s_add_u32 s15, s15, s93
    s_add_u32 s15, s15, 102400
    buffer_load_dwordx4 v66, s[52:55], s15 offen offset:0 sc1 lds
    buffer_load_dwordx4 v66, s[52:55], s15 offen offset:1024 sc1 lds
    buffer_load_dwordx4 v66, s[52:55], s15 offen offset:2048 sc1 lds
    buffer_load_dwordx4 v66, s[52:55], s15 offen offset:3072 sc1 lds
    s_add_u32 m0, m0, 4096
    s_nop 0
    buffer_load_dwordx4 v67, s[52:55], s15 offen sc1 lds
    s_waitcnt vmcnt(14)
    s_barrier
    s_add_u32 s15, s82, 8
    s_cmp_ge_u32 s15, 12
    s_cselect_b32 s13, 12, 0
    s_sub_u32 s15, s15, s13
    s_add_u32 m0, s61, 16384
    s_lshl_b32 s15, s15, 12
    s_add_u32 s15, s15, s94
    buffer_load_dwordx4 v143, s[52:55], s15 offen offset:0 sc1 lds
    buffer_load_dwordx4 v143, s[52:55], s15 offen offset:1024 sc1 lds
    buffer_load_dwordx4 v143, s[52:55], s15 offen offset:2048 sc1 lds
    buffer_load_dwordx4 v143, s[52:55], s15 offen offset:3072 sc1 lds
    s_add_u32 s15, s82, 10
    s_cmp_ge_u32 s15, 12
    s_cselect_b32 s13, 12, 0
    s_sub_u32 s15, s15, s13
    s_add_u32 m0, s62, 49152
    s_mul_i32 s15, s15, 20480
    s_add_u32 s15, s15, s93
    s_add_u32 s15, s15, 102400
    buffer_load_dwordx4 v66, s[52:55], s15 offen offset:0 sc1 lds
    buffer_load_dwordx4 v66, s[52:55], s15 offen offset:1024 sc1 lds
    buffer_load_dwordx4 v66, s[52:55], s15 offen offset:2048 sc1 lds
    buffer_load_dwordx4 v66, s[52:55], s15 offen offset:3072 sc1 lds
    s_add_u32 m0, m0, 4096
    s_nop 0
    buffer_load_dwordx4 v67, s[52:55], s15 offen sc1 lds
    s_waitcnt vmcnt(14)
    s_barrier
    s_add_u32 s15, s82, 9
    s_cmp_ge_u32 s15, 12
    s_cselect_b32 s13, 12, 0
    s_sub_u32 s15, s15, s13
    s_add_u32 m0, s61, 32768
    s_lshl_b32 s15, s15, 12
    s_add_u32 s15, s15, s94
    buffer_load_dwordx4 v143, s[52:55], s15 offen offset:0 sc1 lds
    buffer_load_dwordx4 v143, s[52:55], s15 offen offset:1024 sc1 lds
    buffer_load_dwordx4 v143, s[52:55], s15 offen offset:2048 sc1 lds
    buffer_load_dwordx4 v143, s[52:55], s15 offen offset:3072 sc1 lds
    s_add_u32 s15, s82, 11
    s_cmp_ge_u32 s15, 12
    s_cselect_b32 s13, 12, 0
    s_sub_u32 s15, s15, s13
    s_add_u32 m0, s62, 69632
    s_mul_i32 s15, s15, 20480
    s_add_u32 s15, s15, s93
    s_add_u32 s15, s15, 102400
    buffer_load_dwordx4 v66, s[52:55], s15 offen offset:0 sc1 lds
    buffer_load_dwordx4 v66, s[52:55], s15 offen offset:1024 sc1 lds
    buffer_load_dwordx4 v66, s[52:55], s15 offen offset:2048 sc1 lds
    buffer_load_dwordx4 v66, s[52:55], s15 offen offset:3072 sc1 lds
    s_add_u32 m0, m0, 4096
    s_nop 0
    buffer_load_dwordx4 v67, s[52:55], s15 offen sc1 lds
    s_waitcnt vmcnt(14)
    s_barrier
    s_add_u32 s15, s82, 10
    s_cmp_ge_u32 s15, 12
    s_cselect_b32 s13, 12, 0
    s_sub_u32 s15, s15, s13
    s_add_u32 m0, s61, 0
    s_lshl_b32 s15, s15, 12
    s_add_u32 s15, s15, s94
    buffer_load_dwordx4 v143, s[52:55], s15 offen offset:0 sc1 lds
    buffer_load_dwordx4 v143, s[52:55], s15 offen offset:1024 sc1 lds
    buffer_load_dwordx4 v143, s[52:55], s15 offen offset:2048 sc1 lds
    buffer_load_dwordx4 v143, s[52:55], s15 offen offset:3072 sc1 lds
    s_lshl_b32 s11, s3, 2
    s_lshr_b32 s13, s4, 1
    s_add_u32 s11, s11, s13
    s_lshl_b32 s84, s5, 1
    s_and_b32 s12, s4, 1
    s_add_u32 s84, s84, s12
    s_lshl_b32 s84, s84, 2
    s_add_u32 s84, s84, s8
    s_mul_i32 s12, s11, 5
    s_lshr_b32 s12, s12, 1
    s_lshl_b32 s12, s12, 10
    s_mul_i32 s85, s84, 20480
    s_add_u32 s85, s85, s12
    s_bitcmp1_b32 s11, 0
    s_cselect_b32 s11, 1024, 0
    s_movk_i32 s12, 2048
    s_cselect_b32 s12, 512, s12
    s_add_u32 s86, s85, s12
    s_add_u32 s85, s85, s11
    s_lshl_b32 s84, s84, 6
    s_add_u32 s84, s84, 17453056
    s_lshl_b32 s87, s8, 12
    s_add_u32 s87, s87, 90112
    v_mov_b32 v120, s79
    v_cmp_gt_u32 vcc, 32, v128
    s_nop 1
    v_cndmask_b32 v121, v120, v143, vcc
    v_cmp_gt_u32 vcc, 4, v128
    s_nop 1
    v_cndmask_b32 v120, v120, v143, vcc
    s_add_u32 m0, s87, 0
    s_add_u32 s15, s85, 2871296
    buffer_load_dwordx4 v143, s[52:55], s15 offen offset:0 sc1 lds
    buffer_load_dwordx4 v143, s[52:55], s15 offen offset:1024 sc1 lds
    s_add_u32 m0, s87, 2048
    s_add_u32 s15, s86, 2871296
    buffer_load_dwordx4 v121, s[52:55], s15 offen sc1 lds
    s_add_u32 m0, s87, 3072
    s_nop 0
    buffer_load_dwordx4 v120, s[52:55], s84 offen sc1 lds
    s_waitcnt vmcnt(13)
    s_barrier
    s_add_u32 s15, s82, 11
    s_cmp_ge_u32 s15, 12
    s_cselect_b32 s13, 12, 0
    s_sub_u32 s15, s15, s13
    s_add_u32 m0, s61, 16384
    s_lshl_b32 s15, s15, 12
    s_add_u32 s15, s15, s94
    buffer_load_dwordx4 v143, s[52:55], s15 offen offset:0 sc1 lds
    buffer_load_dwordx4 v143, s[52:55], s15 offen offset:1024 sc1 lds
    buffer_load_dwordx4 v143, s[52:55], s15 offen offset:2048 sc1 lds
    buffer_load_dwordx4 v143, s[52:55], s15 offen offset:3072 sc1 lds
    s_waitcnt vmcnt(8)
    s_barrier
    s_waitcnt vmcnt(0)
    s_barrier
    s_endpgm
gated_mix__linear_kernel_hedgehog__mixer_s_mlp__prompt_kernel_end:
    s_endpgm
text_end:
.section .rodata,"a"
.p2align 6
.amdhsa_kernel gated_mix__linear_kernel_hedgehog__mixer_s_mlp__prompt_kernel
  .amdhsa_next_free_vgpr 256
  .amdhsa_next_free_sgpr 102
  .amdhsa_accum_offset 144
  .amdhsa_group_segment_fixed_size 0
  .amdhsa_kernarg_size 104
  .amdhsa_user_sgpr_count 2
  .amdhsa_user_sgpr_kernarg_segment_ptr 1
  .amdhsa_system_sgpr_workgroup_id_x 1
.end_amdhsa_kernel
```
